```python
import torch

def _softmax(x, axis=-1):
    return torch.softmax(x, dim=axis)
def _gelu(x):
    return torch.nn.functional.gelu(x, approximate="tanh")
def _silu(x):
    return torch.nn.functional.silu(x)
def _sigmoid(x):
    return torch.sigmoid(x)
def _layernorm(x, axis=-1, eps=1e-5):
    m = x.mean(dim=axis, keepdim=True)
    v = x.var(dim=axis, keepdim=True, unbiased=False)
    return (x - m) / torch.sqrt(v + eps)
def _scatter_add(tgt, idx, src, axis=0):
    return tgt.clone().index_add_(axis, idx, src)
def _segment_sum(src, seg, n):
    out = torch.zeros((n,) + src.shape[1:], dtype=src.dtype)
    return out.index_add_(0, seg, src)
def _pad(x, pw):
    flat = tuple(v for pair in reversed(pw) for v in pair)
    return torch.nn.functional.pad(x, flat)

kernel_name = 'recurrent_scan__mha_block__geglu_ffn__prompt'

def setup_inputs():

    _w = (lambda a: (lambda t: t.to(torch.bfloat16) if t.is_floating_point() else t)(torch.as_tensor(a)))
    def _A_setup():
        B, S, D, H = 1, 2048, 448, 16
        return {
            "x": _w((lambda *s: torch.randn(*s, dtype=torch.bfloat16) * 0.05)(B, S, D)),
            "wqkv": _w((lambda *s: torch.randn(*s, dtype=torch.bfloat16) * 0.05)(D, 3 * D)),
            "wo": _w((lambda *s: torch.randn(*s, dtype=torch.bfloat16) * 0.05)(D, D)),
        }
    _A_in = _A_setup()

    def _B_setup():
        B, S, D, F = 1, 2048, 448, 1792
        return {
            "x": _w((lambda *s: torch.randn(*s, dtype=torch.bfloat16) * 0.05)(B, S, D)),
            "w_gate": _w((lambda *s: torch.randn(*s, dtype=torch.bfloat16) * 0.05)(D, F)),
            "w_up": _w((lambda *s: torch.randn(*s, dtype=torch.bfloat16) * 0.05)(D, F)),
            "w_down": _w((lambda *s: torch.randn(*s, dtype=torch.bfloat16) * 0.05)(F, D)),
        }
    _B_in = _B_setup()

    return {
        "A_x": _A_in["x"],
        "A_wqkv": _A_in["wqkv"],
        "A_wo": _A_in["wo"],
        "B_x": _B_in["x"],
        "B_w_gate": _B_in["w_gate"],
        "B_w_up": _B_in["w_up"],
        "B_w_down": _B_in["w_down"],
    }

def reference(A_x, A_wqkv, A_wo, B_x, B_w_gate, B_w_up, B_w_down):
    def _A_ref(x, wqkv, wo):
        B, S, D = x.shape
        H = 16
        Dh = D // H
        qkv = (lambda x, *d: x.permute(*d))((x @ wqkv).reshape(B, S, 3, H, Dh), 2, 0, 3, 1, 4)
        q, k, v = qkv[0], qkv[1], qkv[2]
        scores = torch.einsum("bhqd,bhkd->bhqk", q, k) * (Dh ** -0.5)
        p = _softmax(scores, axis=-1)
        o = torch.einsum("bhqk,bhkd->bhqd", p, v)
        return (lambda x, *d: x.permute(*d))(o, 0, 2, 1, 3).reshape(B, S, D) @ wo

    def _B_ref(x, w_gate, w_up, w_down):
        return (_gelu(x @ w_gate) * (x @ w_up)) @ w_down

    x = A_x
    xn = _layernorm(x, axis=-1)
    s = _A_ref(xn, A_wqkv, A_wo)
    g = _silu(_B_ref(xn, B_w_gate, B_w_up, B_w_down))
    return x + s * g
```

```asm
; @launch grid=(256,1,1) block=(768,1,1) lds=163840
.amdgcn_target "amdgcn-amd-amdhsa--gfx950"
.text
.globl recurrent_scan__mha_block__geglu_ffn__prompt_kernel
.p2align 8
.type recurrent_scan__mha_block__geglu_ffn__prompt_kernel,@function
recurrent_scan__mha_block__geglu_ffn__prompt_kernel:
    s_cmp_ge_u32 s2, 256
    s_cbranch_scc1 L_end
    s_load_dwordx4 s[4:7], s[0:1], 0
    s_load_dwordx2 s[68:69], s[0:1], 72
    s_load_dwordx4 s[8:11], s[0:1], 32
    s_load_dwordx4 s[64:67], s[0:1], 48
    s_load_dwordx2 s[70:71], s[0:1], 16
    v_lshrrev_b32 v1, 6, v0
    v_and_b32 v0, 63, v0
    v_readfirstlane_b32 s38, v1
    s_and_b32 s3, s2, 7
    s_lshr_b32 s78, s2, 3
    s_lshr_b32 s14, s3, 1
    s_lshr_b32 s15, s78, 3
    s_mul_i32 s37, s14, 3
    s_add_u32 s37, s37, s15
    s_add_u32 s12, s14, 12
    s_cmp_eq_u32 s15, 3
    s_cselect_b32 s37, s12, s37
    s_sub_u32 s12, 26, s37
    s_and_b32 s13, s37, 11
    s_cmp_eq_u32 s13, 11
    s_cselect_b32 s37, s12, s37
    s_and_b32 s36, s78, 7
    s_and_b32 s3, s3, 1
    s_lshl_b32 s3, s3, 3
    s_add_u32 s36, s36, s3
    s_and_b32 s39, s38, 3
    s_cmp_ge_u32 s38, 8
    s_cbranch_scc1 L_H
    s_waitcnt lgkmcnt(0)
    s_cmp_ge_u32 s38, 4
    s_cbranch_scc1 L_Bsel
    s_mov_b32 s32, s68
    s_mov_b32 s33, s69
    s_mov_b32 s34, 20971520
    s_mov_b32 s35, 0x00020000
    s_mov_b32 s3, 16777216
    s_load_dword s49, s[68:69], s3
    s_waitcnt lgkmcnt(0)
    s_add_u32 s49, s49, 0x9e3779b9
    s_cmp_ge_u32 s37, 12
    s_cbranch_scc1 L_AQ
    s_cmp_eq_u32 s37, 11
    s_cbranch_scc1 L_AP
    s_branch L_AF
L_Bsel:
    s_cmp_ge_u32 s37, 12
    s_cbranch_scc1 L_BQ
    s_cmp_eq_u32 s37, 11
    s_cbranch_scc1 L_BP
    s_branch L_BF
L_H:
    v_lshrrev_b32 v2, 3, v0
    v_and_b32 v3, 7, v0
    v_lshrrev_b32 v4, 4, v0
    v_xor_b32 v5, v3, v4
    v_lshlrev_b32 v5, 4, v5
    v_mul_u32_u24 v6, 896, v2
    v_add_u32 v16, v6, v5
    v_xor_b32 v5, 64, v5
    v_add_u32 v17, v6, v5
    v_add_u32 v17, 6144, v17
    v_add_u32 v18, 12288, v16
    v_add_u32 v19, 12288, v17
    s_lshl_b32 s15, s36, 2
    s_add_u32 s15, s15, s39
    s_mul_i32 s45, s15, 28672
    s_lshl_b32 s48, s39, 12
    s_waitcnt lgkmcnt(0)
    s_mov_b32 s16, s4
    s_mov_b32 s17, s5
    s_mov_b32 s18, 1835008
    s_mov_b32 s19, 0x00020000
    s_add_u32 m0, s48, 0
    s_add_u32 s52, s45, 0
    buffer_load_dwordx4 v16, s[16:19], s52 offen offset:0 lds
    buffer_load_dwordx4 v17, s[16:19], s52 offen offset:1024 lds
    buffer_load_dwordx4 v18, s[16:19], s52 offen offset:2048 lds
    buffer_load_dwordx4 v19, s[16:19], s52 offen offset:3072 lds
    s_lshl_b32 s46, s39, 10
    s_add_u32 s46, s46, 114688
    s_lshl_b32 s47, s39, 11
    s_add_u32 s47, s47, 114688
    v_and_b32 v5, 1, v4
    v_lshlrev_b32 v5, 2, v5
    v_xor_b32 v5, v3, v5
    v_lshlrev_b32 v5, 4, v5
    v_add_u32 v25, v6, v5
    v_mul_u32_u24 v6, 2688, v2
    v_add_u32 v22, v6, v5
    s_mov_b32 s20, s6
    s_mov_b32 s21, s7
    s_mov_b32 s22, 1204224
    s_mov_b32 s23, 0x00020000
    s_cmp_ge_u32 s37, 12
    s_cbranch_scc1 L_H1Q
    s_cmp_eq_u32 s37, 11
    s_cbranch_scc1 L_H1P
    s_branch L_H1F
L_H1F:
    s_mov_b32 s60, s37
    s_lshl_b32 s101, s37, 1
    s_lshl_b32 s14, s60, 7
    s_mul_i32 s15, s39, 21504
    s_add_u32 s43, s14, s15
    s_add_u32 s44, s43, s15
    v_add_u32 v23, 20480, v22
    v_xor_b32 v7, 32, v5
    v_add3_u32 v45, v6, v7, 64
    v_add_u32 v45, 64, v45
    s_add_u32 m0, s47, 0
    s_add_u32 s52, s44, 0
    buffer_load_dwordx4 v22, s[20:23], s52 offen lds
    buffer_load_dwordx4 v23, s[20:23], s52 offen offset:1024 lds
    s_add_u32 m0, s48, 16384
    s_add_u32 s52, s45, 128
    buffer_load_dwordx4 v16, s[16:19], s52 offen offset:0 lds
    buffer_load_dwordx4 v17, s[16:19], s52 offen offset:1024 lds
    buffer_load_dwordx4 v18, s[16:19], s52 offen offset:2048 lds
    buffer_load_dwordx4 v19, s[16:19], s52 offen offset:3072 lds
    s_add_u32 m0, s47, 8192
    s_add_u32 s52, s44, 172032
    buffer_load_dwordx4 v22, s[20:23], s52 offen lds
    buffer_load_dwordx4 v23, s[20:23], s52 offen offset:1024 lds
    s_mov_b32 s24, s8
    s_mov_b32 s25, s9
    s_mov_b32 s26, 1605632
    s_mov_b32 s27, 0x00020000
    s_mov_b32 s28, s10
    s_mov_b32 s29, s11
    s_mov_b32 s30, 1605632
    s_mov_b32 s31, 0x00020000
    v_mul_u32_u24 v6, 3584, v2
    v_add_u32 v20, v6, v5
    v_add_u32 v21, v6, v7
    s_lshl_b32 s42, s101, 7
    s_mul_i32 s15, s39, 28672
    s_add_u32 s42, s42, s15
    v_add_u32 v26, 6144, v25
    v_lshlrev_b32 v24, 4, v0
    s_mov_b32 s32, s68
    s_mov_b32 s33, s69
    s_mov_b32 s34, 20971520
    s_mov_b32 s35, 0x00020000
    s_mov_b32 s3, 16777216
    s_load_dword s49, s[68:69], s3
    s_waitcnt lgkmcnt(0)
    s_add_u32 s49, s49, 0x9e3779b9
    s_and_b32 s3, s2, 7
    s_and_b32 s14, s78, 1
    s_lshl_b32 s74, s3, 1
    s_add_u32 s74, s74, s14
    s_lshr_b32 s75, s78, 1
    s_mul_i32 s14, s3, 29
    s_sub_u32 s15, s3, 4
    s_max_i32 s15, s15, 0
    s_add_u32 s14, s14, s15
    s_cmp_eq_u32 s3, 7
    s_cselect_b32 s14, 200, s14
    s_cmp_lt_u32 s3, 4
    s_cselect_b32 s15, 29, 30
    s_cmp_lt_u32 s3, 6
    s_cselect_b32 s15, s15, 24
    s_add_u32 s14, s14, s78
    s_mul_i32 s76, s14, 9363
    s_lshr_b32 s76, s76, 16
    s_mul_i32 s77, s76, 7
    s_sub_u32 s77, s14, s77
    s_cmp_ge_u32 s78, s15
    s_cselect_b32 s76, 32, s76
    s_mul_i32 s14, s74, 28
    s_lshr_b32 s15, s14, 6
    s_add_u32 s14, s14, 27
    s_lshr_b32 s14, s14, 6
    s_sub_u32 s14, s14, s15
    s_lshl_b32 s14, s14, 8
    s_lshl_b32 s15, s15, 8
    s_mov_b32 s58, 16781312
    v_bfe_u32 v1, v0, 4, 1
    v_mul_u32_u24 v1, s14, v1
    v_lshrrev_b32 v2, 5, v0
    v_mul_u32_u24 v3, 1792, v2
    v_add3_u32 v1, v1, v3, s15
    v_and_b32 v3, 15, v0
    v_lshl_add_u32 v1, v3, 4, v1
    v_add_u32 v36, 1792, v1
    v_and_b32 v1, 1, v0
    v_mul_u32_u24 v1, s14, v1
    s_lshl_b32 s13, s75, 4
    s_add_u32 s15, s15, s13
    v_add_u32 v39, s15, v1
    v_and_b32 v3, 31, v0
    v_min_u32 v3, 27, v3
    v_lshlrev_b32 v4, 2, v3
    v_lshl_add_u32 v4, v2, 12, v4
    s_lshl_b32 s13, s76, 7
    s_add_u32 s13, s13, 8192
    v_add_u32 v37, s13, v4
    v_mov_b32 v38, 158720
    v_mov_b32 v1, 0
    ds_write_b32 v38, v1
    s_mov_b32 s79, 0
    s_waitcnt lgkmcnt(0)
    s_waitcnt vmcnt(6)
    s_barrier
    s_add_u32 m0, s48, 32768
    s_add_u32 s52, s45, 256
    buffer_load_dwordx4 v16, s[16:19], s52 offen offset:0 lds
    buffer_load_dwordx4 v17, s[16:19], s52 offen offset:1024 lds
    buffer_load_dwordx4 v18, s[16:19], s52 offen offset:2048 lds
    buffer_load_dwordx4 v19, s[16:19], s52 offen offset:3072 lds
    s_add_u32 m0, s47, 16384
    s_add_u32 s52, s44, 344064
    buffer_load_dwordx4 v22, s[20:23], s52 offen lds
    buffer_load_dwordx4 v23, s[20:23], s52 offen offset:1024 lds
    s_add_u32 m0, s48, 49152
    s_add_u32 s52, s45, 384
    buffer_load_dwordx4 v16, s[16:19], s52 offen offset:0 lds
    buffer_load_dwordx4 v17, s[16:19], s52 offen offset:1024 lds
    buffer_load_dwordx4 v18, s[16:19], s52 offen offset:2048 lds
    buffer_load_dwordx4 v19, s[16:19], s52 offen offset:3072 lds
    s_add_u32 m0, s47, 24576
    s_add_u32 s52, s44, 516096
    buffer_load_dwordx4 v22, s[20:23], s52 offen lds
    buffer_load_dwordx4 v23, s[20:23], s52 offen offset:1024 lds
    s_waitcnt vmcnt(12)
    s_barrier
    s_add_u32 m0, s48, 65536
    s_add_u32 s52, s45, 512
    buffer_load_dwordx4 v16, s[16:19], s52 offen offset:0 lds
    buffer_load_dwordx4 v17, s[16:19], s52 offen offset:1024 lds
    buffer_load_dwordx4 v18, s[16:19], s52 offen offset:2048 lds
    buffer_load_dwordx4 v19, s[16:19], s52 offen offset:3072 lds
    s_add_u32 m0, s47, 32768
    s_add_u32 s52, s44, 688128
    buffer_load_dwordx4 v22, s[20:23], s52 offen lds
    buffer_load_dwordx4 v23, s[20:23], s52 offen offset:1024 lds
    s_waitcnt vmcnt(12)
    s_barrier
    s_add_u32 m0, s48, 81920
    s_add_u32 s52, s45, 640
    buffer_load_dwordx4 v16, s[16:19], s52 offen offset:0 lds
    buffer_load_dwordx4 v17, s[16:19], s52 offen offset:1024 lds
    buffer_load_dwordx4 v18, s[16:19], s52 offen offset:2048 lds
    buffer_load_dwordx4 v19, s[16:19], s52 offen offset:3072 lds
    s_add_u32 m0, s47, 0
    s_add_u32 s52, s44, 860160
    buffer_load_dwordx4 v22, s[20:23], s52 offen lds
    buffer_load_dwordx4 v23, s[20:23], s52 offen offset:1024 lds
    s_waitcnt vmcnt(12)
    s_barrier
    s_add_u32 m0, s48, 98304
    s_add_u32 s52, s45, 768
    buffer_load_dwordx4 v16, s[16:19], s52 offen offset:0 lds
    buffer_load_dwordx4 v17, s[16:19], s52 offen offset:1024 lds
    buffer_load_dwordx4 v18, s[16:19], s52 offen offset:2048 lds
    buffer_load_dwordx4 v19, s[16:19], s52 offen offset:3072 lds
    s_add_u32 m0, s47, 8192
    s_add_u32 s52, s44, 1032192
    buffer_load_dwordx4 v22, s[20:23], s52 offen lds
    buffer_load_dwordx4 v23, s[20:23], s52 offen offset:1024 lds
    s_waitcnt vmcnt(12)
    s_barrier
    s_add_u32 m0, s46, 16384
    s_add_u32 s52, s42, 0
    buffer_load_dwordx4 v20, s[24:27], s52 offen lds
    s_add_u32 m0, s46, 20480
    s_nop 0
    buffer_load_dwordx4 v21, s[28:31], s52 offen lds
    s_waitcnt vmcnt(8)
    s_barrier
    s_add_u32 m0, s46, 24576
    s_add_u32 s52, s42, 114688
    buffer_load_dwordx4 v20, s[24:27], s52 offen lds
    s_add_u32 m0, s46, 28672
    s_nop 0
    buffer_load_dwordx4 v21, s[28:31], s52 offen lds
    s_waitcnt vmcnt(4)
    s_barrier
    s_add_u32 m0, s46, 32768
    s_add_u32 s52, s42, 229376
    buffer_load_dwordx4 v20, s[24:27], s52 offen lds
    s_add_u32 m0, s46, 36864
    s_nop 0
    buffer_load_dwordx4 v21, s[28:31], s52 offen lds
    s_waitcnt vmcnt(4)
    s_barrier
    s_add_u32 m0, s46, 0
    s_add_u32 s52, s42, 344064
    buffer_load_dwordx4 v20, s[24:27], s52 offen lds
    s_add_u32 m0, s46, 4096
    s_nop 0
    buffer_load_dwordx4 v21, s[28:31], s52 offen lds
    s_waitcnt vmcnt(4)
    s_barrier
    s_add_u32 m0, s46, 8192
    s_add_u32 s52, s42, 458752
    buffer_load_dwordx4 v20, s[24:27], s52 offen lds
    s_add_u32 m0, s46, 12288
    s_nop 0
    buffer_load_dwordx4 v21, s[28:31], s52 offen lds
    s_waitcnt vmcnt(4)
    s_barrier
    s_add_u32 m0, s46, 16384
    s_add_u32 s52, s42, 573440
    buffer_load_dwordx4 v20, s[24:27], s52 offen lds
    s_add_u32 m0, s46, 20480
    s_nop 0
    buffer_load_dwordx4 v21, s[28:31], s52 offen lds
    s_waitcnt vmcnt(4)
    s_barrier
    s_add_u32 m0, s46, 24576
    s_add_u32 s52, s42, 688128
    buffer_load_dwordx4 v20, s[24:27], s52 offen lds
    s_add_u32 m0, s46, 28672
    s_nop 0
    buffer_load_dwordx4 v21, s[28:31], s52 offen lds
    s_waitcnt vmcnt(4)
    s_barrier
    s_add_u32 m0, s46, 32768
    s_add_u32 s52, s42, 802816
    buffer_load_dwordx4 v20, s[24:27], s52 offen lds
    s_add_u32 m0, s46, 36864
    s_nop 0
    buffer_load_dwordx4 v21, s[28:31], s52 offen lds
    s_waitcnt vmcnt(4)
    s_barrier
    s_add_u32 m0, s46, 0
    s_add_u32 s52, s42, 917504
    buffer_load_dwordx4 v20, s[24:27], s52 offen lds
    s_add_u32 m0, s46, 4096
    s_nop 0
    buffer_load_dwordx4 v21, s[28:31], s52 offen lds
    s_waitcnt vmcnt(4)
    s_barrier
    s_add_u32 m0, s46, 8192
    s_add_u32 s52, s42, 1032192
    buffer_load_dwordx4 v20, s[24:27], s52 offen lds
    s_add_u32 m0, s46, 12288
    s_nop 0
    buffer_load_dwordx4 v21, s[28:31], s52 offen lds
    s_waitcnt vmcnt(4)
    s_barrier
    s_add_u32 m0, s46, 16384
    s_add_u32 s52, s42, 1146880
    buffer_load_dwordx4 v20, s[24:27], s52 offen lds
    s_add_u32 m0, s46, 20480
    s_nop 0
    buffer_load_dwordx4 v21, s[28:31], s52 offen lds
    s_waitcnt vmcnt(4)
    s_barrier
    s_add_u32 m0, s46, 24576
    s_add_u32 s52, s42, 1261568
    buffer_load_dwordx4 v20, s[24:27], s52 offen lds
    s_add_u32 m0, s46, 28672
    s_nop 0
    buffer_load_dwordx4 v21, s[28:31], s52 offen lds
    s_waitcnt vmcnt(4)
    s_barrier
    s_add_u32 m0, s46, 32768
    s_add_u32 s52, s42, 1376256
    buffer_load_dwordx4 v20, s[24:27], s52 offen lds
    s_add_u32 m0, s46, 36864
    s_nop 0
    buffer_load_dwordx4 v21, s[28:31], s52 offen lds
    s_waitcnt vmcnt(4)
    s_barrier
    s_add_u32 m0, s46, 0
    s_add_u32 s52, s42, 1490944
    buffer_load_dwordx4 v20, s[24:27], s52 offen lds
    s_add_u32 m0, s46, 4096
    s_nop 0
    buffer_load_dwordx4 v21, s[28:31], s52 offen lds
    s_waitcnt vmcnt(4)
    s_barrier
    s_add_u32 m0, s46, 8192
    s_add_u32 s52, s42, 128
    buffer_load_dwordx4 v20, s[24:27], s52 offen lds
    s_add_u32 m0, s46, 12288
    s_nop 0
    buffer_load_dwordx4 v21, s[28:31], s52 offen lds
    s_waitcnt vmcnt(4)
    s_barrier
    s_add_u32 m0, s46, 16384
    s_add_u32 s52, s42, 114816
    buffer_load_dwordx4 v20, s[24:27], s52 offen lds
    s_add_u32 m0, s46, 20480
    s_nop 0
    buffer_load_dwordx4 v21, s[28:31], s52 offen lds
    s_waitcnt vmcnt(4)
    s_barrier
    s_add_u32 m0, s46, 24576
    s_add_u32 s52, s42, 229504
    buffer_load_dwordx4 v20, s[24:27], s52 offen lds
    s_add_u32 m0, s46, 28672
    s_nop 0
    buffer_load_dwordx4 v21, s[28:31], s52 offen lds
    s_waitcnt vmcnt(4)
    s_barrier
    s_add_u32 m0, s46, 32768
    s_add_u32 s52, s42, 344192
    buffer_load_dwordx4 v20, s[24:27], s52 offen lds
    s_add_u32 m0, s46, 36864
    s_nop 0
    buffer_load_dwordx4 v21, s[28:31], s52 offen lds
    s_waitcnt vmcnt(4)
    s_barrier
    s_add_u32 m0, s46, 0
    s_add_u32 s52, s42, 458880
    buffer_load_dwordx4 v20, s[24:27], s52 offen lds
    s_add_u32 m0, s46, 4096
    s_nop 0
    buffer_load_dwordx4 v21, s[28:31], s52 offen lds
    s_waitcnt vmcnt(4)
    s_barrier
    s_add_u32 m0, s46, 8192
    s_add_u32 s52, s42, 573568
    buffer_load_dwordx4 v20, s[24:27], s52 offen lds
    s_add_u32 m0, s46, 12288
    s_nop 0
    buffer_load_dwordx4 v21, s[28:31], s52 offen lds
    s_waitcnt vmcnt(4)
    s_barrier
    s_add_u32 m0, s46, 16384
    s_add_u32 s52, s42, 688256
    buffer_load_dwordx4 v20, s[24:27], s52 offen lds
    s_add_u32 m0, s46, 20480
    s_nop 0
    buffer_load_dwordx4 v21, s[28:31], s52 offen lds
    s_waitcnt vmcnt(4)
    s_barrier
    s_add_u32 m0, s46, 24576
    s_add_u32 s52, s42, 802944
    buffer_load_dwordx4 v20, s[24:27], s52 offen lds
    s_add_u32 m0, s46, 28672
    s_nop 0
    buffer_load_dwordx4 v21, s[28:31], s52 offen lds
    s_waitcnt vmcnt(4)
    s_barrier
    s_add_u32 m0, s46, 32768
    s_add_u32 s52, s42, 917632
    buffer_load_dwordx4 v20, s[24:27], s52 offen lds
    s_add_u32 m0, s46, 36864
    s_nop 0
    buffer_load_dwordx4 v21, s[28:31], s52 offen lds
    s_waitcnt vmcnt(4)
    s_barrier
    s_add_u32 m0, s46, 0
    s_add_u32 s52, s42, 1032320
    buffer_load_dwordx4 v20, s[24:27], s52 offen lds
    s_add_u32 m0, s46, 4096
    s_nop 0
    buffer_load_dwordx4 v21, s[28:31], s52 offen lds
    s_waitcnt vmcnt(4)
    s_barrier
    s_add_u32 m0, s46, 8192
    s_add_u32 s52, s42, 1147008
    buffer_load_dwordx4 v20, s[24:27], s52 offen lds
    s_add_u32 m0, s46, 12288
    s_nop 0
    buffer_load_dwordx4 v21, s[28:31], s52 offen lds
    s_waitcnt vmcnt(4)
    s_barrier
    s_add_u32 m0, s46, 16384
    s_add_u32 s52, s42, 1261696
    buffer_load_dwordx4 v20, s[24:27], s52 offen lds
    s_add_u32 m0, s46, 20480
    s_nop 0
    buffer_load_dwordx4 v21, s[28:31], s52 offen lds
    s_waitcnt vmcnt(4)
    s_barrier
    s_add_u32 m0, s46, 24576
    s_add_u32 s52, s42, 1376384
    buffer_load_dwordx4 v20, s[24:27], s52 offen lds
    s_add_u32 m0, s46, 28672
    s_nop 0
    buffer_load_dwordx4 v21, s[28:31], s52 offen lds
    s_waitcnt vmcnt(4)
    s_barrier
    s_add_u32 m0, s46, 32768
    s_add_u32 s52, s42, 1491072
    buffer_load_dwordx4 v20, s[24:27], s52 offen lds
    s_add_u32 m0, s46, 36864
    s_nop 0
    buffer_load_dwordx4 v21, s[28:31], s52 offen lds
    s_waitcnt vmcnt(4)
    s_barrier
    s_cmp_lg_u32 s39, 0
    s_cbranch_scc1 L_HF_e1
    buffer_load_dwordx4 v[40:43], v36, s[32:35], s58 offen sc1
    buffer_load_dwordx4 v[112:115], v39, s[32:35], s58 offen sc1
L_HF_e1:
    s_waitcnt vmcnt(2)
    s_barrier
    s_waitcnt vmcnt(0)
    s_barrier
    s_cmp_lg_u32 s39, 0
    s_cbranch_scc1 L_HF_e2
    s_waitcnt vmcnt(0)
    v_cmp_ne_u32 vcc, s49, v40
    v_cmp_ne_u32 s[54:55], s49, v41
    s_or_b64 vcc, vcc, s[54:55]
    v_cmp_ne_u32 s[54:55], s49, v42
    s_or_b64 vcc, vcc, s[54:55]
    v_cmp_ne_u32 s[54:55], s49, v43
    s_or_b64 vcc, vcc, s[54:55]
    v_cmp_ne_u32 s[54:55], s49, v112
    s_or_b64 vcc, vcc, s[54:55]
    v_cmp_ne_u32 s[54:55], s49, v113
    s_or_b64 vcc, vcc, s[54:55]
    v_cmp_ne_u32 s[54:55], s49, v114
    s_or_b64 vcc, vcc, s[54:55]
    v_cmp_ne_u32 s[54:55], s49, v115
    s_or_b64 vcc, vcc, s[54:55]
    s_cbranch_vccnz L_HF_e2
    v_mov_b32 v1, s49
    ds_write_b32 v38, v1
    s_mov_b32 s79, 1
    s_waitcnt lgkmcnt(0)
L_HF_e2:
    s_barrier
    s_branch L_H2
L_BF:
    v_and_b32 v7, 31, v0
    v_lshrrev_b32 v8, 5, v0
    v_mul_u32_u24 v9, 896, v8
    v_lshl_add_u32 v9, v7, 4, v9
    s_lshl_b32 s14, s36, 4
    s_add_u32 s14, s14, s37
    s_lshl_b32 s14, s14, 2
    s_add_u32 s14, s14, s39
    s_lshl_b32 s45, s14, 1
    s_mul_i32 s14, s45, 896
    v_mov_b32 v52, 0
    v_mov_b32 v53, 0
    v_mov_b32 v54, 0
    v_mov_b32 v55, 0
    s_mov_b32 s16, s4
    s_mov_b32 s17, s5
    s_mov_b32 s18, 1835008
    s_mov_b32 s19, 0x00020000
    buffer_load_dwordx4 v[48:51], v9, s[16:19], s14 offen
    s_mov_b32 exec_lo, 0x00ffffff
    s_mov_b32 exec_hi, 0x00ffffff
    buffer_load_dwordx4 v[52:55], v9, s[16:19], s14 offen offset:512
    s_mov_b64 exec, -1
    s_getpc_b64 s[12:13]
L_pcF:
    s_sub_u32 s12, s12, L_pcF-recurrent_scan__mha_block__geglu_ffn__prompt_kernel
    s_subb_u32 s13, s13, 0
    s_lshl_b32 s14, s78, 12
    v_lshl_add_u32 v10, v7, 7, s14
    v_min_u32 v10, L_tabend-recurrent_scan__mha_block__geglu_ffn__prompt_kernel-4, v10
    global_load_dword v39, v10, s[12:13]
    s_mov_b32 s60, s37
    s_lshl_b32 s101, s37, 1
    s_and_b32 s42, s36, 7
    s_cmp_ge_u32 s42, 5
    s_cselect_b32 s46, 5, 0
    s_lshr_b32 s14, s42, 1
    s_lshl_b32 s14, s14, 7
    s_lshl_b32 s15, s101, 7
    s_add_u32 s14, s14, s15
    s_add_u32 s15, s60, s42
    s_sub_u32 s15, s15, 4
    s_lshl_b32 s15, s15, 7
    s_bitcmp1_b32 s42, 0
    s_cselect_b32 s8, s10, s8
    s_cselect_b32 s9, s11, s9
    s_cmp_ge_u32 s42, 4
    s_cselect_b32 s43, s15, s14
    s_cselect_b32 s8, s6, s8
    s_cselect_b32 s9, s7, s9
    s_mov_b32 s14, 3584
    s_cselect_b32 s44, 2688, s14
    s_mov_b32 s14, 1605632
    s_cselect_b32 s14, 1204224, s14
    s_mov_b32 s24, s8
    s_mov_b32 s25, s9
    s_mov_b32 s26, s14
    s_mov_b32 s27, 0x00020000
    v_lshrrev_b32 v12, 3, v0
    v_mul_lo_u32 v12, v12, s44
    v_and_b32 v13, 7, v0
    v_lshl_add_u32 v12, v13, 4, v12
    s_mul_i32 s14, s39, 112
    s_mul_i32 s14, s14, s44
    s_add_u32 s43, s43, s14
    s_lshl_b32 s44, s44, 3
    v_mov_b32 v38, v12
    s_and_b32 s40, s38, 1
    s_lshr_b32 s41, s39, 1
    s_mov_b32 s50, 0
    s_mov_b32 s51, -1
    v_and_b32 v7, 31, v0
    v_lshrrev_b32 v8, 5, v0
    v_bfe_u32 v9, v0, 1, 3
    v_xor_b32 v9, v9, v8
    v_lshlrev_b32 v9, 4, v9
    v_lshl_add_u32 v9, v7, 7, v9
    s_lshl_b32 s15, s40, 13
    v_add_u32 v16, s15, v9
    v_xor_b32 v17, 32, v16
    v_xor_b32 v18, 64, v16
    v_xor_b32 v19, 96, v16
    v_add_u32 v20, 0x10000, v16
    v_add_u32 v21, 0x10000, v17
    v_add_u32 v22, 0x10000, v18
    v_add_u32 v23, 0x10000, v19
    v_bfe_u32 v10, v0, 2, 2
    v_and_b32 v11, 3, v0
    v_bfe_u32 v12, v0, 4, 1
    v_bfe_u32 v13, v0, 3, 1
    v_lshlrev_b32 v13, 2, v13
    v_lshlrev_b32 v14, 10, v8
    v_lshl_add_u32 v14, v10, 7, v14
    v_add_u32 v14, 114688, v14
    v_lshl_add_u32 v2, v12, 2, v11
    s_lshl_b32 s15, s41, 3
    v_add_u32 v3, s15, v2
    v_lshrrev_b32 v1, 1, v3
    v_xor_b32 v1, v1, v13
    v_lshl_add_u32 v1, v1, 4, v14
    v_and_b32 v15, 1, v3
    v_lshl_add_u32 v26, v15, 3, v1
    v_lshrrev_b32 v1, 1, v11
    v_xor_b32 v1, v1, v13
    v_lshlrev_b32 v3, 1, v12
    v_xor_b32 v1, v1, v3
    s_lshl_b32 s14, s41, 2
    v_xor_b32 v1, s14, v1
    v_lshl_add_u32 v1, v1, 4, v14
    v_and_b32 v15, 1, v11
    v_lshl_add_u32 v1, v15, 3, v1
    v_lshl_add_u32 v35, v12, 12, v1
    v_xor_b32 v36, 32, v35
    s_lshl_b32 s14, s41, 7
    s_add_u32 s14, s14, 155648
    v_lshl_add_u32 v30, v8, 4, s14
    s_lshl_b32 s14, s41, 7
    s_add_u32 s14, s14, 155648
    v_lshl_add_u32 v31, v8, 4, s14
    s_lshl_b32 s14, s40, 8
    s_add_u32 s14, s14, 155648
    v_lshl_add_u32 v32, v7, 2, s14
    v_lshlrev_b32 v27, 4, v0
    v_lshlrev_b32 v28, 3, v7
    v_mov_b32 v29, v8
    s_mov_b32 s60, s37
    s_lshl_b32 s101, s37, 1
    s_and_b32 s3, s2, 7
    s_and_b32 s14, s78, 1
    s_lshl_b32 s74, s3, 1
    s_add_u32 s74, s74, s14
    s_lshr_b32 s75, s78, 1
    s_mul_i32 s14, s3, 29
    s_sub_u32 s15, s3, 4
    s_max_i32 s15, s15, 0
    s_add_u32 s14, s14, s15
    s_cmp_eq_u32 s3, 7
    s_cselect_b32 s14, 200, s14
    s_cmp_lt_u32 s3, 4
    s_cselect_b32 s15, 29, 30
    s_cmp_lt_u32 s3, 6
    s_cselect_b32 s15, s15, 24
    s_add_u32 s14, s14, s78
    s_mul_i32 s76, s14, 9363
    s_lshr_b32 s76, s76, 16
    s_mul_i32 s77, s76, 7
    s_sub_u32 s77, s14, s77
    s_cmp_ge_u32 s78, s15
    s_cselect_b32 s76, 32, s76
    s_mov_b32 s32, s68
    s_mov_b32 s33, s69
    s_mov_b32 s34, 20971520
    s_mov_b32 s35, 0x00020000
    s_mov_b32 s3, 16777216
    s_load_dword s49, s[68:69], s3
    s_waitcnt lgkmcnt(0)
    s_add_u32 s49, s49, 0x9e3779b9
    s_barrier
    s_cmp_ge_u32 s46, 5
    s_cbranch_scc1 L_BF_nd1
    buffer_load_dwordx4 v[96:99], v38, s[24:27], s43 offen
    s_add_u32 s43, s43, s44
    buffer_load_dwordx4 v[100:103], v38, s[24:27], s43 offen
    s_add_u32 s43, s43, s44
    buffer_load_dwordx4 v[104:107], v38, s[24:27], s43 offen
    s_add_u32 s43, s43, s44
    buffer_load_dwordx4 v[108:111], v38, s[24:27], s43 offen
    s_add_u32 s43, s43, s44
    buffer_load_dwordx4 v[112:115], v38, s[24:27], s43 offen
    s_add_u32 s43, s43, s44
    buffer_load_dwordx4 v[116:119], v38, s[24:27], s43 offen
    s_add_u32 s43, s43, s44
    buffer_load_dwordx4 v[120:123], v38, s[24:27], s43 offen
    s_add_u32 s43, s43, s44
    buffer_load_dwordx4 v[124:127], v38, s[24:27], s43 offen
    s_add_u32 s43, s43, s44
    buffer_load_dwordx4 v[128:131], v38, s[24:27], s43 offen
    s_add_u32 s43, s43, s44
    buffer_load_dwordx4 v[132:135], v38, s[24:27], s43 offen
    s_add_u32 s43, s43, s44
    buffer_load_dwordx4 v[136:139], v38, s[24:27], s43 offen
    s_add_u32 s43, s43, s44
    buffer_load_dwordx4 v[140:143], v38, s[24:27], s43 offen
    s_add_u32 s43, s43, s44
    buffer_load_dwordx4 v[144:147], v38, s[24:27], s43 offen
    s_add_u32 s43, s43, s44
    buffer_load_dwordx4 v[148:151], v38, s[24:27], s43 offen
L_BF_nd1:
    s_cmp_ge_u32 s46, 5
    s_cbranch_scc1 L_BF_w1
    s_waitcnt vmcnt(15)
    s_branch L_BF_w2
L_BF_w1:
    s_waitcnt vmcnt(1)
L_BF_w2:
    v_mov_b32 v1, 0
    v_mov_b32 v2, 0
    v_lshlrev_b32 v3, 16, v48
    v_and_b32 v4, 0xffff0000, v48
    v_add_f32 v1, v1, v3
    v_fmac_f32 v2, v3, v3
    v_add_f32 v1, v1, v4
    v_fmac_f32 v2, v4, v4
    v_lshlrev_b32 v3, 16, v49
    v_and_b32 v4, 0xffff0000, v49
    v_add_f32 v1, v1, v3
    v_fmac_f32 v2, v3, v3
    v_add_f32 v1, v1, v4
    v_fmac_f32 v2, v4, v4
    v_lshlrev_b32 v3, 16, v50
    v_and_b32 v4, 0xffff0000, v50
    v_add_f32 v1, v1, v3
    v_fmac_f32 v2, v3, v3
    v_add_f32 v1, v1, v4
    v_fmac_f32 v2, v4, v4
    v_lshlrev_b32 v3, 16, v51
    v_and_b32 v4, 0xffff0000, v51
    v_add_f32 v1, v1, v3
    v_fmac_f32 v2, v3, v3
    v_add_f32 v1, v1, v4
    v_fmac_f32 v2, v4, v4
    v_lshlrev_b32 v3, 16, v52
    v_and_b32 v4, 0xffff0000, v52
    v_add_f32 v1, v1, v3
    v_fmac_f32 v2, v3, v3
    v_add_f32 v1, v1, v4
    v_fmac_f32 v2, v4, v4
    v_lshlrev_b32 v3, 16, v53
    v_and_b32 v4, 0xffff0000, v53
    v_add_f32 v1, v1, v3
    v_fmac_f32 v2, v3, v3
    v_add_f32 v1, v1, v4
    v_fmac_f32 v2, v4, v4
    v_lshlrev_b32 v3, 16, v54
    v_and_b32 v4, 0xffff0000, v54
    v_add_f32 v1, v1, v3
    v_fmac_f32 v2, v3, v3
    v_add_f32 v1, v1, v4
    v_fmac_f32 v2, v4, v4
    v_lshlrev_b32 v3, 16, v55
    v_and_b32 v4, 0xffff0000, v55
    v_add_f32 v1, v1, v3
    v_fmac_f32 v2, v3, v3
    v_add_f32 v1, v1, v4
    v_fmac_f32 v2, v4, v4
    s_nop 0
    v_add_f32_dpp v1, v1, v1 quad_perm:[1,0,3,2] row_mask:0xf bank_mask:0xf
    v_add_f32_dpp v2, v2, v2 quad_perm:[1,0,3,2] row_mask:0xf bank_mask:0xf
    s_nop 0
    v_add_f32_dpp v1, v1, v1 quad_perm:[2,3,0,1] row_mask:0xf bank_mask:0xf
    v_add_f32_dpp v2, v2, v2 quad_perm:[2,3,0,1] row_mask:0xf bank_mask:0xf
    s_nop 0
    v_add_f32_dpp v1, v1, v1 row_half_mirror row_mask:0xf bank_mask:0xf
    v_add_f32_dpp v2, v2, v2 row_half_mirror row_mask:0xf bank_mask:0xf
    s_nop 0
    v_add_f32_dpp v1, v1, v1 row_mirror row_mask:0xf bank_mask:0xf
    v_add_f32_dpp v2, v2, v2 row_mirror row_mask:0xf bank_mask:0xf
    v_mov_b32 v3, v1
    v_mov_b32 v4, v2
    s_nop 0
    v_permlane16_swap_b32 v1, v3
    v_permlane16_swap_b32 v2, v4
    v_add_f32 v1, v1, v3
    v_add_f32 v2, v2, v4
    v_mul_f32 v1, 0x3b124925, v1
    v_mul_f32 v2, 0x3b124925, v2
    v_fma_f32 v2, -v1, v1, v2
    v_max_f32 v2, 0, v2
    v_cvt_pk_bf16_f32 v3, v1, v2
    v_and_b32 v5, 0xffff0000, v3
    v_add_f32 v5, 0x3727c5ac, v5
    v_cvt_pk_bf16_f32 v5, v5, v5
    v_and_b32 v5, 0xffff0000, v5
    v_sqrt_f32 v5, v5
    s_nop 0
    v_cvt_pk_bf16_f32 v4, v1, v5
    v_mov_b32 v5, s49
    v_lshrrev_b32 v6, 2, v0
    v_and_b32 v6, 8, v6
    s_lshl_b32 s14, s45, 3
    s_add_u32 s14, s14, 16809984
    s_mov_b32 exec_lo, 1
    s_mov_b32 exec_hi, 1
    buffer_store_dwordx2 v[4:5], v6, s[32:35], s14 offen sc1
    s_mov_b64 exec, -1
    s_barrier
    s_barrier
    s_barrier
    s_cmp_ge_u32 s46, 5
    s_cbranch_scc1 L_BF_c3
    s_waitcnt vmcnt(14)
    v_lshlrev_b32 v40, 16, v96
    v_and_b32 v41, 0xffff0000, v96
    v_lshlrev_b32 v42, 16, v97
    v_and_b32 v43, 0xffff0000, v97
    v_lshlrev_b32 v44, 16, v98
    v_and_b32 v45, 0xffff0000, v98
    v_lshlrev_b32 v46, 16, v99
    v_and_b32 v47, 0xffff0000, v99
    s_waitcnt vmcnt(13)
    v_lshlrev_b32 v3, 16, v100
    v_and_b32 v4, 0xffff0000, v100
    v_add_f32 v40, v40, v3
    v_add_f32 v41, v41, v4
    v_lshlrev_b32 v3, 16, v101
    v_and_b32 v4, 0xffff0000, v101
    v_add_f32 v42, v42, v3
    v_add_f32 v43, v43, v4
    v_lshlrev_b32 v3, 16, v102
    v_and_b32 v4, 0xffff0000, v102
    v_add_f32 v44, v44, v3
    v_add_f32 v45, v45, v4
    v_lshlrev_b32 v3, 16, v103
    v_and_b32 v4, 0xffff0000, v103
    v_add_f32 v46, v46, v3
    v_add_f32 v47, v47, v4
    s_waitcnt vmcnt(12)
    v_lshlrev_b32 v3, 16, v104
    v_and_b32 v4, 0xffff0000, v104
    v_add_f32 v40, v40, v3
    v_add_f32 v41, v41, v4
    v_lshlrev_b32 v3, 16, v105
    v_and_b32 v4, 0xffff0000, v105
    v_add_f32 v42, v42, v3
    v_add_f32 v43, v43, v4
    v_lshlrev_b32 v3, 16, v106
    v_and_b32 v4, 0xffff0000, v106
    v_add_f32 v44, v44, v3
    v_add_f32 v45, v45, v4
    v_lshlrev_b32 v3, 16, v107
    v_and_b32 v4, 0xffff0000, v107
    v_add_f32 v46, v46, v3
    v_add_f32 v47, v47, v4
    s_waitcnt vmcnt(11)
    v_lshlrev_b32 v3, 16, v108
    v_and_b32 v4, 0xffff0000, v108
    v_add_f32 v40, v40, v3
    v_add_f32 v41, v41, v4
    v_lshlrev_b32 v3, 16, v109
    v_and_b32 v4, 0xffff0000, v109
    v_add_f32 v42, v42, v3
    v_add_f32 v43, v43, v4
    v_lshlrev_b32 v3, 16, v110
    v_and_b32 v4, 0xffff0000, v110
    v_add_f32 v44, v44, v3
    v_add_f32 v45, v45, v4
    v_lshlrev_b32 v3, 16, v111
    v_and_b32 v4, 0xffff0000, v111
    v_add_f32 v46, v46, v3
    v_add_f32 v47, v47, v4
    s_waitcnt vmcnt(10)
    v_lshlrev_b32 v3, 16, v112
    v_and_b32 v4, 0xffff0000, v112
    v_add_f32 v40, v40, v3
    v_add_f32 v41, v41, v4
    v_lshlrev_b32 v3, 16, v113
    v_and_b32 v4, 0xffff0000, v113
    v_add_f32 v42, v42, v3
    v_add_f32 v43, v43, v4
    v_lshlrev_b32 v3, 16, v114
    v_and_b32 v4, 0xffff0000, v114
    v_add_f32 v44, v44, v3
    v_add_f32 v45, v45, v4
    v_lshlrev_b32 v3, 16, v115
    v_and_b32 v4, 0xffff0000, v115
    v_add_f32 v46, v46, v3
    v_add_f32 v47, v47, v4
L_BF_c3:
    s_barrier
    s_cmp_ge_u32 s46, 5
    s_cbranch_scc1 L_BF_c4
    s_waitcnt vmcnt(9)
    v_lshlrev_b32 v3, 16, v116
    v_and_b32 v4, 0xffff0000, v116
    v_add_f32 v40, v40, v3
    v_add_f32 v41, v41, v4
    v_lshlrev_b32 v3, 16, v117
    v_and_b32 v4, 0xffff0000, v117
    v_add_f32 v42, v42, v3
    v_add_f32 v43, v43, v4
    v_lshlrev_b32 v3, 16, v118
    v_and_b32 v4, 0xffff0000, v118
    v_add_f32 v44, v44, v3
    v_add_f32 v45, v45, v4
    v_lshlrev_b32 v3, 16, v119
    v_and_b32 v4, 0xffff0000, v119
    v_add_f32 v46, v46, v3
    v_add_f32 v47, v47, v4
    s_waitcnt vmcnt(8)
    v_lshlrev_b32 v3, 16, v120
    v_and_b32 v4, 0xffff0000, v120
    v_add_f32 v40, v40, v3
    v_add_f32 v41, v41, v4
    v_lshlrev_b32 v3, 16, v121
    v_and_b32 v4, 0xffff0000, v121
    v_add_f32 v42, v42, v3
    v_add_f32 v43, v43, v4
    v_lshlrev_b32 v3, 16, v122
    v_and_b32 v4, 0xffff0000, v122
    v_add_f32 v44, v44, v3
    v_add_f32 v45, v45, v4
    v_lshlrev_b32 v3, 16, v123
    v_and_b32 v4, 0xffff0000, v123
    v_add_f32 v46, v46, v3
    v_add_f32 v47, v47, v4
    s_waitcnt vmcnt(7)
    v_lshlrev_b32 v3, 16, v124
    v_and_b32 v4, 0xffff0000, v124
    v_add_f32 v40, v40, v3
    v_add_f32 v41, v41, v4
    v_lshlrev_b32 v3, 16, v125
    v_and_b32 v4, 0xffff0000, v125
    v_add_f32 v42, v42, v3
    v_add_f32 v43, v43, v4
    v_lshlrev_b32 v3, 16, v126
    v_and_b32 v4, 0xffff0000, v126
    v_add_f32 v44, v44, v3
    v_add_f32 v45, v45, v4
    v_lshlrev_b32 v3, 16, v127
    v_and_b32 v4, 0xffff0000, v127
    v_add_f32 v46, v46, v3
    v_add_f32 v47, v47, v4
    s_waitcnt vmcnt(6)
    v_lshlrev_b32 v3, 16, v128
    v_and_b32 v4, 0xffff0000, v128
    v_add_f32 v40, v40, v3
    v_add_f32 v41, v41, v4
    v_lshlrev_b32 v3, 16, v129
    v_and_b32 v4, 0xffff0000, v129
    v_add_f32 v42, v42, v3
    v_add_f32 v43, v43, v4
    v_lshlrev_b32 v3, 16, v130
    v_and_b32 v4, 0xffff0000, v130
    v_add_f32 v44, v44, v3
    v_add_f32 v45, v45, v4
    v_lshlrev_b32 v3, 16, v131
    v_and_b32 v4, 0xffff0000, v131
    v_add_f32 v46, v46, v3
    v_add_f32 v47, v47, v4
    s_waitcnt vmcnt(5)
    v_lshlrev_b32 v3, 16, v132
    v_and_b32 v4, 0xffff0000, v132
    v_add_f32 v40, v40, v3
    v_add_f32 v41, v41, v4
    v_lshlrev_b32 v3, 16, v133
    v_and_b32 v4, 0xffff0000, v133
    v_add_f32 v42, v42, v3
    v_add_f32 v43, v43, v4
    v_lshlrev_b32 v3, 16, v134
    v_and_b32 v4, 0xffff0000, v134
    v_add_f32 v44, v44, v3
    v_add_f32 v45, v45, v4
    v_lshlrev_b32 v3, 16, v135
    v_and_b32 v4, 0xffff0000, v135
    v_add_f32 v46, v46, v3
    v_add_f32 v47, v47, v4
L_BF_c4:
    s_barrier
    s_cmp_ge_u32 s46, 5
    s_cbranch_scc1 L_BF_c5
    s_waitcnt vmcnt(4)
    v_lshlrev_b32 v3, 16, v136
    v_and_b32 v4, 0xffff0000, v136
    v_add_f32 v40, v40, v3
    v_add_f32 v41, v41, v4
    v_lshlrev_b32 v3, 16, v137
    v_and_b32 v4, 0xffff0000, v137
    v_add_f32 v42, v42, v3
    v_add_f32 v43, v43, v4
    v_lshlrev_b32 v3, 16, v138
    v_and_b32 v4, 0xffff0000, v138
    v_add_f32 v44, v44, v3
    v_add_f32 v45, v45, v4
    v_lshlrev_b32 v3, 16, v139
    v_and_b32 v4, 0xffff0000, v139
    v_add_f32 v46, v46, v3
    v_add_f32 v47, v47, v4
    s_waitcnt vmcnt(3)
    v_lshlrev_b32 v3, 16, v140
    v_and_b32 v4, 0xffff0000, v140
    v_add_f32 v40, v40, v3
    v_add_f32 v41, v41, v4
    v_lshlrev_b32 v3, 16, v141
    v_and_b32 v4, 0xffff0000, v141
    v_add_f32 v42, v42, v3
    v_add_f32 v43, v43, v4
    v_lshlrev_b32 v3, 16, v142
    v_and_b32 v4, 0xffff0000, v142
    v_add_f32 v44, v44, v3
    v_add_f32 v45, v45, v4
    v_lshlrev_b32 v3, 16, v143
    v_and_b32 v4, 0xffff0000, v143
    v_add_f32 v46, v46, v3
    v_add_f32 v47, v47, v4
    s_waitcnt vmcnt(2)
    v_lshlrev_b32 v3, 16, v144
    v_and_b32 v4, 0xffff0000, v144
    v_add_f32 v40, v40, v3
    v_add_f32 v41, v41, v4
    v_lshlrev_b32 v3, 16, v145
    v_and_b32 v4, 0xffff0000, v145
    v_add_f32 v42, v42, v3
    v_add_f32 v43, v43, v4
    v_lshlrev_b32 v3, 16, v146
    v_and_b32 v4, 0xffff0000, v146
    v_add_f32 v44, v44, v3
    v_add_f32 v45, v45, v4
    v_lshlrev_b32 v3, 16, v147
    v_and_b32 v4, 0xffff0000, v147
    v_add_f32 v46, v46, v3
    v_add_f32 v47, v47, v4
    s_waitcnt vmcnt(1)
    v_lshlrev_b32 v3, 16, v148
    v_and_b32 v4, 0xffff0000, v148
    v_add_f32 v40, v40, v3
    v_add_f32 v41, v41, v4
    v_lshlrev_b32 v3, 16, v149
    v_and_b32 v4, 0xffff0000, v149
    v_add_f32 v42, v42, v3
    v_add_f32 v43, v43, v4
    v_lshlrev_b32 v3, 16, v150
    v_and_b32 v4, 0xffff0000, v150
    v_add_f32 v44, v44, v3
    v_add_f32 v45, v45, v4
    v_lshlrev_b32 v3, 16, v151
    v_and_b32 v4, 0xffff0000, v151
    v_add_f32 v46, v46, v3
    v_add_f32 v47, v47, v4
    v_add_f32_dpp v40, v40, v40 row_ror:8 row_mask:0xf bank_mask:0xf
    v_add_f32_dpp v41, v41, v41 row_ror:8 row_mask:0xf bank_mask:0xf
    v_add_f32_dpp v42, v42, v42 row_ror:8 row_mask:0xf bank_mask:0xf
    v_add_f32_dpp v43, v43, v43 row_ror:8 row_mask:0xf bank_mask:0xf
    v_add_f32_dpp v44, v44, v44 row_ror:8 row_mask:0xf bank_mask:0xf
    v_add_f32_dpp v45, v45, v45 row_ror:8 row_mask:0xf bank_mask:0xf
    v_add_f32_dpp v46, v46, v46 row_ror:8 row_mask:0xf bank_mask:0xf
    v_add_f32_dpp v47, v47, v47 row_ror:8 row_mask:0xf bank_mask:0xf
    v_mov_b32 v96, v40
    v_mov_b32 v97, v41
    v_mov_b32 v98, v42
    v_mov_b32 v99, v43
    v_mov_b32 v100, v44
    v_mov_b32 v101, v45
    v_mov_b32 v102, v46
    v_mov_b32 v103, v47
    v_permlane16_swap_b32 v96, v40
    v_permlane16_swap_b32 v97, v41
    v_permlane16_swap_b32 v98, v42
    v_permlane16_swap_b32 v99, v43
    v_permlane16_swap_b32 v100, v44
    v_permlane16_swap_b32 v101, v45
    v_permlane16_swap_b32 v102, v46
    v_permlane16_swap_b32 v103, v47
    v_add_f32 v40, v40, v96
    v_add_f32 v41, v41, v97
    v_add_f32 v42, v42, v98
    v_add_f32 v43, v43, v99
    v_add_f32 v44, v44, v100
    v_add_f32 v45, v45, v101
    v_add_f32 v46, v46, v102
    v_add_f32 v47, v47, v103
    v_mov_b32 v96, v40
    v_mov_b32 v97, v41
    v_mov_b32 v98, v42
    v_mov_b32 v99, v43
    v_mov_b32 v100, v44
    v_mov_b32 v101, v45
    v_mov_b32 v102, v46
    v_mov_b32 v103, v47
    v_permlane32_swap_b32 v96, v40
    v_permlane32_swap_b32 v97, v41
    v_permlane32_swap_b32 v98, v42
    v_permlane32_swap_b32 v99, v43
    v_permlane32_swap_b32 v100, v44
    v_permlane32_swap_b32 v101, v45
    v_permlane32_swap_b32 v102, v46
    v_permlane32_swap_b32 v103, v47
    v_add_f32 v40, v40, v96
    v_add_f32 v41, v41, v97
    v_add_f32 v42, v42, v98
    v_add_f32 v43, v43, v99
    v_add_f32 v44, v44, v100
    v_add_f32 v45, v45, v101
    v_add_f32 v46, v46, v102
    v_add_f32 v47, v47, v103
    s_lshl_b32 s14, s39, 8
    s_add_u32 s14, s14, 157696
    v_and_b32 v3, 7, v0
    v_lshl_add_u32 v3, v3, 5, s14
    ds_write_b128 v3, v[40:43]
    ds_write_b128 v3, v[44:47] offset:16
    s_waitcnt lgkmcnt(0)
L_BF_c5:
    s_barrier
    s_cmp_ge_u32 s46, 5
    s_cbranch_scc1 L_BF_c9
    s_cmp_lg_u32 s39, 0
    s_cbranch_scc1 L_BF_c9
    v_lshlrev_b32 v3, 2, v0
    v_add_u32 v3, 157696, v3
    ds_read_b32 v4, v3 offset:0
    ds_read_b32 v5, v3 offset:256
    ds_read_b32 v6, v3 offset:512
    ds_read_b32 v7, v3 offset:768
    s_mul_i32 s14, s37, 6
    s_add_u32 s14, s14, s42
    s_lshl_b32 s14, s14, 9
    s_add_u32 s14, s14, 16826368
    v_lshlrev_b32 v3, 3, v0
    s_waitcnt lgkmcnt(0)
    v_add_f32 v4, v4, v5
    v_add_f32 v6, v6, v7
    v_add_f32 v4, v4, v6
    v_mov_b32 v5, s49
    buffer_store_dwordx2 v[4:5], v3, s[32:35], s14 offen sc1
L_BF_c9:
    s_waitcnt vmcnt(1)
    s_mov_b32 s43, 0
    s_barrier
    s_setprio 2
    ds_read_b64_tr_b16 v[48:49], v35 offset:16384
    ds_read_b64_tr_b16 v[50:51], v35 offset:16896
    ds_read_b128 v[40:43], v16 offset:0
    ds_read_b128 v[44:47], v16 offset:4096
    ds_read_b64_tr_b16 v[52:53], v36 offset:16384
    ds_read_b64_tr_b16 v[54:55], v36 offset:16896
    ds_read_b64_tr_b16 v[64:65], v35 offset:18432
    ds_read_b64_tr_b16 v[66:67], v35 offset:18944
    ds_read_b128 v[56:59], v17 offset:0
    ds_read_b128 v[60:63], v17 offset:4096
    ds_read_b64_tr_b16 v[68:69], v36 offset:18432
    ds_read_b64_tr_b16 v[70:71], v36 offset:18944
    s_waitcnt lgkmcnt(8)
    v_mfma_f32_32x32x16_bf16 v[96:111], v[48:51], v[40:43], 0
    v_mfma_f32_32x32x16_bf16 v[128:143], v[48:51], v[44:47], 0
    s_barrier
    s_waitcnt lgkmcnt(6)
    v_mfma_f32_32x32x16_bf16 v[112:127], v[52:55], v[40:43], 0
    ds_read_b64_tr_b16 v[80:81], v35 offset:24576
    ds_read_b64_tr_b16 v[82:83], v35 offset:25088
    ds_read_b128 v[72:75], v18 offset:0
    ds_read_b128 v[76:79], v18 offset:4096
    v_mfma_f32_32x32x16_bf16 v[144:159], v[52:55], v[44:47], 0
    ds_read_b64_tr_b16 v[84:85], v36 offset:24576
    ds_read_b64_tr_b16 v[86:87], v36 offset:25088
    s_waitcnt lgkmcnt(8)
    v_mfma_f32_32x32x16_bf16 v[96:111], v[64:67], v[56:59], v[96:111]
    ds_read_b64_tr_b16 v[48:49], v35 offset:26624
    ds_read_b64_tr_b16 v[50:51], v35 offset:27136
    v_mfma_f32_32x32x16_bf16 v[128:143], v[64:67], v[60:63], v[128:143]
    ds_read_b128 v[40:43], v19 offset:0
    ds_read_b128 v[44:47], v19 offset:4096
    s_waitcnt lgkmcnt(10)
    v_mfma_f32_32x32x16_bf16 v[112:127], v[68:71], v[56:59], v[112:127]
    ds_read_b64_tr_b16 v[52:53], v36 offset:26624
    ds_read_b64_tr_b16 v[54:55], v36 offset:27136
    v_mfma_f32_32x32x16_bf16 v[144:159], v[68:71], v[60:63], v[144:159]
    s_waitcnt lgkmcnt(8)
    v_mfma_f32_32x32x16_bf16 v[96:111], v[80:83], v[72:75], v[96:111]
    v_mfma_f32_32x32x16_bf16 v[128:143], v[80:83], v[76:79], v[128:143]
    s_barrier
    s_waitcnt lgkmcnt(6)
    v_mfma_f32_32x32x16_bf16 v[112:127], v[84:87], v[72:75], v[112:127]
    ds_read_b64_tr_b16 v[64:65], v35 offset:32768
    ds_read_b64_tr_b16 v[66:67], v35 offset:33280
    ds_read_b128 v[56:59], v16 offset:16384
    ds_read_b128 v[60:63], v16 offset:20480
    v_mfma_f32_32x32x16_bf16 v[144:159], v[84:87], v[76:79], v[144:159]
    ds_read_b64_tr_b16 v[68:69], v36 offset:32768
    ds_read_b64_tr_b16 v[70:71], v36 offset:33280
    s_waitcnt lgkmcnt(8)
    v_mfma_f32_32x32x16_bf16 v[96:111], v[48:51], v[40:43], v[96:111]
    ds_read_b64_tr_b16 v[80:81], v35 offset:34816
    ds_read_b64_tr_b16 v[82:83], v35 offset:35328
    v_mfma_f32_32x32x16_bf16 v[128:143], v[48:51], v[44:47], v[128:143]
    ds_read_b128 v[72:75], v17 offset:16384
    ds_read_b128 v[76:79], v17 offset:20480
    s_waitcnt lgkmcnt(10)
    v_mfma_f32_32x32x16_bf16 v[112:127], v[52:55], v[40:43], v[112:127]
    ds_read_b64_tr_b16 v[84:85], v36 offset:34816
    ds_read_b64_tr_b16 v[86:87], v36 offset:35328
    v_mfma_f32_32x32x16_bf16 v[144:159], v[52:55], v[44:47], v[144:159]
    s_waitcnt lgkmcnt(8)
    v_mfma_f32_32x32x16_bf16 v[96:111], v[64:67], v[56:59], v[96:111]
    v_mfma_f32_32x32x16_bf16 v[128:143], v[64:67], v[60:63], v[128:143]
    s_barrier
    s_waitcnt lgkmcnt(6)
    v_mfma_f32_32x32x16_bf16 v[112:127], v[68:71], v[56:59], v[112:127]
    ds_read_b64_tr_b16 v[48:49], v35 offset:0
    ds_read_b64_tr_b16 v[50:51], v35 offset:512
    ds_read_b128 v[40:43], v18 offset:16384
    ds_read_b128 v[44:47], v18 offset:20480
    v_mfma_f32_32x32x16_bf16 v[144:159], v[68:71], v[60:63], v[144:159]
    ds_read_b64_tr_b16 v[52:53], v36 offset:0
    ds_read_b64_tr_b16 v[54:55], v36 offset:512
    s_waitcnt lgkmcnt(8)
    v_mfma_f32_32x32x16_bf16 v[96:111], v[80:83], v[72:75], v[96:111]
    ds_read_b64_tr_b16 v[64:65], v35 offset:2048
    ds_read_b64_tr_b16 v[66:67], v35 offset:2560
    v_mfma_f32_32x32x16_bf16 v[128:143], v[80:83], v[76:79], v[128:143]
    ds_read_b128 v[56:59], v19 offset:16384
    ds_read_b128 v[60:63], v19 offset:20480
    s_waitcnt lgkmcnt(10)
    v_mfma_f32_32x32x16_bf16 v[112:127], v[84:87], v[72:75], v[112:127]
    ds_read_b64_tr_b16 v[68:69], v36 offset:2048
    ds_read_b64_tr_b16 v[70:71], v36 offset:2560
    v_mfma_f32_32x32x16_bf16 v[144:159], v[84:87], v[76:79], v[144:159]
    s_waitcnt lgkmcnt(8)
    v_mfma_f32_32x32x16_bf16 v[96:111], v[48:51], v[40:43], v[96:111]
    v_mfma_f32_32x32x16_bf16 v[128:143], v[48:51], v[44:47], v[128:143]
    s_barrier
    s_waitcnt lgkmcnt(6)
    v_mfma_f32_32x32x16_bf16 v[112:127], v[52:55], v[40:43], v[112:127]
    ds_read_b64_tr_b16 v[80:81], v35 offset:8192
    ds_read_b64_tr_b16 v[82:83], v35 offset:8704
    ds_read_b128 v[72:75], v16 offset:32768
    ds_read_b128 v[76:79], v16 offset:36864
    v_mfma_f32_32x32x16_bf16 v[144:159], v[52:55], v[44:47], v[144:159]
    ds_read_b64_tr_b16 v[84:85], v36 offset:8192
    ds_read_b64_tr_b16 v[86:87], v36 offset:8704
    s_waitcnt lgkmcnt(8)
    v_mfma_f32_32x32x16_bf16 v[96:111], v[64:67], v[56:59], v[96:111]
    ds_read_b64_tr_b16 v[48:49], v35 offset:10240
    ds_read_b64_tr_b16 v[50:51], v35 offset:10752
    v_mfma_f32_32x32x16_bf16 v[128:143], v[64:67], v[60:63], v[128:143]
    ds_read_b128 v[40:43], v17 offset:32768
    ds_read_b128 v[44:47], v17 offset:36864
    s_waitcnt lgkmcnt(10)
    v_mfma_f32_32x32x16_bf16 v[112:127], v[68:71], v[56:59], v[112:127]
    ds_read_b64_tr_b16 v[52:53], v36 offset:10240
    ds_read_b64_tr_b16 v[54:55], v36 offset:10752
    v_mfma_f32_32x32x16_bf16 v[144:159], v[68:71], v[60:63], v[144:159]
    s_waitcnt lgkmcnt(8)
    v_mfma_f32_32x32x16_bf16 v[96:111], v[80:83], v[72:75], v[96:111]
    v_mfma_f32_32x32x16_bf16 v[128:143], v[80:83], v[76:79], v[128:143]
    s_barrier
    s_waitcnt lgkmcnt(6)
    v_mfma_f32_32x32x16_bf16 v[112:127], v[84:87], v[72:75], v[112:127]
    ds_read_b64_tr_b16 v[64:65], v35 offset:16384
    ds_read_b64_tr_b16 v[66:67], v35 offset:16896
    ds_read_b128 v[56:59], v18 offset:32768
    ds_read_b128 v[60:63], v18 offset:36864
    v_mfma_f32_32x32x16_bf16 v[144:159], v[84:87], v[76:79], v[144:159]
    ds_read_b64_tr_b16 v[68:69], v36 offset:16384
    ds_read_b64_tr_b16 v[70:71], v36 offset:16896
    s_waitcnt lgkmcnt(8)
    v_mfma_f32_32x32x16_bf16 v[96:111], v[48:51], v[40:43], v[96:111]
    ds_read_b64_tr_b16 v[80:81], v35 offset:18432
    ds_read_b64_tr_b16 v[82:83], v35 offset:18944
    v_mfma_f32_32x32x16_bf16 v[128:143], v[48:51], v[44:47], v[128:143]
    ds_read_b128 v[72:75], v19 offset:32768
    ds_read_b128 v[76:79], v19 offset:36864
    s_waitcnt lgkmcnt(10)
    v_mfma_f32_32x32x16_bf16 v[112:127], v[52:55], v[40:43], v[112:127]
    ds_read_b64_tr_b16 v[84:85], v36 offset:18432
    ds_read_b64_tr_b16 v[86:87], v36 offset:18944
    v_mfma_f32_32x32x16_bf16 v[144:159], v[52:55], v[44:47], v[144:159]
    s_waitcnt lgkmcnt(8)
    v_mfma_f32_32x32x16_bf16 v[96:111], v[64:67], v[56:59], v[96:111]
    v_mfma_f32_32x32x16_bf16 v[128:143], v[64:67], v[60:63], v[128:143]
    s_barrier
    s_waitcnt lgkmcnt(6)
    v_mfma_f32_32x32x16_bf16 v[112:127], v[68:71], v[56:59], v[112:127]
    ds_read_b64_tr_b16 v[48:49], v35 offset:24576
    ds_read_b64_tr_b16 v[50:51], v35 offset:25088
    ds_read_b128 v[40:43], v16 offset:49152
    ds_read_b128 v[44:47], v16 offset:53248
    v_mfma_f32_32x32x16_bf16 v[144:159], v[68:71], v[60:63], v[144:159]
    ds_read_b64_tr_b16 v[52:53], v36 offset:24576
    ds_read_b64_tr_b16 v[54:55], v36 offset:25088
    s_waitcnt lgkmcnt(8)
    v_mfma_f32_32x32x16_bf16 v[96:111], v[80:83], v[72:75], v[96:111]
    ds_read_b64_tr_b16 v[64:65], v35 offset:26624
    ds_read_b64_tr_b16 v[66:67], v35 offset:27136
    v_mfma_f32_32x32x16_bf16 v[128:143], v[80:83], v[76:79], v[128:143]
    ds_read_b128 v[56:59], v17 offset:49152
    ds_read_b128 v[60:63], v17 offset:53248
    s_waitcnt lgkmcnt(10)
    v_mfma_f32_32x32x16_bf16 v[112:127], v[84:87], v[72:75], v[112:127]
    ds_read_b64_tr_b16 v[68:69], v36 offset:26624
    ds_read_b64_tr_b16 v[70:71], v36 offset:27136
    v_mfma_f32_32x32x16_bf16 v[144:159], v[84:87], v[76:79], v[144:159]
    s_waitcnt lgkmcnt(8)
    v_mfma_f32_32x32x16_bf16 v[96:111], v[48:51], v[40:43], v[96:111]
    v_mfma_f32_32x32x16_bf16 v[128:143], v[48:51], v[44:47], v[128:143]
    s_barrier
    s_waitcnt lgkmcnt(6)
    v_mfma_f32_32x32x16_bf16 v[112:127], v[52:55], v[40:43], v[112:127]
    ds_read_b64_tr_b16 v[80:81], v35 offset:32768
    ds_read_b64_tr_b16 v[82:83], v35 offset:33280
    ds_read_b128 v[72:75], v18 offset:49152
    ds_read_b128 v[76:79], v18 offset:53248
    v_mfma_f32_32x32x16_bf16 v[144:159], v[52:55], v[44:47], v[144:159]
    ds_read_b64_tr_b16 v[84:85], v36 offset:32768
    ds_read_b64_tr_b16 v[86:87], v36 offset:33280
    s_waitcnt lgkmcnt(8)
    v_mfma_f32_32x32x16_bf16 v[96:111], v[64:67], v[56:59], v[96:111]
    ds_read_b64_tr_b16 v[48:49], v35 offset:34816
    ds_read_b64_tr_b16 v[50:51], v35 offset:35328
    v_mfma_f32_32x32x16_bf16 v[128:143], v[64:67], v[60:63], v[128:143]
    ds_read_b128 v[40:43], v19 offset:49152
    ds_read_b128 v[44:47], v19 offset:53248
    s_waitcnt lgkmcnt(10)
    v_mfma_f32_32x32x16_bf16 v[112:127], v[68:71], v[56:59], v[112:127]
    ds_read_b64_tr_b16 v[52:53], v36 offset:34816
    ds_read_b64_tr_b16 v[54:55], v36 offset:35328
    v_mfma_f32_32x32x16_bf16 v[144:159], v[68:71], v[60:63], v[144:159]
    s_waitcnt lgkmcnt(8)
    v_mfma_f32_32x32x16_bf16 v[96:111], v[80:83], v[72:75], v[96:111]
    v_mfma_f32_32x32x16_bf16 v[128:143], v[80:83], v[76:79], v[128:143]
    s_barrier
    s_waitcnt lgkmcnt(6)
    v_mfma_f32_32x32x16_bf16 v[112:127], v[84:87], v[72:75], v[112:127]
    ds_read_b64_tr_b16 v[64:65], v35 offset:0
    ds_read_b64_tr_b16 v[66:67], v35 offset:512
    ds_read_b128 v[56:59], v20 offset:0
    ds_read_b128 v[60:63], v20 offset:4096
    v_mfma_f32_32x32x16_bf16 v[144:159], v[84:87], v[76:79], v[144:159]
    ds_read_b64_tr_b16 v[68:69], v36 offset:0
    ds_read_b64_tr_b16 v[70:71], v36 offset:512
    s_waitcnt lgkmcnt(8)
    v_mfma_f32_32x32x16_bf16 v[96:111], v[48:51], v[40:43], v[96:111]
    ds_read_b64_tr_b16 v[80:81], v35 offset:2048
    ds_read_b64_tr_b16 v[82:83], v35 offset:2560
    v_mfma_f32_32x32x16_bf16 v[128:143], v[48:51], v[44:47], v[128:143]
    ds_read_b128 v[72:75], v21 offset:0
    ds_read_b128 v[76:79], v21 offset:4096
    s_waitcnt lgkmcnt(10)
    v_mfma_f32_32x32x16_bf16 v[112:127], v[52:55], v[40:43], v[112:127]
    ds_read_b64_tr_b16 v[84:85], v36 offset:2048
    ds_read_b64_tr_b16 v[86:87], v36 offset:2560
    v_mfma_f32_32x32x16_bf16 v[144:159], v[52:55], v[44:47], v[144:159]
    s_waitcnt lgkmcnt(8)
    v_mfma_f32_32x32x16_bf16 v[96:111], v[64:67], v[56:59], v[96:111]
    v_mfma_f32_32x32x16_bf16 v[128:143], v[64:67], v[60:63], v[128:143]
    s_barrier
    s_waitcnt lgkmcnt(6)
    v_mfma_f32_32x32x16_bf16 v[112:127], v[68:71], v[56:59], v[112:127]
    ds_read_b64_tr_b16 v[48:49], v35 offset:8192
    ds_read_b64_tr_b16 v[50:51], v35 offset:8704
    ds_read_b128 v[40:43], v22 offset:0
    ds_read_b128 v[44:47], v22 offset:4096
    v_mfma_f32_32x32x16_bf16 v[144:159], v[68:71], v[60:63], v[144:159]
    ds_read_b64_tr_b16 v[52:53], v36 offset:8192
    ds_read_b64_tr_b16 v[54:55], v36 offset:8704
    s_waitcnt lgkmcnt(8)
    v_mfma_f32_32x32x16_bf16 v[96:111], v[80:83], v[72:75], v[96:111]
    ds_read_b64_tr_b16 v[64:65], v35 offset:10240
    ds_read_b64_tr_b16 v[66:67], v35 offset:10752
    v_mfma_f32_32x32x16_bf16 v[128:143], v[80:83], v[76:79], v[128:143]
    ds_read_b128 v[56:59], v23 offset:0
    ds_read_b128 v[60:63], v23 offset:4096
    s_waitcnt lgkmcnt(10)
    v_mfma_f32_32x32x16_bf16 v[112:127], v[84:87], v[72:75], v[112:127]
    ds_read_b64_tr_b16 v[68:69], v36 offset:10240
    ds_read_b64_tr_b16 v[70:71], v36 offset:10752
    v_mfma_f32_32x32x16_bf16 v[144:159], v[84:87], v[76:79], v[144:159]
    s_waitcnt lgkmcnt(8)
    v_mfma_f32_32x32x16_bf16 v[96:111], v[48:51], v[40:43], v[96:111]
    v_mfma_f32_32x32x16_bf16 v[128:143], v[48:51], v[44:47], v[128:143]
    s_barrier
    s_waitcnt lgkmcnt(6)
    v_mfma_f32_32x32x16_bf16 v[112:127], v[52:55], v[40:43], v[112:127]
    ds_read_b64_tr_b16 v[80:81], v35 offset:16384
    ds_read_b64_tr_b16 v[82:83], v35 offset:16896
    ds_read_b128 v[72:75], v20 offset:16384
    ds_read_b128 v[76:79], v20 offset:20480
    v_mfma_f32_32x32x16_bf16 v[144:159], v[52:55], v[44:47], v[144:159]
    ds_read_b64_tr_b16 v[84:85], v36 offset:16384
    ds_read_b64_tr_b16 v[86:87], v36 offset:16896
    s_waitcnt lgkmcnt(8)
    v_mfma_f32_32x32x16_bf16 v[96:111], v[64:67], v[56:59], v[96:111]
    ds_read_b64_tr_b16 v[48:49], v35 offset:18432
    ds_read_b64_tr_b16 v[50:51], v35 offset:18944
    v_mfma_f32_32x32x16_bf16 v[128:143], v[64:67], v[60:63], v[128:143]
    ds_read_b128 v[40:43], v21 offset:16384
    ds_read_b128 v[44:47], v21 offset:20480
    s_waitcnt lgkmcnt(10)
    v_mfma_f32_32x32x16_bf16 v[112:127], v[68:71], v[56:59], v[112:127]
    ds_read_b64_tr_b16 v[52:53], v36 offset:18432
    ds_read_b64_tr_b16 v[54:55], v36 offset:18944
    v_mfma_f32_32x32x16_bf16 v[144:159], v[68:71], v[60:63], v[144:159]
    s_waitcnt lgkmcnt(8)
    v_mfma_f32_32x32x16_bf16 v[96:111], v[80:83], v[72:75], v[96:111]
    v_mfma_f32_32x32x16_bf16 v[128:143], v[80:83], v[76:79], v[128:143]
    s_barrier
    s_waitcnt lgkmcnt(6)
    v_mfma_f32_32x32x16_bf16 v[112:127], v[84:87], v[72:75], v[112:127]
    ds_read_b64_tr_b16 v[64:65], v35 offset:24576
    ds_read_b64_tr_b16 v[66:67], v35 offset:25088
    ds_read_b128 v[56:59], v22 offset:16384
    ds_read_b128 v[60:63], v22 offset:20480
    v_mfma_f32_32x32x16_bf16 v[144:159], v[84:87], v[76:79], v[144:159]
    ds_read_b64_tr_b16 v[68:69], v36 offset:24576
    ds_read_b64_tr_b16 v[70:71], v36 offset:25088
    s_waitcnt lgkmcnt(8)
    v_mfma_f32_32x32x16_bf16 v[96:111], v[48:51], v[40:43], v[96:111]
    ds_read_b64_tr_b16 v[80:81], v35 offset:26624
    ds_read_b64_tr_b16 v[82:83], v35 offset:27136
    v_mfma_f32_32x32x16_bf16 v[128:143], v[48:51], v[44:47], v[128:143]
    ds_read_b128 v[72:75], v23 offset:16384
    ds_read_b128 v[76:79], v23 offset:20480
    s_waitcnt lgkmcnt(10)
    v_mfma_f32_32x32x16_bf16 v[112:127], v[52:55], v[40:43], v[112:127]
    ds_read_b64_tr_b16 v[84:85], v36 offset:26624
    ds_read_b64_tr_b16 v[86:87], v36 offset:27136
    v_mfma_f32_32x32x16_bf16 v[144:159], v[52:55], v[44:47], v[144:159]
    s_waitcnt lgkmcnt(8)
    v_mfma_f32_32x32x16_bf16 v[96:111], v[64:67], v[56:59], v[96:111]
    v_mfma_f32_32x32x16_bf16 v[128:143], v[64:67], v[60:63], v[128:143]
    s_barrier
    s_waitcnt lgkmcnt(6)
    v_mfma_f32_32x32x16_bf16 v[112:127], v[68:71], v[56:59], v[112:127]
    ds_read_b64_tr_b16 v[48:49], v35 offset:32768
    ds_read_b64_tr_b16 v[50:51], v35 offset:33280
    ds_read_b128 v[40:43], v20 offset:32768
    ds_read_b128 v[44:47], v20 offset:36864
    v_mfma_f32_32x32x16_bf16 v[144:159], v[68:71], v[60:63], v[144:159]
    ds_read_b64_tr_b16 v[52:53], v36 offset:32768
    ds_read_b64_tr_b16 v[54:55], v36 offset:33280
    s_waitcnt lgkmcnt(8)
    v_mfma_f32_32x32x16_bf16 v[96:111], v[80:83], v[72:75], v[96:111]
    ds_read_b64_tr_b16 v[64:65], v35 offset:34816
    ds_read_b64_tr_b16 v[66:67], v35 offset:35328
    v_mfma_f32_32x32x16_bf16 v[128:143], v[80:83], v[76:79], v[128:143]
    ds_read_b128 v[56:59], v21 offset:32768
    ds_read_b128 v[60:63], v21 offset:36864
    s_waitcnt lgkmcnt(10)
    v_mfma_f32_32x32x16_bf16 v[112:127], v[84:87], v[72:75], v[112:127]
    ds_read_b64_tr_b16 v[68:69], v36 offset:34816
    ds_read_b64_tr_b16 v[70:71], v36 offset:35328
    v_mfma_f32_32x32x16_bf16 v[144:159], v[84:87], v[76:79], v[144:159]
    s_waitcnt lgkmcnt(8)
    v_mfma_f32_32x32x16_bf16 v[96:111], v[48:51], v[40:43], v[96:111]
    v_mfma_f32_32x32x16_bf16 v[128:143], v[48:51], v[44:47], v[128:143]
    s_barrier
    s_waitcnt lgkmcnt(6)
    v_mfma_f32_32x32x16_bf16 v[112:127], v[52:55], v[40:43], v[112:127]
    ds_read_b64_tr_b16 v[80:81], v35 offset:0
    ds_read_b64_tr_b16 v[82:83], v35 offset:512
    ds_read_b128 v[72:75], v22 offset:32768
    ds_read_b128 v[76:79], v22 offset:36864
    v_mfma_f32_32x32x16_bf16 v[144:159], v[52:55], v[44:47], v[144:159]
    ds_read_b64_tr_b16 v[84:85], v36 offset:0
    ds_read_b64_tr_b16 v[86:87], v36 offset:512
    s_waitcnt lgkmcnt(8)
    v_mfma_f32_32x32x16_bf16 v[96:111], v[64:67], v[56:59], v[96:111]
    ds_read_b64_tr_b16 v[48:49], v35 offset:2048
    ds_read_b64_tr_b16 v[50:51], v35 offset:2560
    v_mfma_f32_32x32x16_bf16 v[128:143], v[64:67], v[60:63], v[128:143]
    ds_read_b128 v[40:43], v23 offset:32768
    ds_read_b128 v[44:47], v23 offset:36864
    s_waitcnt lgkmcnt(10)
    v_mfma_f32_32x32x16_bf16 v[112:127], v[68:71], v[56:59], v[112:127]
    ds_read_b64_tr_b16 v[52:53], v36 offset:2048
    ds_read_b64_tr_b16 v[54:55], v36 offset:2560
    v_mfma_f32_32x32x16_bf16 v[144:159], v[68:71], v[60:63], v[144:159]
    s_waitcnt lgkmcnt(8)
    v_mfma_f32_32x32x16_bf16 v[96:111], v[80:83], v[72:75], v[96:111]
    v_mfma_f32_32x32x16_bf16 v[128:143], v[80:83], v[76:79], v[128:143]
    s_barrier
    s_waitcnt lgkmcnt(6)
    v_mfma_f32_32x32x16_bf16 v[112:127], v[84:87], v[72:75], v[112:127]
    v_mfma_f32_32x32x16_bf16 v[144:159], v[84:87], v[76:79], v[144:159]
    s_waitcnt lgkmcnt(2)
    v_mfma_f32_32x32x16_bf16 v[96:111], v[48:51], v[40:43], v[96:111]
    v_mfma_f32_32x32x16_bf16 v[128:143], v[48:51], v[44:47], v[128:143]
    s_waitcnt lgkmcnt(0)
    v_mfma_f32_32x32x16_bf16 v[112:127], v[52:55], v[40:43], v[112:127]
    v_mfma_f32_32x32x16_bf16 v[144:159], v[52:55], v[44:47], v[144:159]
    s_setprio 0
    s_lshl_b32 s54, s36, 1
    s_add_u32 s54, s54, s40
    s_mul_i32 s54, s54, 229376
    s_lshl_b32 s55, s101, 1
    s_add_u32 s55, s55, s41
    s_lshl_b32 s55, s55, 11
    s_add_u32 s55, s55, 6291456
    s_add_u32 s56, s54, s55
    s_add_u32 s57, s56, 114688
    ds_read_b32 v81, v32 offset:0
    ds_read_b32 v87, v32 offset:128
    s_waitcnt lgkmcnt(0)
    v_lshlrev_b32 v80, 16, v81
    v_and_b32 v81, 0xffff0000, v81
    v_rcp_f32 v85, v81
    v_mul_f32 v84, v81, v81
    v_mul_f32 v82, 0xc0135761, v85
    v_mul_f32 v83, v85, v85
    v_mul_f32 v83, v83, v85
    v_mul_f32 v83, 0xbdd2d3e8, v83
    v_lshlrev_b32 v86, 16, v87
    v_and_b32 v87, 0xffff0000, v87
    v_rcp_f32 v91, v87
    v_mul_f32 v90, v87, v87
    v_mul_f32 v88, 0xc0135761, v91
    v_mul_f32 v89, v91, v91
    v_mul_f32 v89, v89, v91
    v_mul_f32 v89, 0xbdd2d3e8, v89
    ds_read_b128 v[64:67], v30 offset:512
    ds_read_b128 v[68:71], v30 offset:544
    ds_read_b128 v[72:75], v30 offset:768
    ds_read_b128 v[76:79], v30 offset:800
    s_waitcnt lgkmcnt(0)
    s_barrier
    v_fma_f32 v96, -v80, v64, v96
    v_fma_f32 v104, -v80, v72, v104
    v_fma_f32 v97, -v80, v65, v97
    v_fma_f32 v105, -v80, v73, v105
    v_fma_f32 v98, -v80, v66, v98
    v_fma_f32 v106, -v80, v74, v106
    v_fma_f32 v99, -v80, v67, v99
    v_fma_f32 v107, -v80, v75, v107
    v_mul_f32 v40, v96, v96
    v_mul_f32 v41, v97, v97
    v_mul_f32 v42, v98, v98
    v_mul_f32 v43, v99, v99
    v_fma_f32 v40, v40, v83, v82
    v_fma_f32 v41, v41, v83, v82
    v_fma_f32 v42, v42, v83, v82
    v_fma_f32 v43, v43, v83, v82
    v_mul_f32 v40, v40, v96
    v_mul_f32 v41, v41, v97
    v_mul_f32 v42, v42, v98
    v_mul_f32 v43, v43, v99
    v_exp_f32 v40, v40
    v_exp_f32 v41, v41
    v_exp_f32 v42, v42
    v_exp_f32 v43, v43
    s_barrier
    v_mul_f32 v96, v96, v104
    v_mul_f32 v97, v97, v105
    v_mul_f32 v98, v98, v106
    v_mul_f32 v99, v99, v107
    v_fma_f32 v40, v40, v84, v84
    v_fma_f32 v41, v41, v84, v84
    v_fma_f32 v42, v42, v84, v84
    v_fma_f32 v43, v43, v84, v84
    v_rcp_f32 v40, v40
    v_rcp_f32 v41, v41
    v_rcp_f32 v42, v42
    v_rcp_f32 v43, v43
    v_mul_f32 v96, v96, v40
    v_mul_f32 v97, v97, v41
    v_mul_f32 v98, v98, v42
    v_mul_f32 v99, v99, v43
    v_cvt_pk_bf16_f32 v48, v96, v97
    v_cvt_pk_bf16_f32 v49, v98, v99
    v_fma_f32 v100, -v80, v68, v100
    v_fma_f32 v108, -v80, v76, v108
    v_fma_f32 v101, -v80, v69, v101
    v_fma_f32 v109, -v80, v77, v109
    v_fma_f32 v102, -v80, v70, v102
    v_fma_f32 v110, -v80, v78, v110
    v_fma_f32 v103, -v80, v71, v103
    v_fma_f32 v111, -v80, v79, v111
    v_mul_f32 v44, v100, v100
    v_mul_f32 v45, v101, v101
    v_mul_f32 v46, v102, v102
    s_barrier
    v_mul_f32 v47, v103, v103
    v_fma_f32 v44, v44, v83, v82
    v_fma_f32 v45, v45, v83, v82
    v_fma_f32 v46, v46, v83, v82
    v_fma_f32 v47, v47, v83, v82
    v_mul_f32 v44, v44, v100
    v_mul_f32 v45, v45, v101
    v_mul_f32 v46, v46, v102
    v_mul_f32 v47, v47, v103
    v_exp_f32 v44, v44
    v_exp_f32 v45, v45
    v_exp_f32 v46, v46
    v_exp_f32 v47, v47
    v_mul_f32 v100, v100, v108
    v_mul_f32 v101, v101, v109
    v_mul_f32 v102, v102, v110
    v_mul_f32 v103, v103, v111
    v_fma_f32 v44, v44, v84, v84
    v_fma_f32 v45, v45, v84, v84
    v_fma_f32 v46, v46, v84, v84
    v_fma_f32 v47, v47, v84, v84
    v_rcp_f32 v44, v44
    v_rcp_f32 v45, v45
    v_rcp_f32 v46, v46
    v_rcp_f32 v47, v47
    s_barrier
    v_mul_f32 v100, v100, v44
    v_mul_f32 v101, v101, v45
    v_mul_f32 v102, v102, v46
    v_mul_f32 v103, v103, v47
    v_cvt_pk_bf16_f32 v50, v100, v101
    v_cvt_pk_bf16_f32 v51, v102, v103
    buffer_store_dwordx4 v[48:51], v27, s[32:35], s56 offen offset:0 sc1
    v_fma_f32 v128, -v86, v64, v128
    v_fma_f32 v136, -v86, v72, v136
    v_fma_f32 v129, -v86, v65, v129
    v_fma_f32 v137, -v86, v73, v137
    v_fma_f32 v130, -v86, v66, v130
    v_fma_f32 v138, -v86, v74, v138
    v_fma_f32 v131, -v86, v67, v131
    v_fma_f32 v139, -v86, v75, v139
    v_mul_f32 v40, v128, v128
    v_mul_f32 v41, v129, v129
    v_mul_f32 v42, v130, v130
    v_mul_f32 v43, v131, v131
    v_fma_f32 v40, v40, v89, v88
    v_fma_f32 v41, v41, v89, v88
    v_fma_f32 v42, v42, v89, v88
    v_fma_f32 v43, v43, v89, v88
    v_mul_f32 v40, v40, v128
    v_mul_f32 v41, v41, v129
    v_mul_f32 v42, v42, v130
    v_mul_f32 v43, v43, v131
    v_exp_f32 v40, v40
    v_exp_f32 v41, v41
    s_barrier
    v_exp_f32 v42, v42
    v_exp_f32 v43, v43
    v_mul_f32 v128, v128, v136
    v_mul_f32 v129, v129, v137
    v_mul_f32 v130, v130, v138
    v_mul_f32 v131, v131, v139
    v_fma_f32 v40, v40, v90, v90
    v_fma_f32 v41, v41, v90, v90
    v_fma_f32 v42, v42, v90, v90
    v_fma_f32 v43, v43, v90, v90
    v_rcp_f32 v40, v40
    v_rcp_f32 v41, v41
    v_rcp_f32 v42, v42
    v_rcp_f32 v43, v43
    v_mul_f32 v128, v128, v40
    v_mul_f32 v129, v129, v41
    v_mul_f32 v130, v130, v42
    v_mul_f32 v131, v131, v43
    v_cvt_pk_bf16_f32 v52, v128, v129
    v_cvt_pk_bf16_f32 v53, v130, v131
    v_fma_f32 v132, -v86, v68, v132
    v_fma_f32 v140, -v86, v76, v140
    v_fma_f32 v133, -v86, v69, v133
    v_fma_f32 v141, -v86, v77, v141
    v_fma_f32 v134, -v86, v70, v134
    v_fma_f32 v142, -v86, v78, v142
    s_barrier
    v_fma_f32 v135, -v86, v71, v135
    v_fma_f32 v143, -v86, v79, v143
    v_mul_f32 v44, v132, v132
    v_mul_f32 v45, v133, v133
    v_mul_f32 v46, v134, v134
    v_mul_f32 v47, v135, v135
    v_fma_f32 v44, v44, v89, v88
    v_fma_f32 v45, v45, v89, v88
    v_fma_f32 v46, v46, v89, v88
    v_fma_f32 v47, v47, v89, v88
    v_mul_f32 v44, v44, v132
    v_mul_f32 v45, v45, v133
    v_mul_f32 v46, v46, v134
    v_mul_f32 v47, v47, v135
    v_exp_f32 v44, v44
    v_exp_f32 v45, v45
    v_exp_f32 v46, v46
    v_exp_f32 v47, v47
    v_mul_f32 v132, v132, v140
    v_mul_f32 v133, v133, v141
    v_mul_f32 v134, v134, v142
    v_mul_f32 v135, v135, v143
    v_fma_f32 v44, v44, v90, v90
    v_fma_f32 v45, v45, v90, v90
    v_fma_f32 v46, v46, v90, v90
    v_fma_f32 v47, v47, v90, v90
    v_rcp_f32 v44, v44
    s_barrier
    v_rcp_f32 v45, v45
    v_rcp_f32 v46, v46
    v_rcp_f32 v47, v47
    v_mul_f32 v132, v132, v44
    v_mul_f32 v133, v133, v45
    v_mul_f32 v134, v134, v46
    v_mul_f32 v135, v135, v47
    v_cvt_pk_bf16_f32 v54, v132, v133
    v_cvt_pk_bf16_f32 v55, v134, v135
    buffer_store_dwordx4 v[52:55], v27, s[32:35], s57 offen offset:0 sc1
    ds_read_b128 v[64:67], v30 offset:576
    ds_read_b128 v[68:71], v30 offset:608
    ds_read_b128 v[72:75], v30 offset:832
    ds_read_b128 v[76:79], v30 offset:864
    s_waitcnt lgkmcnt(0)
    v_fma_f32 v112, -v80, v64, v112
    v_fma_f32 v120, -v80, v72, v120
    v_fma_f32 v113, -v80, v65, v113
    v_fma_f32 v121, -v80, v73, v121
    v_fma_f32 v114, -v80, v66, v114
    v_fma_f32 v122, -v80, v74, v122
    v_fma_f32 v115, -v80, v67, v115
    v_fma_f32 v123, -v80, v75, v123
    v_mul_f32 v40, v112, v112
    v_mul_f32 v41, v113, v113
    s_barrier
    v_mul_f32 v42, v114, v114
    v_mul_f32 v43, v115, v115
    v_fma_f32 v40, v40, v83, v82
    v_fma_f32 v41, v41, v83, v82
    v_fma_f32 v42, v42, v83, v82
    v_fma_f32 v43, v43, v83, v82
    v_mul_f32 v40, v40, v112
    v_mul_f32 v41, v41, v113
    v_mul_f32 v42, v42, v114
    v_mul_f32 v43, v43, v115
    v_exp_f32 v40, v40
    v_exp_f32 v41, v41
    v_exp_f32 v42, v42
    v_exp_f32 v43, v43
    v_mul_f32 v112, v112, v120
    v_mul_f32 v113, v113, v121
    v_mul_f32 v114, v114, v122
    v_mul_f32 v115, v115, v123
    v_fma_f32 v40, v40, v84, v84
    v_fma_f32 v41, v41, v84, v84
    v_fma_f32 v42, v42, v84, v84
    v_fma_f32 v43, v43, v84, v84
    v_rcp_f32 v40, v40
    v_rcp_f32 v41, v41
    v_rcp_f32 v42, v42
    s_barrier
    v_rcp_f32 v43, v43
    v_mul_f32 v112, v112, v40
    v_mul_f32 v113, v113, v41
    v_mul_f32 v114, v114, v42
    v_mul_f32 v115, v115, v43
    v_cvt_pk_bf16_f32 v48, v112, v113
    v_cvt_pk_bf16_f32 v49, v114, v115
    v_fma_f32 v116, -v80, v68, v116
    v_fma_f32 v124, -v80, v76, v124
    v_fma_f32 v117, -v80, v69, v117
    v_fma_f32 v125, -v80, v77, v125
    v_fma_f32 v118, -v80, v70, v118
    v_fma_f32 v126, -v80, v78, v126
    v_fma_f32 v119, -v80, v71, v119
    v_fma_f32 v127, -v80, v79, v127
    v_mul_f32 v44, v116, v116
    v_mul_f32 v45, v117, v117
    v_mul_f32 v46, v118, v118
    v_mul_f32 v47, v119, v119
    v_fma_f32 v44, v44, v83, v82
    v_fma_f32 v45, v45, v83, v82
    v_fma_f32 v46, v46, v83, v82
    v_fma_f32 v47, v47, v83, v82
    v_mul_f32 v44, v44, v116
    v_mul_f32 v45, v45, v117
    v_mul_f32 v46, v46, v118
    v_mul_f32 v47, v47, v119
    v_exp_f32 v44, v44
    v_exp_f32 v45, v45
    s_barrier
    v_exp_f32 v46, v46
    v_exp_f32 v47, v47
    v_mul_f32 v116, v116, v124
    v_mul_f32 v117, v117, v125
    v_mul_f32 v118, v118, v126
    v_mul_f32 v119, v119, v127
    v_fma_f32 v44, v44, v84, v84
    v_fma_f32 v45, v45, v84, v84
    v_fma_f32 v46, v46, v84, v84
    v_fma_f32 v47, v47, v84, v84
    v_rcp_f32 v44, v44
    v_rcp_f32 v45, v45
    v_rcp_f32 v46, v46
    v_rcp_f32 v47, v47
    v_mul_f32 v116, v116, v44
    v_mul_f32 v117, v117, v45
    v_mul_f32 v118, v118, v46
    v_mul_f32 v119, v119, v47
    v_cvt_pk_bf16_f32 v50, v116, v117
    v_cvt_pk_bf16_f32 v51, v118, v119
    buffer_store_dwordx4 v[48:51], v27, s[32:35], s56 offen offset:1024 sc1
    v_fma_f32 v144, -v86, v64, v144
    v_fma_f32 v152, -v86, v72, v152
    v_fma_f32 v145, -v86, v65, v145
    v_fma_f32 v153, -v86, v73, v153
    v_fma_f32 v146, -v86, v66, v146
    s_barrier
    v_fma_f32 v154, -v86, v74, v154
    v_fma_f32 v147, -v86, v67, v147
    v_fma_f32 v155, -v86, v75, v155
    v_mul_f32 v40, v144, v144
    v_mul_f32 v41, v145, v145
    v_mul_f32 v42, v146, v146
    v_mul_f32 v43, v147, v147
    v_fma_f32 v40, v40, v89, v88
    v_fma_f32 v41, v41, v89, v88
    v_fma_f32 v42, v42, v89, v88
    v_fma_f32 v43, v43, v89, v88
    v_mul_f32 v40, v40, v144
    v_mul_f32 v41, v41, v145
    v_mul_f32 v42, v42, v146
    v_mul_f32 v43, v43, v147
    v_exp_f32 v40, v40
    v_exp_f32 v41, v41
    v_exp_f32 v42, v42
    v_exp_f32 v43, v43
    v_mul_f32 v144, v144, v152
    v_mul_f32 v145, v145, v153
    v_mul_f32 v146, v146, v154
    v_mul_f32 v147, v147, v155
    v_fma_f32 v40, v40, v90, v90
    v_fma_f32 v41, v41, v90, v90
    v_fma_f32 v42, v42, v90, v90
    v_fma_f32 v43, v43, v90, v90
    v_rcp_f32 v40, v40
    s_barrier
    v_rcp_f32 v41, v41
    v_rcp_f32 v42, v42
    v_rcp_f32 v43, v43
    v_mul_f32 v144, v144, v40
    v_mul_f32 v145, v145, v41
    v_mul_f32 v146, v146, v42
    v_mul_f32 v147, v147, v43
    v_cvt_pk_bf16_f32 v52, v144, v145
    v_cvt_pk_bf16_f32 v53, v146, v147
    v_fma_f32 v148, -v86, v68, v148
    v_fma_f32 v156, -v86, v76, v156
    v_fma_f32 v149, -v86, v69, v149
    v_fma_f32 v157, -v86, v77, v157
    v_fma_f32 v150, -v86, v70, v150
    v_fma_f32 v158, -v86, v78, v158
    v_fma_f32 v151, -v86, v71, v151
    v_fma_f32 v159, -v86, v79, v159
    v_mul_f32 v44, v148, v148
    v_mul_f32 v45, v149, v149
    v_mul_f32 v46, v150, v150
    v_mul_f32 v47, v151, v151
    v_fma_f32 v44, v44, v89, v88
    v_fma_f32 v45, v45, v89, v88
    v_fma_f32 v46, v46, v89, v88
    v_fma_f32 v47, v47, v89, v88
    v_mul_f32 v44, v44, v148
    v_mul_f32 v45, v45, v149
    v_mul_f32 v46, v46, v150
    s_barrier
    v_mul_f32 v47, v47, v151
    v_exp_f32 v44, v44
    v_exp_f32 v45, v45
    v_exp_f32 v46, v46
    v_exp_f32 v47, v47
    v_mul_f32 v148, v148, v156
    v_mul_f32 v149, v149, v157
    v_mul_f32 v150, v150, v158
    v_mul_f32 v151, v151, v159
    v_fma_f32 v44, v44, v90, v90
    v_fma_f32 v45, v45, v90, v90
    v_fma_f32 v46, v46, v90, v90
    v_fma_f32 v47, v47, v90, v90
    v_rcp_f32 v44, v44
    v_rcp_f32 v45, v45
    v_rcp_f32 v46, v46
    v_rcp_f32 v47, v47
    v_mul_f32 v148, v148, v44
    v_mul_f32 v149, v149, v45
    v_mul_f32 v150, v150, v46
    v_mul_f32 v151, v151, v47
    v_cvt_pk_bf16_f32 v54, v148, v149
    v_cvt_pk_bf16_f32 v55, v150, v151
    buffer_store_dwordx4 v[52:55], v27, s[32:35], s57 offen offset:1024 sc1
    s_barrier
    s_lshl_b32 s14, s36, 1
    s_add_u32 s14, s14, s40
    s_lshl_b32 s14, s14, 5
    s_and_b32 s15, s101, -2
    s_add_u32 s14, s14, s15
    s_add_u32 s14, s14, s41
    s_lshl_b32 s14, s14, 2
    s_and_b32 s15, s101, 1
    s_lshl_b32 s15, s15, 12
    s_add_u32 s14, s14, s15
    s_add_u32 s14, s14, 16789504
    s_waitcnt vmcnt(0)
    v_mov_b32 v1, s49
    v_mov_b32 v2, 0
    s_mov_b64 exec, 1
    buffer_store_dword v1, v2, s[32:35], s14 offen offset:0 sc1
    s_mov_b64 exec, -1
    s_branch L_P2poll
L_AF:
    s_mov_b32 s60, s37
    s_lshl_b32 s101, s37, 1
    s_mov_b32 s20, s6
    s_mov_b32 s21, s7
    s_mov_b32 s22, 1204224
    s_mov_b32 s23, 0x00020000
    s_and_b32 s14, s36, 7
    s_mul_i32 s14, s14, 150528
    s_and_b32 s15, s39, 0
    s_add_u32 s15, s15, s60
    s_lshl_b32 s15, s15, 7
    s_add_u32 s14, s14, s15
    v_min_u32 v1, 55, v0
    v_mul_u32_u24 v1, 2688, v1
    buffer_load_dword v39, v1, s[20:23], s14 offen
    s_and_b32 s40, s38, 1
    s_lshr_b32 s41, s39, 1
    s_mov_b32 s50, 0
    s_mov_b32 s51, -1
    v_and_b32 v7, 31, v0
    v_lshrrev_b32 v8, 5, v0
    v_bfe_u32 v9, v0, 1, 3
    v_xor_b32 v9, v9, v8
    v_lshlrev_b32 v9, 4, v9
    v_lshl_add_u32 v9, v7, 7, v9
    s_lshl_b32 s15, s40, 13
    v_add_u32 v16, s15, v9
    v_xor_b32 v17, 32, v16
    v_xor_b32 v18, 64, v16
    v_xor_b32 v19, 96, v16
    v_add_u32 v20, 0x10000, v16
    v_add_u32 v21, 0x10000, v17
    v_add_u32 v22, 0x10000, v18
    v_add_u32 v23, 0x10000, v19
    v_bfe_u32 v10, v0, 2, 2
    v_and_b32 v11, 3, v0
    v_bfe_u32 v12, v0, 4, 1
    v_bfe_u32 v13, v0, 3, 1
    v_lshlrev_b32 v13, 2, v13
    v_lshlrev_b32 v14, 10, v8
    v_lshl_add_u32 v14, v10, 7, v14
    v_add_u32 v14, 114688, v14
    v_lshl_add_u32 v2, v12, 2, v11
    s_lshl_b32 s15, s41, 3
    v_add_u32 v3, s15, v2
    v_lshrrev_b32 v1, 1, v3
    v_xor_b32 v1, v1, v13
    v_lshl_add_u32 v1, v1, 4, v14
    v_and_b32 v15, 1, v3
    v_lshl_add_u32 v26, v15, 3, v1
    v_lshrrev_b32 v1, 1, v11
    v_xor_b32 v1, v1, v13
    v_lshlrev_b32 v3, 1, v12
    v_xor_b32 v1, v1, v3
    s_lshl_b32 s14, s41, 2
    v_xor_b32 v1, s14, v1
    v_lshl_add_u32 v1, v1, 4, v14
    v_and_b32 v15, 1, v11
    v_lshl_add_u32 v1, v15, 3, v1
    v_lshl_add_u32 v35, v12, 12, v1
    v_xor_b32 v36, 32, v35
    s_lshl_b32 s14, s41, 7
    s_add_u32 s14, s14, 155648
    v_lshl_add_u32 v30, v8, 4, s14
    s_lshl_b32 s14, s41, 7
    s_add_u32 s14, s14, 155648
    v_lshl_add_u32 v31, v8, 4, s14
    s_lshl_b32 s14, s40, 8
    s_add_u32 s14, s14, 155648
    v_lshl_add_u32 v32, v7, 2, s14
    v_lshlrev_b32 v27, 4, v0
    v_lshlrev_b32 v28, 3, v7
    v_mov_b32 v29, v8
    s_mov_b32 s60, s37
    s_lshl_b32 s101, s37, 1
    s_and_b32 s3, s2, 7
    s_and_b32 s14, s78, 1
    s_lshl_b32 s74, s3, 1
    s_add_u32 s74, s74, s14
    s_lshr_b32 s75, s78, 1
    s_mul_i32 s14, s3, 29
    s_sub_u32 s15, s3, 4
    s_max_i32 s15, s15, 0
    s_add_u32 s14, s14, s15
    s_cmp_eq_u32 s3, 7
    s_cselect_b32 s14, 200, s14
    s_cmp_lt_u32 s3, 4
    s_cselect_b32 s15, 29, 30
    s_cmp_lt_u32 s3, 6
    s_cselect_b32 s15, s15, 24
    s_add_u32 s14, s14, s78
    s_mul_i32 s76, s14, 9363
    s_lshr_b32 s76, s76, 16
    s_mul_i32 s77, s76, 7
    s_sub_u32 s77, s14, s77
    s_cmp_ge_u32 s78, s15
    s_cselect_b32 s76, 32, s76
    s_mov_b32 s43, 0
    s_barrier
    s_setprio 2
    ds_read_b64_tr_b16 v[48:49], v26 offset:0
    ds_read_b64_tr_b16 v[50:51], v26 offset:512
    ds_read_b128 v[40:43], v16 offset:0
    ds_read_b128 v[44:47], v16 offset:4096
    ds_read_b64_tr_b16 v[60:61], v26 offset:2048
    ds_read_b64_tr_b16 v[62:63], v26 offset:2560
    ds_read_b128 v[52:55], v17 offset:0
    ds_read_b128 v[56:59], v17 offset:4096
    ds_read_b64_tr_b16 v[72:73], v26 offset:4096
    ds_read_b64_tr_b16 v[74:75], v26 offset:4608
    ds_read_b128 v[64:67], v18 offset:0
    ds_read_b128 v[68:71], v18 offset:4096
    s_waitcnt lgkmcnt(8)
    v_mfma_f32_32x32x16_bf16 v[96:111], v[48:51], v[40:43], 0
    ds_read_b64_tr_b16 v[84:85], v26 offset:6144
    ds_read_b64_tr_b16 v[86:87], v26 offset:6656
    ds_read_b128 v[76:79], v19 offset:0
    ds_read_b128 v[80:83], v19 offset:4096
    v_mfma_f32_32x32x16_bf16 v[128:143], v[48:51], v[44:47], 0
    s_barrier
    s_waitcnt lgkmcnt(8)
    v_mfma_f32_32x32x16_bf16 v[96:111], v[60:63], v[52:55], v[96:111]
    ds_read_b64_tr_b16 v[48:49], v26 offset:8192
    ds_read_b64_tr_b16 v[50:51], v26 offset:8704
    ds_read_b128 v[40:43], v16 offset:16384
    ds_read_b128 v[44:47], v16 offset:20480
    v_mfma_f32_32x32x16_bf16 v[128:143], v[60:63], v[56:59], v[128:143]
    s_waitcnt lgkmcnt(8)
    v_mfma_f32_32x32x16_bf16 v[96:111], v[72:75], v[64:67], v[96:111]
    ds_read_b64_tr_b16 v[60:61], v26 offset:10240
    ds_read_b64_tr_b16 v[62:63], v26 offset:10752
    ds_read_b128 v[52:55], v17 offset:16384
    ds_read_b128 v[56:59], v17 offset:20480
    v_mfma_f32_32x32x16_bf16 v[128:143], v[72:75], v[68:71], v[128:143]
    s_waitcnt lgkmcnt(8)
    v_mfma_f32_32x32x16_bf16 v[96:111], v[84:87], v[76:79], v[96:111]
    ds_read_b64_tr_b16 v[72:73], v26 offset:12288
    ds_read_b64_tr_b16 v[74:75], v26 offset:12800
    ds_read_b128 v[64:67], v18 offset:16384
    ds_read_b128 v[68:71], v18 offset:20480
    v_mfma_f32_32x32x16_bf16 v[128:143], v[84:87], v[80:83], v[128:143]
    s_waitcnt lgkmcnt(8)
    v_mfma_f32_32x32x16_bf16 v[96:111], v[48:51], v[40:43], v[96:111]
    ds_read_b64_tr_b16 v[84:85], v26 offset:14336
    ds_read_b64_tr_b16 v[86:87], v26 offset:14848
    ds_read_b128 v[76:79], v19 offset:16384
    ds_read_b128 v[80:83], v19 offset:20480
    v_mfma_f32_32x32x16_bf16 v[128:143], v[48:51], v[44:47], v[128:143]
    s_barrier
    s_waitcnt lgkmcnt(8)
    v_mfma_f32_32x32x16_bf16 v[96:111], v[60:63], v[52:55], v[96:111]
    ds_read_b64_tr_b16 v[48:49], v26 offset:16384
    ds_read_b64_tr_b16 v[50:51], v26 offset:16896
    ds_read_b128 v[40:43], v16 offset:32768
    ds_read_b128 v[44:47], v16 offset:36864
    v_mfma_f32_32x32x16_bf16 v[128:143], v[60:63], v[56:59], v[128:143]
    s_waitcnt lgkmcnt(8)
    v_mfma_f32_32x32x16_bf16 v[96:111], v[72:75], v[64:67], v[96:111]
    ds_read_b64_tr_b16 v[60:61], v26 offset:18432
    ds_read_b64_tr_b16 v[62:63], v26 offset:18944
    ds_read_b128 v[52:55], v17 offset:32768
    ds_read_b128 v[56:59], v17 offset:36864
    v_mfma_f32_32x32x16_bf16 v[128:143], v[72:75], v[68:71], v[128:143]
    s_waitcnt lgkmcnt(8)
    v_mfma_f32_32x32x16_bf16 v[96:111], v[84:87], v[76:79], v[96:111]
    ds_read_b64_tr_b16 v[72:73], v26 offset:20480
    ds_read_b64_tr_b16 v[74:75], v26 offset:20992
    ds_read_b128 v[64:67], v18 offset:32768
    ds_read_b128 v[68:71], v18 offset:36864
    v_mfma_f32_32x32x16_bf16 v[128:143], v[84:87], v[80:83], v[128:143]
    s_waitcnt lgkmcnt(8)
    v_mfma_f32_32x32x16_bf16 v[96:111], v[48:51], v[40:43], v[96:111]
    ds_read_b64_tr_b16 v[84:85], v26 offset:22528
    ds_read_b64_tr_b16 v[86:87], v26 offset:23040
    ds_read_b128 v[76:79], v19 offset:32768
    ds_read_b128 v[80:83], v19 offset:36864
    v_mfma_f32_32x32x16_bf16 v[128:143], v[48:51], v[44:47], v[128:143]
    s_barrier
    s_waitcnt lgkmcnt(8)
    v_mfma_f32_32x32x16_bf16 v[96:111], v[60:63], v[52:55], v[96:111]
    ds_read_b64_tr_b16 v[48:49], v26 offset:24576
    ds_read_b64_tr_b16 v[50:51], v26 offset:25088
    ds_read_b128 v[40:43], v16 offset:49152
    ds_read_b128 v[44:47], v16 offset:53248
    v_mfma_f32_32x32x16_bf16 v[128:143], v[60:63], v[56:59], v[128:143]
    s_waitcnt lgkmcnt(8)
    v_mfma_f32_32x32x16_bf16 v[96:111], v[72:75], v[64:67], v[96:111]
    ds_read_b64_tr_b16 v[60:61], v26 offset:26624
    ds_read_b64_tr_b16 v[62:63], v26 offset:27136
    ds_read_b128 v[52:55], v17 offset:49152
    ds_read_b128 v[56:59], v17 offset:53248
    v_mfma_f32_32x32x16_bf16 v[128:143], v[72:75], v[68:71], v[128:143]
    s_waitcnt lgkmcnt(8)
    v_mfma_f32_32x32x16_bf16 v[96:111], v[84:87], v[76:79], v[96:111]
    ds_read_b64_tr_b16 v[72:73], v26 offset:28672
    ds_read_b64_tr_b16 v[74:75], v26 offset:29184
    ds_read_b128 v[64:67], v18 offset:49152
    ds_read_b128 v[68:71], v18 offset:53248
    v_mfma_f32_32x32x16_bf16 v[128:143], v[84:87], v[80:83], v[128:143]
    s_waitcnt lgkmcnt(8)
    v_mfma_f32_32x32x16_bf16 v[96:111], v[48:51], v[40:43], v[96:111]
    ds_read_b64_tr_b16 v[84:85], v26 offset:30720
    ds_read_b64_tr_b16 v[86:87], v26 offset:31232
    ds_read_b128 v[76:79], v19 offset:49152
    ds_read_b128 v[80:83], v19 offset:53248
    v_mfma_f32_32x32x16_bf16 v[128:143], v[48:51], v[44:47], v[128:143]
    s_barrier
    s_waitcnt lgkmcnt(8)
    v_mfma_f32_32x32x16_bf16 v[96:111], v[60:63], v[52:55], v[96:111]
    ds_read_b64_tr_b16 v[48:49], v26 offset:32768
    ds_read_b64_tr_b16 v[50:51], v26 offset:33280
    ds_read_b128 v[40:43], v20 offset:0
    ds_read_b128 v[44:47], v20 offset:4096
    v_mfma_f32_32x32x16_bf16 v[128:143], v[60:63], v[56:59], v[128:143]
    s_waitcnt lgkmcnt(8)
    v_mfma_f32_32x32x16_bf16 v[96:111], v[72:75], v[64:67], v[96:111]
    ds_read_b64_tr_b16 v[60:61], v26 offset:34816
    ds_read_b64_tr_b16 v[62:63], v26 offset:35328
    ds_read_b128 v[52:55], v21 offset:0
    ds_read_b128 v[56:59], v21 offset:4096
    v_mfma_f32_32x32x16_bf16 v[128:143], v[72:75], v[68:71], v[128:143]
    s_waitcnt lgkmcnt(8)
    v_mfma_f32_32x32x16_bf16 v[96:111], v[84:87], v[76:79], v[96:111]
    ds_read_b64_tr_b16 v[72:73], v26 offset:36864
    ds_read_b64_tr_b16 v[74:75], v26 offset:37376
    ds_read_b128 v[64:67], v22 offset:0
    ds_read_b128 v[68:71], v22 offset:4096
    v_mfma_f32_32x32x16_bf16 v[128:143], v[84:87], v[80:83], v[128:143]
    s_waitcnt lgkmcnt(8)
    v_mfma_f32_32x32x16_bf16 v[96:111], v[48:51], v[40:43], v[96:111]
    ds_read_b64_tr_b16 v[84:85], v26 offset:38912
    ds_read_b64_tr_b16 v[86:87], v26 offset:39424
    ds_read_b128 v[76:79], v23 offset:0
    ds_read_b128 v[80:83], v23 offset:4096
    v_mfma_f32_32x32x16_bf16 v[128:143], v[48:51], v[44:47], v[128:143]
    s_barrier
    s_waitcnt lgkmcnt(8)
    v_mfma_f32_32x32x16_bf16 v[96:111], v[60:63], v[52:55], v[96:111]
    ds_read_b64_tr_b16 v[48:49], v26 offset:0
    ds_read_b64_tr_b16 v[50:51], v26 offset:512
    ds_read_b128 v[40:43], v20 offset:16384
    ds_read_b128 v[44:47], v20 offset:20480
    v_mfma_f32_32x32x16_bf16 v[128:143], v[60:63], v[56:59], v[128:143]
    s_waitcnt lgkmcnt(8)
    v_mfma_f32_32x32x16_bf16 v[96:111], v[72:75], v[64:67], v[96:111]
    ds_read_b64_tr_b16 v[60:61], v26 offset:2048
    ds_read_b64_tr_b16 v[62:63], v26 offset:2560
    ds_read_b128 v[52:55], v21 offset:16384
    ds_read_b128 v[56:59], v21 offset:20480
    v_mfma_f32_32x32x16_bf16 v[128:143], v[72:75], v[68:71], v[128:143]
    s_waitcnt lgkmcnt(8)
    v_mfma_f32_32x32x16_bf16 v[96:111], v[84:87], v[76:79], v[96:111]
    ds_read_b64_tr_b16 v[72:73], v26 offset:4096
    ds_read_b64_tr_b16 v[74:75], v26 offset:4608
    ds_read_b128 v[64:67], v22 offset:16384
    ds_read_b128 v[68:71], v22 offset:20480
    v_mfma_f32_32x32x16_bf16 v[128:143], v[84:87], v[80:83], v[128:143]
    s_waitcnt lgkmcnt(8)
    v_mfma_f32_32x32x16_bf16 v[96:111], v[48:51], v[40:43], v[96:111]
    ds_read_b64_tr_b16 v[84:85], v26 offset:6144
    ds_read_b64_tr_b16 v[86:87], v26 offset:6656
    ds_read_b128 v[76:79], v23 offset:16384
    ds_read_b128 v[80:83], v23 offset:20480
    v_mfma_f32_32x32x16_bf16 v[128:143], v[48:51], v[44:47], v[128:143]
    s_barrier
    s_waitcnt lgkmcnt(8)
    v_mfma_f32_32x32x16_bf16 v[96:111], v[60:63], v[52:55], v[96:111]
    ds_read_b64_tr_b16 v[48:49], v26 offset:8192
    ds_read_b64_tr_b16 v[50:51], v26 offset:8704
    ds_read_b128 v[40:43], v20 offset:32768
    ds_read_b128 v[44:47], v20 offset:36864
    v_mfma_f32_32x32x16_bf16 v[128:143], v[60:63], v[56:59], v[128:143]
    s_waitcnt lgkmcnt(8)
    v_mfma_f32_32x32x16_bf16 v[96:111], v[72:75], v[64:67], v[96:111]
    ds_read_b64_tr_b16 v[60:61], v26 offset:10240
    ds_read_b64_tr_b16 v[62:63], v26 offset:10752
    ds_read_b128 v[52:55], v21 offset:32768
    ds_read_b128 v[56:59], v21 offset:36864
    v_mfma_f32_32x32x16_bf16 v[128:143], v[72:75], v[68:71], v[128:143]
    s_waitcnt lgkmcnt(8)
    v_mfma_f32_32x32x16_bf16 v[96:111], v[84:87], v[76:79], v[96:111]
    ds_read_b64_tr_b16 v[72:73], v26 offset:12288
    ds_read_b64_tr_b16 v[74:75], v26 offset:12800
    ds_read_b128 v[64:67], v22 offset:32768
    ds_read_b128 v[68:71], v22 offset:36864
    v_mfma_f32_32x32x16_bf16 v[128:143], v[84:87], v[80:83], v[128:143]
    s_waitcnt lgkmcnt(8)
    v_mfma_f32_32x32x16_bf16 v[96:111], v[48:51], v[40:43], v[96:111]
    ds_read_b64_tr_b16 v[84:85], v26 offset:14336
    ds_read_b64_tr_b16 v[86:87], v26 offset:14848
    ds_read_b128 v[76:79], v23 offset:32768
    ds_read_b128 v[80:83], v23 offset:36864
    v_mfma_f32_32x32x16_bf16 v[128:143], v[48:51], v[44:47], v[128:143]
    s_barrier
    s_waitcnt lgkmcnt(8)
    v_mfma_f32_32x32x16_bf16 v[96:111], v[60:63], v[52:55], v[96:111]
    v_mfma_f32_32x32x16_bf16 v[128:143], v[60:63], v[56:59], v[128:143]
    s_waitcnt lgkmcnt(4)
    v_mfma_f32_32x32x16_bf16 v[96:111], v[72:75], v[64:67], v[96:111]
    v_mfma_f32_32x32x16_bf16 v[128:143], v[72:75], v[68:71], v[128:143]
    s_waitcnt lgkmcnt(0)
    v_mfma_f32_32x32x16_bf16 v[96:111], v[84:87], v[76:79], v[96:111]
    v_mfma_f32_32x32x16_bf16 v[128:143], v[84:87], v[80:83], v[128:143]
    s_setprio 0
    s_waitcnt vmcnt(0)
    s_barrier
    s_barrier
    s_barrier
    s_barrier
    v_lshlrev_b32 v44, 3, v0
    s_mul_i32 s11, s37, 3072
    s_add_u32 s11, s11, 16826368
    s_lshl_b32 s12, s39, 1
    s_sub_u32 s12, s12, 2
    s_add_u32 s13, s12, 1
    s_min_u32 s13, s13, 4
    s_lshl_b32 s14, s36, 10
    s_add_u32 s14, s14, 16809984
    s_add_u32 s15, s14, 512
    s_lshl_b32 s12, s12, 9
    s_lshl_b32 s13, s13, 9
    s_add_u32 s12, s12, s11
    s_add_u32 s13, s13, s11
    s_cmp_eq_u32 s39, 0
    s_cselect_b32 s56, s14, s12
    s_cselect_b32 s57, s15, s13
    s_lshl_b32 s14, s39, 9
    s_add_u32 s14, s14, 155648
    v_lshl_add_u32 v45, v0, 2, s14
    buffer_load_dwordx2 v[46:47], v44, s[32:35], s56 offen sc1
    buffer_load_dwordx2 v[48:49], v44, s[32:35], s57 offen sc1
    s_barrier
    s_barrier
    s_waitcnt vmcnt(0)
    v_cmp_ne_u32 vcc, s49, v47
    v_cmp_ne_u32 s[54:55], s49, v49
    s_or_b64 vcc, vcc, s[54:55]
    s_cbranch_vccz L_gF_ok
    s_mov_b32 s96, 200000
L_gF:
    buffer_load_dwordx2 v[46:47], v44, s[32:35], s56 offen sc1
    buffer_load_dwordx2 v[48:49], v44, s[32:35], s57 offen sc1
    s_waitcnt vmcnt(0)
    v_cmp_ne_u32 vcc, s49, v47
    v_cmp_ne_u32 s[54:55], s49, v49
    s_or_b64 vcc, vcc, s[54:55]
    s_cbranch_vccz L_gF_ok
    s_sleep 2
    s_sub_u32 s96, s96, 1
    s_cbranch_scc0 L_gF
L_gF_ok:
    ds_write_b32 v45, v46
    ds_write_b32 v45, v48 offset:256
    s_waitcnt lgkmcnt(0)
    s_barrier
    ds_read_b128 v[64:67], v31 offset:1536
    ds_read_b128 v[68:71], v31 offset:1568
    ds_read_b128 v[72:75], v31 offset:1600
    ds_read_b128 v[76:79], v31 offset:1632
    ds_read_b32 v81, v32 offset:0
    ds_read_b32 v87, v32 offset:128
    s_waitcnt lgkmcnt(0)
    v_lshlrev_b32 v80, 16, v81
    v_and_b32 v81, 0xffff0000, v81
    v_rcp_f32 v85, v81
    v_lshlrev_b32 v86, 16, v87
    v_and_b32 v87, 0xffff0000, v87
    v_rcp_f32 v91, v87
    s_add_u32 s54, s60, 0
    s_mov_b32 s55, s41
    s_mul_i32 s57, s54, 37
    s_lshr_b32 s57, s57, 8
    s_mul_i32 s14, s57, 7
    s_sub_u32 s14, s54, s14
    s_lshl_b32 s14, s14, 1
    s_add_u32 s14, s14, s55
    s_lshl_b32 s14, s14, 5
    s_getpc_b64 s[12:13]
L_tpf:
    s_add_u32 s14, s14, L_tab-L_tpf
    s_load_dwordx8 s[4:11], s[12:13], s14
    s_lshl_b32 s56, s57, 21
    s_lshl_b32 s54, s36, 1
    s_add_u32 s54, s54, s40
    s_lshl_b32 s54, s54, 12
    s_add_u32 s56, s56, s54
    s_cmp_eq_u32 s57, 0
    s_cselect_b32 s61, 0x3e8b97f6, 1.0
    s_cselect_b32 s14, 0, 0x3f80
    s_cmp_eq_u32 s57, 1
    s_cselect_b32 s14, 0x3f803f80, s14
    s_cselect_b32 s15, 0x3f80, 0
    v_mov_b32 v38, s14
    v_mov_b32 v39, s15
    v_mul_f32 v82, s61, v85
    v_fma_f32 v96, -v80, v64, v96
    v_fma_f32 v97, -v80, v65, v97
    s_barrier
    v_fma_f32 v98, -v80, v66, v98
    v_fma_f32 v99, -v80, v67, v99
    v_fma_f32 v100, -v80, v68, v100
    v_fma_f32 v101, -v80, v69, v101
    v_fma_f32 v102, -v80, v70, v102
    v_fma_f32 v103, -v80, v71, v103
    v_fma_f32 v104, -v80, v72, v104
    v_fma_f32 v105, -v80, v73, v105
    v_fma_f32 v106, -v80, v74, v106
    v_fma_f32 v107, -v80, v75, v107
    v_fma_f32 v108, -v80, v76, v108
    v_fma_f32 v109, -v80, v77, v109
    v_fma_f32 v110, -v80, v78, v110
    v_fma_f32 v111, -v80, v79, v111
    v_mul_f32 v96, v96, v82
    v_mul_f32 v97, v97, v82
    v_mul_f32 v98, v98, v82
    v_mul_f32 v99, v99, v82
    v_mul_f32 v100, v100, v82
    v_mul_f32 v101, v101, v82
    v_mul_f32 v102, v102, v82
    v_mul_f32 v103, v103, v82
    v_mul_f32 v104, v104, v82
    v_mul_f32 v105, v105, v82
    v_mul_f32 v106, v106, v82
    v_mul_f32 v107, v107, v82
    v_mul_f32 v108, v108, v82
    v_mul_f32 v109, v109, v82
    v_mul_f32 v110, v110, v82
    s_barrier
    v_mul_f32 v111, v111, v82
    v_cvt_pk_bf16_f32 v48, v96, v97
    v_cvt_pk_bf16_f32 v49, v98, v99
    v_cvt_pk_bf16_f32 v50, v100, v101
    v_cvt_pk_bf16_f32 v51, v102, v103
    v_cvt_pk_bf16_f32 v52, v104, v105
    v_cvt_pk_bf16_f32 v53, v106, v107
    v_cvt_pk_bf16_f32 v54, v108, v109
    v_cvt_pk_bf16_f32 v55, v110, v111
    v_mul_f32 v88, s61, v91
    v_fma_f32 v128, -v86, v64, v128
    v_fma_f32 v129, -v86, v65, v129
    v_fma_f32 v130, -v86, v66, v130
    v_fma_f32 v131, -v86, v67, v131
    v_fma_f32 v132, -v86, v68, v132
    v_fma_f32 v133, -v86, v69, v133
    v_fma_f32 v134, -v86, v70, v134
    v_fma_f32 v135, -v86, v71, v135
    v_fma_f32 v136, -v86, v72, v136
    v_fma_f32 v137, -v86, v73, v137
    v_fma_f32 v138, -v86, v74, v138
    v_fma_f32 v139, -v86, v75, v139
    v_fma_f32 v140, -v86, v76, v140
    v_fma_f32 v141, -v86, v77, v141
    v_fma_f32 v142, -v86, v78, v142
    v_fma_f32 v143, -v86, v79, v143
    v_mul_f32 v128, v128, v88
    v_mul_f32 v129, v129, v88
    v_mul_f32 v130, v130, v88
    s_barrier
    v_mul_f32 v131, v131, v88
    v_mul_f32 v132, v132, v88
    v_mul_f32 v133, v133, v88
    v_mul_f32 v134, v134, v88
    v_mul_f32 v135, v135, v88
    v_mul_f32 v136, v136, v88
    v_mul_f32 v137, v137, v88
    v_mul_f32 v138, v138, v88
    v_mul_f32 v139, v139, v88
    v_mul_f32 v140, v140, v88
    v_mul_f32 v141, v141, v88
    v_mul_f32 v142, v142, v88
    v_mul_f32 v143, v143, v88
    v_cvt_pk_bf16_f32 v56, v128, v129
    v_cvt_pk_bf16_f32 v57, v130, v131
    v_cvt_pk_bf16_f32 v58, v132, v133
    v_cvt_pk_bf16_f32 v59, v134, v135
    v_cvt_pk_bf16_f32 v60, v136, v137
    v_cvt_pk_bf16_f32 v61, v138, v139
    v_cvt_pk_bf16_f32 v62, v140, v141
    v_cvt_pk_bf16_f32 v63, v142, v143
    s_waitcnt lgkmcnt(0)
    s_and_b32 s14, s5, -8
    v_mul_i32_i24 v1, s14, v29
    v_add3_u32 v2, v1, s4, v28
    buffer_store_dwordx2 v[48:49], v2, s[32:35], s56 offen offset:0 sc1
    s_barrier
    buffer_store_dwordx2 v[56:57], v2, s[32:35], s56 offen offset:2048 sc1
    s_and_b32 s14, s5, 3
    s_cbranch_scc0 L_npf_0
    s_cmp_eq_u32 s14, 1
    s_cselect_b32 exec_lo, -1, 0
    s_cselect_b32 exec_hi, 0, -1
    buffer_store_dwordx2 v[38:39], v2, s[32:35], s56 offen offset:256 sc1
    buffer_store_dwordx2 v[38:39], v2, s[32:35], s56 offen offset:2304 sc1
    s_mov_b64 exec, -1
L_npf_0:
    s_and_b32 s14, s7, -8
    v_mul_i32_i24 v1, s14, v29
    v_add3_u32 v2, v1, s6, v28
    buffer_store_dwordx2 v[50:51], v2, s[32:35], s56 offen offset:0 sc1
    buffer_store_dwordx2 v[58:59], v2, s[32:35], s56 offen offset:2048 sc1
    s_and_b32 s14, s7, 3
    s_cbranch_scc0 L_npf_1
    s_cmp_eq_u32 s14, 1
    s_cselect_b32 exec_lo, -1, 0
    s_cselect_b32 exec_hi, 0, -1
    buffer_store_dwordx2 v[38:39], v2, s[32:35], s56 offen offset:256 sc1
    buffer_store_dwordx2 v[38:39], v2, s[32:35], s56 offen offset:2304 sc1
    s_mov_b64 exec, -1
L_npf_1:
    s_and_b32 s14, s9, -8
    v_mul_i32_i24 v1, s14, v29
    v_add3_u32 v2, v1, s8, v28
    buffer_store_dwordx2 v[52:53], v2, s[32:35], s56 offen offset:0 sc1
    buffer_store_dwordx2 v[60:61], v2, s[32:35], s56 offen offset:2048 sc1
    s_and_b32 s14, s9, 3
    s_cbranch_scc0 L_npf_2
    s_cmp_eq_u32 s14, 1
    s_cselect_b32 exec_lo, -1, 0
    s_cselect_b32 exec_hi, 0, -1
    buffer_store_dwordx2 v[38:39], v2, s[32:35], s56 offen offset:256 sc1
    buffer_store_dwordx2 v[38:39], v2, s[32:35], s56 offen offset:2304 sc1
    s_mov_b64 exec, -1
L_npf_2:
    s_and_b32 s14, s11, -8
    v_mul_i32_i24 v1, s14, v29
    v_add3_u32 v2, v1, s10, v28
    buffer_store_dwordx2 v[54:55], v2, s[32:35], s56 offen offset:0 sc1
    buffer_store_dwordx2 v[62:63], v2, s[32:35], s56 offen offset:2048 sc1
    s_and_b32 s14, s11, 3
    s_cbranch_scc0 L_npf_3
    s_cmp_eq_u32 s14, 1
    s_cselect_b32 exec_lo, -1, 0
    s_cselect_b32 exec_hi, 0, -1
    buffer_store_dwordx2 v[38:39], v2, s[32:35], s56 offen offset:256 sc1
    buffer_store_dwordx2 v[38:39], v2, s[32:35], s56 offen offset:2304 sc1
    s_mov_b64 exec, -1
L_npf_3:
    s_barrier
    s_barrier
    s_barrier
    s_setprio 2
    ds_read_b64_tr_b16 v[48:49], v35 offset:8192
    ds_read_b64_tr_b16 v[50:51], v35 offset:8704
    ds_read_b128 v[40:43], v16 offset:0
    ds_read_b128 v[44:47], v16 offset:4096
    ds_read_b64_tr_b16 v[52:53], v36 offset:8192
    ds_read_b64_tr_b16 v[54:55], v36 offset:8704
    ds_read_b64_tr_b16 v[64:65], v35 offset:10240
    ds_read_b64_tr_b16 v[66:67], v35 offset:10752
    ds_read_b128 v[56:59], v17 offset:0
    ds_read_b128 v[60:63], v17 offset:4096
    ds_read_b64_tr_b16 v[68:69], v36 offset:10240
    ds_read_b64_tr_b16 v[70:71], v36 offset:10752
    s_waitcnt lgkmcnt(8)
    v_mfma_f32_32x32x16_bf16 v[96:111], v[48:51], v[40:43], 0
    v_mfma_f32_32x32x16_bf16 v[128:143], v[48:51], v[44:47], 0
    s_barrier
    s_waitcnt lgkmcnt(6)
    v_mfma_f32_32x32x16_bf16 v[112:127], v[52:55], v[40:43], 0
    ds_read_b64_tr_b16 v[80:81], v35 offset:16384
    ds_read_b64_tr_b16 v[82:83], v35 offset:16896
    ds_read_b128 v[72:75], v18 offset:0
    ds_read_b128 v[76:79], v18 offset:4096
    v_mfma_f32_32x32x16_bf16 v[144:159], v[52:55], v[44:47], 0
    ds_read_b64_tr_b16 v[84:85], v36 offset:16384
    ds_read_b64_tr_b16 v[86:87], v36 offset:16896
    s_waitcnt lgkmcnt(8)
    v_mfma_f32_32x32x16_bf16 v[96:111], v[64:67], v[56:59], v[96:111]
    ds_read_b64_tr_b16 v[48:49], v35 offset:18432
    ds_read_b64_tr_b16 v[50:51], v35 offset:18944
    v_mfma_f32_32x32x16_bf16 v[128:143], v[64:67], v[60:63], v[128:143]
    ds_read_b128 v[40:43], v19 offset:0
    ds_read_b128 v[44:47], v19 offset:4096
    s_waitcnt lgkmcnt(10)
    v_mfma_f32_32x32x16_bf16 v[112:127], v[68:71], v[56:59], v[112:127]
    ds_read_b64_tr_b16 v[52:53], v36 offset:18432
    ds_read_b64_tr_b16 v[54:55], v36 offset:18944
    v_mfma_f32_32x32x16_bf16 v[144:159], v[68:71], v[60:63], v[144:159]
    s_waitcnt lgkmcnt(8)
    v_mfma_f32_32x32x16_bf16 v[96:111], v[80:83], v[72:75], v[96:111]
    v_mfma_f32_32x32x16_bf16 v[128:143], v[80:83], v[76:79], v[128:143]
    s_barrier
    s_waitcnt lgkmcnt(6)
    v_mfma_f32_32x32x16_bf16 v[112:127], v[84:87], v[72:75], v[112:127]
    ds_read_b64_tr_b16 v[64:65], v35 offset:24576
    ds_read_b64_tr_b16 v[66:67], v35 offset:25088
    ds_read_b128 v[56:59], v16 offset:16384
    ds_read_b128 v[60:63], v16 offset:20480
    v_mfma_f32_32x32x16_bf16 v[144:159], v[84:87], v[76:79], v[144:159]
    ds_read_b64_tr_b16 v[68:69], v36 offset:24576
    ds_read_b64_tr_b16 v[70:71], v36 offset:25088
    s_waitcnt lgkmcnt(8)
    v_mfma_f32_32x32x16_bf16 v[96:111], v[48:51], v[40:43], v[96:111]
    ds_read_b64_tr_b16 v[80:81], v35 offset:26624
    ds_read_b64_tr_b16 v[82:83], v35 offset:27136
    v_mfma_f32_32x32x16_bf16 v[128:143], v[48:51], v[44:47], v[128:143]
    ds_read_b128 v[72:75], v17 offset:16384
    ds_read_b128 v[76:79], v17 offset:20480
    s_waitcnt lgkmcnt(10)
    v_mfma_f32_32x32x16_bf16 v[112:127], v[52:55], v[40:43], v[112:127]
    ds_read_b64_tr_b16 v[84:85], v36 offset:26624
    ds_read_b64_tr_b16 v[86:87], v36 offset:27136
    v_mfma_f32_32x32x16_bf16 v[144:159], v[52:55], v[44:47], v[144:159]
    s_add_u32 s14, s60, 0
    s_lshl_b32 s14, s14, 4
    s_add_u32 s14, s14, s36
    s_lshl_b32 s14, s14, 2
    s_add_u32 s14, s14, s39
    s_lshl_b32 s14, s14, 2
    s_add_u32 s14, s14, 16781312
    s_waitcnt vmcnt(0)
    v_mov_b32 v1, s49
    v_mov_b32 v2, 0
    s_mov_b64 exec, 1
    buffer_store_dword v1, v2, s[32:35], s14 offen offset:0 sc1
    s_mov_b64 exec, -1
    s_waitcnt lgkmcnt(8)
    v_mfma_f32_32x32x16_bf16 v[96:111], v[64:67], v[56:59], v[96:111]
    v_mfma_f32_32x32x16_bf16 v[128:143], v[64:67], v[60:63], v[128:143]
    s_barrier
    s_waitcnt lgkmcnt(6)
    v_mfma_f32_32x32x16_bf16 v[112:127], v[68:71], v[56:59], v[112:127]
    ds_read_b64_tr_b16 v[48:49], v35 offset:32768
    ds_read_b64_tr_b16 v[50:51], v35 offset:33280
    ds_read_b128 v[40:43], v18 offset:16384
    ds_read_b128 v[44:47], v18 offset:20480
    v_mfma_f32_32x32x16_bf16 v[144:159], v[68:71], v[60:63], v[144:159]
    ds_read_b64_tr_b16 v[52:53], v36 offset:32768
    ds_read_b64_tr_b16 v[54:55], v36 offset:33280
    s_waitcnt lgkmcnt(8)
    v_mfma_f32_32x32x16_bf16 v[96:111], v[80:83], v[72:75], v[96:111]
    ds_read_b64_tr_b16 v[64:65], v35 offset:34816
    ds_read_b64_tr_b16 v[66:67], v35 offset:35328
    v_mfma_f32_32x32x16_bf16 v[128:143], v[80:83], v[76:79], v[128:143]
    ds_read_b128 v[56:59], v19 offset:16384
    ds_read_b128 v[60:63], v19 offset:20480
    s_waitcnt lgkmcnt(10)
    v_mfma_f32_32x32x16_bf16 v[112:127], v[84:87], v[72:75], v[112:127]
    ds_read_b64_tr_b16 v[68:69], v36 offset:34816
    ds_read_b64_tr_b16 v[70:71], v36 offset:35328
    v_mfma_f32_32x32x16_bf16 v[144:159], v[84:87], v[76:79], v[144:159]
    s_waitcnt lgkmcnt(8)
    v_mfma_f32_32x32x16_bf16 v[96:111], v[48:51], v[40:43], v[96:111]
    v_mfma_f32_32x32x16_bf16 v[128:143], v[48:51], v[44:47], v[128:143]
    s_barrier
    s_waitcnt lgkmcnt(6)
    v_mfma_f32_32x32x16_bf16 v[112:127], v[52:55], v[40:43], v[112:127]
    ds_read_b64_tr_b16 v[80:81], v35 offset:0
    ds_read_b64_tr_b16 v[82:83], v35 offset:512
    ds_read_b128 v[72:75], v16 offset:32768
    ds_read_b128 v[76:79], v16 offset:36864
    v_mfma_f32_32x32x16_bf16 v[144:159], v[52:55], v[44:47], v[144:159]
    ds_read_b64_tr_b16 v[84:85], v36 offset:0
    ds_read_b64_tr_b16 v[86:87], v36 offset:512
    s_waitcnt lgkmcnt(8)
    v_mfma_f32_32x32x16_bf16 v[96:111], v[64:67], v[56:59], v[96:111]
    ds_read_b64_tr_b16 v[48:49], v35 offset:2048
    ds_read_b64_tr_b16 v[50:51], v35 offset:2560
    v_mfma_f32_32x32x16_bf16 v[128:143], v[64:67], v[60:63], v[128:143]
    ds_read_b128 v[40:43], v17 offset:32768
    ds_read_b128 v[44:47], v17 offset:36864
    s_waitcnt lgkmcnt(10)
    v_mfma_f32_32x32x16_bf16 v[112:127], v[68:71], v[56:59], v[112:127]
    ds_read_b64_tr_b16 v[52:53], v36 offset:2048
    ds_read_b64_tr_b16 v[54:55], v36 offset:2560
    v_mfma_f32_32x32x16_bf16 v[144:159], v[68:71], v[60:63], v[144:159]
    s_waitcnt lgkmcnt(8)
    v_mfma_f32_32x32x16_bf16 v[96:111], v[80:83], v[72:75], v[96:111]
    v_mfma_f32_32x32x16_bf16 v[128:143], v[80:83], v[76:79], v[128:143]
    s_barrier
    s_waitcnt lgkmcnt(6)
    v_mfma_f32_32x32x16_bf16 v[112:127], v[84:87], v[72:75], v[112:127]
    ds_read_b64_tr_b16 v[64:65], v35 offset:8192
    ds_read_b64_tr_b16 v[66:67], v35 offset:8704
    ds_read_b128 v[56:59], v18 offset:32768
    ds_read_b128 v[60:63], v18 offset:36864
    v_mfma_f32_32x32x16_bf16 v[144:159], v[84:87], v[76:79], v[144:159]
    ds_read_b64_tr_b16 v[68:69], v36 offset:8192
    ds_read_b64_tr_b16 v[70:71], v36 offset:8704
    s_waitcnt lgkmcnt(8)
    v_mfma_f32_32x32x16_bf16 v[96:111], v[48:51], v[40:43], v[96:111]
    ds_read_b64_tr_b16 v[80:81], v35 offset:10240
    ds_read_b64_tr_b16 v[82:83], v35 offset:10752
    v_mfma_f32_32x32x16_bf16 v[128:143], v[48:51], v[44:47], v[128:143]
    ds_read_b128 v[72:75], v19 offset:32768
    ds_read_b128 v[76:79], v19 offset:36864
    s_waitcnt lgkmcnt(10)
    v_mfma_f32_32x32x16_bf16 v[112:127], v[52:55], v[40:43], v[112:127]
    ds_read_b64_tr_b16 v[84:85], v36 offset:10240
    ds_read_b64_tr_b16 v[86:87], v36 offset:10752
    v_mfma_f32_32x32x16_bf16 v[144:159], v[52:55], v[44:47], v[144:159]
    s_waitcnt lgkmcnt(8)
    v_mfma_f32_32x32x16_bf16 v[96:111], v[64:67], v[56:59], v[96:111]
    v_mfma_f32_32x32x16_bf16 v[128:143], v[64:67], v[60:63], v[128:143]
    s_barrier
    s_waitcnt lgkmcnt(6)
    v_mfma_f32_32x32x16_bf16 v[112:127], v[68:71], v[56:59], v[112:127]
    ds_read_b64_tr_b16 v[48:49], v35 offset:16384
    ds_read_b64_tr_b16 v[50:51], v35 offset:16896
    ds_read_b128 v[40:43], v16 offset:49152
    ds_read_b128 v[44:47], v16 offset:53248
    v_mfma_f32_32x32x16_bf16 v[144:159], v[68:71], v[60:63], v[144:159]
    ds_read_b64_tr_b16 v[52:53], v36 offset:16384
    ds_read_b64_tr_b16 v[54:55], v36 offset:16896
    s_waitcnt lgkmcnt(8)
    v_mfma_f32_32x32x16_bf16 v[96:111], v[80:83], v[72:75], v[96:111]
    ds_read_b64_tr_b16 v[64:65], v35 offset:18432
    ds_read_b64_tr_b16 v[66:67], v35 offset:18944
    v_mfma_f32_32x32x16_bf16 v[128:143], v[80:83], v[76:79], v[128:143]
    ds_read_b128 v[56:59], v17 offset:49152
    ds_read_b128 v[60:63], v17 offset:53248
    s_waitcnt lgkmcnt(10)
    v_mfma_f32_32x32x16_bf16 v[112:127], v[84:87], v[72:75], v[112:127]
    ds_read_b64_tr_b16 v[68:69], v36 offset:18432
    ds_read_b64_tr_b16 v[70:71], v36 offset:18944
    v_mfma_f32_32x32x16_bf16 v[144:159], v[84:87], v[76:79], v[144:159]
    s_waitcnt lgkmcnt(8)
    v_mfma_f32_32x32x16_bf16 v[96:111], v[48:51], v[40:43], v[96:111]
    v_mfma_f32_32x32x16_bf16 v[128:143], v[48:51], v[44:47], v[128:143]
    s_barrier
    s_waitcnt lgkmcnt(6)
    v_mfma_f32_32x32x16_bf16 v[112:127], v[52:55], v[40:43], v[112:127]
    ds_read_b64_tr_b16 v[80:81], v35 offset:24576
    ds_read_b64_tr_b16 v[82:83], v35 offset:25088
    ds_read_b128 v[72:75], v18 offset:49152
    ds_read_b128 v[76:79], v18 offset:53248
    v_mfma_f32_32x32x16_bf16 v[144:159], v[52:55], v[44:47], v[144:159]
    ds_read_b64_tr_b16 v[84:85], v36 offset:24576
    ds_read_b64_tr_b16 v[86:87], v36 offset:25088
    s_waitcnt lgkmcnt(8)
    v_mfma_f32_32x32x16_bf16 v[96:111], v[64:67], v[56:59], v[96:111]
    ds_read_b64_tr_b16 v[48:49], v35 offset:26624
    ds_read_b64_tr_b16 v[50:51], v35 offset:27136
    v_mfma_f32_32x32x16_bf16 v[128:143], v[64:67], v[60:63], v[128:143]
    ds_read_b128 v[40:43], v19 offset:49152
    ds_read_b128 v[44:47], v19 offset:53248
    s_waitcnt lgkmcnt(10)
    v_mfma_f32_32x32x16_bf16 v[112:127], v[68:71], v[56:59], v[112:127]
    ds_read_b64_tr_b16 v[52:53], v36 offset:26624
    ds_read_b64_tr_b16 v[54:55], v36 offset:27136
    v_mfma_f32_32x32x16_bf16 v[144:159], v[68:71], v[60:63], v[144:159]
    s_waitcnt lgkmcnt(8)
    v_mfma_f32_32x32x16_bf16 v[96:111], v[80:83], v[72:75], v[96:111]
    v_mfma_f32_32x32x16_bf16 v[128:143], v[80:83], v[76:79], v[128:143]
    s_barrier
    s_waitcnt lgkmcnt(6)
    v_mfma_f32_32x32x16_bf16 v[112:127], v[84:87], v[72:75], v[112:127]
    ds_read_b64_tr_b16 v[64:65], v35 offset:32768
    ds_read_b64_tr_b16 v[66:67], v35 offset:33280
    ds_read_b128 v[56:59], v20 offset:0
    ds_read_b128 v[60:63], v20 offset:4096
    v_mfma_f32_32x32x16_bf16 v[144:159], v[84:87], v[76:79], v[144:159]
    ds_read_b64_tr_b16 v[68:69], v36 offset:32768
    ds_read_b64_tr_b16 v[70:71], v36 offset:33280
    s_waitcnt lgkmcnt(8)
    v_mfma_f32_32x32x16_bf16 v[96:111], v[48:51], v[40:43], v[96:111]
    ds_read_b64_tr_b16 v[80:81], v35 offset:34816
    ds_read_b64_tr_b16 v[82:83], v35 offset:35328
    v_mfma_f32_32x32x16_bf16 v[128:143], v[48:51], v[44:47], v[128:143]
    ds_read_b128 v[72:75], v21 offset:0
    ds_read_b128 v[76:79], v21 offset:4096
    s_waitcnt lgkmcnt(10)
    v_mfma_f32_32x32x16_bf16 v[112:127], v[52:55], v[40:43], v[112:127]
    ds_read_b64_tr_b16 v[84:85], v36 offset:34816
    ds_read_b64_tr_b16 v[86:87], v36 offset:35328
    v_mfma_f32_32x32x16_bf16 v[144:159], v[52:55], v[44:47], v[144:159]
    s_waitcnt lgkmcnt(8)
    v_mfma_f32_32x32x16_bf16 v[96:111], v[64:67], v[56:59], v[96:111]
    v_mfma_f32_32x32x16_bf16 v[128:143], v[64:67], v[60:63], v[128:143]
    s_barrier
    s_waitcnt lgkmcnt(6)
    v_mfma_f32_32x32x16_bf16 v[112:127], v[68:71], v[56:59], v[112:127]
    ds_read_b64_tr_b16 v[48:49], v35 offset:0
    ds_read_b64_tr_b16 v[50:51], v35 offset:512
    ds_read_b128 v[40:43], v22 offset:0
    ds_read_b128 v[44:47], v22 offset:4096
    v_mfma_f32_32x32x16_bf16 v[144:159], v[68:71], v[60:63], v[144:159]
    ds_read_b64_tr_b16 v[52:53], v36 offset:0
    ds_read_b64_tr_b16 v[54:55], v36 offset:512
    s_waitcnt lgkmcnt(8)
    v_mfma_f32_32x32x16_bf16 v[96:111], v[80:83], v[72:75], v[96:111]
    ds_read_b64_tr_b16 v[64:65], v35 offset:2048
    ds_read_b64_tr_b16 v[66:67], v35 offset:2560
    v_mfma_f32_32x32x16_bf16 v[128:143], v[80:83], v[76:79], v[128:143]
    ds_read_b128 v[56:59], v23 offset:0
    ds_read_b128 v[60:63], v23 offset:4096
    s_waitcnt lgkmcnt(10)
    v_mfma_f32_32x32x16_bf16 v[112:127], v[84:87], v[72:75], v[112:127]
    ds_read_b64_tr_b16 v[68:69], v36 offset:2048
    ds_read_b64_tr_b16 v[70:71], v36 offset:2560
    v_mfma_f32_32x32x16_bf16 v[144:159], v[84:87], v[76:79], v[144:159]
    s_waitcnt lgkmcnt(8)
    v_mfma_f32_32x32x16_bf16 v[96:111], v[48:51], v[40:43], v[96:111]
    v_mfma_f32_32x32x16_bf16 v[128:143], v[48:51], v[44:47], v[128:143]
    s_barrier
    s_waitcnt lgkmcnt(6)
    v_mfma_f32_32x32x16_bf16 v[112:127], v[52:55], v[40:43], v[112:127]
    ds_read_b64_tr_b16 v[80:81], v35 offset:8192
    ds_read_b64_tr_b16 v[82:83], v35 offset:8704
    ds_read_b128 v[72:75], v20 offset:16384
    ds_read_b128 v[76:79], v20 offset:20480
    v_mfma_f32_32x32x16_bf16 v[144:159], v[52:55], v[44:47], v[144:159]
    ds_read_b64_tr_b16 v[84:85], v36 offset:8192
    ds_read_b64_tr_b16 v[86:87], v36 offset:8704
    s_waitcnt lgkmcnt(8)
    v_mfma_f32_32x32x16_bf16 v[96:111], v[64:67], v[56:59], v[96:111]
    ds_read_b64_tr_b16 v[48:49], v35 offset:10240
    ds_read_b64_tr_b16 v[50:51], v35 offset:10752
    v_mfma_f32_32x32x16_bf16 v[128:143], v[64:67], v[60:63], v[128:143]
    ds_read_b128 v[40:43], v21 offset:16384
    ds_read_b128 v[44:47], v21 offset:20480
    s_waitcnt lgkmcnt(10)
    v_mfma_f32_32x32x16_bf16 v[112:127], v[68:71], v[56:59], v[112:127]
    ds_read_b64_tr_b16 v[52:53], v36 offset:10240
    ds_read_b64_tr_b16 v[54:55], v36 offset:10752
    v_mfma_f32_32x32x16_bf16 v[144:159], v[68:71], v[60:63], v[144:159]
    s_waitcnt lgkmcnt(8)
    v_mfma_f32_32x32x16_bf16 v[96:111], v[80:83], v[72:75], v[96:111]
    v_mfma_f32_32x32x16_bf16 v[128:143], v[80:83], v[76:79], v[128:143]
    s_barrier
    s_waitcnt lgkmcnt(6)
    v_mfma_f32_32x32x16_bf16 v[112:127], v[84:87], v[72:75], v[112:127]
    ds_read_b64_tr_b16 v[64:65], v35 offset:16384
    ds_read_b64_tr_b16 v[66:67], v35 offset:16896
    ds_read_b128 v[56:59], v22 offset:16384
    ds_read_b128 v[60:63], v22 offset:20480
    v_mfma_f32_32x32x16_bf16 v[144:159], v[84:87], v[76:79], v[144:159]
    ds_read_b64_tr_b16 v[68:69], v36 offset:16384
    ds_read_b64_tr_b16 v[70:71], v36 offset:16896
    s_waitcnt lgkmcnt(8)
    v_mfma_f32_32x32x16_bf16 v[96:111], v[48:51], v[40:43], v[96:111]
    ds_read_b64_tr_b16 v[80:81], v35 offset:18432
    ds_read_b64_tr_b16 v[82:83], v35 offset:18944
    v_mfma_f32_32x32x16_bf16 v[128:143], v[48:51], v[44:47], v[128:143]
    ds_read_b128 v[72:75], v23 offset:16384
    ds_read_b128 v[76:79], v23 offset:20480
    s_waitcnt lgkmcnt(10)
    v_mfma_f32_32x32x16_bf16 v[112:127], v[52:55], v[40:43], v[112:127]
    ds_read_b64_tr_b16 v[84:85], v36 offset:18432
    ds_read_b64_tr_b16 v[86:87], v36 offset:18944
    v_mfma_f32_32x32x16_bf16 v[144:159], v[52:55], v[44:47], v[144:159]
    s_waitcnt lgkmcnt(8)
    v_mfma_f32_32x32x16_bf16 v[96:111], v[64:67], v[56:59], v[96:111]
    v_mfma_f32_32x32x16_bf16 v[128:143], v[64:67], v[60:63], v[128:143]
    s_barrier
    s_waitcnt lgkmcnt(6)
    v_mfma_f32_32x32x16_bf16 v[112:127], v[68:71], v[56:59], v[112:127]
    ds_read_b64_tr_b16 v[48:49], v35 offset:24576
    ds_read_b64_tr_b16 v[50:51], v35 offset:25088
    ds_read_b128 v[40:43], v20 offset:32768
    ds_read_b128 v[44:47], v20 offset:36864
    v_mfma_f32_32x32x16_bf16 v[144:159], v[68:71], v[60:63], v[144:159]
    ds_read_b64_tr_b16 v[52:53], v36 offset:24576
    ds_read_b64_tr_b16 v[54:55], v36 offset:25088
    s_waitcnt lgkmcnt(8)
    v_mfma_f32_32x32x16_bf16 v[96:111], v[80:83], v[72:75], v[96:111]
    ds_read_b64_tr_b16 v[64:65], v35 offset:26624
    ds_read_b64_tr_b16 v[66:67], v35 offset:27136
    v_mfma_f32_32x32x16_bf16 v[128:143], v[80:83], v[76:79], v[128:143]
    ds_read_b128 v[56:59], v21 offset:32768
    ds_read_b128 v[60:63], v21 offset:36864
    s_waitcnt lgkmcnt(10)
    v_mfma_f32_32x32x16_bf16 v[112:127], v[84:87], v[72:75], v[112:127]
    ds_read_b64_tr_b16 v[68:69], v36 offset:26624
    ds_read_b64_tr_b16 v[70:71], v36 offset:27136
    v_mfma_f32_32x32x16_bf16 v[144:159], v[84:87], v[76:79], v[144:159]
    s_waitcnt lgkmcnt(8)
    v_mfma_f32_32x32x16_bf16 v[96:111], v[48:51], v[40:43], v[96:111]
    v_mfma_f32_32x32x16_bf16 v[128:143], v[48:51], v[44:47], v[128:143]
    s_barrier
    s_waitcnt lgkmcnt(6)
    v_mfma_f32_32x32x16_bf16 v[112:127], v[52:55], v[40:43], v[112:127]
    ds_read_b64_tr_b16 v[80:81], v35 offset:32768
    ds_read_b64_tr_b16 v[82:83], v35 offset:33280
    ds_read_b128 v[72:75], v22 offset:32768
    ds_read_b128 v[76:79], v22 offset:36864
    v_mfma_f32_32x32x16_bf16 v[144:159], v[52:55], v[44:47], v[144:159]
    ds_read_b64_tr_b16 v[84:85], v36 offset:32768
    ds_read_b64_tr_b16 v[86:87], v36 offset:33280
    s_waitcnt lgkmcnt(8)
    v_mfma_f32_32x32x16_bf16 v[96:111], v[64:67], v[56:59], v[96:111]
    ds_read_b64_tr_b16 v[48:49], v35 offset:34816
    ds_read_b64_tr_b16 v[50:51], v35 offset:35328
    v_mfma_f32_32x32x16_bf16 v[128:143], v[64:67], v[60:63], v[128:143]
    ds_read_b128 v[40:43], v23 offset:32768
    ds_read_b128 v[44:47], v23 offset:36864
    s_waitcnt lgkmcnt(10)
    v_mfma_f32_32x32x16_bf16 v[112:127], v[68:71], v[56:59], v[112:127]
    ds_read_b64_tr_b16 v[52:53], v36 offset:34816
    ds_read_b64_tr_b16 v[54:55], v36 offset:35328
    v_mfma_f32_32x32x16_bf16 v[144:159], v[68:71], v[60:63], v[144:159]
    s_waitcnt lgkmcnt(8)
    v_mfma_f32_32x32x16_bf16 v[96:111], v[80:83], v[72:75], v[96:111]
    v_mfma_f32_32x32x16_bf16 v[128:143], v[80:83], v[76:79], v[128:143]
    s_waitcnt lgkmcnt(0)
    s_barrier
    v_mfma_f32_32x32x16_bf16 v[112:127], v[84:87], v[72:75], v[112:127]
    v_mfma_f32_32x32x16_bf16 v[144:159], v[84:87], v[76:79], v[144:159]
    v_mfma_f32_32x32x16_bf16 v[96:111], v[48:51], v[40:43], v[96:111]
    v_mfma_f32_32x32x16_bf16 v[128:143], v[48:51], v[44:47], v[128:143]
    v_mfma_f32_32x32x16_bf16 v[112:127], v[52:55], v[40:43], v[112:127]
    v_mfma_f32_32x32x16_bf16 v[144:159], v[52:55], v[44:47], v[144:159]
    s_setprio 0
    s_mov_b32 s79, 0
    s_lshl_b32 s54, s36, 1
    s_add_u32 s54, s54, s40
    s_mul_i32 s54, s54, 229376
    s_lshl_b32 s55, s101, 1
    s_add_u32 s55, s55, s41
    s_lshl_b32 s55, s55, 11
    s_add_u32 s55, s55, 6295552
    s_add_u32 s56, s54, s55
    s_add_u32 s57, s56, 114688
    ds_read_b32 v81, v32 offset:0
    ds_read_b32 v87, v32 offset:128
    s_waitcnt lgkmcnt(0)
    v_lshlrev_b32 v80, 16, v81
    v_and_b32 v81, 0xffff0000, v81
    v_rcp_f32 v85, v81
    v_mul_f32 v84, v81, v81
    v_mul_f32 v82, 0xc0135761, v85
    v_mul_f32 v83, v85, v85
    v_mul_f32 v83, v83, v85
    v_mul_f32 v83, 0xbdd2d3e8, v83
    v_lshlrev_b32 v86, 16, v87
    v_and_b32 v87, 0xffff0000, v87
    v_rcp_f32 v91, v87
    v_mul_f32 v90, v87, v87
    v_mul_f32 v88, 0xc0135761, v91
    v_mul_f32 v89, v91, v91
    v_mul_f32 v89, v89, v91
    v_mul_f32 v89, 0xbdd2d3e8, v89
    ds_read_b128 v[64:67], v30 offset:1024
    ds_read_b128 v[68:71], v30 offset:1056
    ds_read_b128 v[72:75], v30 offset:1280
    ds_read_b128 v[76:79], v30 offset:1312
    s_waitcnt lgkmcnt(0)
    v_fma_f32 v96, -v80, v64, v96
    v_fma_f32 v104, -v80, v72, v104
    v_fma_f32 v97, -v80, v65, v97
    v_fma_f32 v105, -v80, v73, v105
    v_fma_f32 v98, -v80, v66, v98
    v_fma_f32 v106, -v80, v74, v106
    v_fma_f32 v99, -v80, v67, v99
    v_fma_f32 v107, -v80, v75, v107
    v_mul_f32 v40, v96, v96
    v_mul_f32 v41, v97, v97
    v_mul_f32 v42, v98, v98
    v_mul_f32 v43, v99, v99
    v_fma_f32 v40, v40, v83, v82
    v_fma_f32 v41, v41, v83, v82
    v_fma_f32 v42, v42, v83, v82
    v_fma_f32 v43, v43, v83, v82
    v_mul_f32 v40, v40, v96
    v_mul_f32 v41, v41, v97
    v_mul_f32 v42, v42, v98
    v_mul_f32 v43, v43, v99
    v_exp_f32 v40, v40
    v_exp_f32 v41, v41
    v_exp_f32 v42, v42
    v_exp_f32 v43, v43
    v_mul_f32 v96, v96, v104
    v_mul_f32 v97, v97, v105
    v_mul_f32 v98, v98, v106
    v_mul_f32 v99, v99, v107
    v_fma_f32 v40, v40, v84, v84
    v_fma_f32 v41, v41, v84, v84
    v_fma_f32 v42, v42, v84, v84
    v_fma_f32 v43, v43, v84, v84
    v_rcp_f32 v40, v40
    v_rcp_f32 v41, v41
    v_rcp_f32 v42, v42
    v_rcp_f32 v43, v43
    v_mul_f32 v96, v96, v40
    v_mul_f32 v97, v97, v41
    v_mul_f32 v98, v98, v42
    v_mul_f32 v99, v99, v43
    v_cvt_pk_bf16_f32 v48, v96, v97
    v_cvt_pk_bf16_f32 v49, v98, v99
    v_fma_f32 v100, -v80, v68, v100
    v_fma_f32 v108, -v80, v76, v108
    v_fma_f32 v101, -v80, v69, v101
    v_fma_f32 v109, -v80, v77, v109
    v_fma_f32 v102, -v80, v70, v102
    v_fma_f32 v110, -v80, v78, v110
    v_fma_f32 v103, -v80, v71, v103
    v_fma_f32 v111, -v80, v79, v111
    v_mul_f32 v44, v100, v100
    v_mul_f32 v45, v101, v101
    v_mul_f32 v46, v102, v102
    v_mul_f32 v47, v103, v103
    v_fma_f32 v44, v44, v83, v82
    v_fma_f32 v45, v45, v83, v82
    v_fma_f32 v46, v46, v83, v82
    v_fma_f32 v47, v47, v83, v82
    v_mul_f32 v44, v44, v100
    v_mul_f32 v45, v45, v101
    v_mul_f32 v46, v46, v102
    v_mul_f32 v47, v47, v103
    v_exp_f32 v44, v44
    v_exp_f32 v45, v45
    v_exp_f32 v46, v46
    v_exp_f32 v47, v47
    v_mul_f32 v100, v100, v108
    v_mul_f32 v101, v101, v109
    v_mul_f32 v102, v102, v110
    v_mul_f32 v103, v103, v111
    v_fma_f32 v44, v44, v84, v84
    v_fma_f32 v45, v45, v84, v84
    v_fma_f32 v46, v46, v84, v84
    v_fma_f32 v47, v47, v84, v84
    v_rcp_f32 v44, v44
    v_rcp_f32 v45, v45
    v_rcp_f32 v46, v46
    v_rcp_f32 v47, v47
    v_mul_f32 v100, v100, v44
    v_mul_f32 v101, v101, v45
    v_mul_f32 v102, v102, v46
    v_mul_f32 v103, v103, v47
    v_cvt_pk_bf16_f32 v50, v100, v101
    v_cvt_pk_bf16_f32 v51, v102, v103
    buffer_store_dwordx4 v[48:51], v27, s[32:35], s56 offen offset:0 sc1
    s_cmp_lg_u32 s79, 0
    s_cbranch_scc1 L_AF_nr0
    v_mov_b32 v1, 158720
    ds_read_b32 v1, v1
    s_waitcnt lgkmcnt(0)
    v_cmp_ne_u32 vcc, s49, v1
    s_cbranch_vccnz L_AF_nr0
    s_mov_b32 s79, 1
    s_lshl_b32 s11, s74, 17
    s_lshl_b32 s12, s75, 2
    s_add_u32 s12, s12, s39
    s_lshl_b32 s13, s12, 11
    s_add_u32 s13, s13, s11
    s_lshr_b32 s14, s38, 2
    s_lshl_b32 s14, s14, 16
    s_add_u32 s14, s14, s11
    s_add_u32 s14, s14, 2097152
    v_lshl_add_u32 v34, v29, 9, v28
    buffer_load_dwordx2 v[160:161], v34, s[32:35], s13 offen offset:0 sc1
    buffer_load_dwordx2 v[162:163], v34, s[32:35], s13 offen offset:256 sc1
    buffer_load_dwordx2 v[164:165], v34, s[32:35], s13 offen offset:1024 sc1
    buffer_load_dwordx2 v[166:167], v34, s[32:35], s13 offen offset:1280 sc1
    buffer_load_dwordx2 v[96:97], v34, s[32:35], s14 offen offset:0 sc1
    buffer_load_dwordx2 v[98:99], v34, s[32:35], s14 offen offset:256 sc1
    buffer_load_dwordx2 v[100:101], v34, s[32:35], s14 offen offset:1024 sc1
    buffer_load_dwordx2 v[102:103], v34, s[32:35], s14 offen offset:1280 sc1
L_AF_nr0:
    v_fma_f32 v128, -v86, v64, v128
    v_fma_f32 v136, -v86, v72, v136
    v_fma_f32 v129, -v86, v65, v129
    v_fma_f32 v137, -v86, v73, v137
    v_fma_f32 v130, -v86, v66, v130
    v_fma_f32 v138, -v86, v74, v138
    v_fma_f32 v131, -v86, v67, v131
    v_fma_f32 v139, -v86, v75, v139
    v_mul_f32 v40, v128, v128
    v_mul_f32 v41, v129, v129
    v_mul_f32 v42, v130, v130
    v_mul_f32 v43, v131, v131
    v_fma_f32 v40, v40, v89, v88
    v_fma_f32 v41, v41, v89, v88
    v_fma_f32 v42, v42, v89, v88
    v_fma_f32 v43, v43, v89, v88
    v_mul_f32 v40, v40, v128
    v_mul_f32 v41, v41, v129
    v_mul_f32 v42, v42, v130
    v_mul_f32 v43, v43, v131
    v_exp_f32 v40, v40
    v_exp_f32 v41, v41
    v_exp_f32 v42, v42
    v_exp_f32 v43, v43
    v_mul_f32 v128, v128, v136
    v_mul_f32 v129, v129, v137
    v_mul_f32 v130, v130, v138
    v_mul_f32 v131, v131, v139
    v_fma_f32 v40, v40, v90, v90
    v_fma_f32 v41, v41, v90, v90
    v_fma_f32 v42, v42, v90, v90
    v_fma_f32 v43, v43, v90, v90
    v_rcp_f32 v40, v40
    v_rcp_f32 v41, v41
    v_rcp_f32 v42, v42
    v_rcp_f32 v43, v43
    v_mul_f32 v128, v128, v40
    v_mul_f32 v129, v129, v41
    v_mul_f32 v130, v130, v42
    v_mul_f32 v131, v131, v43
    v_cvt_pk_bf16_f32 v52, v128, v129
    v_cvt_pk_bf16_f32 v53, v130, v131
    v_fma_f32 v132, -v86, v68, v132
    v_fma_f32 v140, -v86, v76, v140
    v_fma_f32 v133, -v86, v69, v133
    v_fma_f32 v141, -v86, v77, v141
    v_fma_f32 v134, -v86, v70, v134
    v_fma_f32 v142, -v86, v78, v142
    v_fma_f32 v135, -v86, v71, v135
    v_fma_f32 v143, -v86, v79, v143
    v_mul_f32 v44, v132, v132
    v_mul_f32 v45, v133, v133
    v_mul_f32 v46, v134, v134
    v_mul_f32 v47, v135, v135
    v_fma_f32 v44, v44, v89, v88
    v_fma_f32 v45, v45, v89, v88
    v_fma_f32 v46, v46, v89, v88
    v_fma_f32 v47, v47, v89, v88
    v_mul_f32 v44, v44, v132
    v_mul_f32 v45, v45, v133
    v_mul_f32 v46, v46, v134
    v_mul_f32 v47, v47, v135
    v_exp_f32 v44, v44
    v_exp_f32 v45, v45
    v_exp_f32 v46, v46
    v_exp_f32 v47, v47
    v_mul_f32 v132, v132, v140
    v_mul_f32 v133, v133, v141
    v_mul_f32 v134, v134, v142
    v_mul_f32 v135, v135, v143
    v_fma_f32 v44, v44, v90, v90
    v_fma_f32 v45, v45, v90, v90
    v_fma_f32 v46, v46, v90, v90
    v_fma_f32 v47, v47, v90, v90
    v_rcp_f32 v44, v44
    v_rcp_f32 v45, v45
    v_rcp_f32 v46, v46
    v_rcp_f32 v47, v47
    v_mul_f32 v132, v132, v44
    v_mul_f32 v133, v133, v45
    v_mul_f32 v134, v134, v46
    v_mul_f32 v135, v135, v47
    v_cvt_pk_bf16_f32 v54, v132, v133
    v_cvt_pk_bf16_f32 v55, v134, v135
    buffer_store_dwordx4 v[52:55], v27, s[32:35], s57 offen offset:0 sc1
    ds_read_b128 v[64:67], v30 offset:1088
    ds_read_b128 v[68:71], v30 offset:1120
    ds_read_b128 v[72:75], v30 offset:1344
    ds_read_b128 v[76:79], v30 offset:1376
    s_waitcnt lgkmcnt(0)
    v_fma_f32 v112, -v80, v64, v112
    v_fma_f32 v120, -v80, v72, v120
    v_fma_f32 v113, -v80, v65, v113
    v_fma_f32 v121, -v80, v73, v121
    v_fma_f32 v114, -v80, v66, v114
    v_fma_f32 v122, -v80, v74, v122
    v_fma_f32 v115, -v80, v67, v115
    v_fma_f32 v123, -v80, v75, v123
    v_mul_f32 v40, v112, v112
    v_mul_f32 v41, v113, v113
    v_mul_f32 v42, v114, v114
    v_mul_f32 v43, v115, v115
    v_fma_f32 v40, v40, v83, v82
    v_fma_f32 v41, v41, v83, v82
    v_fma_f32 v42, v42, v83, v82
    v_fma_f32 v43, v43, v83, v82
    v_mul_f32 v40, v40, v112
    v_mul_f32 v41, v41, v113
    v_mul_f32 v42, v42, v114
    v_mul_f32 v43, v43, v115
    v_exp_f32 v40, v40
    v_exp_f32 v41, v41
    v_exp_f32 v42, v42
    v_exp_f32 v43, v43
    v_mul_f32 v112, v112, v120
    v_mul_f32 v113, v113, v121
    v_mul_f32 v114, v114, v122
    v_mul_f32 v115, v115, v123
    v_fma_f32 v40, v40, v84, v84
    v_fma_f32 v41, v41, v84, v84
    v_fma_f32 v42, v42, v84, v84
    v_fma_f32 v43, v43, v84, v84
    v_rcp_f32 v40, v40
    v_rcp_f32 v41, v41
    v_rcp_f32 v42, v42
    v_rcp_f32 v43, v43
    v_mul_f32 v112, v112, v40
    v_mul_f32 v113, v113, v41
    v_mul_f32 v114, v114, v42
    v_mul_f32 v115, v115, v43
    v_cvt_pk_bf16_f32 v48, v112, v113
    v_cvt_pk_bf16_f32 v49, v114, v115
    v_fma_f32 v116, -v80, v68, v116
    v_fma_f32 v124, -v80, v76, v124
    v_fma_f32 v117, -v80, v69, v117
    v_fma_f32 v125, -v80, v77, v125
    v_fma_f32 v118, -v80, v70, v118
    v_fma_f32 v126, -v80, v78, v126
    v_fma_f32 v119, -v80, v71, v119
    v_fma_f32 v127, -v80, v79, v127
    v_mul_f32 v44, v116, v116
    v_mul_f32 v45, v117, v117
    v_mul_f32 v46, v118, v118
    v_mul_f32 v47, v119, v119
    v_fma_f32 v44, v44, v83, v82
    v_fma_f32 v45, v45, v83, v82
    v_fma_f32 v46, v46, v83, v82
    v_fma_f32 v47, v47, v83, v82
    v_mul_f32 v44, v44, v116
    v_mul_f32 v45, v45, v117
    v_mul_f32 v46, v46, v118
    v_mul_f32 v47, v47, v119
    v_exp_f32 v44, v44
    v_exp_f32 v45, v45
    v_exp_f32 v46, v46
    v_exp_f32 v47, v47
    v_mul_f32 v116, v116, v124
    v_mul_f32 v117, v117, v125
    v_mul_f32 v118, v118, v126
    v_mul_f32 v119, v119, v127
    v_fma_f32 v44, v44, v84, v84
    v_fma_f32 v45, v45, v84, v84
    v_fma_f32 v46, v46, v84, v84
    v_fma_f32 v47, v47, v84, v84
    v_rcp_f32 v44, v44
    v_rcp_f32 v45, v45
    v_rcp_f32 v46, v46
    v_rcp_f32 v47, v47
    v_mul_f32 v116, v116, v44
    v_mul_f32 v117, v117, v45
    v_mul_f32 v118, v118, v46
    v_mul_f32 v119, v119, v47
    v_cvt_pk_bf16_f32 v50, v116, v117
    v_cvt_pk_bf16_f32 v51, v118, v119
    buffer_store_dwordx4 v[48:51], v27, s[32:35], s56 offen offset:1024 sc1
    s_cmp_lg_u32 s79, 0
    s_cbranch_scc1 L_AF_nr1
    v_mov_b32 v1, 158720
    ds_read_b32 v1, v1
    s_waitcnt lgkmcnt(0)
    v_cmp_ne_u32 vcc, s49, v1
    s_cbranch_vccnz L_AF_nr1
    s_mov_b32 s79, 2
    s_lshl_b32 s11, s74, 17
    s_lshl_b32 s12, s75, 2
    s_add_u32 s12, s12, s39
    s_lshl_b32 s13, s12, 11
    s_add_u32 s13, s13, s11
    s_lshr_b32 s14, s38, 2
    s_lshl_b32 s14, s14, 16
    s_add_u32 s14, s14, s11
    s_add_u32 s14, s14, 2097152
    v_lshl_add_u32 v34, v29, 9, v28
    buffer_load_dwordx2 v[160:161], v34, s[32:35], s13 offen offset:0 sc1
    buffer_load_dwordx2 v[162:163], v34, s[32:35], s13 offen offset:256 sc1
    buffer_load_dwordx2 v[164:165], v34, s[32:35], s13 offen offset:1024 sc1
    buffer_load_dwordx2 v[166:167], v34, s[32:35], s13 offen offset:1280 sc1
    buffer_load_dwordx2 v[96:97], v34, s[32:35], s14 offen offset:0 sc1
    buffer_load_dwordx2 v[98:99], v34, s[32:35], s14 offen offset:256 sc1
    buffer_load_dwordx2 v[100:101], v34, s[32:35], s14 offen offset:1024 sc1
    buffer_load_dwordx2 v[102:103], v34, s[32:35], s14 offen offset:1280 sc1
L_AF_nr1:
    v_fma_f32 v144, -v86, v64, v144
    v_fma_f32 v152, -v86, v72, v152
    v_fma_f32 v145, -v86, v65, v145
    v_fma_f32 v153, -v86, v73, v153
    v_fma_f32 v146, -v86, v66, v146
    v_fma_f32 v154, -v86, v74, v154
    v_fma_f32 v147, -v86, v67, v147
    v_fma_f32 v155, -v86, v75, v155
    v_mul_f32 v40, v144, v144
    v_mul_f32 v41, v145, v145
    v_mul_f32 v42, v146, v146
    v_mul_f32 v43, v147, v147
    v_fma_f32 v40, v40, v89, v88
    v_fma_f32 v41, v41, v89, v88
    v_fma_f32 v42, v42, v89, v88
    v_fma_f32 v43, v43, v89, v88
    v_mul_f32 v40, v40, v144
    v_mul_f32 v41, v41, v145
    v_mul_f32 v42, v42, v146
    v_mul_f32 v43, v43, v147
    v_exp_f32 v40, v40
    v_exp_f32 v41, v41
    v_exp_f32 v42, v42
    v_exp_f32 v43, v43
    v_mul_f32 v144, v144, v152
    v_mul_f32 v145, v145, v153
    v_mul_f32 v146, v146, v154
    v_mul_f32 v147, v147, v155
    v_fma_f32 v40, v40, v90, v90
    v_fma_f32 v41, v41, v90, v90
    v_fma_f32 v42, v42, v90, v90
    v_fma_f32 v43, v43, v90, v90
    v_rcp_f32 v40, v40
    v_rcp_f32 v41, v41
    v_rcp_f32 v42, v42
    v_rcp_f32 v43, v43
    v_mul_f32 v144, v144, v40
    v_mul_f32 v145, v145, v41
    v_mul_f32 v146, v146, v42
    v_mul_f32 v147, v147, v43
    v_cvt_pk_bf16_f32 v52, v144, v145
    v_cvt_pk_bf16_f32 v53, v146, v147
    v_fma_f32 v148, -v86, v68, v148
    v_fma_f32 v156, -v86, v76, v156
    v_fma_f32 v149, -v86, v69, v149
    v_fma_f32 v157, -v86, v77, v157
    v_fma_f32 v150, -v86, v70, v150
    v_fma_f32 v158, -v86, v78, v158
    v_fma_f32 v151, -v86, v71, v151
    v_fma_f32 v159, -v86, v79, v159
    v_mul_f32 v44, v148, v148
    v_mul_f32 v45, v149, v149
    v_mul_f32 v46, v150, v150
    v_mul_f32 v47, v151, v151
    v_fma_f32 v44, v44, v89, v88
    v_fma_f32 v45, v45, v89, v88
    v_fma_f32 v46, v46, v89, v88
    v_fma_f32 v47, v47, v89, v88
    v_mul_f32 v44, v44, v148
    v_mul_f32 v45, v45, v149
    v_mul_f32 v46, v46, v150
    v_mul_f32 v47, v47, v151
    v_exp_f32 v44, v44
    v_exp_f32 v45, v45
    v_exp_f32 v46, v46
    v_exp_f32 v47, v47
    v_mul_f32 v148, v148, v156
    v_mul_f32 v149, v149, v157
    v_mul_f32 v150, v150, v158
    v_mul_f32 v151, v151, v159
    v_fma_f32 v44, v44, v90, v90
    v_fma_f32 v45, v45, v90, v90
    v_fma_f32 v46, v46, v90, v90
    v_fma_f32 v47, v47, v90, v90
    v_rcp_f32 v44, v44
    v_rcp_f32 v45, v45
    v_rcp_f32 v46, v46
    v_rcp_f32 v47, v47
    v_mul_f32 v148, v148, v44
    v_mul_f32 v149, v149, v45
    v_mul_f32 v150, v150, v46
    v_mul_f32 v151, v151, v47
    v_cvt_pk_bf16_f32 v54, v148, v149
    v_cvt_pk_bf16_f32 v55, v150, v151
    buffer_store_dwordx4 v[52:55], v27, s[32:35], s57 offen offset:1024 sc1
    s_lshl_b32 s14, s36, 1
    s_add_u32 s14, s14, s40
    s_lshl_b32 s14, s14, 5
    s_and_b32 s15, s101, -2
    s_add_u32 s14, s14, s15
    s_add_u32 s14, s14, s41
    s_lshl_b32 s14, s14, 2
    s_and_b32 s15, s101, 1
    s_lshl_b32 s15, s15, 12
    s_add_u32 s14, s14, s15
    s_add_u32 s14, s14, 16793600
    s_mov_b32 s43, s14
    s_waitcnt vmcnt(3)
    s_cmp_eq_u32 s79, 1
    s_cbranch_scc1 L_P2
    s_cmp_eq_u32 s79, 0
    s_cbranch_scc1 L_AF_late
    s_waitcnt vmcnt(1)
    s_branch L_P2
L_AF_late:
    s_waitcnt vmcnt(0)
    v_mov_b32 v1, s49
    v_mov_b32 v2, 0
    s_mov_b64 exec, 1
    buffer_store_dword v1, v2, s[32:35], s43 offen offset:0 sc1
    s_mov_b64 exec, -1
    s_mov_b32 s43, 0
    s_branch L_P2poll
L_H2:
    s_setprio 0
    s_and_b32 s40, s39, 1
    s_lshr_b32 s41, s39, 1
    s_lshl_b32 s14, s39, 11
    s_cmp_lt_u32 s39, 2
    s_mov_b32 s97, 4190208
    s_cselect_b32 s97, 2099200, s97
    s_add_u32 s97, s97, s14
    s_lshl_b32 s14, s74, 17
    s_add_u32 s97, s97, s14
    s_cmp_eq_u32 s39, 1
    s_cselect_b32 s14, 2048, 0
    s_sub_u32 s42, s97, s14
    s_add_u32 s42, s42, 61440
    s_mul_i32 s98, s76, 229376
    s_lshl_b32 s14, s40, 11
    s_add_u32 s98, s98, s14
    s_add_u32 s98, s98, 6291456
    s_mul_i32 s99, s40, 28672
    s_lshl_b32 s14, s77, 7
    s_add_u32 s99, s99, s14
    s_mov_b32 s20, s64
    s_mov_b32 s21, s65
    s_mov_b32 s22, 1605632
    s_mov_b32 s23, 0x00020000
    s_cmp_ge_u32 s39, 2
    s_cselect_b32 s14, 0x60, 0
    s_cselect_b32 s15, 0x80, 0
    v_lshlrev_b32 v1, 1, v0
    v_and_b32 v1, s14, v1
    v_xor_b32 v46, v1, v24
    v_xor_b32 v47, s15, v46
    s_cmp_ge_u32 s76, 32
    s_cbranch_scc1 L_H2N
L_H2G:
    s_cmp_lg_u32 s39, 0
    s_cbranch_scc1 L_H2G_lp0
    s_cmp_eq_u32 s79, 1
    s_cbranch_scc1 L_H2G_lp_ok
    s_mov_b32 s96, 200000
L_H2G_f3:
    buffer_load_dwordx4 v[40:43], v36, s[32:35], s58 offen sc1
    buffer_load_dwordx4 v[112:115], v39, s[32:35], s58 offen sc1
    s_waitcnt vmcnt(0)
    v_cmp_ne_u32 vcc, s49, v40
    v_cmp_ne_u32 s[54:55], s49, v41
    s_or_b64 vcc, vcc, s[54:55]
    v_cmp_ne_u32 s[54:55], s49, v42
    s_or_b64 vcc, vcc, s[54:55]
    v_cmp_ne_u32 s[54:55], s49, v43
    s_or_b64 vcc, vcc, s[54:55]
    v_cmp_ne_u32 s[54:55], s49, v112
    s_or_b64 vcc, vcc, s[54:55]
    v_cmp_ne_u32 s[54:55], s49, v113
    s_or_b64 vcc, vcc, s[54:55]
    v_cmp_ne_u32 s[54:55], s49, v114
    s_or_b64 vcc, vcc, s[54:55]
    v_cmp_ne_u32 s[54:55], s49, v115
    s_or_b64 vcc, vcc, s[54:55]
    s_cbranch_vccz L_H2G_f3_ok
    s_sleep 3
    s_sub_u32 s96, s96, 1
    s_cbranch_scc0 L_H2G_f3
L_H2G_f3_ok:
    v_mov_b32 v1, s49
    ds_write_b32 v38, v1
L_H2G_lp0:
    s_mov_b32 s96, 4000000
L_H2G_lp:
    ds_read_b32 v1, v38
    s_waitcnt lgkmcnt(0)
    v_cmp_ne_u32 vcc, s49, v1
    s_cbranch_vccz L_H2G_lp_ok
    s_sleep 1
    s_sub_u32 s96, s96, 1
    s_cbranch_scc0 L_H2G_lp
L_H2G_lp_ok:
    s_add_u32 m0, s47, -114688
    s_add_u32 s52, s97, 0
    buffer_load_dwordx4 v46, s[32:35], s52 offen sc1 lds
    buffer_load_dwordx4 v47, s[32:35], s52 offen offset:1024 sc1 lds
    s_add_u32 m0, s47, -106496
    s_add_u32 s52, s97, 65536
    buffer_load_dwordx4 v46, s[32:35], s52 offen sc1 lds
    buffer_load_dwordx4 v47, s[32:35], s52 offen offset:1024 sc1 lds
    s_add_u32 m0, s47, -98304
    s_add_u32 s52, s97, 4096
    buffer_load_dwordx4 v46, s[32:35], s52 offen sc1 lds
    buffer_load_dwordx4 v47, s[32:35], s52 offen offset:1024 sc1 lds
    s_add_u32 m0, s47, -90112
    s_add_u32 s52, s97, 69632
    buffer_load_dwordx4 v46, s[32:35], s52 offen sc1 lds
    buffer_load_dwordx4 v47, s[32:35], s52 offen offset:1024 sc1 lds
    s_mul_i32 s54, s41, 114688
    s_add_u32 s54, s54, s99
    s_add_u32 s54, s54, 0
    s_add_u32 s55, s54, 14336
    s_add_u32 m0, s48, 65536
    s_nop 0
    buffer_load_dwordx4 v25, s[20:23], s54 offen lds
    buffer_load_dwordx4 v26, s[20:23], s54 offen offset:1024 lds
    s_add_u32 m0, s48, 67584
    s_nop 0
    buffer_load_dwordx4 v25, s[20:23], s55 offen lds
    buffer_load_dwordx4 v26, s[20:23], s55 offen offset:1024 lds
    s_mul_i32 s54, s41, 114688
    s_add_u32 s54, s54, s99
    s_add_u32 s54, s54, 229376
    s_add_u32 s55, s54, 14336
    s_add_u32 m0, s48, 81920
    s_nop 0
    buffer_load_dwordx4 v25, s[20:23], s54 offen lds
    buffer_load_dwordx4 v26, s[20:23], s54 offen offset:1024 lds
    s_add_u32 m0, s48, 83968
    s_nop 0
    buffer_load_dwordx4 v25, s[20:23], s55 offen lds
    buffer_load_dwordx4 v26, s[20:23], s55 offen offset:1024 lds
    v_lshrrev_b32 v11, 5, v0
    v_bfe_u32 v12, v0, 2, 2
    v_bfe_u32 v13, v0, 4, 1
    v_and_b32 v14, 1, v0
    v_bfe_u32 v15, v0, 1, 1
    v_lshl_add_u32 v1, v13, 1, v15
    v_bfe_u32 v2, v0, 3, 1
    v_lshlrev_b32 v2, 2, v2
    v_xor_b32 v1, v1, v2
    v_lshlrev_b32 v1, 4, v1
    v_lshl_add_u32 v1, v14, 3, v1
    v_lshl_add_u32 v1, v12, 7, v1
    v_lshl_add_u32 v1, v11, 9, v1
    s_add_u32 s14, s48, 65536
    v_add_u32 v28, s14, v1
    v_xor_b32 v27, 64, v28
    buffer_load_dword v44, v37, s[32:35], s58 offen sc1
    s_waitcnt vmcnt(13)
    s_barrier
    s_add_u32 m0, s47, -81920
    s_add_u32 s52, s97, 8192
    buffer_load_dwordx4 v46, s[32:35], s52 offen sc1 lds
    buffer_load_dwordx4 v47, s[32:35], s52 offen offset:1024 sc1 lds
    s_add_u32 m0, s47, -73728
    s_add_u32 s52, s97, 73728
    buffer_load_dwordx4 v46, s[32:35], s52 offen sc1 lds
    buffer_load_dwordx4 v47, s[32:35], s52 offen offset:1024 sc1 lds
    s_waitcnt vmcnt(4)
    v_cmp_ne_u32 vcc, s49, v44
    s_mov_b32 s72, 0x0f3fffff
    s_mov_b32 s73, 0x0f000000
    s_and_b64 vcc, vcc, s[72:73]
    s_cbranch_vccz L_H2G_f4a_ok
    s_mov_b32 s96, 200000
L_H2G_f4a:
    buffer_load_dword v44, v37, s[32:35], s58 offen sc1
    s_waitcnt vmcnt(0)
    v_cmp_ne_u32 vcc, s49, v44
    s_mov_b32 s72, 0x0f3fffff
    s_mov_b32 s73, 0x0f000000
    s_and_b64 vcc, vcc, s[72:73]
    s_cbranch_vccz L_H2G_f4a_ok
    s_sleep 2
    s_sub_u32 s96, s96, 1
    s_cbranch_scc0 L_H2G_f4a
L_H2G_f4a_ok:
    s_mul_i32 s53, s41, 8192
    s_add_u32 s53, s53, s98
    s_add_u32 s53, s53, 0
    s_add_u32 s15, s53, 114688
    buffer_load_dwordx4 v[112:115], v24, s[32:35], s53 offen offset:0 sc1
    buffer_load_dwordx4 v[116:119], v24, s[32:35], s53 offen offset:1024 sc1
    buffer_load_dwordx4 v[120:123], v24, s[32:35], s15 offen offset:0 sc1
    buffer_load_dwordx4 v[124:127], v24, s[32:35], s15 offen offset:1024 sc1
    s_barrier
    s_add_u32 m0, s47, -65536
    s_add_u32 s52, s97, 12288
    buffer_load_dwordx4 v46, s[32:35], s52 offen sc1 lds
    buffer_load_dwordx4 v47, s[32:35], s52 offen offset:1024 sc1 lds
    s_add_u32 m0, s47, -57344
    s_add_u32 s52, s97, 77824
    buffer_load_dwordx4 v46, s[32:35], s52 offen sc1 lds
    buffer_load_dwordx4 v47, s[32:35], s52 offen offset:1024 sc1 lds
    s_mul_i32 s53, s41, 8192
    s_add_u32 s53, s53, s98
    s_add_u32 s53, s53, 16384
    s_add_u32 s15, s53, 114688
    buffer_load_dwordx4 v[128:131], v24, s[32:35], s53 offen offset:0 sc1
    buffer_load_dwordx4 v[132:135], v24, s[32:35], s53 offen offset:1024 sc1
    buffer_load_dwordx4 v[136:139], v24, s[32:35], s15 offen offset:0 sc1
    buffer_load_dwordx4 v[140:143], v24, s[32:35], s15 offen offset:1024 sc1
    s_waitcnt vmcnt(8)
    s_barrier
    ds_read_b64_tr_b16 v[16:17], v28 offset:0
    ds_read_b64_tr_b16 v[18:19], v28 offset:1024
    ds_read_b64_tr_b16 v[20:21], v27 offset:0
    ds_read_b64_tr_b16 v[22:23], v27 offset:1024
    ds_read_b64_tr_b16 v[160:161], v28 offset:2048
    ds_read_b64_tr_b16 v[162:163], v28 offset:3072
    ds_read_b64_tr_b16 v[164:165], v27 offset:2048
    ds_read_b64_tr_b16 v[166:167], v27 offset:3072
    s_add_u32 m0, s47, -114688
    s_add_u32 s52, s97, 16384
    buffer_load_dwordx4 v46, s[32:35], s52 offen sc1 lds
    buffer_load_dwordx4 v47, s[32:35], s52 offen offset:1024 sc1 lds
    s_waitcnt lgkmcnt(6)
    v_mfma_f32_32x32x16_bf16 v[48:63], v[16:19], v[112:115], 0
    s_add_u32 m0, s47, -106496
    s_add_u32 s52, s97, 81920
    buffer_load_dwordx4 v46, s[32:35], s52 offen sc1 lds
    buffer_load_dwordx4 v47, s[32:35], s52 offen offset:1024 sc1 lds
    v_mfma_f32_32x32x16_bf16 v[80:95], v[16:19], v[120:123], 0
    s_mul_i32 s53, s41, 8192
    s_add_u32 s53, s53, s98
    s_add_u32 s53, s53, 32768
    s_add_u32 s15, s53, 114688
    buffer_load_dwordx4 v[144:147], v24, s[32:35], s53 offen offset:0 sc1
    buffer_load_dwordx4 v[148:151], v24, s[32:35], s53 offen offset:1024 sc1
    s_waitcnt lgkmcnt(4)
    v_mfma_f32_32x32x16_bf16 v[64:79], v[20:23], v[112:115], 0
    buffer_load_dwordx4 v[152:155], v24, s[32:35], s15 offen offset:0 sc1
    v_mfma_f32_32x32x16_bf16 v[96:111], v[20:23], v[120:123], 0
    buffer_load_dwordx4 v[156:159], v24, s[32:35], s15 offen offset:1024 sc1
    s_mul_i32 s54, s41, 114688
    s_add_u32 s54, s54, s99
    s_add_u32 s54, s54, 458752
    s_add_u32 s55, s54, 14336
    s_add_u32 m0, s48, 98304
    s_nop 0
    buffer_load_dwordx4 v25, s[20:23], s54 offen lds
    s_waitcnt lgkmcnt(2)
    v_mfma_f32_32x32x16_bf16 v[48:63], v[160:163], v[116:119], v[48:63]
    buffer_load_dwordx4 v26, s[20:23], s54 offen offset:1024 lds
    s_add_u32 m0, s48, 100352
    s_nop 0
    buffer_load_dwordx4 v25, s[20:23], s55 offen lds
    v_mfma_f32_32x32x16_bf16 v[80:95], v[160:163], v[124:127], v[80:95]
    buffer_load_dwordx4 v26, s[20:23], s55 offen offset:1024 lds
    s_waitcnt lgkmcnt(0)
    v_mfma_f32_32x32x16_bf16 v[64:79], v[164:167], v[116:119], v[64:79]
    v_mfma_f32_32x32x16_bf16 v[96:111], v[164:167], v[124:127], v[96:111]
    s_waitcnt vmcnt(12)
    s_barrier
    ds_read_b64_tr_b16 v[16:17], v28 offset:16384
    ds_read_b64_tr_b16 v[18:19], v28 offset:17408
    ds_read_b64_tr_b16 v[20:21], v27 offset:16384
    ds_read_b64_tr_b16 v[22:23], v27 offset:17408
    ds_read_b64_tr_b16 v[160:161], v28 offset:18432
    ds_read_b64_tr_b16 v[162:163], v28 offset:19456
    ds_read_b64_tr_b16 v[164:165], v27 offset:18432
    ds_read_b64_tr_b16 v[166:167], v27 offset:19456
    s_add_u32 m0, s47, -98304
    s_add_u32 s52, s97, 20480
    buffer_load_dwordx4 v46, s[32:35], s52 offen sc1 lds
    buffer_load_dwordx4 v47, s[32:35], s52 offen offset:1024 sc1 lds
    s_waitcnt lgkmcnt(6)
    v_mfma_f32_32x32x16_bf16 v[48:63], v[16:19], v[128:131], v[48:63]
    s_add_u32 m0, s47, -90112
    s_add_u32 s52, s97, 86016
    buffer_load_dwordx4 v46, s[32:35], s52 offen sc1 lds
    buffer_load_dwordx4 v47, s[32:35], s52 offen offset:1024 sc1 lds
    v_mfma_f32_32x32x16_bf16 v[80:95], v[16:19], v[136:139], v[80:95]
    s_mul_i32 s53, s41, 8192
    s_add_u32 s53, s53, s98
    s_add_u32 s53, s53, 49152
    s_add_u32 s15, s53, 114688
    buffer_load_dwordx4 v[112:115], v24, s[32:35], s53 offen offset:0 sc1
    buffer_load_dwordx4 v[116:119], v24, s[32:35], s53 offen offset:1024 sc1
    s_waitcnt lgkmcnt(4)
    v_mfma_f32_32x32x16_bf16 v[64:79], v[20:23], v[128:131], v[64:79]
    buffer_load_dwordx4 v[120:123], v24, s[32:35], s15 offen offset:0 sc1
    v_mfma_f32_32x32x16_bf16 v[96:111], v[20:23], v[136:139], v[96:111]
    buffer_load_dwordx4 v[124:127], v24, s[32:35], s15 offen offset:1024 sc1
    s_mul_i32 s54, s41, 114688
    s_add_u32 s54, s54, s99
    s_add_u32 s54, s54, 688128
    s_add_u32 s55, s54, 14336
    s_add_u32 m0, s48, 65536
    s_nop 0
    buffer_load_dwordx4 v25, s[20:23], s54 offen lds
    s_waitcnt lgkmcnt(2)
    v_mfma_f32_32x32x16_bf16 v[48:63], v[160:163], v[132:135], v[48:63]
    buffer_load_dwordx4 v26, s[20:23], s54 offen offset:1024 lds
    s_add_u32 m0, s48, 67584
    s_nop 0
    buffer_load_dwordx4 v25, s[20:23], s55 offen lds
    v_mfma_f32_32x32x16_bf16 v[80:95], v[160:163], v[140:143], v[80:95]
    buffer_load_dwordx4 v26, s[20:23], s55 offen offset:1024 lds
    s_waitcnt lgkmcnt(0)
    v_mfma_f32_32x32x16_bf16 v[64:79], v[164:167], v[132:135], v[64:79]
    v_mfma_f32_32x32x16_bf16 v[96:111], v[164:167], v[140:143], v[96:111]
    s_waitcnt vmcnt(12)
    s_barrier
    ds_read_b64_tr_b16 v[16:17], v28 offset:32768
    ds_read_b64_tr_b16 v[18:19], v28 offset:33792
    ds_read_b64_tr_b16 v[20:21], v27 offset:32768
    ds_read_b64_tr_b16 v[22:23], v27 offset:33792
    ds_read_b64_tr_b16 v[160:161], v28 offset:34816
    ds_read_b64_tr_b16 v[162:163], v28 offset:35840
    ds_read_b64_tr_b16 v[164:165], v27 offset:34816
    ds_read_b64_tr_b16 v[166:167], v27 offset:35840
    s_add_u32 m0, s47, -81920
    s_add_u32 s52, s97, 24576
    buffer_load_dwordx4 v46, s[32:35], s52 offen sc1 lds
    buffer_load_dwordx4 v47, s[32:35], s52 offen offset:1024 sc1 lds
    s_waitcnt lgkmcnt(6)
    v_mfma_f32_32x32x16_bf16 v[48:63], v[16:19], v[144:147], v[48:63]
    s_add_u32 m0, s47, -73728
    s_add_u32 s52, s97, 90112
    buffer_load_dwordx4 v46, s[32:35], s52 offen sc1 lds
    buffer_load_dwordx4 v47, s[32:35], s52 offen offset:1024 sc1 lds
    v_mfma_f32_32x32x16_bf16 v[80:95], v[16:19], v[152:155], v[80:95]
    s_mul_i32 s53, s41, 8192
    s_add_u32 s53, s53, s98
    s_add_u32 s53, s53, 65536
    s_add_u32 s15, s53, 114688
    buffer_load_dwordx4 v[128:131], v24, s[32:35], s53 offen offset:0 sc1
    buffer_load_dwordx4 v[132:135], v24, s[32:35], s53 offen offset:1024 sc1
    s_waitcnt lgkmcnt(4)
    v_mfma_f32_32x32x16_bf16 v[64:79], v[20:23], v[144:147], v[64:79]
    buffer_load_dwordx4 v[136:139], v24, s[32:35], s15 offen offset:0 sc1
    v_mfma_f32_32x32x16_bf16 v[96:111], v[20:23], v[152:155], v[96:111]
    buffer_load_dwordx4 v[140:143], v24, s[32:35], s15 offen offset:1024 sc1
    s_mul_i32 s54, s41, 114688
    s_add_u32 s54, s54, s99
    s_add_u32 s54, s54, 917504
    s_add_u32 s55, s54, 14336
    s_add_u32 m0, s48, 81920
    s_nop 0
    buffer_load_dwordx4 v25, s[20:23], s54 offen lds
    s_waitcnt lgkmcnt(2)
    v_mfma_f32_32x32x16_bf16 v[48:63], v[160:163], v[148:151], v[48:63]
    buffer_load_dwordx4 v26, s[20:23], s54 offen offset:1024 lds
    s_add_u32 m0, s48, 83968
    s_nop 0
    buffer_load_dwordx4 v25, s[20:23], s55 offen lds
    v_mfma_f32_32x32x16_bf16 v[80:95], v[160:163], v[156:159], v[80:95]
    buffer_load_dwordx4 v26, s[20:23], s55 offen offset:1024 lds
    s_waitcnt lgkmcnt(0)
    v_mfma_f32_32x32x16_bf16 v[64:79], v[164:167], v[148:151], v[64:79]
    v_mfma_f32_32x32x16_bf16 v[96:111], v[164:167], v[156:159], v[96:111]
    s_waitcnt vmcnt(12)
    s_barrier
    ds_read_b64_tr_b16 v[16:17], v28 offset:0
    ds_read_b64_tr_b16 v[18:19], v28 offset:1024
    ds_read_b64_tr_b16 v[20:21], v27 offset:0
    ds_read_b64_tr_b16 v[22:23], v27 offset:1024
    ds_read_b64_tr_b16 v[160:161], v28 offset:2048
    ds_read_b64_tr_b16 v[162:163], v28 offset:3072
    ds_read_b64_tr_b16 v[164:165], v27 offset:2048
    ds_read_b64_tr_b16 v[166:167], v27 offset:3072
    buffer_load_dword v44, v37, s[32:35], s58 offen sc1
    s_add_u32 m0, s47, -65536
    s_add_u32 s52, s97, 28672
    buffer_load_dwordx4 v46, s[32:35], s52 offen sc1 lds
    buffer_load_dwordx4 v47, s[32:35], s52 offen offset:1024 sc1 lds
    s_waitcnt lgkmcnt(6)
    v_mfma_f32_32x32x16_bf16 v[48:63], v[16:19], v[112:115], v[48:63]
    s_add_u32 m0, s47, -57344
    s_add_u32 s52, s97, 94208
    buffer_load_dwordx4 v46, s[32:35], s52 offen sc1 lds
    buffer_load_dwordx4 v47, s[32:35], s52 offen offset:1024 sc1 lds
    v_mfma_f32_32x32x16_bf16 v[80:95], v[16:19], v[120:123], v[80:95]
    s_mul_i32 s53, s41, 16384
    s_add_u32 s53, s53, s98
    s_add_u32 s53, s53, 81920
    s_add_u32 s15, s53, 114688
    buffer_load_dwordx4 v[144:147], v24, s[32:35], s53 offen offset:0 sc1
    buffer_load_dwordx4 v[148:151], v24, s[32:35], s53 offen offset:1024 sc1
    s_waitcnt lgkmcnt(4)
    v_mfma_f32_32x32x16_bf16 v[64:79], v[20:23], v[112:115], v[64:79]
    buffer_load_dwordx4 v[152:155], v24, s[32:35], s15 offen offset:0 sc1
    v_mfma_f32_32x32x16_bf16 v[96:111], v[20:23], v[120:123], v[96:111]
    buffer_load_dwordx4 v[156:159], v24, s[32:35], s15 offen offset:1024 sc1
    s_mul_i32 s54, s41, 229376
    s_add_u32 s54, s54, s99
    s_add_u32 s54, s54, 1146880
    s_add_u32 s55, s54, 14336
    s_add_u32 m0, s48, 98304
    s_nop 0
    buffer_load_dwordx4 v25, s[20:23], s54 offen lds
    s_waitcnt lgkmcnt(2)
    v_mfma_f32_32x32x16_bf16 v[48:63], v[160:163], v[116:119], v[48:63]
    buffer_load_dwordx4 v26, s[20:23], s54 offen offset:1024 lds
    s_add_u32 m0, s48, 100352
    s_nop 0
    buffer_load_dwordx4 v25, s[20:23], s55 offen lds
    v_mfma_f32_32x32x16_bf16 v[80:95], v[160:163], v[124:127], v[80:95]
    buffer_load_dwordx4 v26, s[20:23], s55 offen offset:1024 lds
    s_waitcnt lgkmcnt(0)
    v_mfma_f32_32x32x16_bf16 v[64:79], v[164:167], v[116:119], v[64:79]
    v_mfma_f32_32x32x16_bf16 v[96:111], v[164:167], v[124:127], v[96:111]
    s_waitcnt vmcnt(13)
    s_barrier
    ds_read_b64_tr_b16 v[16:17], v28 offset:16384
    ds_read_b64_tr_b16 v[18:19], v28 offset:17408
    ds_read_b64_tr_b16 v[20:21], v27 offset:16384
    ds_read_b64_tr_b16 v[22:23], v27 offset:17408
    ds_read_b64_tr_b16 v[160:161], v28 offset:18432
    ds_read_b64_tr_b16 v[162:163], v28 offset:19456
    ds_read_b64_tr_b16 v[164:165], v27 offset:18432
    ds_read_b64_tr_b16 v[166:167], v27 offset:19456
    s_add_u32 m0, s47, -114688
    s_add_u32 s52, s97, 32768
    buffer_load_dwordx4 v46, s[32:35], s52 offen sc1 lds
    buffer_load_dwordx4 v47, s[32:35], s52 offen offset:1024 sc1 lds
    s_waitcnt lgkmcnt(6)
    v_mfma_f32_32x32x16_bf16 v[48:63], v[16:19], v[128:131], v[48:63]
    s_add_u32 m0, s47, -106496
    s_add_u32 s52, s97, 98304
    buffer_load_dwordx4 v46, s[32:35], s52 offen sc1 lds
    buffer_load_dwordx4 v47, s[32:35], s52 offen offset:1024 sc1 lds
    v_mfma_f32_32x32x16_bf16 v[80:95], v[16:19], v[136:139], v[80:95]
    s_mul_i32 s53, s41, 4096
    s_add_u32 s53, s53, s98
    s_add_u32 s53, s53, 102400
    s_add_u32 s15, s53, 114688
    buffer_load_dwordx4 v[112:115], v24, s[32:35], s53 offen offset:0 sc1
    buffer_load_dwordx4 v[116:119], v24, s[32:35], s53 offen offset:1024 sc1
    s_waitcnt lgkmcnt(4)
    v_mfma_f32_32x32x16_bf16 v[64:79], v[20:23], v[128:131], v[64:79]
    buffer_load_dwordx4 v[120:123], v24, s[32:35], s15 offen offset:0 sc1
    v_mfma_f32_32x32x16_bf16 v[96:111], v[20:23], v[136:139], v[96:111]
    buffer_load_dwordx4 v[124:127], v24, s[32:35], s15 offen offset:1024 sc1
    s_mul_i32 s54, s41, 57344
    s_add_u32 s54, s54, s99
    s_add_u32 s54, s54, 1433600
    s_add_u32 s55, s54, 14336
    s_add_u32 m0, s48, 65536
    s_nop 0
    buffer_load_dwordx4 v25, s[20:23], s54 offen lds
    s_waitcnt lgkmcnt(2)
    v_mfma_f32_32x32x16_bf16 v[48:63], v[160:163], v[132:135], v[48:63]
    buffer_load_dwordx4 v26, s[20:23], s54 offen offset:1024 lds
    s_add_u32 m0, s48, 67584
    s_nop 0
    buffer_load_dwordx4 v25, s[20:23], s55 offen lds
    v_mfma_f32_32x32x16_bf16 v[80:95], v[160:163], v[140:143], v[80:95]
    buffer_load_dwordx4 v26, s[20:23], s55 offen offset:1024 lds
    s_waitcnt lgkmcnt(0)
    v_mfma_f32_32x32x16_bf16 v[64:79], v[164:167], v[132:135], v[64:79]
    v_mfma_f32_32x32x16_bf16 v[96:111], v[164:167], v[140:143], v[96:111]
    s_waitcnt vmcnt(24)
    v_cmp_ne_u32 vcc, s49, v44
    s_mov_b32 s72, 0
    s_mov_b32 s73, 0x003fffff
    s_and_b64 vcc, vcc, s[72:73]
    s_cbranch_vccz L_H2G_f4b_ok
    s_mov_b32 s96, 200000
L_H2G_f4b:
    buffer_load_dword v44, v37, s[32:35], s58 offen sc1
    s_waitcnt vmcnt(0)
    v_cmp_ne_u32 vcc, s49, v44
    s_mov_b32 s72, 0
    s_mov_b32 s73, 0x003fffff
    s_and_b64 vcc, vcc, s[72:73]
    s_cbranch_vccz L_H2G_f4b_ok
    s_sleep 2
    s_sub_u32 s96, s96, 1
    s_cbranch_scc0 L_H2G_f4b
L_H2G_f4b_ok:
    s_waitcnt vmcnt(12)
    s_barrier
    ds_read_b64_tr_b16 v[16:17], v28 offset:32768
    ds_read_b64_tr_b16 v[18:19], v28 offset:33792
    ds_read_b64_tr_b16 v[20:21], v27 offset:32768
    ds_read_b64_tr_b16 v[22:23], v27 offset:33792
    ds_read_b64_tr_b16 v[160:161], v28 offset:34816
    ds_read_b64_tr_b16 v[162:163], v28 offset:35840
    ds_read_b64_tr_b16 v[164:165], v27 offset:34816
    ds_read_b64_tr_b16 v[166:167], v27 offset:35840
    s_add_u32 m0, s47, -98304
    s_add_u32 s52, s97, 36864
    buffer_load_dwordx4 v46, s[32:35], s52 offen sc1 lds
    buffer_load_dwordx4 v47, s[32:35], s52 offen offset:1024 sc1 lds
    s_waitcnt lgkmcnt(6)
    v_mfma_f32_32x32x16_bf16 v[48:63], v[16:19], v[144:147], v[48:63]
    s_add_u32 m0, s47, -90112
    s_add_u32 s52, s97, 102400
    buffer_load_dwordx4 v46, s[32:35], s52 offen sc1 lds
    buffer_load_dwordx4 v47, s[32:35], s52 offen offset:1024 sc1 lds
    v_mfma_f32_32x32x16_bf16 v[80:95], v[16:19], v[152:155], v[80:95]
    s_mul_i32 s53, s41, -106496
    s_add_u32 s53, s53, s98
    s_add_u32 s53, s53, 110592
    s_add_u32 s15, s53, 114688
    buffer_load_dwordx4 v[128:131], v24, s[32:35], s53 offen offset:0 sc1
    buffer_load_dwordx4 v[132:135], v24, s[32:35], s53 offen offset:1024 sc1
    s_waitcnt lgkmcnt(4)
    v_mfma_f32_32x32x16_bf16 v[64:79], v[20:23], v[144:147], v[64:79]
    buffer_load_dwordx4 v[136:139], v24, s[32:35], s15 offen offset:0 sc1
    v_mfma_f32_32x32x16_bf16 v[96:111], v[20:23], v[152:155], v[96:111]
    buffer_load_dwordx4 v[140:143], v24, s[32:35], s15 offen offset:1024 sc1
    s_mul_i32 s54, s41, -1490944
    s_add_u32 s54, s54, s99
    s_add_u32 s54, s54, 1548288
    s_add_u32 s55, s54, 14336
    s_add_u32 m0, s48, 81920
    s_nop 0
    buffer_load_dwordx4 v25, s[20:23], s54 offen lds
    s_waitcnt lgkmcnt(2)
    v_mfma_f32_32x32x16_bf16 v[48:63], v[160:163], v[148:151], v[48:63]
    buffer_load_dwordx4 v26, s[20:23], s54 offen offset:1024 lds
    s_add_u32 m0, s48, 83968
    s_nop 0
    buffer_load_dwordx4 v25, s[20:23], s55 offen lds
    v_mfma_f32_32x32x16_bf16 v[80:95], v[160:163], v[156:159], v[80:95]
    buffer_load_dwordx4 v26, s[20:23], s55 offen offset:1024 lds
    s_waitcnt lgkmcnt(0)
    v_mfma_f32_32x32x16_bf16 v[64:79], v[164:167], v[148:151], v[64:79]
    v_mfma_f32_32x32x16_bf16 v[96:111], v[164:167], v[156:159], v[96:111]
    s_waitcnt vmcnt(12)
    s_barrier
    ds_read_b64_tr_b16 v[16:17], v28 offset:0
    ds_read_b64_tr_b16 v[18:19], v28 offset:1024
    ds_read_b64_tr_b16 v[20:21], v27 offset:0
    ds_read_b64_tr_b16 v[22:23], v27 offset:1024
    ds_read_b64_tr_b16 v[160:161], v28 offset:2048
    ds_read_b64_tr_b16 v[162:163], v28 offset:3072
    ds_read_b64_tr_b16 v[164:165], v27 offset:2048
    ds_read_b64_tr_b16 v[166:167], v27 offset:3072
    s_add_u32 m0, s47, -81920
    s_add_u32 s52, s97, 40960
    buffer_load_dwordx4 v46, s[32:35], s52 offen sc1 lds
    buffer_load_dwordx4 v47, s[32:35], s52 offen offset:1024 sc1 lds
    s_waitcnt lgkmcnt(6)
    v_mfma_f32_32x32x16_bf16 v[48:63], v[16:19], v[112:115], v[48:63]
    s_add_u32 m0, s47, -73728
    s_add_u32 s52, s97, 106496
    buffer_load_dwordx4 v46, s[32:35], s52 offen sc1 lds
    buffer_load_dwordx4 v47, s[32:35], s52 offen offset:1024 sc1 lds
    v_mfma_f32_32x32x16_bf16 v[80:95], v[16:19], v[120:123], v[80:95]
    s_mul_i32 s53, s41, 8192
    s_add_u32 s53, s53, s98
    s_add_u32 s53, s53, 12288
    s_add_u32 s15, s53, 114688
    buffer_load_dwordx4 v[144:147], v24, s[32:35], s53 offen offset:0 sc1
    buffer_load_dwordx4 v[148:151], v24, s[32:35], s53 offen offset:1024 sc1
    s_waitcnt lgkmcnt(4)
    v_mfma_f32_32x32x16_bf16 v[64:79], v[20:23], v[112:115], v[64:79]
    buffer_load_dwordx4 v[152:155], v24, s[32:35], s15 offen offset:0 sc1
    v_mfma_f32_32x32x16_bf16 v[96:111], v[20:23], v[120:123], v[96:111]
    buffer_load_dwordx4 v[156:159], v24, s[32:35], s15 offen offset:1024 sc1
    s_mul_i32 s54, s41, 114688
    s_add_u32 s54, s54, s99
    s_add_u32 s54, s54, 172032
    s_add_u32 s55, s54, 14336
    s_add_u32 m0, s48, 98304
    s_nop 0
    buffer_load_dwordx4 v25, s[20:23], s54 offen lds
    s_waitcnt lgkmcnt(2)
    v_mfma_f32_32x32x16_bf16 v[48:63], v[160:163], v[116:119], v[48:63]
    buffer_load_dwordx4 v26, s[20:23], s54 offen offset:1024 lds
    s_add_u32 m0, s48, 100352
    s_nop 0
    buffer_load_dwordx4 v25, s[20:23], s55 offen lds
    v_mfma_f32_32x32x16_bf16 v[80:95], v[160:163], v[124:127], v[80:95]
    buffer_load_dwordx4 v26, s[20:23], s55 offen offset:1024 lds
    s_waitcnt lgkmcnt(0)
    v_mfma_f32_32x32x16_bf16 v[64:79], v[164:167], v[116:119], v[64:79]
    v_mfma_f32_32x32x16_bf16 v[96:111], v[164:167], v[124:127], v[96:111]
    s_waitcnt vmcnt(12)
    s_barrier
    ds_read_b64_tr_b16 v[16:17], v28 offset:16384
    ds_read_b64_tr_b16 v[18:19], v28 offset:17408
    ds_read_b64_tr_b16 v[20:21], v27 offset:16384
    ds_read_b64_tr_b16 v[22:23], v27 offset:17408
    ds_read_b64_tr_b16 v[160:161], v28 offset:18432
    ds_read_b64_tr_b16 v[162:163], v28 offset:19456
    ds_read_b64_tr_b16 v[164:165], v27 offset:18432
    ds_read_b64_tr_b16 v[166:167], v27 offset:19456
    s_add_u32 m0, s47, -65536
    s_add_u32 s52, s97, 45056
    buffer_load_dwordx4 v46, s[32:35], s52 offen sc1 lds
    buffer_load_dwordx4 v47, s[32:35], s52 offen offset:1024 sc1 lds
    s_waitcnt lgkmcnt(6)
    v_mfma_f32_32x32x16_bf16 v[48:63], v[16:19], v[128:131], v[48:63]
    s_add_u32 m0, s47, -57344
    s_add_u32 s52, s97, 110592
    buffer_load_dwordx4 v46, s[32:35], s52 offen sc1 lds
    buffer_load_dwordx4 v47, s[32:35], s52 offen offset:1024 sc1 lds
    v_mfma_f32_32x32x16_bf16 v[80:95], v[16:19], v[136:139], v[80:95]
    s_mul_i32 s53, s41, 8192
    s_add_u32 s53, s53, s98
    s_add_u32 s53, s53, 28672
    s_add_u32 s15, s53, 114688
    buffer_load_dwordx4 v[112:115], v24, s[32:35], s53 offen offset:0 sc1
    buffer_load_dwordx4 v[116:119], v24, s[32:35], s53 offen offset:1024 sc1
    s_waitcnt lgkmcnt(4)
    v_mfma_f32_32x32x16_bf16 v[64:79], v[20:23], v[128:131], v[64:79]
    buffer_load_dwordx4 v[120:123], v24, s[32:35], s15 offen offset:0 sc1
    v_mfma_f32_32x32x16_bf16 v[96:111], v[20:23], v[136:139], v[96:111]
    buffer_load_dwordx4 v[124:127], v24, s[32:35], s15 offen offset:1024 sc1
    s_mul_i32 s54, s41, 114688
    s_add_u32 s54, s54, s99
    s_add_u32 s54, s54, 401408
    s_add_u32 s55, s54, 14336
    s_add_u32 m0, s48, 65536
    s_nop 0
    buffer_load_dwordx4 v25, s[20:23], s54 offen lds
    s_waitcnt lgkmcnt(2)
    v_mfma_f32_32x32x16_bf16 v[48:63], v[160:163], v[132:135], v[48:63]
    buffer_load_dwordx4 v26, s[20:23], s54 offen offset:1024 lds
    s_add_u32 m0, s48, 67584
    s_nop 0
    buffer_load_dwordx4 v25, s[20:23], s55 offen lds
    v_mfma_f32_32x32x16_bf16 v[80:95], v[160:163], v[140:143], v[80:95]
    buffer_load_dwordx4 v26, s[20:23], s55 offen offset:1024 lds
    s_waitcnt lgkmcnt(0)
    v_mfma_f32_32x32x16_bf16 v[64:79], v[164:167], v[132:135], v[64:79]
    v_mfma_f32_32x32x16_bf16 v[96:111], v[164:167], v[140:143], v[96:111]
    s_waitcnt vmcnt(12)
    s_barrier
    ds_read_b64_tr_b16 v[16:17], v28 offset:32768
    ds_read_b64_tr_b16 v[18:19], v28 offset:33792
    ds_read_b64_tr_b16 v[20:21], v27 offset:32768
    ds_read_b64_tr_b16 v[22:23], v27 offset:33792
    ds_read_b64_tr_b16 v[160:161], v28 offset:34816
    ds_read_b64_tr_b16 v[162:163], v28 offset:35840
    ds_read_b64_tr_b16 v[164:165], v27 offset:34816
    ds_read_b64_tr_b16 v[166:167], v27 offset:35840
    s_add_u32 m0, s47, -114688
    s_add_u32 s52, s97, 49152
    buffer_load_dwordx4 v46, s[32:35], s52 offen sc1 lds
    buffer_load_dwordx4 v47, s[32:35], s52 offen offset:1024 sc1 lds
    s_waitcnt lgkmcnt(6)
    v_mfma_f32_32x32x16_bf16 v[48:63], v[16:19], v[144:147], v[48:63]
    s_add_u32 m0, s47, -106496
    s_add_u32 s52, s97, 114688
    buffer_load_dwordx4 v46, s[32:35], s52 offen sc1 lds
    buffer_load_dwordx4 v47, s[32:35], s52 offen offset:1024 sc1 lds
    v_mfma_f32_32x32x16_bf16 v[80:95], v[16:19], v[152:155], v[80:95]
    s_mul_i32 s53, s41, 8192
    s_add_u32 s53, s53, s98
    s_add_u32 s53, s53, 45056
    s_add_u32 s15, s53, 114688
    buffer_load_dwordx4 v[128:131], v24, s[32:35], s53 offen offset:0 sc1
    buffer_load_dwordx4 v[132:135], v24, s[32:35], s53 offen offset:1024 sc1
    s_waitcnt lgkmcnt(4)
    v_mfma_f32_32x32x16_bf16 v[64:79], v[20:23], v[144:147], v[64:79]
    buffer_load_dwordx4 v[136:139], v24, s[32:35], s15 offen offset:0 sc1
    v_mfma_f32_32x32x16_bf16 v[96:111], v[20:23], v[152:155], v[96:111]
    buffer_load_dwordx4 v[140:143], v24, s[32:35], s15 offen offset:1024 sc1
    s_mul_i32 s54, s41, 114688
    s_add_u32 s54, s54, s99
    s_add_u32 s54, s54, 630784
    s_add_u32 s55, s54, 14336
    s_add_u32 m0, s48, 81920
    s_nop 0
    buffer_load_dwordx4 v25, s[20:23], s54 offen lds
    s_waitcnt lgkmcnt(2)
    v_mfma_f32_32x32x16_bf16 v[48:63], v[160:163], v[148:151], v[48:63]
    buffer_load_dwordx4 v26, s[20:23], s54 offen offset:1024 lds
    s_add_u32 m0, s48, 83968
    s_nop 0
    buffer_load_dwordx4 v25, s[20:23], s55 offen lds
    v_mfma_f32_32x32x16_bf16 v[80:95], v[160:163], v[156:159], v[80:95]
    buffer_load_dwordx4 v26, s[20:23], s55 offen offset:1024 lds
    s_waitcnt lgkmcnt(0)
    v_mfma_f32_32x32x16_bf16 v[64:79], v[164:167], v[148:151], v[64:79]
    v_mfma_f32_32x32x16_bf16 v[96:111], v[164:167], v[156:159], v[96:111]
    s_waitcnt vmcnt(12)
    s_barrier
    ds_read_b64_tr_b16 v[16:17], v28 offset:0
    ds_read_b64_tr_b16 v[18:19], v28 offset:1024
    ds_read_b64_tr_b16 v[20:21], v27 offset:0
    ds_read_b64_tr_b16 v[22:23], v27 offset:1024
    ds_read_b64_tr_b16 v[160:161], v28 offset:2048
    ds_read_b64_tr_b16 v[162:163], v28 offset:3072
    ds_read_b64_tr_b16 v[164:165], v27 offset:2048
    ds_read_b64_tr_b16 v[166:167], v27 offset:3072
    buffer_load_dword v44, v37, s[32:35], s58 offen sc1
    s_add_u32 m0, s47, -98304
    s_add_u32 s52, s97, 53248
    buffer_load_dwordx4 v46, s[32:35], s52 offen sc1 lds
    buffer_load_dwordx4 v47, s[32:35], s52 offen offset:1024 sc1 lds
    s_waitcnt lgkmcnt(6)
    v_mfma_f32_32x32x16_bf16 v[48:63], v[16:19], v[112:115], v[48:63]
    s_add_u32 m0, s47, -90112
    s_add_u32 s52, s97, 118784
    buffer_load_dwordx4 v46, s[32:35], s52 offen sc1 lds
    buffer_load_dwordx4 v47, s[32:35], s52 offen offset:1024 sc1 lds
    v_mfma_f32_32x32x16_bf16 v[80:95], v[16:19], v[120:123], v[80:95]
    s_mul_i32 s53, s41, 8192
    s_add_u32 s53, s53, s98
    s_add_u32 s53, s53, 61440
    s_add_u32 s15, s53, 114688
    buffer_load_dwordx4 v[144:147], v24, s[32:35], s53 offen offset:0 sc1
    buffer_load_dwordx4 v[148:151], v24, s[32:35], s53 offen offset:1024 sc1
    s_waitcnt lgkmcnt(4)
    v_mfma_f32_32x32x16_bf16 v[64:79], v[20:23], v[112:115], v[64:79]
    buffer_load_dwordx4 v[152:155], v24, s[32:35], s15 offen offset:0 sc1
    v_mfma_f32_32x32x16_bf16 v[96:111], v[20:23], v[120:123], v[96:111]
    buffer_load_dwordx4 v[156:159], v24, s[32:35], s15 offen offset:1024 sc1
    s_mul_i32 s54, s41, 114688
    s_add_u32 s54, s54, s99
    s_add_u32 s54, s54, 860160
    s_add_u32 s55, s54, 14336
    s_add_u32 m0, s48, 98304
    s_nop 0
    buffer_load_dwordx4 v25, s[20:23], s54 offen lds
    s_waitcnt lgkmcnt(2)
    v_mfma_f32_32x32x16_bf16 v[48:63], v[160:163], v[116:119], v[48:63]
    buffer_load_dwordx4 v26, s[20:23], s54 offen offset:1024 lds
    s_add_u32 m0, s48, 100352
    s_nop 0
    buffer_load_dwordx4 v25, s[20:23], s55 offen lds
    v_mfma_f32_32x32x16_bf16 v[80:95], v[160:163], v[124:127], v[80:95]
    buffer_load_dwordx4 v26, s[20:23], s55 offen offset:1024 lds
    s_waitcnt lgkmcnt(0)
    v_mfma_f32_32x32x16_bf16 v[64:79], v[164:167], v[116:119], v[64:79]
    v_mfma_f32_32x32x16_bf16 v[96:111], v[164:167], v[124:127], v[96:111]
    s_waitcnt vmcnt(13)
    s_barrier
    ds_read_b64_tr_b16 v[16:17], v28 offset:16384
    ds_read_b64_tr_b16 v[18:19], v28 offset:17408
    ds_read_b64_tr_b16 v[20:21], v27 offset:16384
    ds_read_b64_tr_b16 v[22:23], v27 offset:17408
    ds_read_b64_tr_b16 v[160:161], v28 offset:18432
    ds_read_b64_tr_b16 v[162:163], v28 offset:19456
    ds_read_b64_tr_b16 v[164:165], v27 offset:18432
    ds_read_b64_tr_b16 v[166:167], v27 offset:19456
    s_add_u32 m0, s47, -81920
    s_add_u32 s52, s97, 57344
    buffer_load_dwordx4 v46, s[32:35], s52 offen sc1 lds
    buffer_load_dwordx4 v47, s[32:35], s52 offen offset:1024 sc1 lds
    s_waitcnt lgkmcnt(6)
    v_mfma_f32_32x32x16_bf16 v[48:63], v[16:19], v[128:131], v[48:63]
    s_add_u32 m0, s47, -73728
    s_add_u32 s52, s97, 122880
    buffer_load_dwordx4 v46, s[32:35], s52 offen sc1 lds
    buffer_load_dwordx4 v47, s[32:35], s52 offen offset:1024 sc1 lds
    v_mfma_f32_32x32x16_bf16 v[80:95], v[16:19], v[136:139], v[80:95]
    s_mul_i32 s53, s41, 8192
    s_add_u32 s53, s53, s98
    s_add_u32 s53, s53, 77824
    s_add_u32 s15, s53, 114688
    buffer_load_dwordx4 v[112:115], v24, s[32:35], s53 offen offset:0 sc1
    buffer_load_dwordx4 v[116:119], v24, s[32:35], s53 offen offset:1024 sc1
    s_waitcnt lgkmcnt(4)
    v_mfma_f32_32x32x16_bf16 v[64:79], v[20:23], v[128:131], v[64:79]
    buffer_load_dwordx4 v[120:123], v24, s[32:35], s15 offen offset:0 sc1
    v_mfma_f32_32x32x16_bf16 v[96:111], v[20:23], v[136:139], v[96:111]
    buffer_load_dwordx4 v[124:127], v24, s[32:35], s15 offen offset:1024 sc1
    s_mul_i32 s54, s41, 114688
    s_add_u32 s54, s54, s99
    s_add_u32 s54, s54, 1089536
    s_add_u32 s55, s54, 14336
    s_add_u32 m0, s48, 65536
    s_nop 0
    buffer_load_dwordx4 v25, s[20:23], s54 offen lds
    s_waitcnt lgkmcnt(2)
    v_mfma_f32_32x32x16_bf16 v[48:63], v[160:163], v[132:135], v[48:63]
    buffer_load_dwordx4 v26, s[20:23], s54 offen offset:1024 lds
    s_add_u32 m0, s48, 67584
    s_nop 0
    buffer_load_dwordx4 v25, s[20:23], s55 offen lds
    v_mfma_f32_32x32x16_bf16 v[80:95], v[160:163], v[140:143], v[80:95]
    buffer_load_dwordx4 v26, s[20:23], s55 offen offset:1024 lds
    s_waitcnt lgkmcnt(0)
    v_mfma_f32_32x32x16_bf16 v[64:79], v[164:167], v[132:135], v[64:79]
    v_mfma_f32_32x32x16_bf16 v[96:111], v[164:167], v[140:143], v[96:111]
    s_waitcnt vmcnt(24)
    v_cmp_ne_u32 vcc, s49, v44
    s_mov_b32 s72, -1
    s_mov_b32 s73, -1
    s_and_b64 vcc, vcc, s[72:73]
    s_cbranch_vccz L_H2G_f4c_ok
    s_mov_b32 s96, 200000
L_H2G_f4c:
    buffer_load_dword v44, v37, s[32:35], s58 offen sc1
    s_waitcnt vmcnt(0)
    v_cmp_ne_u32 vcc, s49, v44
    s_mov_b32 s72, -1
    s_mov_b32 s73, -1
    s_and_b64 vcc, vcc, s[72:73]
    s_cbranch_vccz L_H2G_f4c_ok
    s_sleep 2
    s_sub_u32 s96, s96, 1
    s_cbranch_scc0 L_H2G_f4c
L_H2G_f4c_ok:
    s_waitcnt vmcnt(12)
    s_barrier
    ds_read_b64_tr_b16 v[16:17], v28 offset:32768
    ds_read_b64_tr_b16 v[18:19], v28 offset:33792
    ds_read_b64_tr_b16 v[20:21], v27 offset:32768
    ds_read_b64_tr_b16 v[22:23], v27 offset:33792
    ds_read_b64_tr_b16 v[160:161], v28 offset:34816
    ds_read_b64_tr_b16 v[162:163], v28 offset:35840
    ds_read_b64_tr_b16 v[164:165], v27 offset:34816
    ds_read_b64_tr_b16 v[166:167], v27 offset:35840
    s_add_u32 m0, s47, -65536
    s_add_u32 s52, s42, 0
    buffer_load_dwordx4 v46, s[32:35], s52 offen sc1 lds
    buffer_load_dwordx4 v47, s[32:35], s52 offen offset:1024 sc1 lds
    s_waitcnt lgkmcnt(6)
    v_mfma_f32_32x32x16_bf16 v[48:63], v[16:19], v[144:147], v[48:63]
    s_add_u32 m0, s47, -57344
    s_add_u32 s52, s42, 65536
    buffer_load_dwordx4 v46, s[32:35], s52 offen sc1 lds
    buffer_load_dwordx4 v47, s[32:35], s52 offen offset:1024 sc1 lds
    v_mfma_f32_32x32x16_bf16 v[80:95], v[16:19], v[152:155], v[80:95]
    s_mul_i32 s53, s41, 4096
    s_add_u32 s53, s53, s98
    s_add_u32 s53, s53, 90112
    s_add_u32 s15, s53, 114688
    buffer_load_dwordx4 v[128:131], v24, s[32:35], s53 offen offset:0 sc1
    buffer_load_dwordx4 v[132:135], v24, s[32:35], s53 offen offset:1024 sc1
    s_waitcnt lgkmcnt(4)
    v_mfma_f32_32x32x16_bf16 v[64:79], v[20:23], v[144:147], v[64:79]
    buffer_load_dwordx4 v[136:139], v24, s[32:35], s15 offen offset:0 sc1
    v_mfma_f32_32x32x16_bf16 v[96:111], v[20:23], v[152:155], v[96:111]
    buffer_load_dwordx4 v[140:143], v24, s[32:35], s15 offen offset:1024 sc1
    s_mul_i32 s54, s41, 57344
    s_add_u32 s54, s54, s99
    s_add_u32 s54, s54, 1261568
    s_add_u32 s55, s54, 14336
    s_add_u32 m0, s48, 81920
    s_nop 0
    buffer_load_dwordx4 v25, s[20:23], s54 offen lds
    s_waitcnt lgkmcnt(2)
    v_mfma_f32_32x32x16_bf16 v[48:63], v[160:163], v[148:151], v[48:63]
    buffer_load_dwordx4 v26, s[20:23], s54 offen offset:1024 lds
    s_add_u32 m0, s48, 83968
    s_nop 0
    buffer_load_dwordx4 v25, s[20:23], s55 offen lds
    v_mfma_f32_32x32x16_bf16 v[80:95], v[160:163], v[156:159], v[80:95]
    buffer_load_dwordx4 v26, s[20:23], s55 offen offset:1024 lds
    s_waitcnt lgkmcnt(0)
    v_mfma_f32_32x32x16_bf16 v[64:79], v[164:167], v[148:151], v[64:79]
    v_mfma_f32_32x32x16_bf16 v[96:111], v[164:167], v[156:159], v[96:111]
    s_waitcnt vmcnt(12)
    s_barrier
    ds_read_b64_tr_b16 v[16:17], v28 offset:0
    ds_read_b64_tr_b16 v[18:19], v28 offset:1024
    ds_read_b64_tr_b16 v[20:21], v27 offset:0
    ds_read_b64_tr_b16 v[22:23], v27 offset:1024
    ds_read_b64_tr_b16 v[160:161], v28 offset:2048
    ds_read_b64_tr_b16 v[162:163], v28 offset:3072
    ds_read_b64_tr_b16 v[164:165], v27 offset:2048
    ds_read_b64_tr_b16 v[166:167], v27 offset:3072
    s_waitcnt lgkmcnt(6)
    v_mfma_f32_32x32x16_bf16 v[48:63], v[16:19], v[112:115], v[48:63]
    v_mfma_f32_32x32x16_bf16 v[80:95], v[16:19], v[120:123], v[80:95]
    s_waitcnt lgkmcnt(4)
    v_mfma_f32_32x32x16_bf16 v[64:79], v[20:23], v[112:115], v[64:79]
    v_mfma_f32_32x32x16_bf16 v[96:111], v[20:23], v[120:123], v[96:111]
    s_waitcnt lgkmcnt(2)
    v_mfma_f32_32x32x16_bf16 v[48:63], v[160:163], v[116:119], v[48:63]
    v_mfma_f32_32x32x16_bf16 v[80:95], v[160:163], v[124:127], v[80:95]
    s_waitcnt lgkmcnt(0)
    v_mfma_f32_32x32x16_bf16 v[64:79], v[164:167], v[116:119], v[64:79]
    v_mfma_f32_32x32x16_bf16 v[96:111], v[164:167], v[124:127], v[96:111]
    s_waitcnt vmcnt(0)
    s_barrier
    ds_read_b64_tr_b16 v[16:17], v28 offset:16384
    ds_read_b64_tr_b16 v[18:19], v28 offset:17408
    ds_read_b64_tr_b16 v[20:21], v27 offset:16384
    ds_read_b64_tr_b16 v[22:23], v27 offset:17408
    ds_read_b64_tr_b16 v[160:161], v28 offset:18432
    ds_read_b64_tr_b16 v[162:163], v28 offset:19456
    ds_read_b64_tr_b16 v[164:165], v27 offset:18432
    ds_read_b64_tr_b16 v[166:167], v27 offset:19456
    s_waitcnt lgkmcnt(6)
    v_mfma_f32_32x32x16_bf16 v[48:63], v[16:19], v[128:131], v[48:63]
    v_mfma_f32_32x32x16_bf16 v[80:95], v[16:19], v[136:139], v[80:95]
    s_waitcnt lgkmcnt(4)
    v_mfma_f32_32x32x16_bf16 v[64:79], v[20:23], v[128:131], v[64:79]
    v_mfma_f32_32x32x16_bf16 v[96:111], v[20:23], v[136:139], v[96:111]
    s_waitcnt lgkmcnt(2)
    v_mfma_f32_32x32x16_bf16 v[48:63], v[160:163], v[132:135], v[48:63]
    v_mfma_f32_32x32x16_bf16 v[80:95], v[160:163], v[140:143], v[80:95]
    s_waitcnt lgkmcnt(0)
    v_mfma_f32_32x32x16_bf16 v[64:79], v[164:167], v[132:135], v[64:79]
    v_mfma_f32_32x32x16_bf16 v[96:111], v[164:167], v[140:143], v[96:111]
    s_add_u32 s14, s39, 1
    s_and_b32 s14, s14, 3
    s_mul_i32 s15, s14, 12288
    s_add_u32 s15, s15, 122880
    v_add_u32 v1, s15, v24
    s_add_u32 s14, s39, 2
    s_and_b32 s14, s14, 3
    s_mul_i32 s15, s14, 12288
    s_add_u32 s15, s15, 118784
    v_add_u32 v2, s15, v24
    s_add_u32 s14, s39, 3
    s_and_b32 s14, s14, 3
    s_mul_i32 s15, s14, 12288
    s_add_u32 s15, s15, 114688
    v_add_u32 v3, s15, v24
    s_cmp_lg_u32 s39, 0
    s_cbranch_scc1 L_gp0
    ds_write_b128 v1, v[64:67] offset:0
    ds_write_b128 v1, v[68:71] offset:1024
    ds_write_b128 v1, v[72:75] offset:2048
    ds_write_b128 v1, v[76:79] offset:3072
    ds_write_b128 v2, v[80:83] offset:0
    ds_write_b128 v2, v[84:87] offset:1024
    ds_write_b128 v2, v[88:91] offset:2048
    ds_write_b128 v2, v[92:95] offset:3072
    ds_write_b128 v3, v[96:99] offset:0
    ds_write_b128 v3, v[100:103] offset:1024
    ds_write_b128 v3, v[104:107] offset:2048
    ds_write_b128 v3, v[108:111] offset:3072
L_gp0:
    s_cmp_lg_u32 s39, 1
    s_cbranch_scc1 L_gp1
    ds_write_b128 v1, v[80:83] offset:0
    ds_write_b128 v1, v[84:87] offset:1024
    ds_write_b128 v1, v[88:91] offset:2048
    ds_write_b128 v1, v[92:95] offset:3072
    ds_write_b128 v2, v[96:99] offset:0
    ds_write_b128 v2, v[100:103] offset:1024
    ds_write_b128 v2, v[104:107] offset:2048
    ds_write_b128 v2, v[108:111] offset:3072
    ds_write_b128 v3, v[48:51] offset:0
    ds_write_b128 v3, v[52:55] offset:1024
    ds_write_b128 v3, v[56:59] offset:2048
    ds_write_b128 v3, v[60:63] offset:3072
    v_mov_b32 v48, v64
    v_mov_b32 v49, v65
    v_mov_b32 v50, v66
    v_mov_b32 v51, v67
    v_mov_b32 v52, v68
    v_mov_b32 v53, v69
    v_mov_b32 v54, v70
    v_mov_b32 v55, v71
    v_mov_b32 v56, v72
    v_mov_b32 v57, v73
    v_mov_b32 v58, v74
    v_mov_b32 v59, v75
    v_mov_b32 v60, v76
    v_mov_b32 v61, v77
    v_mov_b32 v62, v78
    v_mov_b32 v63, v79
L_gp1:
    s_cmp_lg_u32 s39, 2
    s_cbranch_scc1 L_gp2
    ds_write_b128 v1, v[96:99] offset:0
    ds_write_b128 v1, v[100:103] offset:1024
    ds_write_b128 v1, v[104:107] offset:2048
    ds_write_b128 v1, v[108:111] offset:3072
    ds_write_b128 v2, v[48:51] offset:0
    ds_write_b128 v2, v[52:55] offset:1024
    ds_write_b128 v2, v[56:59] offset:2048
    ds_write_b128 v2, v[60:63] offset:3072
    ds_write_b128 v3, v[64:67] offset:0
    ds_write_b128 v3, v[68:71] offset:1024
    ds_write_b128 v3, v[72:75] offset:2048
    ds_write_b128 v3, v[76:79] offset:3072
    v_mov_b32 v48, v80
    v_mov_b32 v49, v81
    v_mov_b32 v50, v82
    v_mov_b32 v51, v83
    v_mov_b32 v52, v84
    v_mov_b32 v53, v85
    v_mov_b32 v54, v86
    v_mov_b32 v55, v87
    v_mov_b32 v56, v88
    v_mov_b32 v57, v89
    v_mov_b32 v58, v90
    v_mov_b32 v59, v91
    v_mov_b32 v60, v92
    v_mov_b32 v61, v93
    v_mov_b32 v62, v94
    v_mov_b32 v63, v95
L_gp2:
    s_cmp_lg_u32 s39, 3
    s_cbranch_scc1 L_gp3
    ds_write_b128 v1, v[48:51] offset:0
    ds_write_b128 v1, v[52:55] offset:1024
    ds_write_b128 v1, v[56:59] offset:2048
    ds_write_b128 v1, v[60:63] offset:3072
    ds_write_b128 v2, v[64:67] offset:0
    ds_write_b128 v2, v[68:71] offset:1024
    ds_write_b128 v2, v[72:75] offset:2048
    ds_write_b128 v2, v[76:79] offset:3072
    ds_write_b128 v3, v[80:83] offset:0
    ds_write_b128 v3, v[84:87] offset:1024
    ds_write_b128 v3, v[88:91] offset:2048
    ds_write_b128 v3, v[92:95] offset:3072
    v_mov_b32 v48, v96
    v_mov_b32 v49, v97
    v_mov_b32 v50, v98
    v_mov_b32 v51, v99
    v_mov_b32 v52, v100
    v_mov_b32 v53, v101
    v_mov_b32 v54, v102
    v_mov_b32 v55, v103
    v_mov_b32 v56, v104
    v_mov_b32 v57, v105
    v_mov_b32 v58, v106
    v_mov_b32 v59, v107
    v_mov_b32 v60, v108
    v_mov_b32 v61, v109
    v_mov_b32 v62, v110
    v_mov_b32 v63, v111
L_gp3:
    s_waitcnt lgkmcnt(0)
    s_barrier
    s_mov_b32 s24, s70
    s_mov_b32 s25, s71
    s_mov_b32 s26, 401408
    s_mov_b32 s27, 0x00020000
    s_mul_i32 s43, s39, 7168
    s_lshl_b32 s14, s77, 7
    s_add_u32 s43, s43, s14
    s_add_u32 m0, s46, -65536
    s_add_u32 s52, s43, 0
    buffer_load_dwordx4 v25, s[24:27], s52 offen lds
    s_add_u32 m0, s46, -61440
    s_add_u32 s52, s43, 28672
    buffer_load_dwordx4 v25, s[24:27], s52 offen lds
    s_add_u32 m0, s46, -57344
    s_add_u32 s52, s43, 57344
    buffer_load_dwordx4 v25, s[24:27], s52 offen lds
    s_add_u32 m0, s46, -53248
    s_add_u32 s52, s43, 86016
    buffer_load_dwordx4 v25, s[24:27], s52 offen lds
    s_add_u32 m0, s46, -49152
    s_add_u32 s52, s43, 114688
    buffer_load_dwordx4 v25, s[24:27], s52 offen lds
    s_add_u32 m0, s46, -45056
    s_add_u32 s52, s43, 143360
    buffer_load_dwordx4 v25, s[24:27], s52 offen lds
    s_add_u32 m0, s46, -40960
    s_add_u32 s52, s43, 172032
    buffer_load_dwordx4 v25, s[24:27], s52 offen lds
    s_add_u32 m0, s46, -36864
    s_add_u32 s52, s43, 200704
    buffer_load_dwordx4 v25, s[24:27], s52 offen lds
    s_add_u32 m0, s46, -32768
    s_add_u32 s52, s43, 200704
    buffer_load_dwordx4 v25, s[24:27], s52 offen lds
    s_add_u32 m0, s46, -28672
    s_add_u32 s52, s43, 229376
    buffer_load_dwordx4 v25, s[24:27], s52 offen lds
    s_add_u32 m0, s46, -24576
    s_add_u32 s52, s43, 258048
    buffer_load_dwordx4 v25, s[24:27], s52 offen lds
    s_add_u32 m0, s46, -20480
    s_add_u32 s52, s43, 286720
    buffer_load_dwordx4 v25, s[24:27], s52 offen lds
    s_add_u32 m0, s46, -16384
    s_add_u32 s52, s43, 315392
    buffer_load_dwordx4 v25, s[24:27], s52 offen lds
    s_add_u32 m0, s46, -12288
    s_add_u32 s52, s43, 344064
    buffer_load_dwordx4 v25, s[24:27], s52 offen lds
    s_add_u32 m0, s46, -8192
    s_add_u32 s52, s43, 372736
    buffer_load_dwordx4 v25, s[24:27], s52 offen lds
    s_add_u32 m0, s46, -4096
    s_add_u32 s52, s43, 401408
    buffer_load_dwordx4 v25, s[24:27], s52 offen lds
    v_mov_b32 v1, 20480
    ds_read_b128 v[4:7], v1
    ds_read_b128 v[8:11], v1 offset:16
    s_waitcnt lgkmcnt(0)
    v_or3_b32 v4, v4, v5, v6
    v_or3_b32 v4, v4, v7, v8
    v_or3_b32 v4, v4, v9, v10
    v_or_b32 v4, v4, v11
    s_nop 0
    v_readfirstlane_b32 s14, v4
    s_cmp_eq_u32 s14, 0
    s_cbranch_scc1 L_H2G_nofb
    s_barrier
L_H2G_nofb:
    s_mul_i32 s14, s39, 12288
    s_add_u32 s14, s14, 114688
    v_add_u32 v1, s14, v24
    ds_read_b128 v[64:67], v1 offset:0
    ds_read_b128 v[68:71], v1 offset:1024
    ds_read_b128 v[72:75], v1 offset:2048
    ds_read_b128 v[76:79], v1 offset:3072
    ds_read_b128 v[80:83], v1 offset:4096
    ds_read_b128 v[84:87], v1 offset:5120
    ds_read_b128 v[88:91], v1 offset:6144
    ds_read_b128 v[92:95], v1 offset:7168
    ds_read_b128 v[96:99], v1 offset:8192
    ds_read_b128 v[100:103], v1 offset:9216
    ds_read_b128 v[104:107], v1 offset:10240
    ds_read_b128 v[108:111], v1 offset:11264
    s_waitcnt lgkmcnt(0)
    v_add_f32 v48, v48, v64
    v_add_f32 v80, v80, v96
    v_add_f32 v49, v49, v65
    v_add_f32 v81, v81, v97
    v_add_f32 v50, v50, v66
    v_add_f32 v82, v82, v98
    v_add_f32 v51, v51, v67
    v_add_f32 v83, v83, v99
    v_add_f32 v52, v52, v68
    v_add_f32 v84, v84, v100
    v_add_f32 v53, v53, v69
    v_add_f32 v85, v85, v101
    v_add_f32 v54, v54, v70
    v_add_f32 v86, v86, v102
    v_add_f32 v55, v55, v71
    v_add_f32 v87, v87, v103
    v_add_f32 v56, v56, v72
    v_add_f32 v88, v88, v104
    v_add_f32 v57, v57, v73
    v_add_f32 v89, v89, v105
    v_add_f32 v58, v58, v74
    v_add_f32 v90, v90, v106
    v_add_f32 v59, v59, v75
    v_add_f32 v91, v91, v107
    v_add_f32 v60, v60, v76
    v_add_f32 v92, v92, v108
    v_add_f32 v61, v61, v77
    v_add_f32 v93, v93, v109
    v_add_f32 v62, v62, v78
    v_add_f32 v94, v94, v110
    v_add_f32 v63, v63, v79
    v_add_f32 v95, v95, v111
    v_add_f32 v48, v48, v80
    v_add_f32 v49, v49, v81
    v_add_f32 v50, v50, v82
    v_add_f32 v51, v51, v83
    v_add_f32 v52, v52, v84
    v_add_f32 v53, v53, v85
    v_add_f32 v54, v54, v86
    v_add_f32 v55, v55, v87
    v_add_f32 v56, v56, v88
    v_add_f32 v57, v57, v89
    v_add_f32 v58, v58, v90
    v_add_f32 v59, v59, v91
    v_add_f32 v60, v60, v92
    v_add_f32 v61, v61, v93
    v_add_f32 v62, v62, v94
    v_add_f32 v63, v63, v95
    v_and_b32 v11, 31, v0
    v_lshrrev_b32 v12, 5, v0
    v_mul_u32_u24 v27, 896, v11
    v_lshl_add_u32 v27, v12, 3, v27
    s_lshl_b32 s98, s76, 1
    s_add_u32 s98, s98, s41
    s_mul_i32 s98, s98, 28672
    s_lshl_b32 s14, s77, 7
    s_add_u32 s98, s98, s14
    s_lshl_b32 s14, s40, 6
    s_add_u32 s98, s98, s14
    buffer_load_dwordx2 v[112:113], v27, s[16:19], s98 offen offset:0
    buffer_load_dwordx2 v[114:115], v27, s[16:19], s98 offen offset:16
    buffer_load_dwordx2 v[116:117], v27, s[16:19], s98 offen offset:32
    buffer_load_dwordx2 v[118:119], v27, s[16:19], s98 offen offset:48
    v_mul_f32 v120, 0xbfb8aa3b, v48
    v_mul_f32 v121, 0xbfb8aa3b, v49
    v_mul_f32 v122, 0xbfb8aa3b, v50
    v_mul_f32 v123, 0xbfb8aa3b, v51
    v_mul_f32 v124, 0xbfb8aa3b, v52
    v_mul_f32 v125, 0xbfb8aa3b, v53
    v_mul_f32 v126, 0xbfb8aa3b, v54
    v_mul_f32 v127, 0xbfb8aa3b, v55
    v_mul_f32 v128, 0xbfb8aa3b, v56
    v_mul_f32 v129, 0xbfb8aa3b, v57
    v_mul_f32 v130, 0xbfb8aa3b, v58
    v_mul_f32 v131, 0xbfb8aa3b, v59
    v_mul_f32 v132, 0xbfb8aa3b, v60
    v_mul_f32 v133, 0xbfb8aa3b, v61
    v_mul_f32 v134, 0xbfb8aa3b, v62
    v_mul_f32 v135, 0xbfb8aa3b, v63
    v_exp_f32 v120, v120
    v_exp_f32 v121, v121
    v_exp_f32 v122, v122
    v_exp_f32 v123, v123
    v_exp_f32 v124, v124
    v_exp_f32 v125, v125
    v_exp_f32 v126, v126
    v_exp_f32 v127, v127
    v_exp_f32 v128, v128
    v_exp_f32 v129, v129
    v_exp_f32 v130, v130
    v_exp_f32 v131, v131
    v_exp_f32 v132, v132
    v_exp_f32 v133, v133
    v_exp_f32 v134, v134
    v_exp_f32 v135, v135
    v_add_f32 v120, 1.0, v120
    v_add_f32 v121, 1.0, v121
    v_add_f32 v122, 1.0, v122
    v_add_f32 v123, 1.0, v123
    v_add_f32 v124, 1.0, v124
    v_add_f32 v125, 1.0, v125
    v_add_f32 v126, 1.0, v126
    v_add_f32 v127, 1.0, v127
    v_add_f32 v128, 1.0, v128
    v_add_f32 v129, 1.0, v129
    v_add_f32 v130, 1.0, v130
    v_add_f32 v131, 1.0, v131
    v_add_f32 v132, 1.0, v132
    v_add_f32 v133, 1.0, v133
    v_add_f32 v134, 1.0, v134
    v_add_f32 v135, 1.0, v135
    v_rcp_f32 v120, v120
    v_rcp_f32 v121, v121
    v_rcp_f32 v122, v122
    v_rcp_f32 v123, v123
    v_rcp_f32 v124, v124
    v_rcp_f32 v125, v125
    v_rcp_f32 v126, v126
    v_rcp_f32 v127, v127
    v_rcp_f32 v128, v128
    v_rcp_f32 v129, v129
    v_rcp_f32 v130, v130
    v_rcp_f32 v131, v131
    v_rcp_f32 v132, v132
    v_rcp_f32 v133, v133
    v_rcp_f32 v134, v134
    v_rcp_f32 v135, v135
    v_mul_f32 v48, v48, v120
    v_mul_f32 v49, v49, v121
    v_mul_f32 v50, v50, v122
    v_mul_f32 v51, v51, v123
    v_mul_f32 v52, v52, v124
    v_mul_f32 v53, v53, v125
    v_mul_f32 v54, v54, v126
    v_mul_f32 v55, v55, v127
    v_mul_f32 v56, v56, v128
    v_mul_f32 v57, v57, v129
    v_mul_f32 v58, v58, v130
    v_mul_f32 v59, v59, v131
    v_mul_f32 v60, v60, v132
    v_mul_f32 v61, v61, v133
    v_mul_f32 v62, v62, v134
    v_mul_f32 v63, v63, v135
    s_mov_b32 s28, s66
    s_mov_b32 s29, s67
    s_mov_b32 s30, 1835008
    s_mov_b32 s31, 0x00020000
    v_and_b32 v36, 7, v0
    v_lshlrev_b32 v36, 2, v36
    s_lshl_b32 s14, s76, 7
    s_lshl_b32 s15, s39, 5
    s_add_u32 s14, s14, s15
    s_add_u32 s58, s14, 16801792
    s_lshl_b32 s53, s76, 16
    s_lshl_b32 s14, s39, 14
    s_add_u32 s53, s53, s14
    s_add_u32 s53, s53, 14680064
    s_mul_i32 s14, s39, 12288
    s_add_u32 s14, s14, 114688
    s_lshl_b32 s11, s39, 12
    s_add_u32 s11, s11, 20480
    s_mov_b32 s12, 0
    s_mov_b32 s96, 200000
L_o_poll:
    buffer_load_dword v38, v36, s[32:35], s58 offen sc1
    s_waitcnt vmcnt(0)
    v_cmp_eq_u32 vcc, s49, v38
    s_andn2_b32 s13, vcc_lo, s12
    s_and_b32 s13, s13, 0xff
    s_cbranch_scc0 L_o_next
    s_or_b32 s12, s12, s13
L_o_bit:
    s_ff1_i32_b32 s15, s13
    s_bitset0_b32 s13, s15
    s_cmp_lt_u32 s15, 6
    s_cselect_b32 s10, s14, s11
    s_lshl_b32 s15, s15, 11
    s_add_u32 m0, s10, s15
    s_add_u32 s52, s53, s15
    buffer_load_dwordx4 v24, s[32:35], s52 offen sc1 lds
    buffer_load_dwordx4 v24, s[32:35], s52 offen offset:1024 sc1 lds
    s_cmp_lg_u32 s13, 0
    s_cbranch_scc1 L_o_bit
    s_cmp_eq_u32 s12, 0xff
    s_cbranch_scc1 L_o_done
L_o_next:
    s_sub_u32 s96, s96, 1
    s_cbranch_scc0 L_o_poll
L_o_done:
    v_lshlrev_b32 v120, 16, v112
    v_and_b32 v121, 0xffff0000, v112
    v_lshlrev_b32 v122, 16, v113
    v_and_b32 v123, 0xffff0000, v113
    v_lshlrev_b32 v124, 16, v114
    v_and_b32 v125, 0xffff0000, v114
    v_lshlrev_b32 v126, 16, v115
    v_and_b32 v127, 0xffff0000, v115
    v_lshlrev_b32 v128, 16, v116
    v_and_b32 v129, 0xffff0000, v116
    v_lshlrev_b32 v130, 16, v117
    v_and_b32 v131, 0xffff0000, v117
    v_lshlrev_b32 v132, 16, v118
    v_and_b32 v133, 0xffff0000, v118
    v_lshlrev_b32 v134, 16, v119
    v_and_b32 v135, 0xffff0000, v119
    s_lshl_b32 s14, s39, 12
    s_add_u32 s14, s14, 0
    v_add_u32 v1, s14, v24
    s_waitcnt vmcnt(0)
    s_barrier
    s_barrier
    ds_read_b128 v[136:139], v1 offset:0
    ds_read_b128 v[140:143], v1 offset:1024
    ds_read_b128 v[144:147], v1 offset:2048
    ds_read_b128 v[148:151], v1 offset:3072
    ds_read_b128 v[152:155], v1 offset:16384
    ds_read_b128 v[156:159], v1 offset:17408
    ds_read_b128 v[160:163], v1 offset:18432
    ds_read_b128 v[164:167], v1 offset:19456
    s_waitcnt lgkmcnt(0)
    v_add_f32 v136, v136, v152
    v_add_f32 v137, v137, v153
    v_add_f32 v138, v138, v154
    v_add_f32 v139, v139, v155
    v_add_f32 v140, v140, v156
    v_add_f32 v141, v141, v157
    v_add_f32 v142, v142, v158
    v_add_f32 v143, v143, v159
    v_add_f32 v144, v144, v160
    v_add_f32 v145, v145, v161
    v_add_f32 v146, v146, v162
    v_add_f32 v147, v147, v163
    v_add_f32 v148, v148, v164
    v_add_f32 v149, v149, v165
    v_add_f32 v150, v150, v166
    v_add_f32 v151, v151, v167
    v_fma_f32 v136, v136, v48, v120
    v_fma_f32 v137, v137, v49, v121
    v_fma_f32 v138, v138, v50, v122
    v_fma_f32 v139, v139, v51, v123
    v_fma_f32 v140, v140, v52, v124
    v_fma_f32 v141, v141, v53, v125
    v_fma_f32 v142, v142, v54, v126
    v_fma_f32 v143, v143, v55, v127
    v_fma_f32 v144, v144, v56, v128
    v_fma_f32 v145, v145, v57, v129
    v_fma_f32 v146, v146, v58, v130
    v_fma_f32 v147, v147, v59, v131
    v_fma_f32 v148, v148, v60, v132
    v_fma_f32 v149, v149, v61, v133
    v_fma_f32 v150, v150, v62, v134
    v_fma_f32 v151, v151, v63, v135
    v_cvt_pk_bf16_f32 v112, v136, v137
    v_cvt_pk_bf16_f32 v113, v138, v139
    v_cvt_pk_bf16_f32 v114, v140, v141
    v_cvt_pk_bf16_f32 v115, v142, v143
    v_cvt_pk_bf16_f32 v116, v144, v145
    v_cvt_pk_bf16_f32 v117, v146, v147
    v_cvt_pk_bf16_f32 v118, v148, v149
    v_cvt_pk_bf16_f32 v119, v150, v151
    buffer_store_dwordx2 v[112:113], v27, s[28:31], s98 offen offset:0
    buffer_store_dwordx2 v[114:115], v27, s[28:31], s98 offen offset:16
    buffer_store_dwordx2 v[116:117], v27, s[28:31], s98 offen offset:32
    buffer_store_dwordx2 v[118:119], v27, s[28:31], s98 offen offset:48
    s_or_b32 s14, s2, s39
    s_cmp_lg_u32 s14, 0
    s_cbranch_scc1 L_H2G_fin
    s_mov_b32 s14, 16777216
    v_mov_b32 v1, s49
    v_mov_b32 v2, 0
    s_mov_b64 exec, 1
    buffer_store_dword v1, v2, s[32:35], s14 offen offset:0 sc1
    s_mov_b64 exec, -1
L_H2G_fin:
    s_endpgm
L_P2poll:
    v_mov_b32 v2, 158720
    s_mov_b32 s96, 4000000
L_P2pl:
    ds_read_b32 v1, v2
    s_waitcnt lgkmcnt(0)
    v_cmp_ne_u32 vcc, s49, v1
    s_cbranch_vccz L_P2pl_ok
    s_sleep 1
    s_sub_u32 s96, s96, 1
    s_cbranch_scc0 L_P2pl
L_P2pl_ok:
    s_lshl_b32 s11, s74, 17
    s_lshl_b32 s12, s75, 2
    s_add_u32 s12, s12, s39
    s_lshl_b32 s13, s12, 11
    s_add_u32 s13, s13, s11
    s_lshr_b32 s14, s38, 2
    s_lshl_b32 s14, s14, 16
    s_add_u32 s14, s14, s11
    s_add_u32 s14, s14, 2097152
    v_lshl_add_u32 v34, v29, 9, v28
    buffer_load_dwordx2 v[160:161], v34, s[32:35], s13 offen offset:0 sc1
    buffer_load_dwordx2 v[162:163], v34, s[32:35], s13 offen offset:256 sc1
    buffer_load_dwordx2 v[164:165], v34, s[32:35], s13 offen offset:1024 sc1
    buffer_load_dwordx2 v[166:167], v34, s[32:35], s13 offen offset:1280 sc1
    buffer_load_dwordx2 v[96:97], v34, s[32:35], s14 offen offset:0 sc1
    buffer_load_dwordx2 v[98:99], v34, s[32:35], s14 offen offset:256 sc1
    buffer_load_dwordx2 v[100:101], v34, s[32:35], s14 offen offset:1024 sc1
    buffer_load_dwordx2 v[102:103], v34, s[32:35], s14 offen offset:1280 sc1
    s_waitcnt vmcnt(0)
L_P2:
    s_lshr_b32 s15, s38, 2
    s_lshl_b32 s9, s15, 13
    v_add_u32 v16, s9, v34
    s_lshl_b32 s3, s39, 12
    s_add_u32 s3, s3, 0
    v_add_u32 v19, s3, v27
    v_bfe_u32 v12, v0, 2, 2
    v_bfe_u32 v13, v0, 4, 1
    v_and_b32 v14, 3, v0
    v_lshl_add_u32 v14, v13, 2, v14
    v_xor_b32 v1, v14, v29
    v_lshl_add_u32 v1, v1, 2, v12
    v_lshlrev_b32 v1, 3, v1
    v_lshl_add_u32 v21, v14, 8, v1
    s_add_u32 s9, s9, 4096
    v_add_u32 v22, s9, v21
    v_xor_b32 v23, 64, v22
    v_xor_b32 v24, 128, v22
    v_xor_b32 v25, 192, v22
    s_lshl_b32 s12, s75, 2
    s_add_u32 s12, s12, s39
    s_lshl_b32 s9, s12, 4
    s_add_u32 s9, s9, s74
    s_lshl_b32 s97, s9, 2
    s_add_u32 s97, s97, 16801792
    s_lshl_b32 s9, s9, 11
    s_add_u32 s100, s9, 14680064
    v_mfma_f32_32x32x16_bf16 v[112:127], v[96:99], v[160:163], 0
    v_mfma_f32_32x32x16_bf16 v[112:127], v[100:103], v[164:167], v[112:127]
    s_nop 11
    v_max3_f32 v64, v112, v113, v114
    v_max3_f32 v64, v64, v115, v116
    v_max3_f32 v64, v64, v117, v118
    v_max3_f32 v64, v64, v119, v120
    v_max3_f32 v64, v64, v121, v122
    v_max3_f32 v64, v64, v123, v124
    v_max3_f32 v64, v64, v125, v126
    v_max_f32 v64, v64, v127
    v_mov_b32 v65, v64
    s_nop 1
    v_permlane32_swap_b32 v64, v65
    v_max_f32 v20, v64, v65
    v_cvt_pk_bf16_f32 v64, -v20, -v20
    v_and_b32 v64, 0xffff0000, v64
    v_sub_f32 v65, -v20, v64
    v_cvt_pk_bf16_f32 v66, -v20, v65
    v_and_b32 v64, 0xffff0000, v66
    v_sub_f32 v65, v65, v64
    v_cvt_pk_bf16_f32 v67, v65, 0
    s_mov_b64 exec, s[50:51]
    v_mov_b32 v166, v66
    v_mov_b32 v167, v67
    s_mov_b64 exec, -1
    v_mfma_f32_32x32x16_bf16 v[112:127], v[96:99], v[160:163], 0
    v_mfma_f32_32x32x16_bf16 v[112:127], v[100:103], v[164:167], v[112:127]
    s_barrier
    s_setprio 1
    ds_read_b64 v[104:105], v16 offset:0
    ds_read_b64 v[106:107], v16 offset:256
    ds_read_b64 v[108:109], v16 offset:1024
    ds_read_b64 v[110:111], v16 offset:1280
    ds_read_b64_tr_b16 v[40:41], v22 offset:0
    ds_read_b64_tr_b16 v[42:43], v23 offset:0
    ds_read_b64_tr_b16 v[44:45], v24 offset:0
    ds_read_b64_tr_b16 v[46:47], v25 offset:0
    s_waitcnt lgkmcnt(6)
    v_mfma_f32_32x32x16_bf16 v[128:143], v[104:107], v[160:163], 0
    ds_read_b64 v[96:97], v16 offset:2048
    ds_read_b64 v[98:99], v16 offset:2304
    ds_read_b64 v[100:101], v16 offset:3072
    ds_read_b64 v[102:103], v16 offset:3328
    v_exp_f32 v112, v112
    v_exp_f32 v113, v113
    v_exp_f32 v114, v114
    v_exp_f32 v115, v115
    v_exp_f32 v116, v116
    ds_read_b64_tr_b16 v[48:49], v22 offset:2048
    ds_read_b64_tr_b16 v[50:51], v23 offset:2048
    ds_read_b64_tr_b16 v[52:53], v24 offset:2048
    ds_read_b64_tr_b16 v[54:55], v25 offset:2048
    v_exp_f32 v117, v117
    v_exp_f32 v118, v118
    v_exp_f32 v119, v119
    v_cvt_pk_bf16_f32 v56, v112, v113
    v_cvt_pk_bf16_f32 v57, v114, v115
    v_cvt_pk_bf16_f32 v58, v116, v117
    v_cvt_pk_bf16_f32 v59, v118, v119
    s_waitcnt lgkmcnt(12)
    v_mfma_f32_32x32x16_bf16 v[128:143], v[108:111], v[164:167], v[128:143]
    v_exp_f32 v120, v120
    v_exp_f32 v121, v121
    v_exp_f32 v122, v122
    v_exp_f32 v123, v123
    v_exp_f32 v124, v124
    s_waitcnt lgkmcnt(10)
    v_mfma_f32_32x32x16_bf16 v[144:159], v[40:43], v[56:59], 0
    v_exp_f32 v125, v125
    v_exp_f32 v126, v126
    v_exp_f32 v127, v127
    v_cvt_pk_bf16_f32 v60, v120, v121
    v_cvt_pk_bf16_f32 v61, v122, v123
    v_cvt_pk_bf16_f32 v62, v124, v125
    v_cvt_pk_bf16_f32 v63, v126, v127
    s_waitcnt lgkmcnt(6)
    v_mfma_f32_32x32x16_bf16 v[112:127], v[96:99], v[160:163], 0
    s_barrier
    ds_read_b64 v[104:105], v16 offset:16384
    ds_read_b64 v[106:107], v16 offset:16640
    ds_read_b64 v[108:109], v16 offset:17408
    ds_read_b64 v[110:111], v16 offset:17664
    v_exp_f32 v128, v128
    v_exp_f32 v129, v129
    v_exp_f32 v130, v130
    v_exp_f32 v131, v131
    v_exp_f32 v132, v132
    v_mfma_f32_32x32x16_bf16 v[144:159], v[44:47], v[60:63], v[144:159]
    ds_read_b64_tr_b16 v[40:41], v22 offset:16384
    ds_read_b64_tr_b16 v[42:43], v23 offset:16384
    ds_read_b64_tr_b16 v[44:45], v24 offset:16384
    ds_read_b64_tr_b16 v[46:47], v25 offset:16384
    v_exp_f32 v133, v133
    v_exp_f32 v134, v134
    v_exp_f32 v135, v135
    v_cvt_pk_bf16_f32 v56, v128, v129
    v_cvt_pk_bf16_f32 v57, v130, v131
    v_cvt_pk_bf16_f32 v58, v132, v133
    v_cvt_pk_bf16_f32 v59, v134, v135
    s_waitcnt lgkmcnt(12)
    v_mfma_f32_32x32x16_bf16 v[112:127], v[100:103], v[164:167], v[112:127]
    v_exp_f32 v136, v136
    v_exp_f32 v137, v137
    v_exp_f32 v138, v138
    v_exp_f32 v139, v139
    v_exp_f32 v140, v140
    s_waitcnt lgkmcnt(10)
    v_mfma_f32_32x32x16_bf16 v[144:159], v[48:51], v[56:59], v[144:159]
    v_exp_f32 v141, v141
    v_exp_f32 v142, v142
    v_exp_f32 v143, v143
    v_cvt_pk_bf16_f32 v60, v136, v137
    v_cvt_pk_bf16_f32 v61, v138, v139
    v_cvt_pk_bf16_f32 v62, v140, v141
    v_cvt_pk_bf16_f32 v63, v142, v143
    s_waitcnt lgkmcnt(6)
    v_mfma_f32_32x32x16_bf16 v[128:143], v[104:107], v[160:163], 0
    ds_read_b64 v[96:97], v16 offset:18432
    ds_read_b64 v[98:99], v16 offset:18688
    ds_read_b64 v[100:101], v16 offset:19456
    ds_read_b64 v[102:103], v16 offset:19712
    v_exp_f32 v112, v112
    v_exp_f32 v113, v113
    v_exp_f32 v114, v114
    v_exp_f32 v115, v115
    v_exp_f32 v116, v116
    v_mfma_f32_32x32x16_bf16 v[144:159], v[52:55], v[60:63], v[144:159]
    ds_read_b64_tr_b16 v[48:49], v22 offset:18432
    ds_read_b64_tr_b16 v[50:51], v23 offset:18432
    ds_read_b64_tr_b16 v[52:53], v24 offset:18432
    ds_read_b64_tr_b16 v[54:55], v25 offset:18432
    v_exp_f32 v117, v117
    v_exp_f32 v118, v118
    v_exp_f32 v119, v119
    v_cvt_pk_bf16_f32 v56, v112, v113
    v_cvt_pk_bf16_f32 v57, v114, v115
    v_cvt_pk_bf16_f32 v58, v116, v117
    v_cvt_pk_bf16_f32 v59, v118, v119
    s_waitcnt lgkmcnt(12)
    v_mfma_f32_32x32x16_bf16 v[128:143], v[108:111], v[164:167], v[128:143]
    v_exp_f32 v120, v120
    v_exp_f32 v121, v121
    v_exp_f32 v122, v122
    v_exp_f32 v123, v123
    v_exp_f32 v124, v124
    s_waitcnt lgkmcnt(10)
    v_mfma_f32_32x32x16_bf16 v[144:159], v[40:43], v[56:59], v[144:159]
    v_exp_f32 v125, v125
    v_exp_f32 v126, v126
    v_exp_f32 v127, v127
    v_cvt_pk_bf16_f32 v60, v120, v121
    v_cvt_pk_bf16_f32 v61, v122, v123
    v_cvt_pk_bf16_f32 v62, v124, v125
    v_cvt_pk_bf16_f32 v63, v126, v127
    s_waitcnt lgkmcnt(6)
    v_mfma_f32_32x32x16_bf16 v[112:127], v[96:99], v[160:163], 0
    s_barrier
    ds_read_b64 v[104:105], v16 offset:32768
    ds_read_b64 v[106:107], v16 offset:33024
    ds_read_b64 v[108:109], v16 offset:33792
    ds_read_b64 v[110:111], v16 offset:34048
    s_cmp_eq_u32 s43, 0
    s_cbranch_scc1 L_nopend
    s_waitcnt vmcnt(0)
    v_mov_b32 v1, s49
    v_mov_b32 v2, 0
    s_mov_b64 exec, 1
    buffer_store_dword v1, v2, s[32:35], s43 offen offset:0 sc1
    s_mov_b64 exec, -1
L_nopend:
    v_exp_f32 v128, v128
    v_exp_f32 v129, v129
    v_exp_f32 v130, v130
    v_exp_f32 v131, v131
    v_exp_f32 v132, v132
    v_mfma_f32_32x32x16_bf16 v[144:159], v[44:47], v[60:63], v[144:159]
    ds_read_b64_tr_b16 v[40:41], v22 offset:32768
    ds_read_b64_tr_b16 v[42:43], v23 offset:32768
    ds_read_b64_tr_b16 v[44:45], v24 offset:32768
    ds_read_b64_tr_b16 v[46:47], v25 offset:32768
    v_exp_f32 v133, v133
    v_exp_f32 v134, v134
    v_exp_f32 v135, v135
    v_cvt_pk_bf16_f32 v56, v128, v129
    v_cvt_pk_bf16_f32 v57, v130, v131
    v_cvt_pk_bf16_f32 v58, v132, v133
    v_cvt_pk_bf16_f32 v59, v134, v135
    s_waitcnt lgkmcnt(12)
    v_mfma_f32_32x32x16_bf16 v[112:127], v[100:103], v[164:167], v[112:127]
    v_exp_f32 v136, v136
    v_exp_f32 v137, v137
    v_exp_f32 v138, v138
    v_exp_f32 v139, v139
    v_exp_f32 v140, v140
    s_waitcnt lgkmcnt(10)
    v_mfma_f32_32x32x16_bf16 v[144:159], v[48:51], v[56:59], v[144:159]
    v_exp_f32 v141, v141
    v_exp_f32 v142, v142
    v_exp_f32 v143, v143
    v_cvt_pk_bf16_f32 v60, v136, v137
    v_cvt_pk_bf16_f32 v61, v138, v139
    v_cvt_pk_bf16_f32 v62, v140, v141
    v_cvt_pk_bf16_f32 v63, v142, v143
    s_waitcnt lgkmcnt(6)
    v_mfma_f32_32x32x16_bf16 v[128:143], v[104:107], v[160:163], 0
    ds_read_b64 v[96:97], v16 offset:34816
    ds_read_b64 v[98:99], v16 offset:35072
    ds_read_b64 v[100:101], v16 offset:35840
    ds_read_b64 v[102:103], v16 offset:36096
    v_exp_f32 v112, v112
    v_exp_f32 v113, v113
    v_exp_f32 v114, v114
    v_exp_f32 v115, v115
    v_exp_f32 v116, v116
    v_mfma_f32_32x32x16_bf16 v[144:159], v[52:55], v[60:63], v[144:159]
    ds_read_b64_tr_b16 v[48:49], v22 offset:34816
    ds_read_b64_tr_b16 v[50:51], v23 offset:34816
    ds_read_b64_tr_b16 v[52:53], v24 offset:34816
    ds_read_b64_tr_b16 v[54:55], v25 offset:34816
    v_exp_f32 v117, v117
    v_exp_f32 v118, v118
    v_exp_f32 v119, v119
    v_cvt_pk_bf16_f32 v56, v112, v113
    v_cvt_pk_bf16_f32 v57, v114, v115
    v_cvt_pk_bf16_f32 v58, v116, v117
    v_cvt_pk_bf16_f32 v59, v118, v119
    s_waitcnt lgkmcnt(12)
    v_mfma_f32_32x32x16_bf16 v[128:143], v[108:111], v[164:167], v[128:143]
    v_exp_f32 v120, v120
    v_exp_f32 v121, v121
    v_exp_f32 v122, v122
    v_exp_f32 v123, v123
    v_exp_f32 v124, v124
    s_waitcnt lgkmcnt(10)
    v_mfma_f32_32x32x16_bf16 v[144:159], v[40:43], v[56:59], v[144:159]
    v_exp_f32 v125, v125
    v_exp_f32 v126, v126
    v_exp_f32 v127, v127
    v_cvt_pk_bf16_f32 v60, v120, v121
    v_cvt_pk_bf16_f32 v61, v122, v123
    v_cvt_pk_bf16_f32 v62, v124, v125
    v_cvt_pk_bf16_f32 v63, v126, v127
    s_waitcnt lgkmcnt(6)
    v_mfma_f32_32x32x16_bf16 v[112:127], v[96:99], v[160:163], 0
    s_barrier
    ds_read_b64 v[104:105], v16 offset:49152
    ds_read_b64 v[106:107], v16 offset:49408
    ds_read_b64 v[108:109], v16 offset:50176
    ds_read_b64 v[110:111], v16 offset:50432
    v_exp_f32 v128, v128
    v_exp_f32 v129, v129
    v_exp_f32 v130, v130
    v_exp_f32 v131, v131
    v_exp_f32 v132, v132
    v_mfma_f32_32x32x16_bf16 v[144:159], v[44:47], v[60:63], v[144:159]
    ds_read_b64_tr_b16 v[40:41], v22 offset:49152
    ds_read_b64_tr_b16 v[42:43], v23 offset:49152
    ds_read_b64_tr_b16 v[44:45], v24 offset:49152
    ds_read_b64_tr_b16 v[46:47], v25 offset:49152
    v_exp_f32 v133, v133
    v_exp_f32 v134, v134
    v_exp_f32 v135, v135
    v_cvt_pk_bf16_f32 v56, v128, v129
    v_cvt_pk_bf16_f32 v57, v130, v131
    v_cvt_pk_bf16_f32 v58, v132, v133
    v_cvt_pk_bf16_f32 v59, v134, v135
    s_waitcnt lgkmcnt(12)
    v_mfma_f32_32x32x16_bf16 v[112:127], v[100:103], v[164:167], v[112:127]
    v_exp_f32 v136, v136
    v_exp_f32 v137, v137
    v_exp_f32 v138, v138
    v_exp_f32 v139, v139
    v_exp_f32 v140, v140
    s_waitcnt lgkmcnt(10)
    v_mfma_f32_32x32x16_bf16 v[144:159], v[48:51], v[56:59], v[144:159]
    v_exp_f32 v141, v141
    v_exp_f32 v142, v142
    v_exp_f32 v143, v143
    v_cvt_pk_bf16_f32 v60, v136, v137
    v_cvt_pk_bf16_f32 v61, v138, v139
    v_cvt_pk_bf16_f32 v62, v140, v141
    v_cvt_pk_bf16_f32 v63, v142, v143
    s_waitcnt lgkmcnt(6)
    v_mfma_f32_32x32x16_bf16 v[128:143], v[104:107], v[160:163], 0
    ds_read_b64 v[96:97], v16 offset:51200
    ds_read_b64 v[98:99], v16 offset:51456
    ds_read_b64 v[100:101], v16 offset:52224
    ds_read_b64 v[102:103], v16 offset:52480
    v_exp_f32 v112, v112
    v_exp_f32 v113, v113
    v_exp_f32 v114, v114
    v_exp_f32 v115, v115
    v_exp_f32 v116, v116
    v_mfma_f32_32x32x16_bf16 v[144:159], v[52:55], v[60:63], v[144:159]
    ds_read_b64_tr_b16 v[48:49], v22 offset:51200
    ds_read_b64_tr_b16 v[50:51], v23 offset:51200
    ds_read_b64_tr_b16 v[52:53], v24 offset:51200
    ds_read_b64_tr_b16 v[54:55], v25 offset:51200
    v_exp_f32 v117, v117
    v_exp_f32 v118, v118
    v_exp_f32 v119, v119
    v_cvt_pk_bf16_f32 v56, v112, v113
    v_cvt_pk_bf16_f32 v57, v114, v115
    v_cvt_pk_bf16_f32 v58, v116, v117
    v_cvt_pk_bf16_f32 v59, v118, v119
    s_waitcnt lgkmcnt(12)
    v_mfma_f32_32x32x16_bf16 v[128:143], v[108:111], v[164:167], v[128:143]
    v_exp_f32 v120, v120
    v_exp_f32 v121, v121
    v_exp_f32 v122, v122
    v_exp_f32 v123, v123
    v_exp_f32 v124, v124
    s_waitcnt lgkmcnt(10)
    v_mfma_f32_32x32x16_bf16 v[144:159], v[40:43], v[56:59], v[144:159]
    v_exp_f32 v125, v125
    v_exp_f32 v126, v126
    v_exp_f32 v127, v127
    v_cvt_pk_bf16_f32 v60, v120, v121
    v_cvt_pk_bf16_f32 v61, v122, v123
    v_cvt_pk_bf16_f32 v62, v124, v125
    v_cvt_pk_bf16_f32 v63, v126, v127
    s_waitcnt lgkmcnt(6)
    v_mfma_f32_32x32x16_bf16 v[112:127], v[96:99], v[160:163], 0
    s_barrier
    ds_read_b64 v[104:105], v16 offset:0
    ds_read_b64 v[106:107], v16 offset:256
    ds_read_b64 v[108:109], v16 offset:1024
    ds_read_b64 v[110:111], v16 offset:1280
    v_exp_f32 v128, v128
    v_exp_f32 v129, v129
    v_exp_f32 v130, v130
    v_exp_f32 v131, v131
    v_exp_f32 v132, v132
    v_mfma_f32_32x32x16_bf16 v[144:159], v[44:47], v[60:63], v[144:159]
    ds_read_b64_tr_b16 v[40:41], v22 offset:0
    ds_read_b64_tr_b16 v[42:43], v23 offset:0
    ds_read_b64_tr_b16 v[44:45], v24 offset:0
    ds_read_b64_tr_b16 v[46:47], v25 offset:0
    v_exp_f32 v133, v133
    v_exp_f32 v134, v134
    v_exp_f32 v135, v135
    v_cvt_pk_bf16_f32 v56, v128, v129
    v_cvt_pk_bf16_f32 v57, v130, v131
    v_cvt_pk_bf16_f32 v58, v132, v133
    v_cvt_pk_bf16_f32 v59, v134, v135
    s_waitcnt lgkmcnt(12)
    v_mfma_f32_32x32x16_bf16 v[112:127], v[100:103], v[164:167], v[112:127]
    v_exp_f32 v136, v136
    v_exp_f32 v137, v137
    v_exp_f32 v138, v138
    v_exp_f32 v139, v139
    v_exp_f32 v140, v140
    s_waitcnt lgkmcnt(10)
    v_mfma_f32_32x32x16_bf16 v[144:159], v[48:51], v[56:59], v[144:159]
    v_exp_f32 v141, v141
    v_exp_f32 v142, v142
    v_exp_f32 v143, v143
    v_cvt_pk_bf16_f32 v60, v136, v137
    v_cvt_pk_bf16_f32 v61, v138, v139
    v_cvt_pk_bf16_f32 v62, v140, v141
    v_cvt_pk_bf16_f32 v63, v142, v143
    s_waitcnt lgkmcnt(6)
    v_mfma_f32_32x32x16_bf16 v[128:143], v[104:107], v[160:163], 0
    ds_read_b64 v[96:97], v16 offset:2048
    ds_read_b64 v[98:99], v16 offset:2304
    ds_read_b64 v[100:101], v16 offset:3072
    ds_read_b64 v[102:103], v16 offset:3328
    v_exp_f32 v112, v112
    v_exp_f32 v113, v113
    v_exp_f32 v114, v114
    v_exp_f32 v115, v115
    v_exp_f32 v116, v116
    v_mfma_f32_32x32x16_bf16 v[144:159], v[52:55], v[60:63], v[144:159]
    ds_read_b64_tr_b16 v[48:49], v22 offset:2048
    ds_read_b64_tr_b16 v[50:51], v23 offset:2048
    ds_read_b64_tr_b16 v[52:53], v24 offset:2048
    ds_read_b64_tr_b16 v[54:55], v25 offset:2048
    v_exp_f32 v117, v117
    v_exp_f32 v118, v118
    v_exp_f32 v119, v119
    v_cvt_pk_bf16_f32 v56, v112, v113
    v_cvt_pk_bf16_f32 v57, v114, v115
    v_cvt_pk_bf16_f32 v58, v116, v117
    v_cvt_pk_bf16_f32 v59, v118, v119
    s_waitcnt lgkmcnt(12)
    v_mfma_f32_32x32x16_bf16 v[128:143], v[108:111], v[164:167], v[128:143]
    v_exp_f32 v120, v120
    v_exp_f32 v121, v121
    v_exp_f32 v122, v122
    v_exp_f32 v123, v123
    v_exp_f32 v124, v124
    s_waitcnt lgkmcnt(10)
    v_mfma_f32_32x32x16_bf16 v[144:159], v[40:43], v[56:59], v[144:159]
    v_exp_f32 v125, v125
    v_exp_f32 v126, v126
    v_exp_f32 v127, v127
    v_cvt_pk_bf16_f32 v60, v120, v121
    v_cvt_pk_bf16_f32 v61, v122, v123
    v_cvt_pk_bf16_f32 v62, v124, v125
    v_cvt_pk_bf16_f32 v63, v126, v127
    s_waitcnt lgkmcnt(6)
    v_mfma_f32_32x32x16_bf16 v[112:127], v[96:99], v[160:163], 0
    s_barrier
    ds_read_b64 v[104:105], v16 offset:16384
    ds_read_b64 v[106:107], v16 offset:16640
    ds_read_b64 v[108:109], v16 offset:17408
    ds_read_b64 v[110:111], v16 offset:17664
    v_exp_f32 v128, v128
    v_exp_f32 v129, v129
    v_exp_f32 v130, v130
    v_exp_f32 v131, v131
    v_exp_f32 v132, v132
    v_mfma_f32_32x32x16_bf16 v[144:159], v[44:47], v[60:63], v[144:159]
    ds_read_b64_tr_b16 v[40:41], v22 offset:16384
    ds_read_b64_tr_b16 v[42:43], v23 offset:16384
    ds_read_b64_tr_b16 v[44:45], v24 offset:16384
    ds_read_b64_tr_b16 v[46:47], v25 offset:16384
    v_exp_f32 v133, v133
    v_exp_f32 v134, v134
    v_exp_f32 v135, v135
    v_cvt_pk_bf16_f32 v56, v128, v129
    v_cvt_pk_bf16_f32 v57, v130, v131
    v_cvt_pk_bf16_f32 v58, v132, v133
    v_cvt_pk_bf16_f32 v59, v134, v135
    s_waitcnt lgkmcnt(12)
    v_mfma_f32_32x32x16_bf16 v[112:127], v[100:103], v[164:167], v[112:127]
    v_exp_f32 v136, v136
    v_exp_f32 v137, v137
    v_exp_f32 v138, v138
    v_exp_f32 v139, v139
    v_exp_f32 v140, v140
    s_waitcnt lgkmcnt(10)
    v_mfma_f32_32x32x16_bf16 v[144:159], v[48:51], v[56:59], v[144:159]
    v_exp_f32 v141, v141
    v_exp_f32 v142, v142
    v_exp_f32 v143, v143
    v_cvt_pk_bf16_f32 v60, v136, v137
    v_cvt_pk_bf16_f32 v61, v138, v139
    v_cvt_pk_bf16_f32 v62, v140, v141
    v_cvt_pk_bf16_f32 v63, v142, v143
    s_waitcnt lgkmcnt(6)
    v_mfma_f32_32x32x16_bf16 v[128:143], v[104:107], v[160:163], 0
    ds_read_b64 v[96:97], v16 offset:18432
    ds_read_b64 v[98:99], v16 offset:18688
    ds_read_b64 v[100:101], v16 offset:19456
    ds_read_b64 v[102:103], v16 offset:19712
    v_exp_f32 v112, v112
    v_exp_f32 v113, v113
    v_exp_f32 v114, v114
    v_exp_f32 v115, v115
    v_exp_f32 v116, v116
    v_mfma_f32_32x32x16_bf16 v[144:159], v[52:55], v[60:63], v[144:159]
    ds_read_b64_tr_b16 v[48:49], v22 offset:18432
    ds_read_b64_tr_b16 v[50:51], v23 offset:18432
    ds_read_b64_tr_b16 v[52:53], v24 offset:18432
    ds_read_b64_tr_b16 v[54:55], v25 offset:18432
    v_exp_f32 v117, v117
    v_exp_f32 v118, v118
    v_exp_f32 v119, v119
    v_cvt_pk_bf16_f32 v56, v112, v113
    v_cvt_pk_bf16_f32 v57, v114, v115
    v_cvt_pk_bf16_f32 v58, v116, v117
    v_cvt_pk_bf16_f32 v59, v118, v119
    s_waitcnt lgkmcnt(12)
    v_mfma_f32_32x32x16_bf16 v[128:143], v[108:111], v[164:167], v[128:143]
    v_exp_f32 v120, v120
    v_exp_f32 v121, v121
    v_exp_f32 v122, v122
    v_exp_f32 v123, v123
    v_exp_f32 v124, v124
    s_waitcnt lgkmcnt(10)
    v_mfma_f32_32x32x16_bf16 v[144:159], v[40:43], v[56:59], v[144:159]
    v_exp_f32 v125, v125
    v_exp_f32 v126, v126
    v_exp_f32 v127, v127
    v_cvt_pk_bf16_f32 v60, v120, v121
    v_cvt_pk_bf16_f32 v61, v122, v123
    v_cvt_pk_bf16_f32 v62, v124, v125
    v_cvt_pk_bf16_f32 v63, v126, v127
    s_waitcnt lgkmcnt(6)
    v_mfma_f32_32x32x16_bf16 v[112:127], v[96:99], v[160:163], 0
    s_barrier
    ds_read_b64 v[104:105], v16 offset:32768
    ds_read_b64 v[106:107], v16 offset:33024
    ds_read_b64 v[108:109], v16 offset:33792
    ds_read_b64 v[110:111], v16 offset:34048
    v_exp_f32 v128, v128
    v_exp_f32 v129, v129
    v_exp_f32 v130, v130
    v_exp_f32 v131, v131
    v_exp_f32 v132, v132
    v_mfma_f32_32x32x16_bf16 v[144:159], v[44:47], v[60:63], v[144:159]
    ds_read_b64_tr_b16 v[40:41], v22 offset:32768
    ds_read_b64_tr_b16 v[42:43], v23 offset:32768
    ds_read_b64_tr_b16 v[44:45], v24 offset:32768
    ds_read_b64_tr_b16 v[46:47], v25 offset:32768
    v_exp_f32 v133, v133
    v_exp_f32 v134, v134
    v_exp_f32 v135, v135
    v_cvt_pk_bf16_f32 v56, v128, v129
    v_cvt_pk_bf16_f32 v57, v130, v131
    v_cvt_pk_bf16_f32 v58, v132, v133
    v_cvt_pk_bf16_f32 v59, v134, v135
    s_waitcnt lgkmcnt(12)
    v_mfma_f32_32x32x16_bf16 v[112:127], v[100:103], v[164:167], v[112:127]
    v_exp_f32 v136, v136
    v_exp_f32 v137, v137
    v_exp_f32 v138, v138
    v_exp_f32 v139, v139
    v_exp_f32 v140, v140
    s_waitcnt lgkmcnt(10)
    v_mfma_f32_32x32x16_bf16 v[144:159], v[48:51], v[56:59], v[144:159]
    v_exp_f32 v141, v141
    v_exp_f32 v142, v142
    v_exp_f32 v143, v143
    v_cvt_pk_bf16_f32 v60, v136, v137
    v_cvt_pk_bf16_f32 v61, v138, v139
    v_cvt_pk_bf16_f32 v62, v140, v141
    v_cvt_pk_bf16_f32 v63, v142, v143
    s_waitcnt lgkmcnt(6)
    v_mfma_f32_32x32x16_bf16 v[128:143], v[104:107], v[160:163], 0
    ds_read_b64 v[96:97], v16 offset:34816
    ds_read_b64 v[98:99], v16 offset:35072
    ds_read_b64 v[100:101], v16 offset:35840
    ds_read_b64 v[102:103], v16 offset:36096
    v_exp_f32 v112, v112
    v_exp_f32 v113, v113
    v_exp_f32 v114, v114
    v_exp_f32 v115, v115
    v_exp_f32 v116, v116
    v_mfma_f32_32x32x16_bf16 v[144:159], v[52:55], v[60:63], v[144:159]
    ds_read_b64_tr_b16 v[48:49], v22 offset:34816
    ds_read_b64_tr_b16 v[50:51], v23 offset:34816
    ds_read_b64_tr_b16 v[52:53], v24 offset:34816
    ds_read_b64_tr_b16 v[54:55], v25 offset:34816
    v_exp_f32 v117, v117
    v_exp_f32 v118, v118
    v_exp_f32 v119, v119
    v_cvt_pk_bf16_f32 v56, v112, v113
    v_cvt_pk_bf16_f32 v57, v114, v115
    v_cvt_pk_bf16_f32 v58, v116, v117
    v_cvt_pk_bf16_f32 v59, v118, v119
    s_waitcnt lgkmcnt(12)
    v_mfma_f32_32x32x16_bf16 v[128:143], v[108:111], v[164:167], v[128:143]
    v_exp_f32 v120, v120
    v_exp_f32 v121, v121
    v_exp_f32 v122, v122
    v_exp_f32 v123, v123
    v_exp_f32 v124, v124
    s_waitcnt lgkmcnt(10)
    v_mfma_f32_32x32x16_bf16 v[144:159], v[40:43], v[56:59], v[144:159]
    v_exp_f32 v125, v125
    v_exp_f32 v126, v126
    v_exp_f32 v127, v127
    v_cvt_pk_bf16_f32 v60, v120, v121
    v_cvt_pk_bf16_f32 v61, v122, v123
    v_cvt_pk_bf16_f32 v62, v124, v125
    v_cvt_pk_bf16_f32 v63, v126, v127
    s_waitcnt lgkmcnt(6)
    v_mfma_f32_32x32x16_bf16 v[112:127], v[96:99], v[160:163], 0
    s_barrier
    ds_read_b64 v[104:105], v16 offset:49152
    ds_read_b64 v[106:107], v16 offset:49408
    ds_read_b64 v[108:109], v16 offset:50176
    ds_read_b64 v[110:111], v16 offset:50432
    v_exp_f32 v128, v128
    v_exp_f32 v129, v129
    v_exp_f32 v130, v130
    v_exp_f32 v131, v131
    v_exp_f32 v132, v132
    v_mfma_f32_32x32x16_bf16 v[144:159], v[44:47], v[60:63], v[144:159]
    ds_read_b64_tr_b16 v[40:41], v22 offset:49152
    ds_read_b64_tr_b16 v[42:43], v23 offset:49152
    ds_read_b64_tr_b16 v[44:45], v24 offset:49152
    ds_read_b64_tr_b16 v[46:47], v25 offset:49152
    v_exp_f32 v133, v133
    v_exp_f32 v134, v134
    v_exp_f32 v135, v135
    v_cvt_pk_bf16_f32 v56, v128, v129
    v_cvt_pk_bf16_f32 v57, v130, v131
    v_cvt_pk_bf16_f32 v58, v132, v133
    v_cvt_pk_bf16_f32 v59, v134, v135
    s_waitcnt lgkmcnt(12)
    v_mfma_f32_32x32x16_bf16 v[112:127], v[100:103], v[164:167], v[112:127]
    v_exp_f32 v136, v136
    v_exp_f32 v137, v137
    v_exp_f32 v138, v138
    v_exp_f32 v139, v139
    v_exp_f32 v140, v140
    s_waitcnt lgkmcnt(10)
    v_mfma_f32_32x32x16_bf16 v[144:159], v[48:51], v[56:59], v[144:159]
    v_exp_f32 v141, v141
    v_exp_f32 v142, v142
    v_exp_f32 v143, v143
    v_cvt_pk_bf16_f32 v60, v136, v137
    v_cvt_pk_bf16_f32 v61, v138, v139
    v_cvt_pk_bf16_f32 v62, v140, v141
    v_cvt_pk_bf16_f32 v63, v142, v143
    s_waitcnt lgkmcnt(6)
    v_mfma_f32_32x32x16_bf16 v[128:143], v[104:107], v[160:163], 0
    ds_read_b64 v[96:97], v16 offset:51200
    ds_read_b64 v[98:99], v16 offset:51456
    ds_read_b64 v[100:101], v16 offset:52224
    ds_read_b64 v[102:103], v16 offset:52480
    v_exp_f32 v112, v112
    v_exp_f32 v113, v113
    v_exp_f32 v114, v114
    v_exp_f32 v115, v115
    v_exp_f32 v116, v116
    v_mfma_f32_32x32x16_bf16 v[144:159], v[52:55], v[60:63], v[144:159]
    ds_read_b64_tr_b16 v[48:49], v22 offset:51200
    ds_read_b64_tr_b16 v[50:51], v23 offset:51200
    ds_read_b64_tr_b16 v[52:53], v24 offset:51200
    ds_read_b64_tr_b16 v[54:55], v25 offset:51200
    v_exp_f32 v117, v117
    v_exp_f32 v118, v118
    v_exp_f32 v119, v119
    v_cvt_pk_bf16_f32 v56, v112, v113
    v_cvt_pk_bf16_f32 v57, v114, v115
    v_cvt_pk_bf16_f32 v58, v116, v117
    v_cvt_pk_bf16_f32 v59, v118, v119
    s_waitcnt lgkmcnt(12)
    v_mfma_f32_32x32x16_bf16 v[128:143], v[108:111], v[164:167], v[128:143]
    v_exp_f32 v120, v120
    v_exp_f32 v121, v121
    v_exp_f32 v122, v122
    v_exp_f32 v123, v123
    v_exp_f32 v124, v124
    s_waitcnt lgkmcnt(10)
    v_mfma_f32_32x32x16_bf16 v[144:159], v[40:43], v[56:59], v[144:159]
    v_exp_f32 v125, v125
    v_exp_f32 v126, v126
    v_exp_f32 v127, v127
    v_cvt_pk_bf16_f32 v60, v120, v121
    v_cvt_pk_bf16_f32 v61, v122, v123
    v_cvt_pk_bf16_f32 v62, v124, v125
    v_cvt_pk_bf16_f32 v63, v126, v127
    s_waitcnt lgkmcnt(6)
    v_mfma_f32_32x32x16_bf16 v[112:127], v[96:99], v[160:163], 0
    s_barrier
    ds_read_b64 v[104:105], v16 offset:0
    ds_read_b64 v[106:107], v16 offset:256
    ds_read_b64 v[108:109], v16 offset:1024
    ds_read_b64 v[110:111], v16 offset:1280
    v_exp_f32 v128, v128
    v_exp_f32 v129, v129
    v_exp_f32 v130, v130
    v_exp_f32 v131, v131
    v_exp_f32 v132, v132
    v_mfma_f32_32x32x16_bf16 v[144:159], v[44:47], v[60:63], v[144:159]
    ds_read_b64_tr_b16 v[40:41], v22 offset:0
    ds_read_b64_tr_b16 v[42:43], v23 offset:0
    ds_read_b64_tr_b16 v[44:45], v24 offset:0
    ds_read_b64_tr_b16 v[46:47], v25 offset:0
    v_exp_f32 v133, v133
    v_exp_f32 v134, v134
    v_exp_f32 v135, v135
    v_cvt_pk_bf16_f32 v56, v128, v129
    v_cvt_pk_bf16_f32 v57, v130, v131
    v_cvt_pk_bf16_f32 v58, v132, v133
    v_cvt_pk_bf16_f32 v59, v134, v135
    s_waitcnt lgkmcnt(12)
    v_mfma_f32_32x32x16_bf16 v[112:127], v[100:103], v[164:167], v[112:127]
    v_exp_f32 v136, v136
    v_exp_f32 v137, v137
    v_exp_f32 v138, v138
    v_exp_f32 v139, v139
    v_exp_f32 v140, v140
    s_waitcnt lgkmcnt(10)
    v_mfma_f32_32x32x16_bf16 v[144:159], v[48:51], v[56:59], v[144:159]
    v_exp_f32 v141, v141
    v_exp_f32 v142, v142
    v_exp_f32 v143, v143
    v_cvt_pk_bf16_f32 v60, v136, v137
    v_cvt_pk_bf16_f32 v61, v138, v139
    v_cvt_pk_bf16_f32 v62, v140, v141
    v_cvt_pk_bf16_f32 v63, v142, v143
    s_waitcnt lgkmcnt(6)
    v_mfma_f32_32x32x16_bf16 v[128:143], v[104:107], v[160:163], 0
    ds_read_b64 v[96:97], v16 offset:2048
    ds_read_b64 v[98:99], v16 offset:2304
    ds_read_b64 v[100:101], v16 offset:3072
    ds_read_b64 v[102:103], v16 offset:3328
    v_exp_f32 v112, v112
    v_exp_f32 v113, v113
    v_exp_f32 v114, v114
    v_exp_f32 v115, v115
    v_exp_f32 v116, v116
    v_mfma_f32_32x32x16_bf16 v[144:159], v[52:55], v[60:63], v[144:159]
    ds_read_b64_tr_b16 v[48:49], v22 offset:2048
    ds_read_b64_tr_b16 v[50:51], v23 offset:2048
    ds_read_b64_tr_b16 v[52:53], v24 offset:2048
    ds_read_b64_tr_b16 v[54:55], v25 offset:2048
    v_exp_f32 v117, v117
    v_exp_f32 v118, v118
    v_exp_f32 v119, v119
    v_cvt_pk_bf16_f32 v56, v112, v113
    v_cvt_pk_bf16_f32 v57, v114, v115
    v_cvt_pk_bf16_f32 v58, v116, v117
    v_cvt_pk_bf16_f32 v59, v118, v119
    s_waitcnt lgkmcnt(12)
    v_mfma_f32_32x32x16_bf16 v[128:143], v[108:111], v[164:167], v[128:143]
    v_exp_f32 v120, v120
    v_exp_f32 v121, v121
    v_exp_f32 v122, v122
    v_exp_f32 v123, v123
    v_exp_f32 v124, v124
    s_waitcnt lgkmcnt(10)
    v_mfma_f32_32x32x16_bf16 v[144:159], v[40:43], v[56:59], v[144:159]
    v_exp_f32 v125, v125
    v_exp_f32 v126, v126
    v_exp_f32 v127, v127
    v_cvt_pk_bf16_f32 v60, v120, v121
    v_cvt_pk_bf16_f32 v61, v122, v123
    v_cvt_pk_bf16_f32 v62, v124, v125
    v_cvt_pk_bf16_f32 v63, v126, v127
    s_waitcnt lgkmcnt(6)
    v_mfma_f32_32x32x16_bf16 v[112:127], v[96:99], v[160:163], 0
    s_barrier
    ds_read_b64 v[104:105], v16 offset:16384
    ds_read_b64 v[106:107], v16 offset:16640
    ds_read_b64 v[108:109], v16 offset:17408
    ds_read_b64 v[110:111], v16 offset:17664
    v_exp_f32 v128, v128
    v_exp_f32 v129, v129
    v_exp_f32 v130, v130
    v_exp_f32 v131, v131
    v_exp_f32 v132, v132
    v_mfma_f32_32x32x16_bf16 v[144:159], v[44:47], v[60:63], v[144:159]
    ds_read_b64_tr_b16 v[40:41], v22 offset:16384
    ds_read_b64_tr_b16 v[42:43], v23 offset:16384
    ds_read_b64_tr_b16 v[44:45], v24 offset:16384
    ds_read_b64_tr_b16 v[46:47], v25 offset:16384
    v_exp_f32 v133, v133
    v_exp_f32 v134, v134
    v_exp_f32 v135, v135
    v_cvt_pk_bf16_f32 v56, v128, v129
    v_cvt_pk_bf16_f32 v57, v130, v131
    v_cvt_pk_bf16_f32 v58, v132, v133
    v_cvt_pk_bf16_f32 v59, v134, v135
    s_waitcnt lgkmcnt(12)
    v_mfma_f32_32x32x16_bf16 v[112:127], v[100:103], v[164:167], v[112:127]
    v_exp_f32 v136, v136
    v_exp_f32 v137, v137
    v_exp_f32 v138, v138
    v_exp_f32 v139, v139
    v_exp_f32 v140, v140
    s_waitcnt lgkmcnt(10)
    v_mfma_f32_32x32x16_bf16 v[144:159], v[48:51], v[56:59], v[144:159]
    v_exp_f32 v141, v141
    v_exp_f32 v142, v142
    v_exp_f32 v143, v143
    v_cvt_pk_bf16_f32 v60, v136, v137
    v_cvt_pk_bf16_f32 v61, v138, v139
    v_cvt_pk_bf16_f32 v62, v140, v141
    v_cvt_pk_bf16_f32 v63, v142, v143
    s_waitcnt lgkmcnt(6)
    v_mfma_f32_32x32x16_bf16 v[128:143], v[104:107], v[160:163], 0
    ds_read_b64 v[96:97], v16 offset:18432
    ds_read_b64 v[98:99], v16 offset:18688
    ds_read_b64 v[100:101], v16 offset:19456
    ds_read_b64 v[102:103], v16 offset:19712
    v_exp_f32 v112, v112
    v_exp_f32 v113, v113
    v_exp_f32 v114, v114
    v_exp_f32 v115, v115
    v_exp_f32 v116, v116
    v_mfma_f32_32x32x16_bf16 v[144:159], v[52:55], v[60:63], v[144:159]
    ds_read_b64_tr_b16 v[48:49], v22 offset:18432
    ds_read_b64_tr_b16 v[50:51], v23 offset:18432
    ds_read_b64_tr_b16 v[52:53], v24 offset:18432
    ds_read_b64_tr_b16 v[54:55], v25 offset:18432
    v_exp_f32 v117, v117
    v_exp_f32 v118, v118
    v_exp_f32 v119, v119
    v_cvt_pk_bf16_f32 v56, v112, v113
    v_cvt_pk_bf16_f32 v57, v114, v115
    v_cvt_pk_bf16_f32 v58, v116, v117
    v_cvt_pk_bf16_f32 v59, v118, v119
    s_waitcnt lgkmcnt(12)
    v_mfma_f32_32x32x16_bf16 v[128:143], v[108:111], v[164:167], v[128:143]
    v_exp_f32 v120, v120
    v_exp_f32 v121, v121
    v_exp_f32 v122, v122
    v_exp_f32 v123, v123
    v_exp_f32 v124, v124
    s_waitcnt lgkmcnt(10)
    v_mfma_f32_32x32x16_bf16 v[144:159], v[40:43], v[56:59], v[144:159]
    v_exp_f32 v125, v125
    v_exp_f32 v126, v126
    v_exp_f32 v127, v127
    v_cvt_pk_bf16_f32 v60, v120, v121
    v_cvt_pk_bf16_f32 v61, v122, v123
    v_cvt_pk_bf16_f32 v62, v124, v125
    v_cvt_pk_bf16_f32 v63, v126, v127
    s_waitcnt lgkmcnt(6)
    v_mfma_f32_32x32x16_bf16 v[112:127], v[96:99], v[160:163], 0
    s_barrier
    ds_read_b64 v[104:105], v16 offset:32768
    ds_read_b64 v[106:107], v16 offset:33024
    ds_read_b64 v[108:109], v16 offset:33792
    ds_read_b64 v[110:111], v16 offset:34048
    v_exp_f32 v128, v128
    v_exp_f32 v129, v129
    v_exp_f32 v130, v130
    v_exp_f32 v131, v131
    v_exp_f32 v132, v132
    v_mfma_f32_32x32x16_bf16 v[144:159], v[44:47], v[60:63], v[144:159]
    ds_read_b64_tr_b16 v[40:41], v22 offset:32768
    ds_read_b64_tr_b16 v[42:43], v23 offset:32768
    ds_read_b64_tr_b16 v[44:45], v24 offset:32768
    ds_read_b64_tr_b16 v[46:47], v25 offset:32768
    v_exp_f32 v133, v133
    v_exp_f32 v134, v134
    v_exp_f32 v135, v135
    v_cvt_pk_bf16_f32 v56, v128, v129
    v_cvt_pk_bf16_f32 v57, v130, v131
    v_cvt_pk_bf16_f32 v58, v132, v133
    v_cvt_pk_bf16_f32 v59, v134, v135
    s_waitcnt lgkmcnt(12)
    v_mfma_f32_32x32x16_bf16 v[112:127], v[100:103], v[164:167], v[112:127]
    v_exp_f32 v136, v136
    v_exp_f32 v137, v137
    v_exp_f32 v138, v138
    v_exp_f32 v139, v139
    v_exp_f32 v140, v140
    s_waitcnt lgkmcnt(10)
    v_mfma_f32_32x32x16_bf16 v[144:159], v[48:51], v[56:59], v[144:159]
    v_exp_f32 v141, v141
    v_exp_f32 v142, v142
    v_exp_f32 v143, v143
    v_cvt_pk_bf16_f32 v60, v136, v137
    v_cvt_pk_bf16_f32 v61, v138, v139
    v_cvt_pk_bf16_f32 v62, v140, v141
    v_cvt_pk_bf16_f32 v63, v142, v143
    s_waitcnt lgkmcnt(6)
    v_mfma_f32_32x32x16_bf16 v[128:143], v[104:107], v[160:163], 0
    ds_read_b64 v[96:97], v16 offset:34816
    ds_read_b64 v[98:99], v16 offset:35072
    ds_read_b64 v[100:101], v16 offset:35840
    ds_read_b64 v[102:103], v16 offset:36096
    v_exp_f32 v112, v112
    v_exp_f32 v113, v113
    v_exp_f32 v114, v114
    v_exp_f32 v115, v115
    v_exp_f32 v116, v116
    v_mfma_f32_32x32x16_bf16 v[144:159], v[52:55], v[60:63], v[144:159]
    ds_read_b64_tr_b16 v[48:49], v22 offset:34816
    ds_read_b64_tr_b16 v[50:51], v23 offset:34816
    ds_read_b64_tr_b16 v[52:53], v24 offset:34816
    ds_read_b64_tr_b16 v[54:55], v25 offset:34816
    v_exp_f32 v117, v117
    v_exp_f32 v118, v118
    v_exp_f32 v119, v119
    v_cvt_pk_bf16_f32 v56, v112, v113
    v_cvt_pk_bf16_f32 v57, v114, v115
    v_cvt_pk_bf16_f32 v58, v116, v117
    v_cvt_pk_bf16_f32 v59, v118, v119
    s_waitcnt lgkmcnt(12)
    v_mfma_f32_32x32x16_bf16 v[128:143], v[108:111], v[164:167], v[128:143]
    v_exp_f32 v120, v120
    v_exp_f32 v121, v121
    v_exp_f32 v122, v122
    v_exp_f32 v123, v123
    v_exp_f32 v124, v124
    s_waitcnt lgkmcnt(10)
    v_mfma_f32_32x32x16_bf16 v[144:159], v[40:43], v[56:59], v[144:159]
    v_exp_f32 v125, v125
    v_exp_f32 v126, v126
    v_exp_f32 v127, v127
    v_cvt_pk_bf16_f32 v60, v120, v121
    v_cvt_pk_bf16_f32 v61, v122, v123
    v_cvt_pk_bf16_f32 v62, v124, v125
    v_cvt_pk_bf16_f32 v63, v126, v127
    s_waitcnt lgkmcnt(6)
    v_mfma_f32_32x32x16_bf16 v[112:127], v[96:99], v[160:163], 0
    s_barrier
    ds_read_b64 v[104:105], v16 offset:49152
    ds_read_b64 v[106:107], v16 offset:49408
    ds_read_b64 v[108:109], v16 offset:50176
    ds_read_b64 v[110:111], v16 offset:50432
    v_exp_f32 v128, v128
    v_exp_f32 v129, v129
    v_exp_f32 v130, v130
    v_exp_f32 v131, v131
    v_exp_f32 v132, v132
    v_mfma_f32_32x32x16_bf16 v[144:159], v[44:47], v[60:63], v[144:159]
    ds_read_b64_tr_b16 v[40:41], v22 offset:49152
    ds_read_b64_tr_b16 v[42:43], v23 offset:49152
    ds_read_b64_tr_b16 v[44:45], v24 offset:49152
    ds_read_b64_tr_b16 v[46:47], v25 offset:49152
    v_exp_f32 v133, v133
    v_exp_f32 v134, v134
    v_exp_f32 v135, v135
    v_cvt_pk_bf16_f32 v56, v128, v129
    v_cvt_pk_bf16_f32 v57, v130, v131
    v_cvt_pk_bf16_f32 v58, v132, v133
    v_cvt_pk_bf16_f32 v59, v134, v135
    s_waitcnt lgkmcnt(12)
    v_mfma_f32_32x32x16_bf16 v[112:127], v[100:103], v[164:167], v[112:127]
    v_exp_f32 v136, v136
    v_exp_f32 v137, v137
    v_exp_f32 v138, v138
    v_exp_f32 v139, v139
    v_exp_f32 v140, v140
    s_waitcnt lgkmcnt(10)
    v_mfma_f32_32x32x16_bf16 v[144:159], v[48:51], v[56:59], v[144:159]
    v_exp_f32 v141, v141
    v_exp_f32 v142, v142
    v_exp_f32 v143, v143
    v_cvt_pk_bf16_f32 v60, v136, v137
    v_cvt_pk_bf16_f32 v61, v138, v139
    v_cvt_pk_bf16_f32 v62, v140, v141
    v_cvt_pk_bf16_f32 v63, v142, v143
    s_waitcnt lgkmcnt(6)
    v_mfma_f32_32x32x16_bf16 v[128:143], v[104:107], v[160:163], 0
    ds_read_b64 v[96:97], v16 offset:51200
    ds_read_b64 v[98:99], v16 offset:51456
    ds_read_b64 v[100:101], v16 offset:52224
    ds_read_b64 v[102:103], v16 offset:52480
    v_exp_f32 v112, v112
    v_exp_f32 v113, v113
    v_exp_f32 v114, v114
    v_exp_f32 v115, v115
    v_exp_f32 v116, v116
    v_mfma_f32_32x32x16_bf16 v[144:159], v[52:55], v[60:63], v[144:159]
    ds_read_b64_tr_b16 v[48:49], v22 offset:51200
    ds_read_b64_tr_b16 v[50:51], v23 offset:51200
    ds_read_b64_tr_b16 v[52:53], v24 offset:51200
    ds_read_b64_tr_b16 v[54:55], v25 offset:51200
    v_exp_f32 v117, v117
    v_exp_f32 v118, v118
    v_exp_f32 v119, v119
    v_cvt_pk_bf16_f32 v56, v112, v113
    v_cvt_pk_bf16_f32 v57, v114, v115
    v_cvt_pk_bf16_f32 v58, v116, v117
    v_cvt_pk_bf16_f32 v59, v118, v119
    s_waitcnt lgkmcnt(12)
    v_mfma_f32_32x32x16_bf16 v[128:143], v[108:111], v[164:167], v[128:143]
    v_exp_f32 v120, v120
    v_exp_f32 v121, v121
    v_exp_f32 v122, v122
    v_exp_f32 v123, v123
    v_exp_f32 v124, v124
    s_waitcnt lgkmcnt(10)
    v_mfma_f32_32x32x16_bf16 v[144:159], v[40:43], v[56:59], v[144:159]
    v_exp_f32 v125, v125
    v_exp_f32 v126, v126
    v_exp_f32 v127, v127
    v_cvt_pk_bf16_f32 v60, v120, v121
    v_cvt_pk_bf16_f32 v61, v122, v123
    v_cvt_pk_bf16_f32 v62, v124, v125
    v_cvt_pk_bf16_f32 v63, v126, v127
    s_waitcnt lgkmcnt(6)
    v_mfma_f32_32x32x16_bf16 v[112:127], v[96:99], v[160:163], 0
    s_barrier
    ds_read_b64 v[104:105], v16 offset:0
    ds_read_b64 v[106:107], v16 offset:256
    ds_read_b64 v[108:109], v16 offset:1024
    ds_read_b64 v[110:111], v16 offset:1280
    v_exp_f32 v128, v128
    v_exp_f32 v129, v129
    v_exp_f32 v130, v130
    v_exp_f32 v131, v131
    v_exp_f32 v132, v132
    v_mfma_f32_32x32x16_bf16 v[144:159], v[44:47], v[60:63], v[144:159]
    ds_read_b64_tr_b16 v[40:41], v22 offset:0
    ds_read_b64_tr_b16 v[42:43], v23 offset:0
    ds_read_b64_tr_b16 v[44:45], v24 offset:0
    ds_read_b64_tr_b16 v[46:47], v25 offset:0
    v_exp_f32 v133, v133
    v_exp_f32 v134, v134
    v_exp_f32 v135, v135
    v_cvt_pk_bf16_f32 v56, v128, v129
    v_cvt_pk_bf16_f32 v57, v130, v131
    v_cvt_pk_bf16_f32 v58, v132, v133
    v_cvt_pk_bf16_f32 v59, v134, v135
    s_waitcnt lgkmcnt(12)
    v_mfma_f32_32x32x16_bf16 v[112:127], v[100:103], v[164:167], v[112:127]
    v_exp_f32 v136, v136
    v_exp_f32 v137, v137
    v_exp_f32 v138, v138
    v_exp_f32 v139, v139
    v_exp_f32 v140, v140
    s_waitcnt lgkmcnt(10)
    v_mfma_f32_32x32x16_bf16 v[144:159], v[48:51], v[56:59], v[144:159]
    v_exp_f32 v141, v141
    v_exp_f32 v142, v142
    v_exp_f32 v143, v143
    v_cvt_pk_bf16_f32 v60, v136, v137
    v_cvt_pk_bf16_f32 v61, v138, v139
    v_cvt_pk_bf16_f32 v62, v140, v141
    v_cvt_pk_bf16_f32 v63, v142, v143
    s_waitcnt lgkmcnt(6)
    v_mfma_f32_32x32x16_bf16 v[128:143], v[104:107], v[160:163], 0
    ds_read_b64 v[96:97], v16 offset:2048
    ds_read_b64 v[98:99], v16 offset:2304
    ds_read_b64 v[100:101], v16 offset:3072
    ds_read_b64 v[102:103], v16 offset:3328
    v_exp_f32 v112, v112
    v_exp_f32 v113, v113
    v_exp_f32 v114, v114
    v_exp_f32 v115, v115
    v_exp_f32 v116, v116
    v_mfma_f32_32x32x16_bf16 v[144:159], v[52:55], v[60:63], v[144:159]
    ds_read_b64_tr_b16 v[48:49], v22 offset:2048
    ds_read_b64_tr_b16 v[50:51], v23 offset:2048
    ds_read_b64_tr_b16 v[52:53], v24 offset:2048
    ds_read_b64_tr_b16 v[54:55], v25 offset:2048
    v_exp_f32 v117, v117
    v_exp_f32 v118, v118
    v_exp_f32 v119, v119
    v_cvt_pk_bf16_f32 v56, v112, v113
    v_cvt_pk_bf16_f32 v57, v114, v115
    v_cvt_pk_bf16_f32 v58, v116, v117
    v_cvt_pk_bf16_f32 v59, v118, v119
    s_waitcnt lgkmcnt(12)
    v_mfma_f32_32x32x16_bf16 v[128:143], v[108:111], v[164:167], v[128:143]
    v_exp_f32 v120, v120
    v_exp_f32 v121, v121
    v_exp_f32 v122, v122
    v_exp_f32 v123, v123
    v_exp_f32 v124, v124
    s_waitcnt lgkmcnt(10)
    v_mfma_f32_32x32x16_bf16 v[144:159], v[40:43], v[56:59], v[144:159]
    v_exp_f32 v125, v125
    v_exp_f32 v126, v126
    v_exp_f32 v127, v127
    v_cvt_pk_bf16_f32 v60, v120, v121
    v_cvt_pk_bf16_f32 v61, v122, v123
    v_cvt_pk_bf16_f32 v62, v124, v125
    v_cvt_pk_bf16_f32 v63, v126, v127
    s_waitcnt lgkmcnt(6)
    v_mfma_f32_32x32x16_bf16 v[112:127], v[96:99], v[160:163], 0
    s_barrier
    ds_read_b64 v[104:105], v16 offset:16384
    ds_read_b64 v[106:107], v16 offset:16640
    ds_read_b64 v[108:109], v16 offset:17408
    ds_read_b64 v[110:111], v16 offset:17664
    v_exp_f32 v128, v128
    v_exp_f32 v129, v129
    v_exp_f32 v130, v130
    v_exp_f32 v131, v131
    v_exp_f32 v132, v132
    v_mfma_f32_32x32x16_bf16 v[144:159], v[44:47], v[60:63], v[144:159]
    ds_read_b64_tr_b16 v[40:41], v22 offset:16384
    ds_read_b64_tr_b16 v[42:43], v23 offset:16384
    ds_read_b64_tr_b16 v[44:45], v24 offset:16384
    ds_read_b64_tr_b16 v[46:47], v25 offset:16384
    v_exp_f32 v133, v133
    v_exp_f32 v134, v134
    v_exp_f32 v135, v135
    v_cvt_pk_bf16_f32 v56, v128, v129
    v_cvt_pk_bf16_f32 v57, v130, v131
    v_cvt_pk_bf16_f32 v58, v132, v133
    v_cvt_pk_bf16_f32 v59, v134, v135
    s_waitcnt lgkmcnt(12)
    v_mfma_f32_32x32x16_bf16 v[112:127], v[100:103], v[164:167], v[112:127]
    v_exp_f32 v136, v136
    v_exp_f32 v137, v137
    v_exp_f32 v138, v138
    v_exp_f32 v139, v139
    v_exp_f32 v140, v140
    s_waitcnt lgkmcnt(10)
    v_mfma_f32_32x32x16_bf16 v[144:159], v[48:51], v[56:59], v[144:159]
    v_exp_f32 v141, v141
    v_exp_f32 v142, v142
    v_exp_f32 v143, v143
    v_cvt_pk_bf16_f32 v60, v136, v137
    v_cvt_pk_bf16_f32 v61, v138, v139
    v_cvt_pk_bf16_f32 v62, v140, v141
    v_cvt_pk_bf16_f32 v63, v142, v143
    s_waitcnt lgkmcnt(6)
    v_mfma_f32_32x32x16_bf16 v[128:143], v[104:107], v[160:163], 0
    ds_read_b64 v[96:97], v16 offset:18432
    ds_read_b64 v[98:99], v16 offset:18688
    ds_read_b64 v[100:101], v16 offset:19456
    ds_read_b64 v[102:103], v16 offset:19712
    v_exp_f32 v112, v112
    v_exp_f32 v113, v113
    v_exp_f32 v114, v114
    v_exp_f32 v115, v115
    v_exp_f32 v116, v116
    v_mfma_f32_32x32x16_bf16 v[144:159], v[52:55], v[60:63], v[144:159]
    ds_read_b64_tr_b16 v[48:49], v22 offset:18432
    ds_read_b64_tr_b16 v[50:51], v23 offset:18432
    ds_read_b64_tr_b16 v[52:53], v24 offset:18432
    ds_read_b64_tr_b16 v[54:55], v25 offset:18432
    v_exp_f32 v117, v117
    v_exp_f32 v118, v118
    v_exp_f32 v119, v119
    v_cvt_pk_bf16_f32 v56, v112, v113
    v_cvt_pk_bf16_f32 v57, v114, v115
    v_cvt_pk_bf16_f32 v58, v116, v117
    v_cvt_pk_bf16_f32 v59, v118, v119
    s_waitcnt lgkmcnt(12)
    v_mfma_f32_32x32x16_bf16 v[128:143], v[108:111], v[164:167], v[128:143]
    v_exp_f32 v120, v120
    v_exp_f32 v121, v121
    v_exp_f32 v122, v122
    v_exp_f32 v123, v123
    v_exp_f32 v124, v124
    s_waitcnt lgkmcnt(10)
    v_mfma_f32_32x32x16_bf16 v[144:159], v[40:43], v[56:59], v[144:159]
    v_exp_f32 v125, v125
    v_exp_f32 v126, v126
    v_exp_f32 v127, v127
    v_cvt_pk_bf16_f32 v60, v120, v121
    v_cvt_pk_bf16_f32 v61, v122, v123
    v_cvt_pk_bf16_f32 v62, v124, v125
    v_cvt_pk_bf16_f32 v63, v126, v127
    s_waitcnt lgkmcnt(6)
    v_mfma_f32_32x32x16_bf16 v[112:127], v[96:99], v[160:163], 0
    s_barrier
    ds_read_b64 v[104:105], v16 offset:32768
    ds_read_b64 v[106:107], v16 offset:33024
    ds_read_b64 v[108:109], v16 offset:33792
    ds_read_b64 v[110:111], v16 offset:34048
    v_exp_f32 v128, v128
    v_exp_f32 v129, v129
    v_exp_f32 v130, v130
    v_exp_f32 v131, v131
    v_exp_f32 v132, v132
    v_mfma_f32_32x32x16_bf16 v[144:159], v[44:47], v[60:63], v[144:159]
    ds_read_b64_tr_b16 v[40:41], v22 offset:32768
    ds_read_b64_tr_b16 v[42:43], v23 offset:32768
    ds_read_b64_tr_b16 v[44:45], v24 offset:32768
    ds_read_b64_tr_b16 v[46:47], v25 offset:32768
    v_exp_f32 v133, v133
    v_exp_f32 v134, v134
    v_exp_f32 v135, v135
    v_cvt_pk_bf16_f32 v56, v128, v129
    v_cvt_pk_bf16_f32 v57, v130, v131
    v_cvt_pk_bf16_f32 v58, v132, v133
    v_cvt_pk_bf16_f32 v59, v134, v135
    s_waitcnt lgkmcnt(12)
    v_mfma_f32_32x32x16_bf16 v[112:127], v[100:103], v[164:167], v[112:127]
    v_exp_f32 v136, v136
    v_exp_f32 v137, v137
    v_exp_f32 v138, v138
    v_exp_f32 v139, v139
    v_exp_f32 v140, v140
    s_waitcnt lgkmcnt(10)
    v_mfma_f32_32x32x16_bf16 v[144:159], v[48:51], v[56:59], v[144:159]
    v_exp_f32 v141, v141
    v_exp_f32 v142, v142
    v_exp_f32 v143, v143
    v_cvt_pk_bf16_f32 v60, v136, v137
    v_cvt_pk_bf16_f32 v61, v138, v139
    v_cvt_pk_bf16_f32 v62, v140, v141
    v_cvt_pk_bf16_f32 v63, v142, v143
    s_waitcnt lgkmcnt(6)
    v_mfma_f32_32x32x16_bf16 v[128:143], v[104:107], v[160:163], 0
    ds_read_b64 v[96:97], v16 offset:34816
    ds_read_b64 v[98:99], v16 offset:35072
    ds_read_b64 v[100:101], v16 offset:35840
    ds_read_b64 v[102:103], v16 offset:36096
    v_exp_f32 v112, v112
    v_exp_f32 v113, v113
    v_exp_f32 v114, v114
    v_exp_f32 v115, v115
    v_exp_f32 v116, v116
    v_mfma_f32_32x32x16_bf16 v[144:159], v[52:55], v[60:63], v[144:159]
    ds_read_b64_tr_b16 v[48:49], v22 offset:34816
    ds_read_b64_tr_b16 v[50:51], v23 offset:34816
    ds_read_b64_tr_b16 v[52:53], v24 offset:34816
    ds_read_b64_tr_b16 v[54:55], v25 offset:34816
    v_exp_f32 v117, v117
    v_exp_f32 v118, v118
    v_exp_f32 v119, v119
    v_cvt_pk_bf16_f32 v56, v112, v113
    v_cvt_pk_bf16_f32 v57, v114, v115
    v_cvt_pk_bf16_f32 v58, v116, v117
    v_cvt_pk_bf16_f32 v59, v118, v119
    s_waitcnt lgkmcnt(12)
    v_mfma_f32_32x32x16_bf16 v[128:143], v[108:111], v[164:167], v[128:143]
    v_exp_f32 v120, v120
    v_exp_f32 v121, v121
    v_exp_f32 v122, v122
    v_exp_f32 v123, v123
    v_exp_f32 v124, v124
    s_waitcnt lgkmcnt(10)
    v_mfma_f32_32x32x16_bf16 v[144:159], v[40:43], v[56:59], v[144:159]
    v_exp_f32 v125, v125
    v_exp_f32 v126, v126
    v_exp_f32 v127, v127
    v_cvt_pk_bf16_f32 v60, v120, v121
    v_cvt_pk_bf16_f32 v61, v122, v123
    v_cvt_pk_bf16_f32 v62, v124, v125
    v_cvt_pk_bf16_f32 v63, v126, v127
    s_waitcnt lgkmcnt(6)
    v_mfma_f32_32x32x16_bf16 v[112:127], v[96:99], v[160:163], 0
    s_barrier
    ds_read_b64 v[104:105], v16 offset:49152
    ds_read_b64 v[106:107], v16 offset:49408
    ds_read_b64 v[108:109], v16 offset:50176
    ds_read_b64 v[110:111], v16 offset:50432
    v_exp_f32 v128, v128
    v_exp_f32 v129, v129
    v_exp_f32 v130, v130
    v_exp_f32 v131, v131
    v_exp_f32 v132, v132
    v_mfma_f32_32x32x16_bf16 v[144:159], v[44:47], v[60:63], v[144:159]
    ds_read_b64_tr_b16 v[40:41], v22 offset:49152
    ds_read_b64_tr_b16 v[42:43], v23 offset:49152
    ds_read_b64_tr_b16 v[44:45], v24 offset:49152
    ds_read_b64_tr_b16 v[46:47], v25 offset:49152
    v_exp_f32 v133, v133
    v_exp_f32 v134, v134
    v_exp_f32 v135, v135
    v_cvt_pk_bf16_f32 v56, v128, v129
    v_cvt_pk_bf16_f32 v57, v130, v131
    v_cvt_pk_bf16_f32 v58, v132, v133
    v_cvt_pk_bf16_f32 v59, v134, v135
    s_waitcnt lgkmcnt(12)
    v_mfma_f32_32x32x16_bf16 v[112:127], v[100:103], v[164:167], v[112:127]
    v_exp_f32 v136, v136
    v_exp_f32 v137, v137
    v_exp_f32 v138, v138
    v_exp_f32 v139, v139
    v_exp_f32 v140, v140
    s_waitcnt lgkmcnt(10)
    v_mfma_f32_32x32x16_bf16 v[144:159], v[48:51], v[56:59], v[144:159]
    v_exp_f32 v141, v141
    v_exp_f32 v142, v142
    v_exp_f32 v143, v143
    v_cvt_pk_bf16_f32 v60, v136, v137
    v_cvt_pk_bf16_f32 v61, v138, v139
    v_cvt_pk_bf16_f32 v62, v140, v141
    v_cvt_pk_bf16_f32 v63, v142, v143
    s_waitcnt lgkmcnt(6)
    v_mfma_f32_32x32x16_bf16 v[128:143], v[104:107], v[160:163], 0
    v_exp_f32 v112, v112
    v_exp_f32 v113, v113
    v_exp_f32 v114, v114
    v_exp_f32 v115, v115
    v_exp_f32 v116, v116
    v_mfma_f32_32x32x16_bf16 v[144:159], v[52:55], v[60:63], v[144:159]
    ds_read_b64_tr_b16 v[48:49], v22 offset:51200
    ds_read_b64_tr_b16 v[50:51], v23 offset:51200
    ds_read_b64_tr_b16 v[52:53], v24 offset:51200
    ds_read_b64_tr_b16 v[54:55], v25 offset:51200
    v_exp_f32 v117, v117
    v_exp_f32 v118, v118
    v_exp_f32 v119, v119
    v_cvt_pk_bf16_f32 v56, v112, v113
    v_cvt_pk_bf16_f32 v57, v114, v115
    v_cvt_pk_bf16_f32 v58, v116, v117
    v_cvt_pk_bf16_f32 v59, v118, v119
    s_waitcnt lgkmcnt(8)
    v_mfma_f32_32x32x16_bf16 v[128:143], v[108:111], v[164:167], v[128:143]
    v_exp_f32 v120, v120
    v_exp_f32 v121, v121
    v_exp_f32 v122, v122
    v_exp_f32 v123, v123
    v_exp_f32 v124, v124
    s_waitcnt lgkmcnt(6)
    v_mfma_f32_32x32x16_bf16 v[144:159], v[40:43], v[56:59], v[144:159]
    v_exp_f32 v125, v125
    v_exp_f32 v126, v126
    v_exp_f32 v127, v127
    v_cvt_pk_bf16_f32 v60, v120, v121
    v_cvt_pk_bf16_f32 v61, v122, v123
    v_cvt_pk_bf16_f32 v62, v124, v125
    v_cvt_pk_bf16_f32 v63, v126, v127
    v_exp_f32 v128, v128
    v_exp_f32 v129, v129
    v_exp_f32 v130, v130
    v_exp_f32 v131, v131
    v_exp_f32 v132, v132
    s_waitcnt lgkmcnt(4)
    v_mfma_f32_32x32x16_bf16 v[144:159], v[44:47], v[60:63], v[144:159]
    v_exp_f32 v133, v133
    v_exp_f32 v134, v134
    v_exp_f32 v135, v135
    v_cvt_pk_bf16_f32 v56, v128, v129
    v_cvt_pk_bf16_f32 v57, v130, v131
    v_cvt_pk_bf16_f32 v58, v132, v133
    v_cvt_pk_bf16_f32 v59, v134, v135
    v_exp_f32 v136, v136
    v_exp_f32 v137, v137
    v_exp_f32 v138, v138
    v_exp_f32 v139, v139
    v_exp_f32 v140, v140
    s_waitcnt lgkmcnt(2)
    v_mfma_f32_32x32x16_bf16 v[144:159], v[48:51], v[56:59], v[144:159]
    v_exp_f32 v141, v141
    v_exp_f32 v142, v142
    v_exp_f32 v143, v143
    v_cvt_pk_bf16_f32 v60, v136, v137
    v_cvt_pk_bf16_f32 v61, v138, v139
    v_cvt_pk_bf16_f32 v62, v140, v141
    v_cvt_pk_bf16_f32 v63, v142, v143
    s_waitcnt lgkmcnt(0)
    s_nop 0
    v_mfma_f32_32x32x16_bf16 v[144:159], v[52:55], v[60:63], v[144:159]
    s_setprio 0
    s_nop 10
    v_mov_b32 v64, v156
    v_mov_b32 v65, v156
    v_mul_f32 v66, 0, v144
    s_nop 0
    v_permlane32_swap_b32 v64, v65
    v_fma_f32 v66, v145, 0, v66
    v_fma_f32 v66, v146, 0, v66
    v_fma_f32 v66, v147, 0, v66
    v_fma_f32 v66, v148, 0, v66
    v_fma_f32 v66, v149, 0, v66
    v_fma_f32 v66, v150, 0, v66
    v_fma_f32 v66, v151, 0, v66
    v_fma_f32 v66, v152, 0, v66
    v_fma_f32 v66, v153, 0, v66
    v_fma_f32 v66, v154, 0, v66
    v_fma_f32 v66, v155, 0, v66
    v_fma_f32 v66, v156, 0, v66
    v_fma_f32 v66, v157, 0, v66
    v_fma_f32 v66, v158, 0, v66
    v_fma_f32 v66, v159, 0, v66
    v_add_f32 v66, v66, v65
    v_cmp_nge_f32 vcc, v66, 0.5
    s_mov_b32 s52, 0x5d800000
    v_cmp_nle_f32 s[54:55], v66, s52
    s_or_b64 vcc, vcc, s[54:55]
    s_or_b32 s14, vcc_lo, vcc_hi
    s_lshl_b32 s15, s38, 2
    s_add_u32 s15, s15, 20480
    v_mov_b32 v67, s15
    v_mov_b32 v68, s14
    ds_write_b32 v67, v68
    v_mov_b32 v64, v20
    s_lshl_b32 s14, s39, 9
    s_add_u32 s14, s14, 16384
    v_lshl_add_u32 v67, v0, 3, s14
    s_cmp_lt_u32 s38, 4
    s_cbranch_scc1 L_xa
    ds_write_b128 v19, v[144:147] offset:0
    ds_write_b128 v19, v[148:151] offset:1024
    ds_write_b128 v19, v[152:155] offset:2048
    ds_write_b128 v19, v[156:159] offset:3072
    ds_write_b64 v67, v[64:65]
L_xa:
    s_waitcnt lgkmcnt(0)
    s_barrier
    v_mov_b32 v1, 20480
    ds_read_b128 v[4:7], v1
    ds_read_b128 v[8:11], v1 offset:16
    s_waitcnt lgkmcnt(0)
    v_or3_b32 v4, v4, v5, v6
    v_or3_b32 v4, v4, v7, v8
    v_or3_b32 v4, v4, v9, v10
    v_or_b32 v4, v4, v11
    s_nop 0
    v_readfirstlane_b32 s14, v4
    s_cmp_lg_u32 s14, 0
    s_cbranch_scc1 L_fb
L_comb:
    s_cmp_ge_u32 s38, 4
    s_cbranch_scc1 L_P3
    ds_read_b64 v[68:69], v67
    ds_read_b128 v[112:115], v19 offset:0
    ds_read_b128 v[116:119], v19 offset:1024
    ds_read_b128 v[120:123], v19 offset:2048
    ds_read_b128 v[124:127], v19 offset:3072
    s_waitcnt lgkmcnt(4)
    v_max_f32 v70, v64, v68
    v_sub_f32 v71, v64, v70
    v_sub_f32 v72, v68, v70
    v_exp_f32 v71, v71
    v_exp_f32 v72, v72
    v_mul_f32 v73, v71, v65
    v_fmac_f32 v73, v72, v69
    v_rcp_f32 v73, v73
    s_nop 0
    v_mul_f32 v71, v71, v73
    v_mul_f32 v72, v72, v73
    s_waitcnt lgkmcnt(0)
    v_mul_f32 v144, v144, v71
    v_mul_f32 v145, v145, v71
    v_mul_f32 v146, v146, v71
    v_mul_f32 v147, v147, v71
    v_mul_f32 v148, v148, v71
    v_mul_f32 v149, v149, v71
    v_mul_f32 v150, v150, v71
    v_mul_f32 v151, v151, v71
    v_mul_f32 v152, v152, v71
    v_mul_f32 v153, v153, v71
    v_mul_f32 v154, v154, v71
    v_mul_f32 v155, v155, v71
    v_mul_f32 v156, v156, v71
    v_mul_f32 v157, v157, v71
    v_mul_f32 v158, v158, v71
    v_mul_f32 v159, v159, v71
    v_fmac_f32 v144, v112, v72
    v_fmac_f32 v145, v113, v72
    v_fmac_f32 v146, v114, v72
    v_fmac_f32 v147, v115, v72
    v_fmac_f32 v148, v116, v72
    v_fmac_f32 v149, v117, v72
    v_fmac_f32 v150, v118, v72
    v_fmac_f32 v151, v119, v72
    v_fmac_f32 v152, v120, v72
    v_fmac_f32 v153, v121, v72
    v_fmac_f32 v154, v122, v72
    v_fmac_f32 v155, v123, v72
    v_fmac_f32 v156, v124, v72
    v_fmac_f32 v157, v125, v72
    v_fmac_f32 v158, v126, v72
    v_fmac_f32 v159, v127, v72
    v_cvt_pk_bf16_f32 v56, v144, v145
    v_cvt_pk_bf16_f32 v57, v146, v147
    v_cvt_pk_bf16_f32 v58, v148, v149
    v_cvt_pk_bf16_f32 v59, v150, v151
    v_cvt_pk_bf16_f32 v60, v152, v153
    v_cvt_pk_bf16_f32 v61, v154, v155
    v_cvt_pk_bf16_f32 v62, v156, v157
    v_cvt_pk_bf16_f32 v63, v158, v159
    s_mov_b64 exec, s[50:51]
    v_mov_b32 v62, 0
    v_mov_b32 v63, 0
    s_mov_b64 exec, -1
    buffer_store_dwordx4 v[56:59], v27, s[32:35], s100 offen sc1
    buffer_store_dwordx4 v[60:63], v27, s[32:35], s100 offen offset:1024 sc1
    s_waitcnt vmcnt(0)
    v_mov_b32 v1, s49
    v_mov_b32 v2, 0
    s_mov_b64 exec, 1
    buffer_store_dword v1, v2, s[32:35], s97 offen offset:0 sc1
    s_mov_b64 exec, -1
L_P3:
    s_cmp_ge_u32 s76, 32
    s_cbranch_scc1 L_fin
    s_lshr_b32 s15, s38, 2
    s_bfe_u32 s3, s38, 0x10001
    s_lshl_b32 s3, s3, 1
    s_add_u32 s3, s3, s15
    s_mul_i32 s12, s3, 12288
    s_add_u32 s12, s12, 114688
    v_add_u32 v16, s12, v27
    s_lshl_b32 s3, s3, 12
    s_add_u32 s3, s3, 32768
    v_add_u32 v19, s3, v27
    v_lshrrev_b32 v11, 5, v0
    v_bfe_u32 v12, v0, 2, 2
    v_bfe_u32 v13, v0, 4, 1
    v_and_b32 v14, 1, v0
    v_bfe_u32 v15, v0, 1, 1
    s_and_b32 s3, s38, 1
    s_lshl_b32 s3, s3, 2
    v_lshl_add_u32 v7, v13, 1, v15
    v_xor_b32 v7, s3, v7
    v_bfe_u32 v6, v0, 3, 1
    v_lshlrev_b32 v6, 2, v6
    v_xor_b32 v7, v7, v6
    v_lshlrev_b32 v7, 4, v7
    v_lshl_add_u32 v7, v14, 3, v7
    v_lshl_add_u32 v7, v12, 7, v7
    v_lshl_add_u32 v7, v11, 9, v7
    s_mul_i32 s3, s15, 32768
    s_add_u32 s3, s3, 49152
    v_add_u32 v17, s3, v7
    s_lshl_b32 s3, s38, 12
    s_add_u32 s3, s3, 0
    v_add_u32 v18, s3, v27
    s_barrier
    ds_read_b64_tr_b16 v[40:41], v17 offset:0
    ds_read_b64_tr_b16 v[42:43], v17 offset:1024
    ds_read_b128 v[44:47], v16 offset:0
    ds_read_b64_tr_b16 v[48:49], v17 offset:2048
    ds_read_b64_tr_b16 v[50:51], v17 offset:3072
    ds_read_b128 v[52:55], v16 offset:1024
    ds_read_b64_tr_b16 v[56:57], v17 offset:3584
    ds_read_b64_tr_b16 v[58:59], v17 offset:4608
    ds_read_b128 v[60:63], v16 offset:2048
    ds_read_b64_tr_b16 v[64:65], v17 offset:5632
    ds_read_b64_tr_b16 v[66:67], v17 offset:6656
    ds_read_b128 v[68:71], v16 offset:3072
    s_waitcnt lgkmcnt(9)
    v_mfma_f32_32x32x16_bf16 v[112:127], v[40:43], v[44:47], 0
    ds_read_b64_tr_b16 v[40:41], v17 offset:7168
    ds_read_b64_tr_b16 v[42:43], v17 offset:8192
    ds_read_b128 v[44:47], v16 offset:4096
    s_waitcnt lgkmcnt(9)
    v_mfma_f32_32x32x16_bf16 v[112:127], v[48:51], v[52:55], v[112:127]
    ds_read_b64_tr_b16 v[48:49], v17 offset:9216
    ds_read_b64_tr_b16 v[50:51], v17 offset:10240
    ds_read_b128 v[52:55], v16 offset:5120
    s_waitcnt lgkmcnt(9)
    v_mfma_f32_32x32x16_bf16 v[112:127], v[56:59], v[60:63], v[112:127]
    ds_read_b64_tr_b16 v[56:57], v17 offset:10752
    ds_read_b64_tr_b16 v[58:59], v17 offset:11776
    ds_read_b128 v[60:63], v16 offset:6144
    s_waitcnt lgkmcnt(9)
    v_mfma_f32_32x32x16_bf16 v[112:127], v[64:67], v[68:71], v[112:127]
    ds_read_b64_tr_b16 v[64:65], v17 offset:12800
    ds_read_b64_tr_b16 v[66:67], v17 offset:13824
    ds_read_b128 v[68:71], v16 offset:7168
    s_waitcnt lgkmcnt(9)
    v_mfma_f32_32x32x16_bf16 v[112:127], v[40:43], v[44:47], v[112:127]
    ds_read_b64_tr_b16 v[40:41], v17 offset:14336
    ds_read_b64_tr_b16 v[42:43], v17 offset:15360
    ds_read_b128 v[44:47], v16 offset:8192
    s_waitcnt lgkmcnt(9)
    v_mfma_f32_32x32x16_bf16 v[112:127], v[48:51], v[52:55], v[112:127]
    ds_read_b64_tr_b16 v[48:49], v17 offset:16384
    ds_read_b64_tr_b16 v[50:51], v17 offset:17408
    ds_read_b128 v[52:55], v16 offset:9216
    s_waitcnt lgkmcnt(9)
    v_mfma_f32_32x32x16_bf16 v[112:127], v[56:59], v[60:63], v[112:127]
    ds_read_b64_tr_b16 v[56:57], v17 offset:17920
    ds_read_b64_tr_b16 v[58:59], v17 offset:18944
    ds_read_b128 v[60:63], v16 offset:10240
    s_waitcnt lgkmcnt(9)
    v_mfma_f32_32x32x16_bf16 v[112:127], v[64:67], v[68:71], v[112:127]
    ds_read_b64_tr_b16 v[64:65], v17 offset:19968
    ds_read_b64_tr_b16 v[66:67], v17 offset:20992
    ds_read_b128 v[68:71], v16 offset:11264
    s_waitcnt lgkmcnt(9)
    v_mfma_f32_32x32x16_bf16 v[112:127], v[40:43], v[44:47], v[112:127]
    ds_read_b64_tr_b16 v[40:41], v17 offset:21504
    ds_read_b64_tr_b16 v[42:43], v17 offset:22528
    ds_read_b128 v[44:47], v19 offset:0
    s_waitcnt lgkmcnt(9)
    v_mfma_f32_32x32x16_bf16 v[112:127], v[48:51], v[52:55], v[112:127]
    ds_read_b64_tr_b16 v[48:49], v17 offset:23552
    ds_read_b64_tr_b16 v[50:51], v17 offset:24576
    ds_read_b128 v[52:55], v19 offset:1024
    s_waitcnt lgkmcnt(9)
    v_mfma_f32_32x32x16_bf16 v[112:127], v[56:59], v[60:63], v[112:127]
    ds_read_b64_tr_b16 v[56:57], v17 offset:25088
    ds_read_b64_tr_b16 v[58:59], v17 offset:26112
    ds_read_b128 v[60:63], v19 offset:2048
    s_waitcnt lgkmcnt(9)
    v_mfma_f32_32x32x16_bf16 v[112:127], v[64:67], v[68:71], v[112:127]
    ds_read_b64_tr_b16 v[64:65], v17 offset:27136
    ds_read_b64_tr_b16 v[66:67], v17 offset:28160
    ds_read_b128 v[68:71], v19 offset:3072
    s_waitcnt lgkmcnt(9)
    v_mfma_f32_32x32x16_bf16 v[112:127], v[40:43], v[44:47], v[112:127]
    s_waitcnt lgkmcnt(6)
    v_mfma_f32_32x32x16_bf16 v[112:127], v[48:51], v[52:55], v[112:127]
    s_waitcnt lgkmcnt(3)
    v_mfma_f32_32x32x16_bf16 v[112:127], v[56:59], v[60:63], v[112:127]
    s_waitcnt lgkmcnt(0)
    v_mfma_f32_32x32x16_bf16 v[112:127], v[64:67], v[68:71], v[112:127]
    s_nop 11
    ds_write_b128 v18, v[112:115] offset:0
    ds_write_b128 v18, v[116:119] offset:1024
    ds_write_b128 v18, v[120:123] offset:2048
    ds_write_b128 v18, v[124:127] offset:3072
    s_waitcnt lgkmcnt(0)
    s_barrier
L_fin:
    s_endpgm
L_fb:
    s_mov_b64 exec, s[50:51]
    v_mov_b32 v166, 0
    v_mov_b32 v167, 0
    s_mov_b64 exec, -1
    s_lshl_b32 s11, s74, 17
    s_lshr_b32 s14, s38, 2
    s_lshl_b32 s14, s14, 16
    s_add_u32 s11, s11, s14
    s_add_u32 s12, s11, 2097152
    s_mov_b32 s13, 32
    v_mov_b32 v72, 0xff800000
L_fb1:
    buffer_load_dwordx2 v[96:97], v34, s[32:35], s12 offen sc1
    buffer_load_dwordx2 v[98:99], v34, s[32:35], s12 offen offset:256 sc1
    buffer_load_dwordx2 v[100:101], v34, s[32:35], s12 offen offset:1024 sc1
    buffer_load_dwordx2 v[102:103], v34, s[32:35], s12 offen offset:1280 sc1
    s_add_u32 s12, s12, 2048
    s_waitcnt vmcnt(0)
    v_mfma_f32_32x32x16_bf16 v[112:127], v[96:99], v[160:163], 0
    v_mfma_f32_32x32x16_bf16 v[112:127], v[100:103], v[164:167], v[112:127]
    s_nop 11
    v_max3_f32 v72, v72, v112, v113
    v_max3_f32 v72, v72, v114, v115
    v_max3_f32 v72, v72, v116, v117
    v_max3_f32 v72, v72, v118, v119
    v_max3_f32 v72, v72, v120, v121
    v_max3_f32 v72, v72, v122, v123
    v_max3_f32 v72, v72, v124, v125
    v_max3_f32 v72, v72, v126, v127
    s_sub_u32 s13, s13, 1
    s_cmp_lg_u32 s13, 0
    s_cbranch_scc1 L_fb1
    v_mov_b32 v65, v72
    s_nop 1
    v_permlane32_swap_b32 v72, v65
    v_max_f32 v20, v72, v65
    v_cvt_pk_bf16_f32 v64, -v20, -v20
    v_and_b32 v64, 0xffff0000, v64
    v_sub_f32 v65, -v20, v64
    v_cvt_pk_bf16_f32 v66, -v20, v65
    v_and_b32 v64, 0xffff0000, v66
    v_sub_f32 v65, v65, v64
    v_cvt_pk_bf16_f32 v67, v65, 0
    s_mov_b64 exec, s[50:51]
    v_mov_b32 v166, v66
    v_mov_b32 v167, v67
    s_mov_b64 exec, -1
    v_mov_b32 v144, 0
    v_mov_b32 v145, 0
    v_mov_b32 v146, 0
    v_mov_b32 v147, 0
    v_mov_b32 v148, 0
    v_mov_b32 v149, 0
    v_mov_b32 v150, 0
    v_mov_b32 v151, 0
    v_mov_b32 v152, 0
    v_mov_b32 v153, 0
    v_mov_b32 v154, 0
    v_mov_b32 v155, 0
    v_mov_b32 v156, 0
    v_mov_b32 v157, 0
    v_mov_b32 v158, 0
    v_mov_b32 v159, 0
    s_add_u32 s12, s11, 2097152
    s_add_u32 s11, s11, 4194304
    s_mov_b32 s13, 32
    s_lshl_b32 s14, s38, 11
    s_add_u32 s14, s14, 32768
    v_add_u32 v22, s14, v21
    v_xor_b32 v23, 64, v22
    v_xor_b32 v24, 128, v22
    v_xor_b32 v25, 192, v22
    s_mov_b32 m0, s14
    v_lshlrev_b32 v17, 1, v0
    v_and_b32 v17, 0x60, v17
    v_xor_b32 v17, v17, v27
    v_xor_b32 v18, 0x80, v17
L_fb2:
    buffer_load_dwordx2 v[96:97], v34, s[32:35], s12 offen sc1
    buffer_load_dwordx2 v[98:99], v34, s[32:35], s12 offen offset:256 sc1
    buffer_load_dwordx2 v[100:101], v34, s[32:35], s12 offen offset:1024 sc1
    buffer_load_dwordx2 v[102:103], v34, s[32:35], s12 offen offset:1280 sc1
    buffer_load_dwordx4 v17, s[32:35], s11 offen sc1 lds
    buffer_load_dwordx4 v18, s[32:35], s11 offen offset:1024 sc1 lds
    s_add_u32 s12, s12, 2048
    s_add_u32 s11, s11, 2048
    s_waitcnt vmcnt(0)
    v_mfma_f32_32x32x16_bf16 v[112:127], v[96:99], v[160:163], 0
    v_mfma_f32_32x32x16_bf16 v[112:127], v[100:103], v[164:167], v[112:127]
    ds_read_b64_tr_b16 v[40:41], v22
    ds_read_b64_tr_b16 v[42:43], v23
    ds_read_b64_tr_b16 v[44:45], v24
    ds_read_b64_tr_b16 v[46:47], v25
    s_nop 7
    v_exp_f32 v112, v112
    v_exp_f32 v113, v113
    v_exp_f32 v114, v114
    v_exp_f32 v115, v115
    v_exp_f32 v116, v116
    v_exp_f32 v117, v117
    v_exp_f32 v118, v118
    v_exp_f32 v119, v119
    v_exp_f32 v120, v120
    v_exp_f32 v121, v121
    v_exp_f32 v122, v122
    v_exp_f32 v123, v123
    v_exp_f32 v124, v124
    v_exp_f32 v125, v125
    v_exp_f32 v126, v126
    v_exp_f32 v127, v127
    v_cvt_pk_bf16_f32 v56, v112, v113
    v_cvt_pk_bf16_f32 v57, v114, v115
    v_cvt_pk_bf16_f32 v58, v116, v117
    v_cvt_pk_bf16_f32 v59, v118, v119
    v_cvt_pk_bf16_f32 v60, v120, v121
    v_cvt_pk_bf16_f32 v61, v122, v123
    v_cvt_pk_bf16_f32 v62, v124, v125
    v_cvt_pk_bf16_f32 v63, v126, v127
    s_waitcnt lgkmcnt(0)
    v_mfma_f32_32x32x16_bf16 v[144:159], v[40:43], v[56:59], v[144:159]
    v_mfma_f32_32x32x16_bf16 v[144:159], v[44:47], v[60:63], v[144:159]
    s_sub_u32 s13, s13, 1
    s_cmp_lg_u32 s13, 0
    s_cbranch_scc1 L_fb2
    s_nop 8
    v_mov_b32 v64, v156
    v_mov_b32 v65, v156
    v_mul_f32 v66, 0, v144
    s_nop 0
    v_permlane32_swap_b32 v64, v65
    v_mov_b32 v64, v20
    s_lshl_b32 s14, s39, 9
    s_add_u32 s14, s14, 16384
    v_lshl_add_u32 v67, v0, 3, s14
    s_cmp_lt_u32 s38, 4
    s_cbranch_scc1 L_xb
    ds_write_b128 v19, v[144:147] offset:0
    ds_write_b128 v19, v[148:151] offset:1024
    ds_write_b128 v19, v[152:155] offset:2048
    ds_write_b128 v19, v[156:159] offset:3072
    ds_write_b64 v67, v[64:65]
L_xb:
    s_waitcnt lgkmcnt(0)
    s_barrier
    s_branch L_comb
L_H2N:
    s_cmp_lg_u32 s39, 0
    s_cbranch_scc1 L_H2N_lp0
    s_cmp_eq_u32 s79, 1
    s_cbranch_scc1 L_H2N_lp_ok
    s_mov_b32 s96, 200000
L_H2N_f3:
    buffer_load_dwordx4 v[40:43], v36, s[32:35], s58 offen sc1
    buffer_load_dwordx4 v[112:115], v39, s[32:35], s58 offen sc1
    s_waitcnt vmcnt(0)
    v_cmp_ne_u32 vcc, s49, v40
    v_cmp_ne_u32 s[54:55], s49, v41
    s_or_b64 vcc, vcc, s[54:55]
    v_cmp_ne_u32 s[54:55], s49, v42
    s_or_b64 vcc, vcc, s[54:55]
    v_cmp_ne_u32 s[54:55], s49, v43
    s_or_b64 vcc, vcc, s[54:55]
    v_cmp_ne_u32 s[54:55], s49, v112
    s_or_b64 vcc, vcc, s[54:55]
    v_cmp_ne_u32 s[54:55], s49, v113
    s_or_b64 vcc, vcc, s[54:55]
    v_cmp_ne_u32 s[54:55], s49, v114
    s_or_b64 vcc, vcc, s[54:55]
    v_cmp_ne_u32 s[54:55], s49, v115
    s_or_b64 vcc, vcc, s[54:55]
    s_cbranch_vccz L_H2N_f3_ok
    s_sleep 3
    s_sub_u32 s96, s96, 1
    s_cbranch_scc0 L_H2N_f3
L_H2N_f3_ok:
    v_mov_b32 v1, s49
    ds_write_b32 v38, v1
L_H2N_lp0:
    s_mov_b32 s96, 4000000
L_H2N_lp:
    ds_read_b32 v1, v38
    s_waitcnt lgkmcnt(0)
    v_cmp_ne_u32 vcc, s49, v1
    s_cbranch_vccz L_H2N_lp_ok
    s_sleep 1
    s_sub_u32 s96, s96, 1
    s_cbranch_scc0 L_H2N_lp
L_H2N_lp_ok:
    s_add_u32 m0, s47, -114688
    s_add_u32 s52, s97, 0
    buffer_load_dwordx4 v46, s[32:35], s52 offen sc1 lds
    buffer_load_dwordx4 v47, s[32:35], s52 offen offset:1024 sc1 lds
    s_add_u32 m0, s47, -106496
    s_add_u32 s52, s97, 65536
    buffer_load_dwordx4 v46, s[32:35], s52 offen sc1 lds
    buffer_load_dwordx4 v47, s[32:35], s52 offen offset:1024 sc1 lds
    s_add_u32 m0, s47, -98304
    s_add_u32 s52, s97, 4096
    buffer_load_dwordx4 v46, s[32:35], s52 offen sc1 lds
    buffer_load_dwordx4 v47, s[32:35], s52 offen offset:1024 sc1 lds
    s_add_u32 m0, s47, -90112
    s_add_u32 s52, s97, 69632
    buffer_load_dwordx4 v46, s[32:35], s52 offen sc1 lds
    buffer_load_dwordx4 v47, s[32:35], s52 offen offset:1024 sc1 lds
    s_waitcnt vmcnt(4)
    s_barrier
    s_add_u32 m0, s47, -81920
    s_add_u32 s52, s97, 8192
    buffer_load_dwordx4 v46, s[32:35], s52 offen sc1 lds
    buffer_load_dwordx4 v47, s[32:35], s52 offen offset:1024 sc1 lds
    s_add_u32 m0, s47, -73728
    s_add_u32 s52, s97, 73728
    buffer_load_dwordx4 v46, s[32:35], s52 offen sc1 lds
    buffer_load_dwordx4 v47, s[32:35], s52 offen offset:1024 sc1 lds
    s_waitcnt vmcnt(4)
    s_barrier
    s_add_u32 m0, s47, -65536
    s_add_u32 s52, s97, 12288
    buffer_load_dwordx4 v46, s[32:35], s52 offen sc1 lds
    buffer_load_dwordx4 v47, s[32:35], s52 offen offset:1024 sc1 lds
    s_add_u32 m0, s47, -57344
    s_add_u32 s52, s97, 77824
    buffer_load_dwordx4 v46, s[32:35], s52 offen sc1 lds
    buffer_load_dwordx4 v47, s[32:35], s52 offen offset:1024 sc1 lds
    s_waitcnt vmcnt(4)
    s_barrier
    s_add_u32 m0, s47, -114688
    s_add_u32 s52, s97, 16384
    buffer_load_dwordx4 v46, s[32:35], s52 offen sc1 lds
    buffer_load_dwordx4 v47, s[32:35], s52 offen offset:1024 sc1 lds
    s_add_u32 m0, s47, -106496
    s_add_u32 s52, s97, 81920
    buffer_load_dwordx4 v46, s[32:35], s52 offen sc1 lds
    buffer_load_dwordx4 v47, s[32:35], s52 offen offset:1024 sc1 lds
    s_waitcnt vmcnt(4)
    s_barrier
    s_add_u32 m0, s47, -98304
    s_add_u32 s52, s97, 20480
    buffer_load_dwordx4 v46, s[32:35], s52 offen sc1 lds
    buffer_load_dwordx4 v47, s[32:35], s52 offen offset:1024 sc1 lds
    s_add_u32 m0, s47, -90112
    s_add_u32 s52, s97, 86016
    buffer_load_dwordx4 v46, s[32:35], s52 offen sc1 lds
    buffer_load_dwordx4 v47, s[32:35], s52 offen offset:1024 sc1 lds
    s_waitcnt vmcnt(4)
    s_barrier
    s_add_u32 m0, s47, -81920
    s_add_u32 s52, s97, 24576
    buffer_load_dwordx4 v46, s[32:35], s52 offen sc1 lds
    buffer_load_dwordx4 v47, s[32:35], s52 offen offset:1024 sc1 lds
    s_add_u32 m0, s47, -73728
    s_add_u32 s52, s97, 90112
    buffer_load_dwordx4 v46, s[32:35], s52 offen sc1 lds
    buffer_load_dwordx4 v47, s[32:35], s52 offen offset:1024 sc1 lds
    s_waitcnt vmcnt(4)
    s_barrier
    s_add_u32 m0, s47, -65536
    s_add_u32 s52, s97, 28672
    buffer_load_dwordx4 v46, s[32:35], s52 offen sc1 lds
    buffer_load_dwordx4 v47, s[32:35], s52 offen offset:1024 sc1 lds
    s_add_u32 m0, s47, -57344
    s_add_u32 s52, s97, 94208
    buffer_load_dwordx4 v46, s[32:35], s52 offen sc1 lds
    buffer_load_dwordx4 v47, s[32:35], s52 offen offset:1024 sc1 lds
    s_waitcnt vmcnt(4)
    s_barrier
    s_add_u32 m0, s47, -114688
    s_add_u32 s52, s97, 32768
    buffer_load_dwordx4 v46, s[32:35], s52 offen sc1 lds
    buffer_load_dwordx4 v47, s[32:35], s52 offen offset:1024 sc1 lds
    s_add_u32 m0, s47, -106496
    s_add_u32 s52, s97, 98304
    buffer_load_dwordx4 v46, s[32:35], s52 offen sc1 lds
    buffer_load_dwordx4 v47, s[32:35], s52 offen offset:1024 sc1 lds
    s_waitcnt vmcnt(4)
    s_barrier
    s_add_u32 m0, s47, -98304
    s_add_u32 s52, s97, 36864
    buffer_load_dwordx4 v46, s[32:35], s52 offen sc1 lds
    buffer_load_dwordx4 v47, s[32:35], s52 offen offset:1024 sc1 lds
    s_add_u32 m0, s47, -90112
    s_add_u32 s52, s97, 102400
    buffer_load_dwordx4 v46, s[32:35], s52 offen sc1 lds
    buffer_load_dwordx4 v47, s[32:35], s52 offen offset:1024 sc1 lds
    s_waitcnt vmcnt(4)
    s_barrier
    s_add_u32 m0, s47, -81920
    s_add_u32 s52, s97, 40960
    buffer_load_dwordx4 v46, s[32:35], s52 offen sc1 lds
    buffer_load_dwordx4 v47, s[32:35], s52 offen offset:1024 sc1 lds
    s_add_u32 m0, s47, -73728
    s_add_u32 s52, s97, 106496
    buffer_load_dwordx4 v46, s[32:35], s52 offen sc1 lds
    buffer_load_dwordx4 v47, s[32:35], s52 offen offset:1024 sc1 lds
    s_waitcnt vmcnt(4)
    s_barrier
    s_add_u32 m0, s47, -65536
    s_add_u32 s52, s97, 45056
    buffer_load_dwordx4 v46, s[32:35], s52 offen sc1 lds
    buffer_load_dwordx4 v47, s[32:35], s52 offen offset:1024 sc1 lds
    s_add_u32 m0, s47, -57344
    s_add_u32 s52, s97, 110592
    buffer_load_dwordx4 v46, s[32:35], s52 offen sc1 lds
    buffer_load_dwordx4 v47, s[32:35], s52 offen offset:1024 sc1 lds
    s_waitcnt vmcnt(4)
    s_barrier
    s_add_u32 m0, s47, -114688
    s_add_u32 s52, s97, 49152
    buffer_load_dwordx4 v46, s[32:35], s52 offen sc1 lds
    buffer_load_dwordx4 v47, s[32:35], s52 offen offset:1024 sc1 lds
    s_add_u32 m0, s47, -106496
    s_add_u32 s52, s97, 114688
    buffer_load_dwordx4 v46, s[32:35], s52 offen sc1 lds
    buffer_load_dwordx4 v47, s[32:35], s52 offen offset:1024 sc1 lds
    s_waitcnt vmcnt(4)
    s_barrier
    s_add_u32 m0, s47, -98304
    s_add_u32 s52, s97, 53248
    buffer_load_dwordx4 v46, s[32:35], s52 offen sc1 lds
    buffer_load_dwordx4 v47, s[32:35], s52 offen offset:1024 sc1 lds
    s_add_u32 m0, s47, -90112
    s_add_u32 s52, s97, 118784
    buffer_load_dwordx4 v46, s[32:35], s52 offen sc1 lds
    buffer_load_dwordx4 v47, s[32:35], s52 offen offset:1024 sc1 lds
    s_waitcnt vmcnt(4)
    s_barrier
    s_add_u32 m0, s47, -81920
    s_add_u32 s52, s97, 57344
    buffer_load_dwordx4 v46, s[32:35], s52 offen sc1 lds
    buffer_load_dwordx4 v47, s[32:35], s52 offen offset:1024 sc1 lds
    s_add_u32 m0, s47, -73728
    s_add_u32 s52, s97, 122880
    buffer_load_dwordx4 v46, s[32:35], s52 offen sc1 lds
    buffer_load_dwordx4 v47, s[32:35], s52 offen offset:1024 sc1 lds
    s_waitcnt vmcnt(4)
    s_barrier
    s_add_u32 m0, s47, -65536
    s_add_u32 s52, s42, 0
    buffer_load_dwordx4 v46, s[32:35], s52 offen sc1 lds
    buffer_load_dwordx4 v47, s[32:35], s52 offen offset:1024 sc1 lds
    s_add_u32 m0, s47, -57344
    s_add_u32 s52, s42, 65536
    buffer_load_dwordx4 v46, s[32:35], s52 offen sc1 lds
    buffer_load_dwordx4 v47, s[32:35], s52 offen offset:1024 sc1 lds
    s_waitcnt vmcnt(4)
    s_barrier
    s_waitcnt vmcnt(0)
    s_barrier
    s_barrier
    v_mov_b32 v1, 20480
    ds_read_b128 v[4:7], v1
    ds_read_b128 v[8:11], v1 offset:16
    s_waitcnt lgkmcnt(0)
    v_or3_b32 v4, v4, v5, v6
    v_or3_b32 v4, v4, v7, v8
    v_or3_b32 v4, v4, v9, v10
    v_or_b32 v4, v4, v11
    s_nop 0
    v_readfirstlane_b32 s14, v4
    s_cmp_eq_u32 s14, 0
    s_cbranch_scc1 L_H2N_nofb
    s_barrier
L_H2N_nofb:
    s_endpgm
L_H1Q:
    s_lshl_b32 s60, s37, 1
    s_sub_u32 s60, s60, 11
    s_add_u32 s101, s37, 12
    s_lshl_b32 s14, s60, 7
    s_mul_i32 s15, s39, 21504
    s_add_u32 s43, s14, s15
    s_add_u32 s44, s43, s15
    v_add_u32 v23, 20480, v22
    v_xor_b32 v7, 32, v5
    v_add3_u32 v45, v6, v7, 64
    v_add_u32 v45, 64, v45
    s_add_u32 m0, s46, 0
    s_add_u32 s52, s43, 0
    buffer_load_dwordx4 v22, s[20:23], s52 offen lds
    s_add_u32 m0, s46, 4096
    s_nop 0
    buffer_load_dwordx4 v45, s[20:23], s52 offen lds
    s_add_u32 m0, s46, 8192
    s_add_u32 s52, s43, 86016
    buffer_load_dwordx4 v22, s[20:23], s52 offen lds
    s_add_u32 m0, s46, 12288
    s_nop 0
    buffer_load_dwordx4 v45, s[20:23], s52 offen lds
    s_add_u32 m0, s48, 16384
    s_add_u32 s52, s45, 128
    buffer_load_dwordx4 v16, s[16:19], s52 offen offset:0 lds
    buffer_load_dwordx4 v17, s[16:19], s52 offen offset:1024 lds
    buffer_load_dwordx4 v18, s[16:19], s52 offen offset:2048 lds
    buffer_load_dwordx4 v19, s[16:19], s52 offen offset:3072 lds
    s_mov_b32 s24, s8
    s_mov_b32 s25, s9
    s_mov_b32 s26, 1605632
    s_mov_b32 s27, 0x00020000
    s_mov_b32 s28, s10
    s_mov_b32 s29, s11
    s_mov_b32 s30, 1605632
    s_mov_b32 s31, 0x00020000
    v_mul_u32_u24 v6, 3584, v2
    v_add_u32 v20, v6, v5
    v_add_u32 v21, v6, v7
    s_lshl_b32 s42, s101, 7
    s_mul_i32 s15, s39, 28672
    s_add_u32 s42, s42, s15
    v_add_u32 v26, 6144, v25
    v_lshlrev_b32 v24, 4, v0
    s_mov_b32 s32, s68
    s_mov_b32 s33, s69
    s_mov_b32 s34, 20971520
    s_mov_b32 s35, 0x00020000
    s_mov_b32 s3, 16777216
    s_load_dword s49, s[68:69], s3
    s_waitcnt lgkmcnt(0)
    s_add_u32 s49, s49, 0x9e3779b9
    s_and_b32 s3, s2, 7
    s_and_b32 s14, s78, 1
    s_lshl_b32 s74, s3, 1
    s_add_u32 s74, s74, s14
    s_lshr_b32 s75, s78, 1
    s_mul_i32 s14, s3, 29
    s_sub_u32 s15, s3, 4
    s_max_i32 s15, s15, 0
    s_add_u32 s14, s14, s15
    s_cmp_eq_u32 s3, 7
    s_cselect_b32 s14, 200, s14
    s_cmp_lt_u32 s3, 4
    s_cselect_b32 s15, 29, 30
    s_cmp_lt_u32 s3, 6
    s_cselect_b32 s15, s15, 24
    s_add_u32 s14, s14, s78
    s_mul_i32 s76, s14, 9363
    s_lshr_b32 s76, s76, 16
    s_mul_i32 s77, s76, 7
    s_sub_u32 s77, s14, s77
    s_cmp_ge_u32 s78, s15
    s_cselect_b32 s76, 32, s76
    s_mul_i32 s14, s74, 28
    s_lshr_b32 s15, s14, 6
    s_add_u32 s14, s14, 27
    s_lshr_b32 s14, s14, 6
    s_sub_u32 s14, s14, s15
    s_lshl_b32 s14, s14, 8
    s_lshl_b32 s15, s15, 8
    s_mov_b32 s58, 16781312
    v_bfe_u32 v1, v0, 4, 1
    v_mul_u32_u24 v1, s14, v1
    v_lshrrev_b32 v2, 5, v0
    v_mul_u32_u24 v3, 1792, v2
    v_add3_u32 v1, v1, v3, s15
    v_and_b32 v3, 15, v0
    v_lshl_add_u32 v1, v3, 4, v1
    v_add_u32 v36, 1792, v1
    v_and_b32 v1, 1, v0
    v_mul_u32_u24 v1, s14, v1
    s_lshl_b32 s13, s75, 4
    s_add_u32 s15, s15, s13
    v_add_u32 v39, s15, v1
    v_and_b32 v3, 31, v0
    v_min_u32 v3, 27, v3
    v_lshlrev_b32 v4, 2, v3
    v_lshl_add_u32 v4, v2, 12, v4
    s_lshl_b32 s13, s76, 7
    s_add_u32 s13, s13, 8192
    v_add_u32 v37, s13, v4
    v_mov_b32 v38, 158720
    v_mov_b32 v1, 0
    ds_write_b32 v38, v1
    s_mov_b32 s79, 0
    s_waitcnt lgkmcnt(0)
    s_waitcnt vmcnt(6)
    s_barrier
    s_add_u32 m0, s46, 16384
    s_add_u32 s52, s43, 172032
    buffer_load_dwordx4 v22, s[20:23], s52 offen lds
    s_add_u32 m0, s46, 20480
    s_nop 0
    buffer_load_dwordx4 v45, s[20:23], s52 offen lds
    s_add_u32 m0, s48, 32768
    s_add_u32 s52, s45, 256
    buffer_load_dwordx4 v16, s[16:19], s52 offen offset:0 lds
    buffer_load_dwordx4 v17, s[16:19], s52 offen offset:1024 lds
    buffer_load_dwordx4 v18, s[16:19], s52 offen offset:2048 lds
    buffer_load_dwordx4 v19, s[16:19], s52 offen offset:3072 lds
    s_add_u32 m0, s46, 24576
    s_add_u32 s52, s43, 258048
    buffer_load_dwordx4 v22, s[20:23], s52 offen lds
    s_add_u32 m0, s46, 28672
    s_nop 0
    buffer_load_dwordx4 v45, s[20:23], s52 offen lds
    s_add_u32 m0, s48, 49152
    s_add_u32 s52, s45, 384
    buffer_load_dwordx4 v16, s[16:19], s52 offen offset:0 lds
    buffer_load_dwordx4 v17, s[16:19], s52 offen offset:1024 lds
    buffer_load_dwordx4 v18, s[16:19], s52 offen offset:2048 lds
    buffer_load_dwordx4 v19, s[16:19], s52 offen offset:3072 lds
    s_waitcnt vmcnt(16)
    s_barrier
    s_add_u32 m0, s46, 32768
    s_add_u32 s52, s43, 344064
    buffer_load_dwordx4 v22, s[20:23], s52 offen lds
    s_add_u32 m0, s46, 36864
    s_nop 0
    buffer_load_dwordx4 v45, s[20:23], s52 offen lds
    s_add_u32 m0, s48, 65536
    s_add_u32 s52, s45, 512
    buffer_load_dwordx4 v16, s[16:19], s52 offen offset:0 lds
    buffer_load_dwordx4 v17, s[16:19], s52 offen offset:1024 lds
    buffer_load_dwordx4 v18, s[16:19], s52 offen offset:2048 lds
    buffer_load_dwordx4 v19, s[16:19], s52 offen offset:3072 lds
    s_waitcnt vmcnt(16)
    s_barrier
    s_add_u32 m0, s46, 0
    s_add_u32 s52, s43, 430080
    buffer_load_dwordx4 v22, s[20:23], s52 offen lds
    s_add_u32 m0, s46, 4096
    s_nop 0
    buffer_load_dwordx4 v45, s[20:23], s52 offen lds
    s_add_u32 m0, s48, 81920
    s_add_u32 s52, s45, 640
    buffer_load_dwordx4 v16, s[16:19], s52 offen offset:0 lds
    buffer_load_dwordx4 v17, s[16:19], s52 offen offset:1024 lds
    buffer_load_dwordx4 v18, s[16:19], s52 offen offset:2048 lds
    buffer_load_dwordx4 v19, s[16:19], s52 offen offset:3072 lds
    s_waitcnt vmcnt(16)
    s_barrier
    s_add_u32 m0, s46, 8192
    s_add_u32 s52, s43, 516096
    buffer_load_dwordx4 v22, s[20:23], s52 offen lds
    s_add_u32 m0, s46, 12288
    s_nop 0
    buffer_load_dwordx4 v45, s[20:23], s52 offen lds
    s_add_u32 m0, s48, 98304
    s_add_u32 s52, s45, 768
    buffer_load_dwordx4 v16, s[16:19], s52 offen offset:0 lds
    buffer_load_dwordx4 v17, s[16:19], s52 offen offset:1024 lds
    buffer_load_dwordx4 v18, s[16:19], s52 offen offset:2048 lds
    buffer_load_dwordx4 v19, s[16:19], s52 offen offset:3072 lds
    s_waitcnt vmcnt(16)
    s_barrier
    s_add_u32 m0, s46, 16384
    s_add_u32 s52, s43, 602112
    buffer_load_dwordx4 v22, s[20:23], s52 offen lds
    s_add_u32 m0, s46, 20480
    s_nop 0
    buffer_load_dwordx4 v45, s[20:23], s52 offen lds
    s_waitcnt vmcnt(12)
    s_barrier
    s_add_u32 m0, s46, 24576
    s_add_u32 s52, s43, 688128
    buffer_load_dwordx4 v22, s[20:23], s52 offen lds
    s_add_u32 m0, s46, 28672
    s_nop 0
    buffer_load_dwordx4 v45, s[20:23], s52 offen lds
    s_waitcnt vmcnt(8)
    s_barrier
    s_add_u32 m0, s46, 32768
    s_add_u32 s52, s43, 774144
    buffer_load_dwordx4 v22, s[20:23], s52 offen lds
    s_add_u32 m0, s46, 36864
    s_nop 0
    buffer_load_dwordx4 v45, s[20:23], s52 offen lds
    s_waitcnt vmcnt(4)
    s_barrier
    s_add_u32 m0, s46, 0
    s_add_u32 s52, s43, 860160
    buffer_load_dwordx4 v22, s[20:23], s52 offen lds
    s_add_u32 m0, s46, 4096
    s_nop 0
    buffer_load_dwordx4 v45, s[20:23], s52 offen lds
    s_waitcnt vmcnt(4)
    s_barrier
    s_add_u32 m0, s46, 8192
    s_add_u32 s52, s43, 946176
    buffer_load_dwordx4 v22, s[20:23], s52 offen lds
    s_add_u32 m0, s46, 12288
    s_nop 0
    buffer_load_dwordx4 v45, s[20:23], s52 offen lds
    s_waitcnt vmcnt(4)
    s_barrier
    s_add_u32 m0, s46, 16384
    s_add_u32 s52, s43, 1032192
    buffer_load_dwordx4 v22, s[20:23], s52 offen lds
    s_add_u32 m0, s46, 20480
    s_nop 0
    buffer_load_dwordx4 v45, s[20:23], s52 offen lds
    s_waitcnt vmcnt(4)
    s_barrier
    s_add_u32 m0, s46, 24576
    s_add_u32 s52, s43, 1118208
    buffer_load_dwordx4 v22, s[20:23], s52 offen lds
    s_add_u32 m0, s46, 28672
    s_nop 0
    buffer_load_dwordx4 v45, s[20:23], s52 offen lds
    s_waitcnt vmcnt(4)
    s_barrier
    s_add_u32 m0, s46, 32768
    s_add_u32 s52, s42, 0
    buffer_load_dwordx4 v20, s[24:27], s52 offen lds
    s_add_u32 m0, s46, 36864
    s_nop 0
    buffer_load_dwordx4 v21, s[28:31], s52 offen lds
    s_waitcnt vmcnt(4)
    s_barrier
    s_add_u32 m0, s46, 0
    s_add_u32 s52, s42, 114688
    buffer_load_dwordx4 v20, s[24:27], s52 offen lds
    s_add_u32 m0, s46, 4096
    s_nop 0
    buffer_load_dwordx4 v21, s[28:31], s52 offen lds
    s_waitcnt vmcnt(4)
    s_barrier
    s_add_u32 m0, s46, 8192
    s_add_u32 s52, s42, 229376
    buffer_load_dwordx4 v20, s[24:27], s52 offen lds
    s_add_u32 m0, s46, 12288
    s_nop 0
    buffer_load_dwordx4 v21, s[28:31], s52 offen lds
    s_waitcnt vmcnt(4)
    s_barrier
    s_add_u32 m0, s46, 16384
    s_add_u32 s52, s42, 344064
    buffer_load_dwordx4 v20, s[24:27], s52 offen lds
    s_add_u32 m0, s46, 20480
    s_nop 0
    buffer_load_dwordx4 v21, s[28:31], s52 offen lds
    s_waitcnt vmcnt(4)
    s_barrier
    s_add_u32 m0, s46, 24576
    s_add_u32 s52, s42, 458752
    buffer_load_dwordx4 v20, s[24:27], s52 offen lds
    s_add_u32 m0, s46, 28672
    s_nop 0
    buffer_load_dwordx4 v21, s[28:31], s52 offen lds
    s_waitcnt vmcnt(4)
    s_barrier
    s_add_u32 m0, s46, 32768
    s_add_u32 s52, s42, 573440
    buffer_load_dwordx4 v20, s[24:27], s52 offen lds
    s_add_u32 m0, s46, 36864
    s_nop 0
    buffer_load_dwordx4 v21, s[28:31], s52 offen lds
    s_waitcnt vmcnt(4)
    s_barrier
    s_add_u32 m0, s46, 0
    s_add_u32 s52, s42, 688128
    buffer_load_dwordx4 v20, s[24:27], s52 offen lds
    s_add_u32 m0, s46, 4096
    s_nop 0
    buffer_load_dwordx4 v21, s[28:31], s52 offen lds
    s_waitcnt vmcnt(4)
    s_barrier
    s_add_u32 m0, s46, 8192
    s_add_u32 s52, s42, 802816
    buffer_load_dwordx4 v20, s[24:27], s52 offen lds
    s_add_u32 m0, s46, 12288
    s_nop 0
    buffer_load_dwordx4 v21, s[28:31], s52 offen lds
    s_waitcnt vmcnt(4)
    s_barrier
    s_add_u32 m0, s46, 16384
    s_add_u32 s52, s42, 917504
    buffer_load_dwordx4 v20, s[24:27], s52 offen lds
    s_add_u32 m0, s46, 20480
    s_nop 0
    buffer_load_dwordx4 v21, s[28:31], s52 offen lds
    s_waitcnt vmcnt(4)
    s_barrier
    s_add_u32 m0, s46, 24576
    s_add_u32 s52, s42, 1032192
    buffer_load_dwordx4 v20, s[24:27], s52 offen lds
    s_add_u32 m0, s46, 28672
    s_nop 0
    buffer_load_dwordx4 v21, s[28:31], s52 offen lds
    s_waitcnt vmcnt(4)
    s_barrier
    s_add_u32 m0, s46, 32768
    s_add_u32 s52, s42, 1146880
    buffer_load_dwordx4 v20, s[24:27], s52 offen lds
    s_add_u32 m0, s46, 36864
    s_nop 0
    buffer_load_dwordx4 v21, s[28:31], s52 offen lds
    s_waitcnt vmcnt(4)
    s_barrier
    s_add_u32 m0, s46, 0
    s_add_u32 s52, s42, 1261568
    buffer_load_dwordx4 v20, s[24:27], s52 offen lds
    s_add_u32 m0, s46, 4096
    s_nop 0
    buffer_load_dwordx4 v21, s[28:31], s52 offen lds
    s_waitcnt vmcnt(4)
    s_barrier
    s_add_u32 m0, s46, 8192
    s_add_u32 s52, s42, 1376256
    buffer_load_dwordx4 v20, s[24:27], s52 offen lds
    s_add_u32 m0, s46, 12288
    s_nop 0
    buffer_load_dwordx4 v21, s[28:31], s52 offen lds
    s_waitcnt vmcnt(4)
    s_barrier
    s_add_u32 m0, s46, 16384
    s_add_u32 s52, s42, 1490944
    buffer_load_dwordx4 v20, s[24:27], s52 offen lds
    s_add_u32 m0, s46, 20480
    s_nop 0
    buffer_load_dwordx4 v21, s[28:31], s52 offen lds
    s_waitcnt vmcnt(4)
    s_barrier
    s_waitcnt vmcnt(2)
    s_barrier
    s_waitcnt vmcnt(0)
    s_barrier
    s_barrier
    s_branch L_H2
L_BQ:
    v_and_b32 v7, 31, v0
    v_lshrrev_b32 v8, 5, v0
    v_mul_u32_u24 v9, 896, v8
    v_lshl_add_u32 v9, v7, 4, v9
    s_lshl_b32 s14, s36, 4
    s_add_u32 s14, s14, s37
    s_lshl_b32 s14, s14, 2
    s_add_u32 s14, s14, s39
    s_lshl_b32 s45, s14, 1
    s_mul_i32 s14, s45, 896
    v_mov_b32 v52, 0
    v_mov_b32 v53, 0
    v_mov_b32 v54, 0
    v_mov_b32 v55, 0
    s_mov_b32 s16, s4
    s_mov_b32 s17, s5
    s_mov_b32 s18, 1835008
    s_mov_b32 s19, 0x00020000
    buffer_load_dwordx4 v[48:51], v9, s[16:19], s14 offen
    s_mov_b32 exec_lo, 0x00ffffff
    s_mov_b32 exec_hi, 0x00ffffff
    buffer_load_dwordx4 v[52:55], v9, s[16:19], s14 offen offset:512
    s_mov_b64 exec, -1
    s_getpc_b64 s[12:13]
L_pcQ:
    s_sub_u32 s12, s12, L_pcQ-recurrent_scan__mha_block__geglu_ffn__prompt_kernel
    s_subb_u32 s13, s13, 0
    s_lshl_b32 s14, s78, 12
    v_lshl_add_u32 v10, v7, 7, s14
    v_min_u32 v10, L_tabend-recurrent_scan__mha_block__geglu_ffn__prompt_kernel-4, v10
    global_load_dword v39, v10, s[12:13]
    s_lshl_b32 s60, s37, 1
    s_sub_u32 s60, s60, 11
    s_add_u32 s101, s37, 12
    s_and_b32 s42, s36, 7
    s_cmp_ge_u32 s42, 4
    s_cselect_b32 s46, 5, 0
    s_add_u32 s14, s42, 2
    s_cmp_ge_u32 s42, 2
    s_cselect_b32 s42, s14, s42
    s_lshr_b32 s14, s42, 1
    s_lshl_b32 s14, s14, 7
    s_lshl_b32 s15, s101, 7
    s_add_u32 s14, s14, s15
    s_add_u32 s15, s60, s42
    s_sub_u32 s15, s15, 4
    s_lshl_b32 s15, s15, 7
    s_bitcmp1_b32 s42, 0
    s_cselect_b32 s8, s10, s8
    s_cselect_b32 s9, s11, s9
    s_cmp_ge_u32 s42, 4
    s_cselect_b32 s43, s15, s14
    s_cselect_b32 s8, s6, s8
    s_cselect_b32 s9, s7, s9
    s_mov_b32 s14, 3584
    s_cselect_b32 s44, 2688, s14
    s_mov_b32 s14, 1605632
    s_cselect_b32 s14, 1204224, s14
    s_mov_b32 s24, s8
    s_mov_b32 s25, s9
    s_mov_b32 s26, s14
    s_mov_b32 s27, 0x00020000
    v_lshrrev_b32 v12, 3, v0
    v_mul_lo_u32 v12, v12, s44
    v_and_b32 v13, 7, v0
    v_lshl_add_u32 v12, v13, 4, v12
    s_mul_i32 s14, s39, 112
    s_mul_i32 s14, s14, s44
    s_add_u32 s43, s43, s14
    s_lshl_b32 s44, s44, 3
    v_mov_b32 v38, v12
    s_and_b32 s40, s38, 1
    s_lshr_b32 s41, s39, 1
    s_mov_b32 s50, 0
    s_mov_b32 s51, -1
    v_and_b32 v7, 31, v0
    v_lshrrev_b32 v8, 5, v0
    v_bfe_u32 v9, v0, 1, 3
    v_xor_b32 v9, v9, v8
    v_lshlrev_b32 v9, 4, v9
    v_lshl_add_u32 v9, v7, 7, v9
    s_lshl_b32 s15, s40, 13
    v_add_u32 v16, s15, v9
    v_xor_b32 v17, 32, v16
    v_xor_b32 v18, 64, v16
    v_xor_b32 v19, 96, v16
    v_add_u32 v20, 0x10000, v16
    v_add_u32 v21, 0x10000, v17
    v_add_u32 v22, 0x10000, v18
    v_add_u32 v23, 0x10000, v19
    v_bfe_u32 v10, v0, 2, 2
    v_and_b32 v11, 3, v0
    v_bfe_u32 v12, v0, 4, 1
    v_bfe_u32 v13, v0, 3, 1
    v_lshlrev_b32 v13, 2, v13
    v_lshlrev_b32 v14, 10, v8
    v_lshl_add_u32 v14, v10, 7, v14
    v_add_u32 v14, 114688, v14
    v_lshl_add_u32 v2, v12, 2, v11
    s_lshl_b32 s15, s41, 3
    v_add_u32 v3, s15, v2
    v_lshrrev_b32 v1, 1, v3
    v_xor_b32 v1, v1, v13
    v_lshl_add_u32 v1, v1, 4, v14
    v_and_b32 v15, 1, v3
    v_lshl_add_u32 v26, v15, 3, v1
    v_add_u32 v4, 8, v2
    s_lshl_b32 s14, s41, 1
    s_lshl_b32 s15, s41, 12
    v_lshrrev_b32 v1, 1, v2
    v_xor_b32 v1, v1, v13
    v_xor_b32 v1, s14, v1
    v_lshl_add_u32 v1, v1, 4, v14
    v_and_b32 v15, 1, v2
    v_lshl_add_u32 v24, v15, 3, v1
    v_add_u32 v24, s15, v24
    v_lshrrev_b32 v1, 1, v4
    v_xor_b32 v1, v1, v13
    v_xor_b32 v1, s14, v1
    v_lshl_add_u32 v1, v1, 4, v14
    v_and_b32 v15, 1, v4
    v_lshl_add_u32 v25, v15, 3, v1
    v_add_u32 v25, s15, v25
    s_lshl_b32 s14, s41, 8
    s_add_u32 s14, s14, 155648
    v_lshl_add_u32 v37, v8, 4, s14
    v_lshrrev_b32 v1, 1, v11
    v_xor_b32 v1, v1, v13
    v_lshlrev_b32 v3, 1, v12
    v_xor_b32 v1, v1, v3
    s_lshl_b32 s14, s41, 2
    v_xor_b32 v1, s14, v1
    v_lshl_add_u32 v1, v1, 4, v14
    v_and_b32 v15, 1, v11
    v_lshl_add_u32 v1, v15, 3, v1
    v_lshl_add_u32 v35, v12, 12, v1
    v_xor_b32 v36, 32, v35
    s_lshl_b32 s14, s41, 7
    s_add_u32 s14, s14, 155648
    v_lshl_add_u32 v30, v8, 4, s14
    s_lshl_b32 s14, s41, 7
    s_add_u32 s14, s14, 155648
    v_lshl_add_u32 v31, v8, 4, s14
    s_lshl_b32 s14, s40, 8
    s_add_u32 s14, s14, 155648
    v_lshl_add_u32 v32, v7, 2, s14
    v_lshlrev_b32 v27, 4, v0
    v_lshlrev_b32 v28, 3, v7
    v_mov_b32 v29, v8
    s_lshl_b32 s60, s37, 1
    s_sub_u32 s60, s60, 11
    s_add_u32 s101, s37, 12
    s_and_b32 s3, s2, 7
    s_and_b32 s14, s78, 1
    s_lshl_b32 s74, s3, 1
    s_add_u32 s74, s74, s14
    s_lshr_b32 s75, s78, 1
    s_mul_i32 s14, s3, 29
    s_sub_u32 s15, s3, 4
    s_max_i32 s15, s15, 0
    s_add_u32 s14, s14, s15
    s_cmp_eq_u32 s3, 7
    s_cselect_b32 s14, 200, s14
    s_cmp_lt_u32 s3, 4
    s_cselect_b32 s15, 29, 30
    s_cmp_lt_u32 s3, 6
    s_cselect_b32 s15, s15, 24
    s_add_u32 s14, s14, s78
    s_mul_i32 s76, s14, 9363
    s_lshr_b32 s76, s76, 16
    s_mul_i32 s77, s76, 7
    s_sub_u32 s77, s14, s77
    s_cmp_ge_u32 s78, s15
    s_cselect_b32 s76, 32, s76
    s_mov_b32 s32, s68
    s_mov_b32 s33, s69
    s_mov_b32 s34, 20971520
    s_mov_b32 s35, 0x00020000
    s_mov_b32 s3, 16777216
    s_load_dword s49, s[68:69], s3
    s_waitcnt lgkmcnt(0)
    s_add_u32 s49, s49, 0x9e3779b9
    s_barrier
    s_cmp_ge_u32 s46, 5
    s_cbranch_scc1 L_BQ_nd1
    buffer_load_dwordx4 v[96:99], v38, s[24:27], s43 offen
    s_add_u32 s43, s43, s44
    buffer_load_dwordx4 v[100:103], v38, s[24:27], s43 offen
    s_add_u32 s43, s43, s44
    buffer_load_dwordx4 v[104:107], v38, s[24:27], s43 offen
    s_add_u32 s43, s43, s44
    buffer_load_dwordx4 v[108:111], v38, s[24:27], s43 offen
    s_add_u32 s43, s43, s44
    buffer_load_dwordx4 v[112:115], v38, s[24:27], s43 offen
    s_add_u32 s43, s43, s44
    buffer_load_dwordx4 v[116:119], v38, s[24:27], s43 offen
    s_add_u32 s43, s43, s44
    buffer_load_dwordx4 v[120:123], v38, s[24:27], s43 offen
    s_add_u32 s43, s43, s44
    buffer_load_dwordx4 v[124:127], v38, s[24:27], s43 offen
    s_add_u32 s43, s43, s44
    buffer_load_dwordx4 v[128:131], v38, s[24:27], s43 offen
    s_add_u32 s43, s43, s44
    buffer_load_dwordx4 v[132:135], v38, s[24:27], s43 offen
    s_add_u32 s43, s43, s44
    buffer_load_dwordx4 v[136:139], v38, s[24:27], s43 offen
    s_add_u32 s43, s43, s44
    buffer_load_dwordx4 v[140:143], v38, s[24:27], s43 offen
    s_add_u32 s43, s43, s44
    buffer_load_dwordx4 v[144:147], v38, s[24:27], s43 offen
    s_add_u32 s43, s43, s44
    buffer_load_dwordx4 v[148:151], v38, s[24:27], s43 offen
L_BQ_nd1:
    s_cmp_ge_u32 s46, 5
    s_cbranch_scc1 L_BQ_w1
    s_waitcnt vmcnt(15)
    s_branch L_BQ_w2
L_BQ_w1:
    s_waitcnt vmcnt(1)
L_BQ_w2:
    v_mov_b32 v1, 0
    v_mov_b32 v2, 0
    v_lshlrev_b32 v3, 16, v48
    v_and_b32 v4, 0xffff0000, v48
    v_add_f32 v1, v1, v3
    v_fmac_f32 v2, v3, v3
    v_add_f32 v1, v1, v4
    v_fmac_f32 v2, v4, v4
    v_lshlrev_b32 v3, 16, v49
    v_and_b32 v4, 0xffff0000, v49
    v_add_f32 v1, v1, v3
    v_fmac_f32 v2, v3, v3
    v_add_f32 v1, v1, v4
    v_fmac_f32 v2, v4, v4
    v_lshlrev_b32 v3, 16, v50
    v_and_b32 v4, 0xffff0000, v50
    v_add_f32 v1, v1, v3
    v_fmac_f32 v2, v3, v3
    v_add_f32 v1, v1, v4
    v_fmac_f32 v2, v4, v4
    v_lshlrev_b32 v3, 16, v51
    v_and_b32 v4, 0xffff0000, v51
    v_add_f32 v1, v1, v3
    v_fmac_f32 v2, v3, v3
    v_add_f32 v1, v1, v4
    v_fmac_f32 v2, v4, v4
    v_lshlrev_b32 v3, 16, v52
    v_and_b32 v4, 0xffff0000, v52
    v_add_f32 v1, v1, v3
    v_fmac_f32 v2, v3, v3
    v_add_f32 v1, v1, v4
    v_fmac_f32 v2, v4, v4
    v_lshlrev_b32 v3, 16, v53
    v_and_b32 v4, 0xffff0000, v53
    v_add_f32 v1, v1, v3
    v_fmac_f32 v2, v3, v3
    v_add_f32 v1, v1, v4
    v_fmac_f32 v2, v4, v4
    v_lshlrev_b32 v3, 16, v54
    v_and_b32 v4, 0xffff0000, v54
    v_add_f32 v1, v1, v3
    v_fmac_f32 v2, v3, v3
    v_add_f32 v1, v1, v4
    v_fmac_f32 v2, v4, v4
    v_lshlrev_b32 v3, 16, v55
    v_and_b32 v4, 0xffff0000, v55
    v_add_f32 v1, v1, v3
    v_fmac_f32 v2, v3, v3
    v_add_f32 v1, v1, v4
    v_fmac_f32 v2, v4, v4
    s_nop 0
    v_add_f32_dpp v1, v1, v1 quad_perm:[1,0,3,2] row_mask:0xf bank_mask:0xf
    v_add_f32_dpp v2, v2, v2 quad_perm:[1,0,3,2] row_mask:0xf bank_mask:0xf
    s_nop 0
    v_add_f32_dpp v1, v1, v1 quad_perm:[2,3,0,1] row_mask:0xf bank_mask:0xf
    v_add_f32_dpp v2, v2, v2 quad_perm:[2,3,0,1] row_mask:0xf bank_mask:0xf
    s_nop 0
    v_add_f32_dpp v1, v1, v1 row_half_mirror row_mask:0xf bank_mask:0xf
    v_add_f32_dpp v2, v2, v2 row_half_mirror row_mask:0xf bank_mask:0xf
    s_nop 0
    v_add_f32_dpp v1, v1, v1 row_mirror row_mask:0xf bank_mask:0xf
    v_add_f32_dpp v2, v2, v2 row_mirror row_mask:0xf bank_mask:0xf
    v_mov_b32 v3, v1
    v_mov_b32 v4, v2
    s_nop 0
    v_permlane16_swap_b32 v1, v3
    v_permlane16_swap_b32 v2, v4
    v_add_f32 v1, v1, v3
    v_add_f32 v2, v2, v4
    v_mul_f32 v1, 0x3b124925, v1
    v_mul_f32 v2, 0x3b124925, v2
    v_fma_f32 v2, -v1, v1, v2
    v_max_f32 v2, 0, v2
    v_cvt_pk_bf16_f32 v3, v1, v2
    v_and_b32 v5, 0xffff0000, v3
    v_add_f32 v5, 0x3727c5ac, v5
    v_cvt_pk_bf16_f32 v5, v5, v5
    v_and_b32 v5, 0xffff0000, v5
    v_sqrt_f32 v5, v5
    s_nop 0
    v_cvt_pk_bf16_f32 v4, v1, v5
    v_mov_b32 v5, s49
    v_lshrrev_b32 v6, 2, v0
    v_and_b32 v6, 8, v6
    s_lshl_b32 s14, s45, 3
    s_add_u32 s14, s14, 16809984
    s_mov_b32 exec_lo, 1
    s_mov_b32 exec_hi, 1
    buffer_store_dwordx2 v[4:5], v6, s[32:35], s14 offen sc1
    s_mov_b64 exec, -1
    s_barrier
    s_barrier
    s_barrier
    s_cmp_ge_u32 s46, 5
    s_cbranch_scc1 L_BQ_c3
    s_waitcnt vmcnt(14)
    v_lshlrev_b32 v40, 16, v96
    v_and_b32 v41, 0xffff0000, v96
    v_lshlrev_b32 v42, 16, v97
    v_and_b32 v43, 0xffff0000, v97
    v_lshlrev_b32 v44, 16, v98
    v_and_b32 v45, 0xffff0000, v98
    v_lshlrev_b32 v46, 16, v99
    v_and_b32 v47, 0xffff0000, v99
    s_waitcnt vmcnt(13)
    v_lshlrev_b32 v3, 16, v100
    v_and_b32 v4, 0xffff0000, v100
    v_add_f32 v40, v40, v3
    v_add_f32 v41, v41, v4
    v_lshlrev_b32 v3, 16, v101
    v_and_b32 v4, 0xffff0000, v101
    v_add_f32 v42, v42, v3
    v_add_f32 v43, v43, v4
    v_lshlrev_b32 v3, 16, v102
    v_and_b32 v4, 0xffff0000, v102
    v_add_f32 v44, v44, v3
    v_add_f32 v45, v45, v4
    v_lshlrev_b32 v3, 16, v103
    v_and_b32 v4, 0xffff0000, v103
    v_add_f32 v46, v46, v3
    v_add_f32 v47, v47, v4
    s_waitcnt vmcnt(12)
    v_lshlrev_b32 v3, 16, v104
    v_and_b32 v4, 0xffff0000, v104
    v_add_f32 v40, v40, v3
    v_add_f32 v41, v41, v4
    v_lshlrev_b32 v3, 16, v105
    v_and_b32 v4, 0xffff0000, v105
    v_add_f32 v42, v42, v3
    v_add_f32 v43, v43, v4
    v_lshlrev_b32 v3, 16, v106
    v_and_b32 v4, 0xffff0000, v106
    v_add_f32 v44, v44, v3
    v_add_f32 v45, v45, v4
    v_lshlrev_b32 v3, 16, v107
    v_and_b32 v4, 0xffff0000, v107
    v_add_f32 v46, v46, v3
    v_add_f32 v47, v47, v4
    s_waitcnt vmcnt(11)
    v_lshlrev_b32 v3, 16, v108
    v_and_b32 v4, 0xffff0000, v108
    v_add_f32 v40, v40, v3
    v_add_f32 v41, v41, v4
    v_lshlrev_b32 v3, 16, v109
    v_and_b32 v4, 0xffff0000, v109
    v_add_f32 v42, v42, v3
    v_add_f32 v43, v43, v4
    v_lshlrev_b32 v3, 16, v110
    v_and_b32 v4, 0xffff0000, v110
    v_add_f32 v44, v44, v3
    v_add_f32 v45, v45, v4
    v_lshlrev_b32 v3, 16, v111
    v_and_b32 v4, 0xffff0000, v111
    v_add_f32 v46, v46, v3
    v_add_f32 v47, v47, v4
    s_waitcnt vmcnt(10)
    v_lshlrev_b32 v3, 16, v112
    v_and_b32 v4, 0xffff0000, v112
    v_add_f32 v40, v40, v3
    v_add_f32 v41, v41, v4
    v_lshlrev_b32 v3, 16, v113
    v_and_b32 v4, 0xffff0000, v113
    v_add_f32 v42, v42, v3
    v_add_f32 v43, v43, v4
    v_lshlrev_b32 v3, 16, v114
    v_and_b32 v4, 0xffff0000, v114
    v_add_f32 v44, v44, v3
    v_add_f32 v45, v45, v4
    v_lshlrev_b32 v3, 16, v115
    v_and_b32 v4, 0xffff0000, v115
    v_add_f32 v46, v46, v3
    v_add_f32 v47, v47, v4
L_BQ_c3:
    s_barrier
    s_cmp_ge_u32 s46, 5
    s_cbranch_scc1 L_BQ_c4
    s_waitcnt vmcnt(9)
    v_lshlrev_b32 v3, 16, v116
    v_and_b32 v4, 0xffff0000, v116
    v_add_f32 v40, v40, v3
    v_add_f32 v41, v41, v4
    v_lshlrev_b32 v3, 16, v117
    v_and_b32 v4, 0xffff0000, v117
    v_add_f32 v42, v42, v3
    v_add_f32 v43, v43, v4
    v_lshlrev_b32 v3, 16, v118
    v_and_b32 v4, 0xffff0000, v118
    v_add_f32 v44, v44, v3
    v_add_f32 v45, v45, v4
    v_lshlrev_b32 v3, 16, v119
    v_and_b32 v4, 0xffff0000, v119
    v_add_f32 v46, v46, v3
    v_add_f32 v47, v47, v4
    s_waitcnt vmcnt(8)
    v_lshlrev_b32 v3, 16, v120
    v_and_b32 v4, 0xffff0000, v120
    v_add_f32 v40, v40, v3
    v_add_f32 v41, v41, v4
    v_lshlrev_b32 v3, 16, v121
    v_and_b32 v4, 0xffff0000, v121
    v_add_f32 v42, v42, v3
    v_add_f32 v43, v43, v4
    v_lshlrev_b32 v3, 16, v122
    v_and_b32 v4, 0xffff0000, v122
    v_add_f32 v44, v44, v3
    v_add_f32 v45, v45, v4
    v_lshlrev_b32 v3, 16, v123
    v_and_b32 v4, 0xffff0000, v123
    v_add_f32 v46, v46, v3
    v_add_f32 v47, v47, v4
    s_waitcnt vmcnt(7)
    v_lshlrev_b32 v3, 16, v124
    v_and_b32 v4, 0xffff0000, v124
    v_add_f32 v40, v40, v3
    v_add_f32 v41, v41, v4
    v_lshlrev_b32 v3, 16, v125
    v_and_b32 v4, 0xffff0000, v125
    v_add_f32 v42, v42, v3
    v_add_f32 v43, v43, v4
    v_lshlrev_b32 v3, 16, v126
    v_and_b32 v4, 0xffff0000, v126
    v_add_f32 v44, v44, v3
    v_add_f32 v45, v45, v4
    v_lshlrev_b32 v3, 16, v127
    v_and_b32 v4, 0xffff0000, v127
    v_add_f32 v46, v46, v3
    v_add_f32 v47, v47, v4
    s_waitcnt vmcnt(6)
    v_lshlrev_b32 v3, 16, v128
    v_and_b32 v4, 0xffff0000, v128
    v_add_f32 v40, v40, v3
    v_add_f32 v41, v41, v4
    v_lshlrev_b32 v3, 16, v129
    v_and_b32 v4, 0xffff0000, v129
    v_add_f32 v42, v42, v3
    v_add_f32 v43, v43, v4
    v_lshlrev_b32 v3, 16, v130
    v_and_b32 v4, 0xffff0000, v130
    v_add_f32 v44, v44, v3
    v_add_f32 v45, v45, v4
    v_lshlrev_b32 v3, 16, v131
    v_and_b32 v4, 0xffff0000, v131
    v_add_f32 v46, v46, v3
    v_add_f32 v47, v47, v4
    s_waitcnt vmcnt(5)
    v_lshlrev_b32 v3, 16, v132
    v_and_b32 v4, 0xffff0000, v132
    v_add_f32 v40, v40, v3
    v_add_f32 v41, v41, v4
    v_lshlrev_b32 v3, 16, v133
    v_and_b32 v4, 0xffff0000, v133
    v_add_f32 v42, v42, v3
    v_add_f32 v43, v43, v4
    v_lshlrev_b32 v3, 16, v134
    v_and_b32 v4, 0xffff0000, v134
    v_add_f32 v44, v44, v3
    v_add_f32 v45, v45, v4
    v_lshlrev_b32 v3, 16, v135
    v_and_b32 v4, 0xffff0000, v135
    v_add_f32 v46, v46, v3
    v_add_f32 v47, v47, v4
L_BQ_c4:
    s_barrier
    s_cmp_ge_u32 s46, 5
    s_cbranch_scc1 L_BQ_c5
    s_waitcnt vmcnt(4)
    v_lshlrev_b32 v3, 16, v136
    v_and_b32 v4, 0xffff0000, v136
    v_add_f32 v40, v40, v3
    v_add_f32 v41, v41, v4
    v_lshlrev_b32 v3, 16, v137
    v_and_b32 v4, 0xffff0000, v137
    v_add_f32 v42, v42, v3
    v_add_f32 v43, v43, v4
    v_lshlrev_b32 v3, 16, v138
    v_and_b32 v4, 0xffff0000, v138
    v_add_f32 v44, v44, v3
    v_add_f32 v45, v45, v4
    v_lshlrev_b32 v3, 16, v139
    v_and_b32 v4, 0xffff0000, v139
    v_add_f32 v46, v46, v3
    v_add_f32 v47, v47, v4
    s_waitcnt vmcnt(3)
    v_lshlrev_b32 v3, 16, v140
    v_and_b32 v4, 0xffff0000, v140
    v_add_f32 v40, v40, v3
    v_add_f32 v41, v41, v4
    v_lshlrev_b32 v3, 16, v141
    v_and_b32 v4, 0xffff0000, v141
    v_add_f32 v42, v42, v3
    v_add_f32 v43, v43, v4
    v_lshlrev_b32 v3, 16, v142
    v_and_b32 v4, 0xffff0000, v142
    v_add_f32 v44, v44, v3
    v_add_f32 v45, v45, v4
    v_lshlrev_b32 v3, 16, v143
    v_and_b32 v4, 0xffff0000, v143
    v_add_f32 v46, v46, v3
    v_add_f32 v47, v47, v4
    s_waitcnt vmcnt(2)
    v_lshlrev_b32 v3, 16, v144
    v_and_b32 v4, 0xffff0000, v144
    v_add_f32 v40, v40, v3
    v_add_f32 v41, v41, v4
    v_lshlrev_b32 v3, 16, v145
    v_and_b32 v4, 0xffff0000, v145
    v_add_f32 v42, v42, v3
    v_add_f32 v43, v43, v4
    v_lshlrev_b32 v3, 16, v146
    v_and_b32 v4, 0xffff0000, v146
    v_add_f32 v44, v44, v3
    v_add_f32 v45, v45, v4
    v_lshlrev_b32 v3, 16, v147
    v_and_b32 v4, 0xffff0000, v147
    v_add_f32 v46, v46, v3
    v_add_f32 v47, v47, v4
    s_waitcnt vmcnt(1)
    v_lshlrev_b32 v3, 16, v148
    v_and_b32 v4, 0xffff0000, v148
    v_add_f32 v40, v40, v3
    v_add_f32 v41, v41, v4
    v_lshlrev_b32 v3, 16, v149
    v_and_b32 v4, 0xffff0000, v149
    v_add_f32 v42, v42, v3
    v_add_f32 v43, v43, v4
    v_lshlrev_b32 v3, 16, v150
    v_and_b32 v4, 0xffff0000, v150
    v_add_f32 v44, v44, v3
    v_add_f32 v45, v45, v4
    v_lshlrev_b32 v3, 16, v151
    v_and_b32 v4, 0xffff0000, v151
    v_add_f32 v46, v46, v3
    v_add_f32 v47, v47, v4
    v_add_f32_dpp v40, v40, v40 row_ror:8 row_mask:0xf bank_mask:0xf
    v_add_f32_dpp v41, v41, v41 row_ror:8 row_mask:0xf bank_mask:0xf
    v_add_f32_dpp v42, v42, v42 row_ror:8 row_mask:0xf bank_mask:0xf
    v_add_f32_dpp v43, v43, v43 row_ror:8 row_mask:0xf bank_mask:0xf
    v_add_f32_dpp v44, v44, v44 row_ror:8 row_mask:0xf bank_mask:0xf
    v_add_f32_dpp v45, v45, v45 row_ror:8 row_mask:0xf bank_mask:0xf
    v_add_f32_dpp v46, v46, v46 row_ror:8 row_mask:0xf bank_mask:0xf
    v_add_f32_dpp v47, v47, v47 row_ror:8 row_mask:0xf bank_mask:0xf
    v_mov_b32 v96, v40
    v_mov_b32 v97, v41
    v_mov_b32 v98, v42
    v_mov_b32 v99, v43
    v_mov_b32 v100, v44
    v_mov_b32 v101, v45
    v_mov_b32 v102, v46
    v_mov_b32 v103, v47
    v_permlane16_swap_b32 v96, v40
    v_permlane16_swap_b32 v97, v41
    v_permlane16_swap_b32 v98, v42
    v_permlane16_swap_b32 v99, v43
    v_permlane16_swap_b32 v100, v44
    v_permlane16_swap_b32 v101, v45
    v_permlane16_swap_b32 v102, v46
    v_permlane16_swap_b32 v103, v47
    v_add_f32 v40, v40, v96
    v_add_f32 v41, v41, v97
    v_add_f32 v42, v42, v98
    v_add_f32 v43, v43, v99
    v_add_f32 v44, v44, v100
    v_add_f32 v45, v45, v101
    v_add_f32 v46, v46, v102
    v_add_f32 v47, v47, v103
    v_mov_b32 v96, v40
    v_mov_b32 v97, v41
    v_mov_b32 v98, v42
    v_mov_b32 v99, v43
    v_mov_b32 v100, v44
    v_mov_b32 v101, v45
    v_mov_b32 v102, v46
    v_mov_b32 v103, v47
    v_permlane32_swap_b32 v96, v40
    v_permlane32_swap_b32 v97, v41
    v_permlane32_swap_b32 v98, v42
    v_permlane32_swap_b32 v99, v43
    v_permlane32_swap_b32 v100, v44
    v_permlane32_swap_b32 v101, v45
    v_permlane32_swap_b32 v102, v46
    v_permlane32_swap_b32 v103, v47
    v_add_f32 v40, v40, v96
    v_add_f32 v41, v41, v97
    v_add_f32 v42, v42, v98
    v_add_f32 v43, v43, v99
    v_add_f32 v44, v44, v100
    v_add_f32 v45, v45, v101
    v_add_f32 v46, v46, v102
    v_add_f32 v47, v47, v103
    s_lshl_b32 s14, s39, 8
    s_add_u32 s14, s14, 157696
    v_and_b32 v3, 7, v0
    v_lshl_add_u32 v3, v3, 5, s14
    ds_write_b128 v3, v[40:43]
    ds_write_b128 v3, v[44:47] offset:16
    s_waitcnt lgkmcnt(0)
L_BQ_c5:
    s_barrier
    s_cmp_ge_u32 s46, 5
    s_cbranch_scc1 L_BQ_c9
    s_cmp_lg_u32 s39, 0
    s_cbranch_scc1 L_BQ_c9
    v_lshlrev_b32 v3, 2, v0
    v_add_u32 v3, 157696, v3
    ds_read_b32 v4, v3 offset:0
    ds_read_b32 v5, v3 offset:256
    ds_read_b32 v6, v3 offset:512
    ds_read_b32 v7, v3 offset:768
    s_mul_i32 s14, s37, 6
    s_add_u32 s14, s14, s42
    s_lshl_b32 s14, s14, 9
    s_add_u32 s14, s14, 16826368
    v_lshlrev_b32 v3, 3, v0
    s_waitcnt lgkmcnt(0)
    v_add_f32 v4, v4, v5
    v_add_f32 v6, v6, v7
    v_add_f32 v4, v4, v6
    v_mov_b32 v5, s49
    buffer_store_dwordx2 v[4:5], v3, s[32:35], s14 offen sc1
L_BQ_c9:
    s_barrier
    s_barrier
    s_barrier
    s_barrier
    v_lshlrev_b32 v44, 3, v0
    s_mul_i32 s11, s37, 3072
    s_add_u32 s11, s11, 16826368
    s_lshl_b32 s12, s39, 1
    s_sub_u32 s12, s12, 2
    s_add_u32 s13, s12, 1
    s_cmp_eq_u32 s39, 2
    s_cselect_b32 s12, 0, s12
    s_cselect_b32 s13, 1, s13
    s_lshl_b32 s14, s36, 10
    s_add_u32 s14, s14, 16809984
    s_add_u32 s15, s14, 512
    s_lshl_b32 s12, s12, 9
    s_lshl_b32 s13, s13, 9
    s_add_u32 s12, s12, s11
    s_add_u32 s13, s13, s11
    s_cmp_eq_u32 s39, 0
    s_cselect_b32 s56, s14, s12
    s_cselect_b32 s57, s15, s13
    s_lshl_b32 s14, s39, 9
    s_add_u32 s14, s14, 155648
    v_lshl_add_u32 v45, v0, 2, s14
    buffer_load_dwordx2 v[46:47], v44, s[32:35], s56 offen sc1
    buffer_load_dwordx2 v[48:49], v44, s[32:35], s57 offen sc1
    s_barrier
    s_barrier
    s_barrier
    s_waitcnt vmcnt(0)
    v_cmp_ne_u32 vcc, s49, v47
    v_cmp_ne_u32 s[54:55], s49, v49
    s_or_b64 vcc, vcc, s[54:55]
    s_cbranch_vccz L_gQ_ok
    s_mov_b32 s96, 200000
L_gQ:
    buffer_load_dwordx2 v[46:47], v44, s[32:35], s56 offen sc1
    buffer_load_dwordx2 v[48:49], v44, s[32:35], s57 offen sc1
    s_waitcnt vmcnt(0)
    v_cmp_ne_u32 vcc, s49, v47
    v_cmp_ne_u32 s[54:55], s49, v49
    s_or_b64 vcc, vcc, s[54:55]
    s_cbranch_vccz L_gQ_ok
    s_sleep 2
    s_sub_u32 s96, s96, 1
    s_cbranch_scc0 L_gQ
L_gQ_ok:
    ds_write_b32 v45, v46
    ds_write_b32 v45, v48 offset:256
    s_waitcnt lgkmcnt(0)
    s_waitcnt vmcnt(1)
    s_mov_b32 s43, 0
    s_barrier
    s_setprio 2
    ds_read_b64_tr_b16 v[48:49], v35 offset:32768
    ds_read_b64_tr_b16 v[50:51], v35 offset:33280
    ds_read_b128 v[40:43], v16 offset:0
    ds_read_b128 v[44:47], v16 offset:4096
    ds_read_b64_tr_b16 v[52:53], v36 offset:32768
    ds_read_b64_tr_b16 v[54:55], v36 offset:33280
    ds_read_b64_tr_b16 v[64:65], v35 offset:34816
    ds_read_b64_tr_b16 v[66:67], v35 offset:35328
    ds_read_b128 v[56:59], v17 offset:0
    ds_read_b128 v[60:63], v17 offset:4096
    ds_read_b64_tr_b16 v[68:69], v36 offset:34816
    ds_read_b64_tr_b16 v[70:71], v36 offset:35328
    s_waitcnt lgkmcnt(8)
    v_mfma_f32_32x32x16_bf16 v[96:111], v[48:51], v[40:43], 0
    v_mfma_f32_32x32x16_bf16 v[128:143], v[48:51], v[44:47], 0
    s_barrier
    s_waitcnt lgkmcnt(6)
    v_mfma_f32_32x32x16_bf16 v[112:127], v[52:55], v[40:43], 0
    ds_read_b64_tr_b16 v[80:81], v35 offset:0
    ds_read_b64_tr_b16 v[82:83], v35 offset:512
    ds_read_b128 v[72:75], v18 offset:0
    ds_read_b128 v[76:79], v18 offset:4096
    v_mfma_f32_32x32x16_bf16 v[144:159], v[52:55], v[44:47], 0
    ds_read_b64_tr_b16 v[84:85], v36 offset:0
    ds_read_b64_tr_b16 v[86:87], v36 offset:512
    s_waitcnt lgkmcnt(8)
    v_mfma_f32_32x32x16_bf16 v[96:111], v[64:67], v[56:59], v[96:111]
    ds_read_b64_tr_b16 v[48:49], v35 offset:2048
    ds_read_b64_tr_b16 v[50:51], v35 offset:2560
    v_mfma_f32_32x32x16_bf16 v[128:143], v[64:67], v[60:63], v[128:143]
    ds_read_b128 v[40:43], v19 offset:0
    ds_read_b128 v[44:47], v19 offset:4096
    s_waitcnt lgkmcnt(10)
    v_mfma_f32_32x32x16_bf16 v[112:127], v[68:71], v[56:59], v[112:127]
    ds_read_b64_tr_b16 v[52:53], v36 offset:2048
    ds_read_b64_tr_b16 v[54:55], v36 offset:2560
    v_mfma_f32_32x32x16_bf16 v[144:159], v[68:71], v[60:63], v[144:159]
    s_waitcnt lgkmcnt(8)
    v_mfma_f32_32x32x16_bf16 v[96:111], v[80:83], v[72:75], v[96:111]
    v_mfma_f32_32x32x16_bf16 v[128:143], v[80:83], v[76:79], v[128:143]
    s_barrier
    s_waitcnt lgkmcnt(6)
    v_mfma_f32_32x32x16_bf16 v[112:127], v[84:87], v[72:75], v[112:127]
    ds_read_b64_tr_b16 v[64:65], v35 offset:8192
    ds_read_b64_tr_b16 v[66:67], v35 offset:8704
    ds_read_b128 v[56:59], v16 offset:16384
    ds_read_b128 v[60:63], v16 offset:20480
    v_mfma_f32_32x32x16_bf16 v[144:159], v[84:87], v[76:79], v[144:159]
    ds_read_b64_tr_b16 v[68:69], v36 offset:8192
    ds_read_b64_tr_b16 v[70:71], v36 offset:8704
    s_waitcnt lgkmcnt(8)
    v_mfma_f32_32x32x16_bf16 v[96:111], v[48:51], v[40:43], v[96:111]
    ds_read_b64_tr_b16 v[80:81], v35 offset:10240
    ds_read_b64_tr_b16 v[82:83], v35 offset:10752
    v_mfma_f32_32x32x16_bf16 v[128:143], v[48:51], v[44:47], v[128:143]
    ds_read_b128 v[72:75], v17 offset:16384
    ds_read_b128 v[76:79], v17 offset:20480
    s_waitcnt lgkmcnt(10)
    v_mfma_f32_32x32x16_bf16 v[112:127], v[52:55], v[40:43], v[112:127]
    ds_read_b64_tr_b16 v[84:85], v36 offset:10240
    ds_read_b64_tr_b16 v[86:87], v36 offset:10752
    v_mfma_f32_32x32x16_bf16 v[144:159], v[52:55], v[44:47], v[144:159]
    s_waitcnt lgkmcnt(8)
    v_mfma_f32_32x32x16_bf16 v[96:111], v[64:67], v[56:59], v[96:111]
    v_mfma_f32_32x32x16_bf16 v[128:143], v[64:67], v[60:63], v[128:143]
    s_barrier
    s_waitcnt lgkmcnt(6)
    v_mfma_f32_32x32x16_bf16 v[112:127], v[68:71], v[56:59], v[112:127]
    ds_read_b64_tr_b16 v[48:49], v35 offset:16384
    ds_read_b64_tr_b16 v[50:51], v35 offset:16896
    ds_read_b128 v[40:43], v18 offset:16384
    ds_read_b128 v[44:47], v18 offset:20480
    v_mfma_f32_32x32x16_bf16 v[144:159], v[68:71], v[60:63], v[144:159]
    ds_read_b64_tr_b16 v[52:53], v36 offset:16384
    ds_read_b64_tr_b16 v[54:55], v36 offset:16896
    s_waitcnt lgkmcnt(8)
    v_mfma_f32_32x32x16_bf16 v[96:111], v[80:83], v[72:75], v[96:111]
    ds_read_b64_tr_b16 v[64:65], v35 offset:18432
    ds_read_b64_tr_b16 v[66:67], v35 offset:18944
    v_mfma_f32_32x32x16_bf16 v[128:143], v[80:83], v[76:79], v[128:143]
    ds_read_b128 v[56:59], v19 offset:16384
    ds_read_b128 v[60:63], v19 offset:20480
    s_waitcnt lgkmcnt(10)
    v_mfma_f32_32x32x16_bf16 v[112:127], v[84:87], v[72:75], v[112:127]
    ds_read_b64_tr_b16 v[68:69], v36 offset:18432
    ds_read_b64_tr_b16 v[70:71], v36 offset:18944
    v_mfma_f32_32x32x16_bf16 v[144:159], v[84:87], v[76:79], v[144:159]
    s_waitcnt lgkmcnt(8)
    v_mfma_f32_32x32x16_bf16 v[96:111], v[48:51], v[40:43], v[96:111]
    v_mfma_f32_32x32x16_bf16 v[128:143], v[48:51], v[44:47], v[128:143]
    s_barrier
    s_waitcnt lgkmcnt(6)
    v_mfma_f32_32x32x16_bf16 v[112:127], v[52:55], v[40:43], v[112:127]
    ds_read_b64_tr_b16 v[80:81], v35 offset:24576
    ds_read_b64_tr_b16 v[82:83], v35 offset:25088
    ds_read_b128 v[72:75], v16 offset:32768
    ds_read_b128 v[76:79], v16 offset:36864
    v_mfma_f32_32x32x16_bf16 v[144:159], v[52:55], v[44:47], v[144:159]
    ds_read_b64_tr_b16 v[84:85], v36 offset:24576
    ds_read_b64_tr_b16 v[86:87], v36 offset:25088
    s_waitcnt lgkmcnt(8)
    v_mfma_f32_32x32x16_bf16 v[96:111], v[64:67], v[56:59], v[96:111]
    ds_read_b64_tr_b16 v[48:49], v35 offset:26624
    ds_read_b64_tr_b16 v[50:51], v35 offset:27136
    v_mfma_f32_32x32x16_bf16 v[128:143], v[64:67], v[60:63], v[128:143]
    ds_read_b128 v[40:43], v17 offset:32768
    ds_read_b128 v[44:47], v17 offset:36864
    s_waitcnt lgkmcnt(10)
    v_mfma_f32_32x32x16_bf16 v[112:127], v[68:71], v[56:59], v[112:127]
    ds_read_b64_tr_b16 v[52:53], v36 offset:26624
    ds_read_b64_tr_b16 v[54:55], v36 offset:27136
    v_mfma_f32_32x32x16_bf16 v[144:159], v[68:71], v[60:63], v[144:159]
    s_waitcnt lgkmcnt(8)
    v_mfma_f32_32x32x16_bf16 v[96:111], v[80:83], v[72:75], v[96:111]
    v_mfma_f32_32x32x16_bf16 v[128:143], v[80:83], v[76:79], v[128:143]
    s_barrier
    s_waitcnt lgkmcnt(6)
    v_mfma_f32_32x32x16_bf16 v[112:127], v[84:87], v[72:75], v[112:127]
    ds_read_b64_tr_b16 v[64:65], v35 offset:32768
    ds_read_b64_tr_b16 v[66:67], v35 offset:33280
    ds_read_b128 v[56:59], v18 offset:32768
    ds_read_b128 v[60:63], v18 offset:36864
    v_mfma_f32_32x32x16_bf16 v[144:159], v[84:87], v[76:79], v[144:159]
    ds_read_b64_tr_b16 v[68:69], v36 offset:32768
    ds_read_b64_tr_b16 v[70:71], v36 offset:33280
    s_waitcnt lgkmcnt(8)
    v_mfma_f32_32x32x16_bf16 v[96:111], v[48:51], v[40:43], v[96:111]
    ds_read_b64_tr_b16 v[80:81], v35 offset:34816
    ds_read_b64_tr_b16 v[82:83], v35 offset:35328
    v_mfma_f32_32x32x16_bf16 v[128:143], v[48:51], v[44:47], v[128:143]
    ds_read_b128 v[72:75], v19 offset:32768
    ds_read_b128 v[76:79], v19 offset:36864
    s_waitcnt lgkmcnt(10)
    v_mfma_f32_32x32x16_bf16 v[112:127], v[52:55], v[40:43], v[112:127]
    ds_read_b64_tr_b16 v[84:85], v36 offset:34816
    ds_read_b64_tr_b16 v[86:87], v36 offset:35328
    v_mfma_f32_32x32x16_bf16 v[144:159], v[52:55], v[44:47], v[144:159]
    s_waitcnt lgkmcnt(8)
    v_mfma_f32_32x32x16_bf16 v[96:111], v[64:67], v[56:59], v[96:111]
    v_mfma_f32_32x32x16_bf16 v[128:143], v[64:67], v[60:63], v[128:143]
    s_barrier
    s_waitcnt lgkmcnt(6)
    v_mfma_f32_32x32x16_bf16 v[112:127], v[68:71], v[56:59], v[112:127]
    ds_read_b64_tr_b16 v[48:49], v35 offset:0
    ds_read_b64_tr_b16 v[50:51], v35 offset:512
    ds_read_b128 v[40:43], v16 offset:49152
    ds_read_b128 v[44:47], v16 offset:53248
    v_mfma_f32_32x32x16_bf16 v[144:159], v[68:71], v[60:63], v[144:159]
    ds_read_b64_tr_b16 v[52:53], v36 offset:0
    ds_read_b64_tr_b16 v[54:55], v36 offset:512
    s_waitcnt lgkmcnt(8)
    v_mfma_f32_32x32x16_bf16 v[96:111], v[80:83], v[72:75], v[96:111]
    ds_read_b64_tr_b16 v[64:65], v35 offset:2048
    ds_read_b64_tr_b16 v[66:67], v35 offset:2560
    v_mfma_f32_32x32x16_bf16 v[128:143], v[80:83], v[76:79], v[128:143]
    ds_read_b128 v[56:59], v17 offset:49152
    ds_read_b128 v[60:63], v17 offset:53248
    s_waitcnt lgkmcnt(10)
    v_mfma_f32_32x32x16_bf16 v[112:127], v[84:87], v[72:75], v[112:127]
    ds_read_b64_tr_b16 v[68:69], v36 offset:2048
    ds_read_b64_tr_b16 v[70:71], v36 offset:2560
    v_mfma_f32_32x32x16_bf16 v[144:159], v[84:87], v[76:79], v[144:159]
    s_waitcnt lgkmcnt(8)
    v_mfma_f32_32x32x16_bf16 v[96:111], v[48:51], v[40:43], v[96:111]
    v_mfma_f32_32x32x16_bf16 v[128:143], v[48:51], v[44:47], v[128:143]
    s_barrier
    s_waitcnt lgkmcnt(6)
    v_mfma_f32_32x32x16_bf16 v[112:127], v[52:55], v[40:43], v[112:127]
    ds_read_b64_tr_b16 v[80:81], v35 offset:8192
    ds_read_b64_tr_b16 v[82:83], v35 offset:8704
    ds_read_b128 v[72:75], v18 offset:49152
    ds_read_b128 v[76:79], v18 offset:53248
    v_mfma_f32_32x32x16_bf16 v[144:159], v[52:55], v[44:47], v[144:159]
    ds_read_b64_tr_b16 v[84:85], v36 offset:8192
    ds_read_b64_tr_b16 v[86:87], v36 offset:8704
    s_waitcnt lgkmcnt(8)
    v_mfma_f32_32x32x16_bf16 v[96:111], v[64:67], v[56:59], v[96:111]
    ds_read_b64_tr_b16 v[48:49], v35 offset:10240
    ds_read_b64_tr_b16 v[50:51], v35 offset:10752
    v_mfma_f32_32x32x16_bf16 v[128:143], v[64:67], v[60:63], v[128:143]
    ds_read_b128 v[40:43], v19 offset:49152
    ds_read_b128 v[44:47], v19 offset:53248
    s_waitcnt lgkmcnt(10)
    v_mfma_f32_32x32x16_bf16 v[112:127], v[68:71], v[56:59], v[112:127]
    ds_read_b64_tr_b16 v[52:53], v36 offset:10240
    ds_read_b64_tr_b16 v[54:55], v36 offset:10752
    v_mfma_f32_32x32x16_bf16 v[144:159], v[68:71], v[60:63], v[144:159]
    s_waitcnt lgkmcnt(8)
    v_mfma_f32_32x32x16_bf16 v[96:111], v[80:83], v[72:75], v[96:111]
    v_mfma_f32_32x32x16_bf16 v[128:143], v[80:83], v[76:79], v[128:143]
    s_barrier
    s_waitcnt lgkmcnt(6)
    v_mfma_f32_32x32x16_bf16 v[112:127], v[84:87], v[72:75], v[112:127]
    ds_read_b64_tr_b16 v[64:65], v35 offset:16384
    ds_read_b64_tr_b16 v[66:67], v35 offset:16896
    ds_read_b128 v[56:59], v20 offset:0
    ds_read_b128 v[60:63], v20 offset:4096
    v_mfma_f32_32x32x16_bf16 v[144:159], v[84:87], v[76:79], v[144:159]
    ds_read_b64_tr_b16 v[68:69], v36 offset:16384
    ds_read_b64_tr_b16 v[70:71], v36 offset:16896
    s_waitcnt lgkmcnt(8)
    v_mfma_f32_32x32x16_bf16 v[96:111], v[48:51], v[40:43], v[96:111]
    ds_read_b64_tr_b16 v[80:81], v35 offset:18432
    ds_read_b64_tr_b16 v[82:83], v35 offset:18944
    v_mfma_f32_32x32x16_bf16 v[128:143], v[48:51], v[44:47], v[128:143]
    ds_read_b128 v[72:75], v21 offset:0
    ds_read_b128 v[76:79], v21 offset:4096
    s_waitcnt lgkmcnt(10)
    v_mfma_f32_32x32x16_bf16 v[112:127], v[52:55], v[40:43], v[112:127]
    ds_read_b64_tr_b16 v[84:85], v36 offset:18432
    ds_read_b64_tr_b16 v[86:87], v36 offset:18944
    v_mfma_f32_32x32x16_bf16 v[144:159], v[52:55], v[44:47], v[144:159]
    s_waitcnt lgkmcnt(8)
    v_mfma_f32_32x32x16_bf16 v[96:111], v[64:67], v[56:59], v[96:111]
    v_mfma_f32_32x32x16_bf16 v[128:143], v[64:67], v[60:63], v[128:143]
    s_barrier
    s_waitcnt lgkmcnt(6)
    v_mfma_f32_32x32x16_bf16 v[112:127], v[68:71], v[56:59], v[112:127]
    ds_read_b64_tr_b16 v[48:49], v35 offset:24576
    ds_read_b64_tr_b16 v[50:51], v35 offset:25088
    ds_read_b128 v[40:43], v22 offset:0
    ds_read_b128 v[44:47], v22 offset:4096
    v_mfma_f32_32x32x16_bf16 v[144:159], v[68:71], v[60:63], v[144:159]
    ds_read_b64_tr_b16 v[52:53], v36 offset:24576
    ds_read_b64_tr_b16 v[54:55], v36 offset:25088
    s_waitcnt lgkmcnt(8)
    v_mfma_f32_32x32x16_bf16 v[96:111], v[80:83], v[72:75], v[96:111]
    ds_read_b64_tr_b16 v[64:65], v35 offset:26624
    ds_read_b64_tr_b16 v[66:67], v35 offset:27136
    v_mfma_f32_32x32x16_bf16 v[128:143], v[80:83], v[76:79], v[128:143]
    ds_read_b128 v[56:59], v23 offset:0
    ds_read_b128 v[60:63], v23 offset:4096
    s_waitcnt lgkmcnt(10)
    v_mfma_f32_32x32x16_bf16 v[112:127], v[84:87], v[72:75], v[112:127]
    ds_read_b64_tr_b16 v[68:69], v36 offset:26624
    ds_read_b64_tr_b16 v[70:71], v36 offset:27136
    v_mfma_f32_32x32x16_bf16 v[144:159], v[84:87], v[76:79], v[144:159]
    s_waitcnt lgkmcnt(8)
    v_mfma_f32_32x32x16_bf16 v[96:111], v[48:51], v[40:43], v[96:111]
    v_mfma_f32_32x32x16_bf16 v[128:143], v[48:51], v[44:47], v[128:143]
    s_barrier
    s_waitcnt lgkmcnt(6)
    v_mfma_f32_32x32x16_bf16 v[112:127], v[52:55], v[40:43], v[112:127]
    ds_read_b64_tr_b16 v[80:81], v35 offset:32768
    ds_read_b64_tr_b16 v[82:83], v35 offset:33280
    ds_read_b128 v[72:75], v20 offset:16384
    ds_read_b128 v[76:79], v20 offset:20480
    v_mfma_f32_32x32x16_bf16 v[144:159], v[52:55], v[44:47], v[144:159]
    ds_read_b64_tr_b16 v[84:85], v36 offset:32768
    ds_read_b64_tr_b16 v[86:87], v36 offset:33280
    s_waitcnt lgkmcnt(8)
    v_mfma_f32_32x32x16_bf16 v[96:111], v[64:67], v[56:59], v[96:111]
    ds_read_b64_tr_b16 v[48:49], v35 offset:34816
    ds_read_b64_tr_b16 v[50:51], v35 offset:35328
    v_mfma_f32_32x32x16_bf16 v[128:143], v[64:67], v[60:63], v[128:143]
    ds_read_b128 v[40:43], v21 offset:16384
    ds_read_b128 v[44:47], v21 offset:20480
    s_waitcnt lgkmcnt(10)
    v_mfma_f32_32x32x16_bf16 v[112:127], v[68:71], v[56:59], v[112:127]
    ds_read_b64_tr_b16 v[52:53], v36 offset:34816
    ds_read_b64_tr_b16 v[54:55], v36 offset:35328
    v_mfma_f32_32x32x16_bf16 v[144:159], v[68:71], v[60:63], v[144:159]
    s_waitcnt lgkmcnt(8)
    v_mfma_f32_32x32x16_bf16 v[96:111], v[80:83], v[72:75], v[96:111]
    v_mfma_f32_32x32x16_bf16 v[128:143], v[80:83], v[76:79], v[128:143]
    s_barrier
    s_waitcnt lgkmcnt(6)
    v_mfma_f32_32x32x16_bf16 v[112:127], v[84:87], v[72:75], v[112:127]
    ds_read_b64_tr_b16 v[64:65], v35 offset:0
    ds_read_b64_tr_b16 v[66:67], v35 offset:512
    ds_read_b128 v[56:59], v22 offset:16384
    ds_read_b128 v[60:63], v22 offset:20480
    v_mfma_f32_32x32x16_bf16 v[144:159], v[84:87], v[76:79], v[144:159]
    ds_read_b64_tr_b16 v[68:69], v36 offset:0
    ds_read_b64_tr_b16 v[70:71], v36 offset:512
    s_waitcnt lgkmcnt(8)
    v_mfma_f32_32x32x16_bf16 v[96:111], v[48:51], v[40:43], v[96:111]
    ds_read_b64_tr_b16 v[80:81], v35 offset:2048
    ds_read_b64_tr_b16 v[82:83], v35 offset:2560
    v_mfma_f32_32x32x16_bf16 v[128:143], v[48:51], v[44:47], v[128:143]
    ds_read_b128 v[72:75], v23 offset:16384
    ds_read_b128 v[76:79], v23 offset:20480
    s_waitcnt lgkmcnt(10)
    v_mfma_f32_32x32x16_bf16 v[112:127], v[52:55], v[40:43], v[112:127]
    ds_read_b64_tr_b16 v[84:85], v36 offset:2048
    ds_read_b64_tr_b16 v[86:87], v36 offset:2560
    v_mfma_f32_32x32x16_bf16 v[144:159], v[52:55], v[44:47], v[144:159]
    s_waitcnt lgkmcnt(8)
    v_mfma_f32_32x32x16_bf16 v[96:111], v[64:67], v[56:59], v[96:111]
    v_mfma_f32_32x32x16_bf16 v[128:143], v[64:67], v[60:63], v[128:143]
    s_barrier
    s_waitcnt lgkmcnt(6)
    v_mfma_f32_32x32x16_bf16 v[112:127], v[68:71], v[56:59], v[112:127]
    ds_read_b64_tr_b16 v[48:49], v35 offset:8192
    ds_read_b64_tr_b16 v[50:51], v35 offset:8704
    ds_read_b128 v[40:43], v20 offset:32768
    ds_read_b128 v[44:47], v20 offset:36864
    v_mfma_f32_32x32x16_bf16 v[144:159], v[68:71], v[60:63], v[144:159]
    ds_read_b64_tr_b16 v[52:53], v36 offset:8192
    ds_read_b64_tr_b16 v[54:55], v36 offset:8704
    s_waitcnt lgkmcnt(8)
    v_mfma_f32_32x32x16_bf16 v[96:111], v[80:83], v[72:75], v[96:111]
    ds_read_b64_tr_b16 v[64:65], v35 offset:10240
    ds_read_b64_tr_b16 v[66:67], v35 offset:10752
    v_mfma_f32_32x32x16_bf16 v[128:143], v[80:83], v[76:79], v[128:143]
    ds_read_b128 v[56:59], v21 offset:32768
    ds_read_b128 v[60:63], v21 offset:36864
    s_waitcnt lgkmcnt(10)
    v_mfma_f32_32x32x16_bf16 v[112:127], v[84:87], v[72:75], v[112:127]
    ds_read_b64_tr_b16 v[68:69], v36 offset:10240
    ds_read_b64_tr_b16 v[70:71], v36 offset:10752
    v_mfma_f32_32x32x16_bf16 v[144:159], v[84:87], v[76:79], v[144:159]
    s_waitcnt lgkmcnt(8)
    v_mfma_f32_32x32x16_bf16 v[96:111], v[48:51], v[40:43], v[96:111]
    v_mfma_f32_32x32x16_bf16 v[128:143], v[48:51], v[44:47], v[128:143]
    s_barrier
    s_waitcnt lgkmcnt(6)
    v_mfma_f32_32x32x16_bf16 v[112:127], v[52:55], v[40:43], v[112:127]
    ds_read_b64_tr_b16 v[80:81], v35 offset:16384
    ds_read_b64_tr_b16 v[82:83], v35 offset:16896
    ds_read_b128 v[72:75], v22 offset:32768
    ds_read_b128 v[76:79], v22 offset:36864
    v_mfma_f32_32x32x16_bf16 v[144:159], v[52:55], v[44:47], v[144:159]
    ds_read_b64_tr_b16 v[84:85], v36 offset:16384
    ds_read_b64_tr_b16 v[86:87], v36 offset:16896
    s_waitcnt lgkmcnt(8)
    v_mfma_f32_32x32x16_bf16 v[96:111], v[64:67], v[56:59], v[96:111]
    ds_read_b64_tr_b16 v[48:49], v35 offset:18432
    ds_read_b64_tr_b16 v[50:51], v35 offset:18944
    v_mfma_f32_32x32x16_bf16 v[128:143], v[64:67], v[60:63], v[128:143]
    ds_read_b128 v[40:43], v23 offset:32768
    ds_read_b128 v[44:47], v23 offset:36864
    s_waitcnt lgkmcnt(10)
    v_mfma_f32_32x32x16_bf16 v[112:127], v[68:71], v[56:59], v[112:127]
    ds_read_b64_tr_b16 v[52:53], v36 offset:18432
    ds_read_b64_tr_b16 v[54:55], v36 offset:18944
    v_mfma_f32_32x32x16_bf16 v[144:159], v[68:71], v[60:63], v[144:159]
    s_waitcnt lgkmcnt(8)
    v_mfma_f32_32x32x16_bf16 v[96:111], v[80:83], v[72:75], v[96:111]
    v_mfma_f32_32x32x16_bf16 v[128:143], v[80:83], v[76:79], v[128:143]
    s_waitcnt lgkmcnt(0)
    s_barrier
    v_mfma_f32_32x32x16_bf16 v[112:127], v[84:87], v[72:75], v[112:127]
    v_mfma_f32_32x32x16_bf16 v[144:159], v[84:87], v[76:79], v[144:159]
    v_mfma_f32_32x32x16_bf16 v[96:111], v[48:51], v[40:43], v[96:111]
    v_mfma_f32_32x32x16_bf16 v[128:143], v[48:51], v[44:47], v[128:143]
    v_mfma_f32_32x32x16_bf16 v[112:127], v[52:55], v[40:43], v[112:127]
    v_mfma_f32_32x32x16_bf16 v[144:159], v[52:55], v[44:47], v[144:159]
    s_setprio 0
    s_lshl_b32 s54, s36, 1
    s_add_u32 s54, s54, s40
    s_mul_i32 s54, s54, 229376
    s_lshl_b32 s55, s101, 1
    s_add_u32 s55, s55, s41
    s_lshl_b32 s55, s55, 11
    s_add_u32 s55, s55, 6291456
    s_add_u32 s56, s54, s55
    s_add_u32 s57, s56, 114688
    ds_read_b32 v81, v32 offset:0
    ds_read_b32 v87, v32 offset:128
    s_waitcnt lgkmcnt(0)
    v_lshlrev_b32 v80, 16, v81
    v_and_b32 v81, 0xffff0000, v81
    v_rcp_f32 v85, v81
    v_mul_f32 v84, v81, v81
    v_mul_f32 v82, 0xc0135761, v85
    v_mul_f32 v83, v85, v85
    v_mul_f32 v83, v83, v85
    v_mul_f32 v83, 0xbdd2d3e8, v83
    v_lshlrev_b32 v86, 16, v87
    v_and_b32 v87, 0xffff0000, v87
    v_rcp_f32 v91, v87
    v_mul_f32 v90, v87, v87
    v_mul_f32 v88, 0xc0135761, v91
    v_mul_f32 v89, v91, v91
    v_mul_f32 v89, v89, v91
    v_mul_f32 v89, 0xbdd2d3e8, v89
    ds_read_b128 v[64:67], v30 offset:512
    ds_read_b128 v[68:71], v30 offset:544
    ds_read_b128 v[72:75], v30 offset:768
    ds_read_b128 v[76:79], v30 offset:800
    s_waitcnt lgkmcnt(0)
    v_fma_f32 v96, -v80, v64, v96
    v_fma_f32 v104, -v80, v72, v104
    v_fma_f32 v97, -v80, v65, v97
    v_fma_f32 v105, -v80, v73, v105
    v_fma_f32 v98, -v80, v66, v98
    v_fma_f32 v106, -v80, v74, v106
    v_fma_f32 v99, -v80, v67, v99
    v_fma_f32 v107, -v80, v75, v107
    v_mul_f32 v40, v96, v96
    v_mul_f32 v41, v97, v97
    v_mul_f32 v42, v98, v98
    v_mul_f32 v43, v99, v99
    v_fma_f32 v40, v40, v83, v82
    v_fma_f32 v41, v41, v83, v82
    v_fma_f32 v42, v42, v83, v82
    v_fma_f32 v43, v43, v83, v82
    v_mul_f32 v40, v40, v96
    v_mul_f32 v41, v41, v97
    v_mul_f32 v42, v42, v98
    v_mul_f32 v43, v43, v99
    v_exp_f32 v40, v40
    v_exp_f32 v41, v41
    v_exp_f32 v42, v42
    v_exp_f32 v43, v43
    v_mul_f32 v96, v96, v104
    v_mul_f32 v97, v97, v105
    v_mul_f32 v98, v98, v106
    v_mul_f32 v99, v99, v107
    v_fma_f32 v40, v40, v84, v84
    v_fma_f32 v41, v41, v84, v84
    v_fma_f32 v42, v42, v84, v84
    v_fma_f32 v43, v43, v84, v84
    v_rcp_f32 v40, v40
    v_rcp_f32 v41, v41
    v_rcp_f32 v42, v42
    v_rcp_f32 v43, v43
    v_mul_f32 v96, v96, v40
    v_mul_f32 v97, v97, v41
    v_mul_f32 v98, v98, v42
    v_mul_f32 v99, v99, v43
    v_cvt_pk_bf16_f32 v48, v96, v97
    v_cvt_pk_bf16_f32 v49, v98, v99
    v_fma_f32 v100, -v80, v68, v100
    v_fma_f32 v108, -v80, v76, v108
    v_fma_f32 v101, -v80, v69, v101
    v_fma_f32 v109, -v80, v77, v109
    v_fma_f32 v102, -v80, v70, v102
    v_fma_f32 v110, -v80, v78, v110
    v_fma_f32 v103, -v80, v71, v103
    v_fma_f32 v111, -v80, v79, v111
    v_mul_f32 v44, v100, v100
    v_mul_f32 v45, v101, v101
    v_mul_f32 v46, v102, v102
    v_mul_f32 v47, v103, v103
    v_fma_f32 v44, v44, v83, v82
    v_fma_f32 v45, v45, v83, v82
    v_fma_f32 v46, v46, v83, v82
    v_fma_f32 v47, v47, v83, v82
    v_mul_f32 v44, v44, v100
    v_mul_f32 v45, v45, v101
    v_mul_f32 v46, v46, v102
    v_mul_f32 v47, v47, v103
    v_exp_f32 v44, v44
    v_exp_f32 v45, v45
    v_exp_f32 v46, v46
    v_exp_f32 v47, v47
    v_mul_f32 v100, v100, v108
    v_mul_f32 v101, v101, v109
    v_mul_f32 v102, v102, v110
    v_mul_f32 v103, v103, v111
    v_fma_f32 v44, v44, v84, v84
    v_fma_f32 v45, v45, v84, v84
    v_fma_f32 v46, v46, v84, v84
    v_fma_f32 v47, v47, v84, v84
    v_rcp_f32 v44, v44
    v_rcp_f32 v45, v45
    v_rcp_f32 v46, v46
    v_rcp_f32 v47, v47
    v_mul_f32 v100, v100, v44
    v_mul_f32 v101, v101, v45
    v_mul_f32 v102, v102, v46
    v_mul_f32 v103, v103, v47
    v_cvt_pk_bf16_f32 v50, v100, v101
    v_cvt_pk_bf16_f32 v51, v102, v103
    buffer_store_dwordx4 v[48:51], v27, s[32:35], s56 offen offset:0 sc1
    v_fma_f32 v128, -v86, v64, v128
    v_fma_f32 v136, -v86, v72, v136
    v_fma_f32 v129, -v86, v65, v129
    v_fma_f32 v137, -v86, v73, v137
    v_fma_f32 v130, -v86, v66, v130
    v_fma_f32 v138, -v86, v74, v138
    v_fma_f32 v131, -v86, v67, v131
    v_fma_f32 v139, -v86, v75, v139
    v_mul_f32 v40, v128, v128
    v_mul_f32 v41, v129, v129
    v_mul_f32 v42, v130, v130
    v_mul_f32 v43, v131, v131
    v_fma_f32 v40, v40, v89, v88
    v_fma_f32 v41, v41, v89, v88
    v_fma_f32 v42, v42, v89, v88
    v_fma_f32 v43, v43, v89, v88
    v_mul_f32 v40, v40, v128
    v_mul_f32 v41, v41, v129
    v_mul_f32 v42, v42, v130
    v_mul_f32 v43, v43, v131
    v_exp_f32 v40, v40
    v_exp_f32 v41, v41
    v_exp_f32 v42, v42
    v_exp_f32 v43, v43
    v_mul_f32 v128, v128, v136
    v_mul_f32 v129, v129, v137
    v_mul_f32 v130, v130, v138
    v_mul_f32 v131, v131, v139
    v_fma_f32 v40, v40, v90, v90
    v_fma_f32 v41, v41, v90, v90
    v_fma_f32 v42, v42, v90, v90
    v_fma_f32 v43, v43, v90, v90
    v_rcp_f32 v40, v40
    v_rcp_f32 v41, v41
    v_rcp_f32 v42, v42
    v_rcp_f32 v43, v43
    v_mul_f32 v128, v128, v40
    v_mul_f32 v129, v129, v41
    v_mul_f32 v130, v130, v42
    v_mul_f32 v131, v131, v43
    v_cvt_pk_bf16_f32 v52, v128, v129
    v_cvt_pk_bf16_f32 v53, v130, v131
    v_fma_f32 v132, -v86, v68, v132
    v_fma_f32 v140, -v86, v76, v140
    v_fma_f32 v133, -v86, v69, v133
    v_fma_f32 v141, -v86, v77, v141
    v_fma_f32 v134, -v86, v70, v134
    v_fma_f32 v142, -v86, v78, v142
    v_fma_f32 v135, -v86, v71, v135
    v_fma_f32 v143, -v86, v79, v143
    v_mul_f32 v44, v132, v132
    v_mul_f32 v45, v133, v133
    v_mul_f32 v46, v134, v134
    v_mul_f32 v47, v135, v135
    v_fma_f32 v44, v44, v89, v88
    v_fma_f32 v45, v45, v89, v88
    v_fma_f32 v46, v46, v89, v88
    v_fma_f32 v47, v47, v89, v88
    v_mul_f32 v44, v44, v132
    v_mul_f32 v45, v45, v133
    v_mul_f32 v46, v46, v134
    v_mul_f32 v47, v47, v135
    v_exp_f32 v44, v44
    v_exp_f32 v45, v45
    v_exp_f32 v46, v46
    v_exp_f32 v47, v47
    v_mul_f32 v132, v132, v140
    v_mul_f32 v133, v133, v141
    v_mul_f32 v134, v134, v142
    v_mul_f32 v135, v135, v143
    v_fma_f32 v44, v44, v90, v90
    v_fma_f32 v45, v45, v90, v90
    v_fma_f32 v46, v46, v90, v90
    v_fma_f32 v47, v47, v90, v90
    v_rcp_f32 v44, v44
    v_rcp_f32 v45, v45
    v_rcp_f32 v46, v46
    v_rcp_f32 v47, v47
    v_mul_f32 v132, v132, v44
    v_mul_f32 v133, v133, v45
    v_mul_f32 v134, v134, v46
    v_mul_f32 v135, v135, v47
    v_cvt_pk_bf16_f32 v54, v132, v133
    v_cvt_pk_bf16_f32 v55, v134, v135
    buffer_store_dwordx4 v[52:55], v27, s[32:35], s57 offen offset:0 sc1
    ds_read_b128 v[64:67], v30 offset:576
    ds_read_b128 v[68:71], v30 offset:608
    ds_read_b128 v[72:75], v30 offset:832
    ds_read_b128 v[76:79], v30 offset:864
    s_waitcnt lgkmcnt(0)
    v_fma_f32 v112, -v80, v64, v112
    v_fma_f32 v120, -v80, v72, v120
    v_fma_f32 v113, -v80, v65, v113
    v_fma_f32 v121, -v80, v73, v121
    v_fma_f32 v114, -v80, v66, v114
    v_fma_f32 v122, -v80, v74, v122
    v_fma_f32 v115, -v80, v67, v115
    v_fma_f32 v123, -v80, v75, v123
    v_mul_f32 v40, v112, v112
    v_mul_f32 v41, v113, v113
    v_mul_f32 v42, v114, v114
    v_mul_f32 v43, v115, v115
    v_fma_f32 v40, v40, v83, v82
    v_fma_f32 v41, v41, v83, v82
    v_fma_f32 v42, v42, v83, v82
    v_fma_f32 v43, v43, v83, v82
    v_mul_f32 v40, v40, v112
    v_mul_f32 v41, v41, v113
    v_mul_f32 v42, v42, v114
    v_mul_f32 v43, v43, v115
    v_exp_f32 v40, v40
    v_exp_f32 v41, v41
    v_exp_f32 v42, v42
    v_exp_f32 v43, v43
    v_mul_f32 v112, v112, v120
    v_mul_f32 v113, v113, v121
    v_mul_f32 v114, v114, v122
    v_mul_f32 v115, v115, v123
    v_fma_f32 v40, v40, v84, v84
    v_fma_f32 v41, v41, v84, v84
    v_fma_f32 v42, v42, v84, v84
    v_fma_f32 v43, v43, v84, v84
    v_rcp_f32 v40, v40
    v_rcp_f32 v41, v41
    v_rcp_f32 v42, v42
    v_rcp_f32 v43, v43
    v_mul_f32 v112, v112, v40
    v_mul_f32 v113, v113, v41
    v_mul_f32 v114, v114, v42
    v_mul_f32 v115, v115, v43
    v_cvt_pk_bf16_f32 v48, v112, v113
    v_cvt_pk_bf16_f32 v49, v114, v115
    v_fma_f32 v116, -v80, v68, v116
    v_fma_f32 v124, -v80, v76, v124
    v_fma_f32 v117, -v80, v69, v117
    v_fma_f32 v125, -v80, v77, v125
    v_fma_f32 v118, -v80, v70, v118
    v_fma_f32 v126, -v80, v78, v126
    v_fma_f32 v119, -v80, v71, v119
    v_fma_f32 v127, -v80, v79, v127
    v_mul_f32 v44, v116, v116
    v_mul_f32 v45, v117, v117
    v_mul_f32 v46, v118, v118
    v_mul_f32 v47, v119, v119
    v_fma_f32 v44, v44, v83, v82
    v_fma_f32 v45, v45, v83, v82
    v_fma_f32 v46, v46, v83, v82
    v_fma_f32 v47, v47, v83, v82
    v_mul_f32 v44, v44, v116
    v_mul_f32 v45, v45, v117
    v_mul_f32 v46, v46, v118
    v_mul_f32 v47, v47, v119
    v_exp_f32 v44, v44
    v_exp_f32 v45, v45
    v_exp_f32 v46, v46
    v_exp_f32 v47, v47
    v_mul_f32 v116, v116, v124
    v_mul_f32 v117, v117, v125
    v_mul_f32 v118, v118, v126
    v_mul_f32 v119, v119, v127
    v_fma_f32 v44, v44, v84, v84
    v_fma_f32 v45, v45, v84, v84
    v_fma_f32 v46, v46, v84, v84
    v_fma_f32 v47, v47, v84, v84
    v_rcp_f32 v44, v44
    v_rcp_f32 v45, v45
    v_rcp_f32 v46, v46
    v_rcp_f32 v47, v47
    v_mul_f32 v116, v116, v44
    v_mul_f32 v117, v117, v45
    v_mul_f32 v118, v118, v46
    v_mul_f32 v119, v119, v47
    v_cvt_pk_bf16_f32 v50, v116, v117
    v_cvt_pk_bf16_f32 v51, v118, v119
    buffer_store_dwordx4 v[48:51], v27, s[32:35], s56 offen offset:1024 sc1
    v_fma_f32 v144, -v86, v64, v144
    v_fma_f32 v152, -v86, v72, v152
    v_fma_f32 v145, -v86, v65, v145
    v_fma_f32 v153, -v86, v73, v153
    v_fma_f32 v146, -v86, v66, v146
    v_fma_f32 v154, -v86, v74, v154
    v_fma_f32 v147, -v86, v67, v147
    v_fma_f32 v155, -v86, v75, v155
    v_mul_f32 v40, v144, v144
    v_mul_f32 v41, v145, v145
    v_mul_f32 v42, v146, v146
    v_mul_f32 v43, v147, v147
    v_fma_f32 v40, v40, v89, v88
    v_fma_f32 v41, v41, v89, v88
    v_fma_f32 v42, v42, v89, v88
    v_fma_f32 v43, v43, v89, v88
    v_mul_f32 v40, v40, v144
    v_mul_f32 v41, v41, v145
    v_mul_f32 v42, v42, v146
    v_mul_f32 v43, v43, v147
    v_exp_f32 v40, v40
    v_exp_f32 v41, v41
    v_exp_f32 v42, v42
    v_exp_f32 v43, v43
    v_mul_f32 v144, v144, v152
    v_mul_f32 v145, v145, v153
    v_mul_f32 v146, v146, v154
    v_mul_f32 v147, v147, v155
    v_fma_f32 v40, v40, v90, v90
    v_fma_f32 v41, v41, v90, v90
    v_fma_f32 v42, v42, v90, v90
    v_fma_f32 v43, v43, v90, v90
    v_rcp_f32 v40, v40
    v_rcp_f32 v41, v41
    v_rcp_f32 v42, v42
    v_rcp_f32 v43, v43
    v_mul_f32 v144, v144, v40
    v_mul_f32 v145, v145, v41
    v_mul_f32 v146, v146, v42
    v_mul_f32 v147, v147, v43
    v_cvt_pk_bf16_f32 v52, v144, v145
    v_cvt_pk_bf16_f32 v53, v146, v147
    v_fma_f32 v148, -v86, v68, v148
    v_fma_f32 v156, -v86, v76, v156
    v_fma_f32 v149, -v86, v69, v149
    v_fma_f32 v157, -v86, v77, v157
    v_fma_f32 v150, -v86, v70, v150
    v_fma_f32 v158, -v86, v78, v158
    v_fma_f32 v151, -v86, v71, v151
    v_fma_f32 v159, -v86, v79, v159
    v_mul_f32 v44, v148, v148
    v_mul_f32 v45, v149, v149
    v_mul_f32 v46, v150, v150
    v_mul_f32 v47, v151, v151
    v_fma_f32 v44, v44, v89, v88
    v_fma_f32 v45, v45, v89, v88
    v_fma_f32 v46, v46, v89, v88
    v_fma_f32 v47, v47, v89, v88
    v_mul_f32 v44, v44, v148
    v_mul_f32 v45, v45, v149
    v_mul_f32 v46, v46, v150
    v_mul_f32 v47, v47, v151
    v_exp_f32 v44, v44
    v_exp_f32 v45, v45
    v_exp_f32 v46, v46
    v_exp_f32 v47, v47
    v_mul_f32 v148, v148, v156
    v_mul_f32 v149, v149, v157
    v_mul_f32 v150, v150, v158
    v_mul_f32 v151, v151, v159
    v_fma_f32 v44, v44, v90, v90
    v_fma_f32 v45, v45, v90, v90
    v_fma_f32 v46, v46, v90, v90
    v_fma_f32 v47, v47, v90, v90
    v_rcp_f32 v44, v44
    v_rcp_f32 v45, v45
    v_rcp_f32 v46, v46
    v_rcp_f32 v47, v47
    v_mul_f32 v148, v148, v44
    v_mul_f32 v149, v149, v45
    v_mul_f32 v150, v150, v46
    v_mul_f32 v151, v151, v47
    v_cvt_pk_bf16_f32 v54, v148, v149
    v_cvt_pk_bf16_f32 v55, v150, v151
    buffer_store_dwordx4 v[52:55], v27, s[32:35], s57 offen offset:1024 sc1
    s_lshl_b32 s14, s36, 1
    s_add_u32 s14, s14, s40
    s_lshl_b32 s14, s14, 5
    s_and_b32 s15, s101, -2
    s_add_u32 s14, s14, s15
    s_add_u32 s14, s14, s41
    s_lshl_b32 s14, s14, 2
    s_and_b32 s15, s101, 1
    s_lshl_b32 s15, s15, 12
    s_add_u32 s14, s14, s15
    s_add_u32 s14, s14, 16789504
    s_waitcnt vmcnt(0)
    v_mov_b32 v1, s49
    v_mov_b32 v2, 0
    s_mov_b64 exec, 1
    buffer_store_dword v1, v2, s[32:35], s14 offen offset:0 sc1
    s_mov_b64 exec, -1
    s_branch L_P2poll
L_AQ:
    s_lshl_b32 s60, s37, 1
    s_sub_u32 s60, s60, 11
    s_add_u32 s101, s37, 12
    s_mov_b32 s20, s6
    s_mov_b32 s21, s7
    s_mov_b32 s22, 1204224
    s_mov_b32 s23, 0x00020000
    s_and_b32 s14, s36, 7
    s_mul_i32 s14, s14, 150528
    s_and_b32 s15, s39, 1
    s_add_u32 s15, s15, s60
    s_lshl_b32 s15, s15, 7
    s_add_u32 s14, s14, s15
    v_min_u32 v1, 55, v0
    v_mul_u32_u24 v1, 2688, v1
    buffer_load_dword v39, v1, s[20:23], s14 offen
    s_and_b32 s40, s38, 1
    s_lshr_b32 s41, s39, 1
    s_mov_b32 s50, 0
    s_mov_b32 s51, -1
    v_and_b32 v7, 31, v0
    v_lshrrev_b32 v8, 5, v0
    v_bfe_u32 v9, v0, 1, 3
    v_xor_b32 v9, v9, v8
    v_lshlrev_b32 v9, 4, v9
    v_lshl_add_u32 v9, v7, 7, v9
    s_lshl_b32 s15, s40, 13
    v_add_u32 v16, s15, v9
    v_xor_b32 v17, 32, v16
    v_xor_b32 v18, 64, v16
    v_xor_b32 v19, 96, v16
    v_add_u32 v20, 0x10000, v16
    v_add_u32 v21, 0x10000, v17
    v_add_u32 v22, 0x10000, v18
    v_add_u32 v23, 0x10000, v19
    v_bfe_u32 v10, v0, 2, 2
    v_and_b32 v11, 3, v0
    v_bfe_u32 v12, v0, 4, 1
    v_bfe_u32 v13, v0, 3, 1
    v_lshlrev_b32 v13, 2, v13
    v_lshlrev_b32 v14, 10, v8
    v_lshl_add_u32 v14, v10, 7, v14
    v_add_u32 v14, 114688, v14
    v_lshl_add_u32 v2, v12, 2, v11
    s_lshl_b32 s15, s41, 3
    v_add_u32 v3, s15, v2
    v_lshrrev_b32 v1, 1, v3
    v_xor_b32 v1, v1, v13
    v_lshl_add_u32 v1, v1, 4, v14
    v_and_b32 v15, 1, v3
    v_lshl_add_u32 v26, v15, 3, v1
    v_add_u32 v4, 8, v2
    s_lshl_b32 s14, s41, 1
    s_lshl_b32 s15, s41, 12
    v_lshrrev_b32 v1, 1, v2
    v_xor_b32 v1, v1, v13
    v_xor_b32 v1, s14, v1
    v_lshl_add_u32 v1, v1, 4, v14
    v_and_b32 v15, 1, v2
    v_lshl_add_u32 v24, v15, 3, v1
    v_add_u32 v24, s15, v24
    v_lshrrev_b32 v1, 1, v4
    v_xor_b32 v1, v1, v13
    v_xor_b32 v1, s14, v1
    v_lshl_add_u32 v1, v1, 4, v14
    v_and_b32 v15, 1, v4
    v_lshl_add_u32 v25, v15, 3, v1
    v_add_u32 v25, s15, v25
    s_lshl_b32 s14, s41, 8
    s_add_u32 s14, s14, 155648
    v_lshl_add_u32 v37, v8, 4, s14
    v_lshrrev_b32 v1, 1, v11
    v_xor_b32 v1, v1, v13
    v_lshlrev_b32 v3, 1, v12
    v_xor_b32 v1, v1, v3
    s_lshl_b32 s14, s41, 2
    v_xor_b32 v1, s14, v1
    v_lshl_add_u32 v1, v1, 4, v14
    v_and_b32 v15, 1, v11
    v_lshl_add_u32 v1, v15, 3, v1
    v_lshl_add_u32 v35, v12, 12, v1
    v_xor_b32 v36, 32, v35
    s_lshl_b32 s14, s41, 7
    s_add_u32 s14, s14, 155648
    v_lshl_add_u32 v30, v8, 4, s14
    s_lshl_b32 s14, s41, 7
    s_add_u32 s14, s14, 155648
    v_lshl_add_u32 v31, v8, 4, s14
    s_lshl_b32 s14, s40, 8
    s_add_u32 s14, s14, 155648
    v_lshl_add_u32 v32, v7, 2, s14
    v_lshlrev_b32 v27, 4, v0
    v_lshlrev_b32 v28, 3, v7
    v_mov_b32 v29, v8
    s_lshl_b32 s60, s37, 1
    s_sub_u32 s60, s60, 11
    s_add_u32 s101, s37, 12
    s_and_b32 s3, s2, 7
    s_and_b32 s14, s78, 1
    s_lshl_b32 s74, s3, 1
    s_add_u32 s74, s74, s14
    s_lshr_b32 s75, s78, 1
    s_mul_i32 s14, s3, 29
    s_sub_u32 s15, s3, 4
    s_max_i32 s15, s15, 0
    s_add_u32 s14, s14, s15
    s_cmp_eq_u32 s3, 7
    s_cselect_b32 s14, 200, s14
    s_cmp_lt_u32 s3, 4
    s_cselect_b32 s15, 29, 30
    s_cmp_lt_u32 s3, 6
    s_cselect_b32 s15, s15, 24
    s_add_u32 s14, s14, s78
    s_mul_i32 s76, s14, 9363
    s_lshr_b32 s76, s76, 16
    s_mul_i32 s77, s76, 7
    s_sub_u32 s77, s14, s77
    s_cmp_ge_u32 s78, s15
    s_cselect_b32 s76, 32, s76
    s_mov_b32 s43, 0
    s_barrier
    s_setprio 2
    ds_read_b64_tr_b16 v[48:49], v24 offset:0
    ds_read_b64_tr_b16 v[50:51], v24 offset:512
    ds_read_b128 v[40:43], v16 offset:0
    ds_read_b128 v[44:47], v16 offset:4096
    ds_read_b64_tr_b16 v[52:53], v25 offset:0
    ds_read_b64_tr_b16 v[54:55], v25 offset:512
    ds_read_b64_tr_b16 v[64:65], v24 offset:2048
    ds_read_b64_tr_b16 v[66:67], v24 offset:2560
    ds_read_b128 v[56:59], v17 offset:0
    ds_read_b128 v[60:63], v17 offset:4096
    ds_read_b64_tr_b16 v[68:69], v25 offset:2048
    ds_read_b64_tr_b16 v[70:71], v25 offset:2560
    s_waitcnt lgkmcnt(8)
    v_mfma_f32_32x32x16_bf16 v[96:111], v[48:51], v[40:43], 0
    v_mfma_f32_32x32x16_bf16 v[128:143], v[48:51], v[44:47], 0
    s_barrier
    s_waitcnt lgkmcnt(6)
    v_mfma_f32_32x32x16_bf16 v[112:127], v[52:55], v[40:43], 0
    ds_read_b64_tr_b16 v[80:81], v24 offset:8192
    ds_read_b64_tr_b16 v[82:83], v24 offset:8704
    ds_read_b128 v[72:75], v18 offset:0
    ds_read_b128 v[76:79], v18 offset:4096
    v_mfma_f32_32x32x16_bf16 v[144:159], v[52:55], v[44:47], 0
    ds_read_b64_tr_b16 v[84:85], v25 offset:8192
    ds_read_b64_tr_b16 v[86:87], v25 offset:8704
    s_waitcnt lgkmcnt(8)
    v_mfma_f32_32x32x16_bf16 v[96:111], v[64:67], v[56:59], v[96:111]
    ds_read_b64_tr_b16 v[48:49], v24 offset:10240
    ds_read_b64_tr_b16 v[50:51], v24 offset:10752
    v_mfma_f32_32x32x16_bf16 v[128:143], v[64:67], v[60:63], v[128:143]
    ds_read_b128 v[40:43], v19 offset:0
    ds_read_b128 v[44:47], v19 offset:4096
    s_waitcnt lgkmcnt(10)
    v_mfma_f32_32x32x16_bf16 v[112:127], v[68:71], v[56:59], v[112:127]
    ds_read_b64_tr_b16 v[52:53], v25 offset:10240
    ds_read_b64_tr_b16 v[54:55], v25 offset:10752
    v_mfma_f32_32x32x16_bf16 v[144:159], v[68:71], v[60:63], v[144:159]
    s_waitcnt lgkmcnt(8)
    v_mfma_f32_32x32x16_bf16 v[96:111], v[80:83], v[72:75], v[96:111]
    v_mfma_f32_32x32x16_bf16 v[128:143], v[80:83], v[76:79], v[128:143]
    s_barrier
    s_waitcnt lgkmcnt(6)
    v_mfma_f32_32x32x16_bf16 v[112:127], v[84:87], v[72:75], v[112:127]
    ds_read_b64_tr_b16 v[64:65], v24 offset:16384
    ds_read_b64_tr_b16 v[66:67], v24 offset:16896
    ds_read_b128 v[56:59], v16 offset:16384
    ds_read_b128 v[60:63], v16 offset:20480
    v_mfma_f32_32x32x16_bf16 v[144:159], v[84:87], v[76:79], v[144:159]
    ds_read_b64_tr_b16 v[68:69], v25 offset:16384
    ds_read_b64_tr_b16 v[70:71], v25 offset:16896
    s_waitcnt lgkmcnt(8)
    v_mfma_f32_32x32x16_bf16 v[96:111], v[48:51], v[40:43], v[96:111]
    ds_read_b64_tr_b16 v[80:81], v24 offset:18432
    ds_read_b64_tr_b16 v[82:83], v24 offset:18944
    v_mfma_f32_32x32x16_bf16 v[128:143], v[48:51], v[44:47], v[128:143]
    ds_read_b128 v[72:75], v17 offset:16384
    ds_read_b128 v[76:79], v17 offset:20480
    s_waitcnt lgkmcnt(10)
    v_mfma_f32_32x32x16_bf16 v[112:127], v[52:55], v[40:43], v[112:127]
    ds_read_b64_tr_b16 v[84:85], v25 offset:18432
    ds_read_b64_tr_b16 v[86:87], v25 offset:18944
    v_mfma_f32_32x32x16_bf16 v[144:159], v[52:55], v[44:47], v[144:159]
    s_waitcnt lgkmcnt(8)
    v_mfma_f32_32x32x16_bf16 v[96:111], v[64:67], v[56:59], v[96:111]
    v_mfma_f32_32x32x16_bf16 v[128:143], v[64:67], v[60:63], v[128:143]
    s_barrier
    s_waitcnt lgkmcnt(6)
    v_mfma_f32_32x32x16_bf16 v[112:127], v[68:71], v[56:59], v[112:127]
    ds_read_b64_tr_b16 v[48:49], v24 offset:24576
    ds_read_b64_tr_b16 v[50:51], v24 offset:25088
    ds_read_b128 v[40:43], v18 offset:16384
    ds_read_b128 v[44:47], v18 offset:20480
    v_mfma_f32_32x32x16_bf16 v[144:159], v[68:71], v[60:63], v[144:159]
    ds_read_b64_tr_b16 v[52:53], v25 offset:24576
    ds_read_b64_tr_b16 v[54:55], v25 offset:25088
    s_waitcnt lgkmcnt(8)
    v_mfma_f32_32x32x16_bf16 v[96:111], v[80:83], v[72:75], v[96:111]
    ds_read_b64_tr_b16 v[64:65], v24 offset:26624
    ds_read_b64_tr_b16 v[66:67], v24 offset:27136
    v_mfma_f32_32x32x16_bf16 v[128:143], v[80:83], v[76:79], v[128:143]
    ds_read_b128 v[56:59], v19 offset:16384
    ds_read_b128 v[60:63], v19 offset:20480
    s_waitcnt lgkmcnt(10)
    v_mfma_f32_32x32x16_bf16 v[112:127], v[84:87], v[72:75], v[112:127]
    ds_read_b64_tr_b16 v[68:69], v25 offset:26624
    ds_read_b64_tr_b16 v[70:71], v25 offset:27136
    v_mfma_f32_32x32x16_bf16 v[144:159], v[84:87], v[76:79], v[144:159]
    s_waitcnt lgkmcnt(8)
    v_mfma_f32_32x32x16_bf16 v[96:111], v[48:51], v[40:43], v[96:111]
    v_mfma_f32_32x32x16_bf16 v[128:143], v[48:51], v[44:47], v[128:143]
    s_barrier
    s_waitcnt lgkmcnt(6)
    v_mfma_f32_32x32x16_bf16 v[112:127], v[52:55], v[40:43], v[112:127]
    ds_read_b64_tr_b16 v[80:81], v24 offset:32768
    ds_read_b64_tr_b16 v[82:83], v24 offset:33280
    ds_read_b128 v[72:75], v16 offset:32768
    ds_read_b128 v[76:79], v16 offset:36864
    v_mfma_f32_32x32x16_bf16 v[144:159], v[52:55], v[44:47], v[144:159]
    ds_read_b64_tr_b16 v[84:85], v25 offset:32768
    ds_read_b64_tr_b16 v[86:87], v25 offset:33280
    s_waitcnt lgkmcnt(8)
    v_mfma_f32_32x32x16_bf16 v[96:111], v[64:67], v[56:59], v[96:111]
    ds_read_b64_tr_b16 v[48:49], v24 offset:34816
    ds_read_b64_tr_b16 v[50:51], v24 offset:35328
    v_mfma_f32_32x32x16_bf16 v[128:143], v[64:67], v[60:63], v[128:143]
    ds_read_b128 v[40:43], v17 offset:32768
    ds_read_b128 v[44:47], v17 offset:36864
    s_waitcnt lgkmcnt(10)
    v_mfma_f32_32x32x16_bf16 v[112:127], v[68:71], v[56:59], v[112:127]
    ds_read_b64_tr_b16 v[52:53], v25 offset:34816
    ds_read_b64_tr_b16 v[54:55], v25 offset:35328
    v_mfma_f32_32x32x16_bf16 v[144:159], v[68:71], v[60:63], v[144:159]
    s_waitcnt lgkmcnt(8)
    v_mfma_f32_32x32x16_bf16 v[96:111], v[80:83], v[72:75], v[96:111]
    v_mfma_f32_32x32x16_bf16 v[128:143], v[80:83], v[76:79], v[128:143]
    s_barrier
    s_waitcnt lgkmcnt(6)
    v_mfma_f32_32x32x16_bf16 v[112:127], v[84:87], v[72:75], v[112:127]
    ds_read_b64_tr_b16 v[64:65], v24 offset:0
    ds_read_b64_tr_b16 v[66:67], v24 offset:512
    ds_read_b128 v[56:59], v18 offset:32768
    ds_read_b128 v[60:63], v18 offset:36864
    v_mfma_f32_32x32x16_bf16 v[144:159], v[84:87], v[76:79], v[144:159]
    ds_read_b64_tr_b16 v[68:69], v25 offset:0
    ds_read_b64_tr_b16 v[70:71], v25 offset:512
    s_waitcnt lgkmcnt(8)
    v_mfma_f32_32x32x16_bf16 v[96:111], v[48:51], v[40:43], v[96:111]
    ds_read_b64_tr_b16 v[80:81], v24 offset:2048
    ds_read_b64_tr_b16 v[82:83], v24 offset:2560
    v_mfma_f32_32x32x16_bf16 v[128:143], v[48:51], v[44:47], v[128:143]
    ds_read_b128 v[72:75], v19 offset:32768
    ds_read_b128 v[76:79], v19 offset:36864
    s_waitcnt lgkmcnt(10)
    v_mfma_f32_32x32x16_bf16 v[112:127], v[52:55], v[40:43], v[112:127]
    ds_read_b64_tr_b16 v[84:85], v25 offset:2048
    ds_read_b64_tr_b16 v[86:87], v25 offset:2560
    v_mfma_f32_32x32x16_bf16 v[144:159], v[52:55], v[44:47], v[144:159]
    s_waitcnt lgkmcnt(8)
    v_mfma_f32_32x32x16_bf16 v[96:111], v[64:67], v[56:59], v[96:111]
    v_mfma_f32_32x32x16_bf16 v[128:143], v[64:67], v[60:63], v[128:143]
    s_barrier
    s_waitcnt lgkmcnt(6)
    v_mfma_f32_32x32x16_bf16 v[112:127], v[68:71], v[56:59], v[112:127]
    ds_read_b64_tr_b16 v[48:49], v24 offset:8192
    ds_read_b64_tr_b16 v[50:51], v24 offset:8704
    ds_read_b128 v[40:43], v16 offset:49152
    ds_read_b128 v[44:47], v16 offset:53248
    v_mfma_f32_32x32x16_bf16 v[144:159], v[68:71], v[60:63], v[144:159]
    ds_read_b64_tr_b16 v[52:53], v25 offset:8192
    ds_read_b64_tr_b16 v[54:55], v25 offset:8704
    s_waitcnt lgkmcnt(8)
    v_mfma_f32_32x32x16_bf16 v[96:111], v[80:83], v[72:75], v[96:111]
    ds_read_b64_tr_b16 v[64:65], v24 offset:10240
    ds_read_b64_tr_b16 v[66:67], v24 offset:10752
    v_mfma_f32_32x32x16_bf16 v[128:143], v[80:83], v[76:79], v[128:143]
    ds_read_b128 v[56:59], v17 offset:49152
    ds_read_b128 v[60:63], v17 offset:53248
    s_waitcnt lgkmcnt(10)
    v_mfma_f32_32x32x16_bf16 v[112:127], v[84:87], v[72:75], v[112:127]
    ds_read_b64_tr_b16 v[68:69], v25 offset:10240
    ds_read_b64_tr_b16 v[70:71], v25 offset:10752
    v_mfma_f32_32x32x16_bf16 v[144:159], v[84:87], v[76:79], v[144:159]
    s_waitcnt lgkmcnt(8)
    v_mfma_f32_32x32x16_bf16 v[96:111], v[48:51], v[40:43], v[96:111]
    v_mfma_f32_32x32x16_bf16 v[128:143], v[48:51], v[44:47], v[128:143]
    s_barrier
    s_waitcnt lgkmcnt(6)
    v_mfma_f32_32x32x16_bf16 v[112:127], v[52:55], v[40:43], v[112:127]
    ds_read_b64_tr_b16 v[80:81], v24 offset:16384
    ds_read_b64_tr_b16 v[82:83], v24 offset:16896
    ds_read_b128 v[72:75], v18 offset:49152
    ds_read_b128 v[76:79], v18 offset:53248
    v_mfma_f32_32x32x16_bf16 v[144:159], v[52:55], v[44:47], v[144:159]
    ds_read_b64_tr_b16 v[84:85], v25 offset:16384
    ds_read_b64_tr_b16 v[86:87], v25 offset:16896
    s_waitcnt lgkmcnt(8)
    v_mfma_f32_32x32x16_bf16 v[96:111], v[64:67], v[56:59], v[96:111]
    ds_read_b64_tr_b16 v[48:49], v24 offset:18432
    ds_read_b64_tr_b16 v[50:51], v24 offset:18944
    v_mfma_f32_32x32x16_bf16 v[128:143], v[64:67], v[60:63], v[128:143]
    ds_read_b128 v[40:43], v19 offset:49152
    ds_read_b128 v[44:47], v19 offset:53248
    s_waitcnt lgkmcnt(10)
    v_mfma_f32_32x32x16_bf16 v[112:127], v[68:71], v[56:59], v[112:127]
    ds_read_b64_tr_b16 v[52:53], v25 offset:18432
    ds_read_b64_tr_b16 v[54:55], v25 offset:18944
    v_mfma_f32_32x32x16_bf16 v[144:159], v[68:71], v[60:63], v[144:159]
    s_waitcnt lgkmcnt(8)
    v_mfma_f32_32x32x16_bf16 v[96:111], v[80:83], v[72:75], v[96:111]
    v_mfma_f32_32x32x16_bf16 v[128:143], v[80:83], v[76:79], v[128:143]
    s_barrier
    s_waitcnt lgkmcnt(6)
    v_mfma_f32_32x32x16_bf16 v[112:127], v[84:87], v[72:75], v[112:127]
    ds_read_b64_tr_b16 v[64:65], v24 offset:24576
    ds_read_b64_tr_b16 v[66:67], v24 offset:25088
    ds_read_b128 v[56:59], v20 offset:0
    ds_read_b128 v[60:63], v20 offset:4096
    v_mfma_f32_32x32x16_bf16 v[144:159], v[84:87], v[76:79], v[144:159]
    ds_read_b64_tr_b16 v[68:69], v25 offset:24576
    ds_read_b64_tr_b16 v[70:71], v25 offset:25088
    s_waitcnt lgkmcnt(8)
    v_mfma_f32_32x32x16_bf16 v[96:111], v[48:51], v[40:43], v[96:111]
    ds_read_b64_tr_b16 v[80:81], v24 offset:26624
    ds_read_b64_tr_b16 v[82:83], v24 offset:27136
    v_mfma_f32_32x32x16_bf16 v[128:143], v[48:51], v[44:47], v[128:143]
    ds_read_b128 v[72:75], v21 offset:0
    ds_read_b128 v[76:79], v21 offset:4096
    s_waitcnt lgkmcnt(10)
    v_mfma_f32_32x32x16_bf16 v[112:127], v[52:55], v[40:43], v[112:127]
    ds_read_b64_tr_b16 v[84:85], v25 offset:26624
    ds_read_b64_tr_b16 v[86:87], v25 offset:27136
    v_mfma_f32_32x32x16_bf16 v[144:159], v[52:55], v[44:47], v[144:159]
    s_waitcnt lgkmcnt(8)
    v_mfma_f32_32x32x16_bf16 v[96:111], v[64:67], v[56:59], v[96:111]
    v_mfma_f32_32x32x16_bf16 v[128:143], v[64:67], v[60:63], v[128:143]
    s_barrier
    s_waitcnt lgkmcnt(6)
    v_mfma_f32_32x32x16_bf16 v[112:127], v[68:71], v[56:59], v[112:127]
    ds_read_b64_tr_b16 v[48:49], v24 offset:32768
    ds_read_b64_tr_b16 v[50:51], v24 offset:33280
    ds_read_b128 v[40:43], v22 offset:0
    ds_read_b128 v[44:47], v22 offset:4096
    v_mfma_f32_32x32x16_bf16 v[144:159], v[68:71], v[60:63], v[144:159]
    ds_read_b64_tr_b16 v[52:53], v25 offset:32768
    ds_read_b64_tr_b16 v[54:55], v25 offset:33280
    s_waitcnt lgkmcnt(8)
    v_mfma_f32_32x32x16_bf16 v[96:111], v[80:83], v[72:75], v[96:111]
    ds_read_b64_tr_b16 v[64:65], v24 offset:34816
    ds_read_b64_tr_b16 v[66:67], v24 offset:35328
    v_mfma_f32_32x32x16_bf16 v[128:143], v[80:83], v[76:79], v[128:143]
    ds_read_b128 v[56:59], v23 offset:0
    ds_read_b128 v[60:63], v23 offset:4096
    s_waitcnt lgkmcnt(10)
    v_mfma_f32_32x32x16_bf16 v[112:127], v[84:87], v[72:75], v[112:127]
    ds_read_b64_tr_b16 v[68:69], v25 offset:34816
    ds_read_b64_tr_b16 v[70:71], v25 offset:35328
    v_mfma_f32_32x32x16_bf16 v[144:159], v[84:87], v[76:79], v[144:159]
    s_waitcnt lgkmcnt(8)
    v_mfma_f32_32x32x16_bf16 v[96:111], v[48:51], v[40:43], v[96:111]
    v_mfma_f32_32x32x16_bf16 v[128:143], v[48:51], v[44:47], v[128:143]
    s_barrier
    s_waitcnt lgkmcnt(6)
    v_mfma_f32_32x32x16_bf16 v[112:127], v[52:55], v[40:43], v[112:127]
    ds_read_b64_tr_b16 v[80:81], v24 offset:0
    ds_read_b64_tr_b16 v[82:83], v24 offset:512
    ds_read_b128 v[72:75], v20 offset:16384
    ds_read_b128 v[76:79], v20 offset:20480
    v_mfma_f32_32x32x16_bf16 v[144:159], v[52:55], v[44:47], v[144:159]
    ds_read_b64_tr_b16 v[84:85], v25 offset:0
    ds_read_b64_tr_b16 v[86:87], v25 offset:512
    s_waitcnt lgkmcnt(8)
    v_mfma_f32_32x32x16_bf16 v[96:111], v[64:67], v[56:59], v[96:111]
    ds_read_b64_tr_b16 v[48:49], v24 offset:2048
    ds_read_b64_tr_b16 v[50:51], v24 offset:2560
    v_mfma_f32_32x32x16_bf16 v[128:143], v[64:67], v[60:63], v[128:143]
    ds_read_b128 v[40:43], v21 offset:16384
    ds_read_b128 v[44:47], v21 offset:20480
    s_waitcnt lgkmcnt(10)
    v_mfma_f32_32x32x16_bf16 v[112:127], v[68:71], v[56:59], v[112:127]
    ds_read_b64_tr_b16 v[52:53], v25 offset:2048
    ds_read_b64_tr_b16 v[54:55], v25 offset:2560
    v_mfma_f32_32x32x16_bf16 v[144:159], v[68:71], v[60:63], v[144:159]
    s_waitcnt lgkmcnt(8)
    v_mfma_f32_32x32x16_bf16 v[96:111], v[80:83], v[72:75], v[96:111]
    v_mfma_f32_32x32x16_bf16 v[128:143], v[80:83], v[76:79], v[128:143]
    s_barrier
    s_waitcnt lgkmcnt(6)
    v_mfma_f32_32x32x16_bf16 v[112:127], v[84:87], v[72:75], v[112:127]
    ds_read_b64_tr_b16 v[64:65], v24 offset:8192
    ds_read_b64_tr_b16 v[66:67], v24 offset:8704
    ds_read_b128 v[56:59], v22 offset:16384
    ds_read_b128 v[60:63], v22 offset:20480
    v_mfma_f32_32x32x16_bf16 v[144:159], v[84:87], v[76:79], v[144:159]
    ds_read_b64_tr_b16 v[68:69], v25 offset:8192
    ds_read_b64_tr_b16 v[70:71], v25 offset:8704
    s_waitcnt lgkmcnt(8)
    v_mfma_f32_32x32x16_bf16 v[96:111], v[48:51], v[40:43], v[96:111]
    ds_read_b64_tr_b16 v[80:81], v24 offset:10240
    ds_read_b64_tr_b16 v[82:83], v24 offset:10752
    v_mfma_f32_32x32x16_bf16 v[128:143], v[48:51], v[44:47], v[128:143]
    ds_read_b128 v[72:75], v23 offset:16384
    ds_read_b128 v[76:79], v23 offset:20480
    s_waitcnt lgkmcnt(10)
    v_mfma_f32_32x32x16_bf16 v[112:127], v[52:55], v[40:43], v[112:127]
    ds_read_b64_tr_b16 v[84:85], v25 offset:10240
    ds_read_b64_tr_b16 v[86:87], v25 offset:10752
    v_mfma_f32_32x32x16_bf16 v[144:159], v[52:55], v[44:47], v[144:159]
    s_waitcnt lgkmcnt(8)
    v_mfma_f32_32x32x16_bf16 v[96:111], v[64:67], v[56:59], v[96:111]
    v_mfma_f32_32x32x16_bf16 v[128:143], v[64:67], v[60:63], v[128:143]
    s_barrier
    s_waitcnt lgkmcnt(6)
    v_mfma_f32_32x32x16_bf16 v[112:127], v[68:71], v[56:59], v[112:127]
    ds_read_b64_tr_b16 v[48:49], v24 offset:16384
    ds_read_b64_tr_b16 v[50:51], v24 offset:16896
    ds_read_b128 v[40:43], v20 offset:32768
    ds_read_b128 v[44:47], v20 offset:36864
    v_mfma_f32_32x32x16_bf16 v[144:159], v[68:71], v[60:63], v[144:159]
    ds_read_b64_tr_b16 v[52:53], v25 offset:16384
    ds_read_b64_tr_b16 v[54:55], v25 offset:16896
    s_waitcnt lgkmcnt(8)
    v_mfma_f32_32x32x16_bf16 v[96:111], v[80:83], v[72:75], v[96:111]
    ds_read_b64_tr_b16 v[64:65], v24 offset:18432
    ds_read_b64_tr_b16 v[66:67], v24 offset:18944
    v_mfma_f32_32x32x16_bf16 v[128:143], v[80:83], v[76:79], v[128:143]
    ds_read_b128 v[56:59], v21 offset:32768
    ds_read_b128 v[60:63], v21 offset:36864
    s_waitcnt lgkmcnt(10)
    v_mfma_f32_32x32x16_bf16 v[112:127], v[84:87], v[72:75], v[112:127]
    ds_read_b64_tr_b16 v[68:69], v25 offset:18432
    ds_read_b64_tr_b16 v[70:71], v25 offset:18944
    v_mfma_f32_32x32x16_bf16 v[144:159], v[84:87], v[76:79], v[144:159]
    s_waitcnt lgkmcnt(8)
    v_mfma_f32_32x32x16_bf16 v[96:111], v[48:51], v[40:43], v[96:111]
    v_mfma_f32_32x32x16_bf16 v[128:143], v[48:51], v[44:47], v[128:143]
    s_barrier
    s_waitcnt lgkmcnt(6)
    v_mfma_f32_32x32x16_bf16 v[112:127], v[52:55], v[40:43], v[112:127]
    ds_read_b64_tr_b16 v[80:81], v24 offset:24576
    ds_read_b64_tr_b16 v[82:83], v24 offset:25088
    ds_read_b128 v[72:75], v22 offset:32768
    ds_read_b128 v[76:79], v22 offset:36864
    v_mfma_f32_32x32x16_bf16 v[144:159], v[52:55], v[44:47], v[144:159]
    ds_read_b64_tr_b16 v[84:85], v25 offset:24576
    ds_read_b64_tr_b16 v[86:87], v25 offset:25088
    s_waitcnt lgkmcnt(8)
    v_mfma_f32_32x32x16_bf16 v[96:111], v[64:67], v[56:59], v[96:111]
    ds_read_b64_tr_b16 v[48:49], v24 offset:26624
    ds_read_b64_tr_b16 v[50:51], v24 offset:27136
    v_mfma_f32_32x32x16_bf16 v[128:143], v[64:67], v[60:63], v[128:143]
    ds_read_b128 v[40:43], v23 offset:32768
    ds_read_b128 v[44:47], v23 offset:36864
    s_waitcnt lgkmcnt(10)
    v_mfma_f32_32x32x16_bf16 v[112:127], v[68:71], v[56:59], v[112:127]
    ds_read_b64_tr_b16 v[52:53], v25 offset:26624
    ds_read_b64_tr_b16 v[54:55], v25 offset:27136
    v_mfma_f32_32x32x16_bf16 v[144:159], v[68:71], v[60:63], v[144:159]
    s_waitcnt lgkmcnt(8)
    v_mfma_f32_32x32x16_bf16 v[96:111], v[80:83], v[72:75], v[96:111]
    v_mfma_f32_32x32x16_bf16 v[128:143], v[80:83], v[76:79], v[128:143]
    s_barrier
    s_waitcnt lgkmcnt(6)
    v_mfma_f32_32x32x16_bf16 v[112:127], v[84:87], v[72:75], v[112:127]
    v_mfma_f32_32x32x16_bf16 v[144:159], v[84:87], v[76:79], v[144:159]
    s_waitcnt lgkmcnt(2)
    v_mfma_f32_32x32x16_bf16 v[96:111], v[48:51], v[40:43], v[96:111]
    v_mfma_f32_32x32x16_bf16 v[128:143], v[48:51], v[44:47], v[128:143]
    s_waitcnt lgkmcnt(0)
    v_mfma_f32_32x32x16_bf16 v[112:127], v[52:55], v[40:43], v[112:127]
    v_mfma_f32_32x32x16_bf16 v[144:159], v[52:55], v[44:47], v[144:159]
    s_setprio 0
    s_waitcnt vmcnt(0)
    ds_read_b32 v81, v32 offset:0
    ds_read_b32 v87, v32 offset:128
    s_waitcnt lgkmcnt(0)
    v_lshlrev_b32 v80, 16, v81
    v_and_b32 v81, 0xffff0000, v81
    v_rcp_f32 v85, v81
    v_lshlrev_b32 v86, 16, v87
    v_and_b32 v87, 0xffff0000, v87
    v_rcp_f32 v91, v87
    ds_read_b128 v[64:67], v37 offset:1536
    ds_read_b128 v[68:71], v37 offset:1568
    ds_read_b128 v[72:75], v37 offset:1600
    ds_read_b128 v[76:79], v37 offset:1632
    s_waitcnt lgkmcnt(0)
    s_add_u32 s54, s60, s41
    s_mov_b32 s55, 0
    s_mul_i32 s57, s54, 37
    s_lshr_b32 s57, s57, 8
    s_mul_i32 s14, s57, 7
    s_sub_u32 s14, s54, s14
    s_lshl_b32 s14, s14, 1
    s_add_u32 s14, s14, s55
    s_lshl_b32 s14, s14, 5
    s_getpc_b64 s[12:13]
L_tpqQ0:
    s_add_u32 s14, s14, L_tab-L_tpqQ0
    s_load_dwordx8 s[4:11], s[12:13], s14
    s_lshl_b32 s56, s57, 21
    s_lshl_b32 s54, s36, 1
    s_add_u32 s54, s54, s40
    s_lshl_b32 s54, s54, 12
    s_add_u32 s56, s56, s54
    s_cmp_eq_u32 s57, 0
    s_cselect_b32 s61, 0x3e8b97f6, 1.0
    s_cselect_b32 s14, 0, 0x3f80
    s_cmp_eq_u32 s57, 1
    s_cselect_b32 s14, 0x3f803f80, s14
    s_cselect_b32 s15, 0x3f80, 0
    v_mov_b32 v38, s14
    v_mov_b32 v39, s15
    v_mul_f32 v82, s61, v85
    v_fma_f32 v96, -v80, v64, v96
    v_fma_f32 v97, -v80, v65, v97
    v_fma_f32 v98, -v80, v66, v98
    s_barrier
    v_fma_f32 v99, -v80, v67, v99
    v_fma_f32 v100, -v80, v68, v100
    v_fma_f32 v101, -v80, v69, v101
    v_fma_f32 v102, -v80, v70, v102
    v_fma_f32 v103, -v80, v71, v103
    v_fma_f32 v104, -v80, v72, v104
    v_fma_f32 v105, -v80, v73, v105
    v_fma_f32 v106, -v80, v74, v106
    v_fma_f32 v107, -v80, v75, v107
    v_fma_f32 v108, -v80, v76, v108
    v_fma_f32 v109, -v80, v77, v109
    v_fma_f32 v110, -v80, v78, v110
    v_fma_f32 v111, -v80, v79, v111
    v_mul_f32 v96, v96, v82
    v_mul_f32 v97, v97, v82
    v_mul_f32 v98, v98, v82
    v_mul_f32 v99, v99, v82
    v_mul_f32 v100, v100, v82
    v_mul_f32 v101, v101, v82
    v_mul_f32 v102, v102, v82
    v_mul_f32 v103, v103, v82
    v_mul_f32 v104, v104, v82
    v_mul_f32 v105, v105, v82
    v_mul_f32 v106, v106, v82
    v_mul_f32 v107, v107, v82
    v_mul_f32 v108, v108, v82
    v_mul_f32 v109, v109, v82
    v_mul_f32 v110, v110, v82
    v_mul_f32 v111, v111, v82
    v_cvt_pk_bf16_f32 v48, v96, v97
    v_cvt_pk_bf16_f32 v49, v98, v99
    v_cvt_pk_bf16_f32 v50, v100, v101
    v_cvt_pk_bf16_f32 v51, v102, v103
    v_cvt_pk_bf16_f32 v52, v104, v105
    v_cvt_pk_bf16_f32 v53, v106, v107
    v_cvt_pk_bf16_f32 v54, v108, v109
    s_barrier
    v_cvt_pk_bf16_f32 v55, v110, v111
    v_mul_f32 v88, s61, v91
    v_fma_f32 v128, -v86, v64, v128
    v_fma_f32 v129, -v86, v65, v129
    v_fma_f32 v130, -v86, v66, v130
    v_fma_f32 v131, -v86, v67, v131
    v_fma_f32 v132, -v86, v68, v132
    v_fma_f32 v133, -v86, v69, v133
    v_fma_f32 v134, -v86, v70, v134
    v_fma_f32 v135, -v86, v71, v135
    v_fma_f32 v136, -v86, v72, v136
    v_fma_f32 v137, -v86, v73, v137
    v_fma_f32 v138, -v86, v74, v138
    v_fma_f32 v139, -v86, v75, v139
    v_fma_f32 v140, -v86, v76, v140
    v_fma_f32 v141, -v86, v77, v141
    v_fma_f32 v142, -v86, v78, v142
    v_fma_f32 v143, -v86, v79, v143
    v_mul_f32 v128, v128, v88
    v_mul_f32 v129, v129, v88
    v_mul_f32 v130, v130, v88
    v_mul_f32 v131, v131, v88
    v_mul_f32 v132, v132, v88
    v_mul_f32 v133, v133, v88
    v_mul_f32 v134, v134, v88
    v_mul_f32 v135, v135, v88
    v_mul_f32 v136, v136, v88
    v_mul_f32 v137, v137, v88
    v_mul_f32 v138, v138, v88
    v_mul_f32 v139, v139, v88
    v_mul_f32 v140, v140, v88
    v_mul_f32 v141, v141, v88
    v_mul_f32 v142, v142, v88
    v_mul_f32 v143, v143, v88
    v_cvt_pk_bf16_f32 v56, v128, v129
    v_cvt_pk_bf16_f32 v57, v130, v131
    s_barrier
    v_cvt_pk_bf16_f32 v58, v132, v133
    v_cvt_pk_bf16_f32 v59, v134, v135
    v_cvt_pk_bf16_f32 v60, v136, v137
    v_cvt_pk_bf16_f32 v61, v138, v139
    v_cvt_pk_bf16_f32 v62, v140, v141
    v_cvt_pk_bf16_f32 v63, v142, v143
    s_waitcnt lgkmcnt(0)
    s_and_b32 s14, s5, -8
    v_mul_i32_i24 v1, s14, v29
    v_add3_u32 v2, v1, s4, v28
    buffer_store_dwordx2 v[48:49], v2, s[32:35], s56 offen offset:0 sc1
    buffer_store_dwordx2 v[56:57], v2, s[32:35], s56 offen offset:2048 sc1
    s_and_b32 s14, s5, 3
    s_cbranch_scc0 L_npqQ0_0
    s_cmp_eq_u32 s14, 1
    s_cselect_b32 exec_lo, -1, 0
    s_cselect_b32 exec_hi, 0, -1
    buffer_store_dwordx2 v[38:39], v2, s[32:35], s56 offen offset:256 sc1
    buffer_store_dwordx2 v[38:39], v2, s[32:35], s56 offen offset:2304 sc1
    s_mov_b64 exec, -1
L_npqQ0_0:
    s_and_b32 s14, s7, -8
    v_mul_i32_i24 v1, s14, v29
    v_add3_u32 v2, v1, s6, v28
    buffer_store_dwordx2 v[50:51], v2, s[32:35], s56 offen offset:0 sc1
    buffer_store_dwordx2 v[58:59], v2, s[32:35], s56 offen offset:2048 sc1
    s_and_b32 s14, s7, 3
    s_cbranch_scc0 L_npqQ0_1
    s_cmp_eq_u32 s14, 1
    s_cselect_b32 exec_lo, -1, 0
    s_cselect_b32 exec_hi, 0, -1
    buffer_store_dwordx2 v[38:39], v2, s[32:35], s56 offen offset:256 sc1
    buffer_store_dwordx2 v[38:39], v2, s[32:35], s56 offen offset:2304 sc1
    s_mov_b64 exec, -1
L_npqQ0_1:
    s_and_b32 s14, s9, -8
    v_mul_i32_i24 v1, s14, v29
    v_add3_u32 v2, v1, s8, v28
    buffer_store_dwordx2 v[52:53], v2, s[32:35], s56 offen offset:0 sc1
    buffer_store_dwordx2 v[60:61], v2, s[32:35], s56 offen offset:2048 sc1
    s_and_b32 s14, s9, 3
    s_cbranch_scc0 L_npqQ0_2
    s_cmp_eq_u32 s14, 1
    s_cselect_b32 exec_lo, -1, 0
    s_cselect_b32 exec_hi, 0, -1
    buffer_store_dwordx2 v[38:39], v2, s[32:35], s56 offen offset:256 sc1
    buffer_store_dwordx2 v[38:39], v2, s[32:35], s56 offen offset:2304 sc1
    s_mov_b64 exec, -1
L_npqQ0_2:
    s_and_b32 s14, s11, -8
    v_mul_i32_i24 v1, s14, v29
    s_barrier
    v_add3_u32 v2, v1, s10, v28
    buffer_store_dwordx2 v[54:55], v2, s[32:35], s56 offen offset:0 sc1
    buffer_store_dwordx2 v[62:63], v2, s[32:35], s56 offen offset:2048 sc1
    s_and_b32 s14, s11, 3
    s_cbranch_scc0 L_npqQ0_3
    s_cmp_eq_u32 s14, 1
    s_cselect_b32 exec_lo, -1, 0
    s_cselect_b32 exec_hi, 0, -1
    buffer_store_dwordx2 v[38:39], v2, s[32:35], s56 offen offset:256 sc1
    buffer_store_dwordx2 v[38:39], v2, s[32:35], s56 offen offset:2304 sc1
    s_mov_b64 exec, -1
L_npqQ0_3:
    ds_read_b128 v[64:67], v37 offset:1664
    ds_read_b128 v[68:71], v37 offset:1696
    ds_read_b128 v[72:75], v37 offset:1728
    ds_read_b128 v[76:79], v37 offset:1760
    s_waitcnt lgkmcnt(0)
    s_add_u32 s54, s60, s41
    s_mov_b32 s55, 1
    s_mul_i32 s57, s54, 37
    s_lshr_b32 s57, s57, 8
    s_mul_i32 s14, s57, 7
    s_sub_u32 s14, s54, s14
    s_lshl_b32 s14, s14, 1
    s_add_u32 s14, s14, s55
    s_lshl_b32 s14, s14, 5
    s_getpc_b64 s[12:13]
L_tpqQ1:
    s_add_u32 s14, s14, L_tab-L_tpqQ1
    s_load_dwordx8 s[4:11], s[12:13], s14
    s_lshl_b32 s56, s57, 21
    s_lshl_b32 s54, s36, 1
    s_add_u32 s54, s54, s40
    s_lshl_b32 s54, s54, 12
    s_add_u32 s56, s56, s54
    s_cmp_eq_u32 s57, 0
    s_cselect_b32 s61, 0x3e8b97f6, 1.0
    s_cselect_b32 s14, 0, 0x3f80
    s_cmp_eq_u32 s57, 1
    s_cselect_b32 s14, 0x3f803f80, s14
    s_cselect_b32 s15, 0x3f80, 0
    v_mov_b32 v38, s14
    v_mov_b32 v39, s15
    v_mul_f32 v82, s61, v85
    v_fma_f32 v112, -v80, v64, v112
    v_fma_f32 v113, -v80, v65, v113
    v_fma_f32 v114, -v80, v66, v114
    v_fma_f32 v115, -v80, v67, v115
    v_fma_f32 v116, -v80, v68, v116
    v_fma_f32 v117, -v80, v69, v117
    v_fma_f32 v118, -v80, v70, v118
    v_fma_f32 v119, -v80, v71, v119
    v_fma_f32 v120, -v80, v72, v120
    v_fma_f32 v121, -v80, v73, v121
    v_fma_f32 v122, -v80, v74, v122
    s_barrier
    v_fma_f32 v123, -v80, v75, v123
    v_fma_f32 v124, -v80, v76, v124
    v_fma_f32 v125, -v80, v77, v125
    v_fma_f32 v126, -v80, v78, v126
    v_fma_f32 v127, -v80, v79, v127
    v_mul_f32 v112, v112, v82
    v_mul_f32 v113, v113, v82
    v_mul_f32 v114, v114, v82
    v_mul_f32 v115, v115, v82
    v_mul_f32 v116, v116, v82
    v_mul_f32 v117, v117, v82
    v_mul_f32 v118, v118, v82
    v_mul_f32 v119, v119, v82
    v_mul_f32 v120, v120, v82
    v_mul_f32 v121, v121, v82
    v_mul_f32 v122, v122, v82
    v_mul_f32 v123, v123, v82
    v_mul_f32 v124, v124, v82
    v_mul_f32 v125, v125, v82
    v_mul_f32 v126, v126, v82
    v_mul_f32 v127, v127, v82
    v_cvt_pk_bf16_f32 v48, v112, v113
    v_cvt_pk_bf16_f32 v49, v114, v115
    v_cvt_pk_bf16_f32 v50, v116, v117
    v_cvt_pk_bf16_f32 v51, v118, v119
    v_cvt_pk_bf16_f32 v52, v120, v121
    v_cvt_pk_bf16_f32 v53, v122, v123
    v_cvt_pk_bf16_f32 v54, v124, v125
    v_cvt_pk_bf16_f32 v55, v126, v127
    v_mul_f32 v88, s61, v91
    v_fma_f32 v144, -v86, v64, v144
    v_fma_f32 v145, -v86, v65, v145
    v_fma_f32 v146, -v86, v66, v146
    v_fma_f32 v147, -v86, v67, v147
    v_fma_f32 v148, -v86, v68, v148
    v_fma_f32 v149, -v86, v69, v149
    s_barrier
    v_fma_f32 v150, -v86, v70, v150
    v_fma_f32 v151, -v86, v71, v151
    v_fma_f32 v152, -v86, v72, v152
    v_fma_f32 v153, -v86, v73, v153
    v_fma_f32 v154, -v86, v74, v154
    v_fma_f32 v155, -v86, v75, v155
    v_fma_f32 v156, -v86, v76, v156
    v_fma_f32 v157, -v86, v77, v157
    v_fma_f32 v158, -v86, v78, v158
    v_fma_f32 v159, -v86, v79, v159
    v_mul_f32 v144, v144, v88
    v_mul_f32 v145, v145, v88
    v_mul_f32 v146, v146, v88
    v_mul_f32 v147, v147, v88
    v_mul_f32 v148, v148, v88
    v_mul_f32 v149, v149, v88
    v_mul_f32 v150, v150, v88
    v_mul_f32 v151, v151, v88
    v_mul_f32 v152, v152, v88
    v_mul_f32 v153, v153, v88
    v_mul_f32 v154, v154, v88
    v_mul_f32 v155, v155, v88
    v_mul_f32 v156, v156, v88
    v_mul_f32 v157, v157, v88
    v_mul_f32 v158, v158, v88
    v_mul_f32 v159, v159, v88
    v_cvt_pk_bf16_f32 v56, v144, v145
    v_cvt_pk_bf16_f32 v57, v146, v147
    v_cvt_pk_bf16_f32 v58, v148, v149
    v_cvt_pk_bf16_f32 v59, v150, v151
    v_cvt_pk_bf16_f32 v60, v152, v153
    v_cvt_pk_bf16_f32 v61, v154, v155
    v_cvt_pk_bf16_f32 v62, v156, v157
    v_cvt_pk_bf16_f32 v63, v158, v159
    s_waitcnt lgkmcnt(0)
    s_barrier
    s_and_b32 s14, s5, -8
    v_mul_i32_i24 v1, s14, v29
    v_add3_u32 v2, v1, s4, v28
    buffer_store_dwordx2 v[48:49], v2, s[32:35], s56 offen offset:0 sc1
    buffer_store_dwordx2 v[56:57], v2, s[32:35], s56 offen offset:2048 sc1
    s_and_b32 s14, s5, 3
    s_cbranch_scc0 L_npqQ1_0
    s_cmp_eq_u32 s14, 1
    s_cselect_b32 exec_lo, -1, 0
    s_cselect_b32 exec_hi, 0, -1
    buffer_store_dwordx2 v[38:39], v2, s[32:35], s56 offen offset:256 sc1
    buffer_store_dwordx2 v[38:39], v2, s[32:35], s56 offen offset:2304 sc1
    s_mov_b64 exec, -1
L_npqQ1_0:
    s_and_b32 s14, s7, -8
    v_mul_i32_i24 v1, s14, v29
    v_add3_u32 v2, v1, s6, v28
    buffer_store_dwordx2 v[50:51], v2, s[32:35], s56 offen offset:0 sc1
    buffer_store_dwordx2 v[58:59], v2, s[32:35], s56 offen offset:2048 sc1
    s_and_b32 s14, s7, 3
    s_cbranch_scc0 L_npqQ1_1
    s_cmp_eq_u32 s14, 1
    s_cselect_b32 exec_lo, -1, 0
    s_cselect_b32 exec_hi, 0, -1
    buffer_store_dwordx2 v[38:39], v2, s[32:35], s56 offen offset:256 sc1
    buffer_store_dwordx2 v[38:39], v2, s[32:35], s56 offen offset:2304 sc1
    s_mov_b64 exec, -1
L_npqQ1_1:
    s_and_b32 s14, s9, -8
    v_mul_i32_i24 v1, s14, v29
    v_add3_u32 v2, v1, s8, v28
    buffer_store_dwordx2 v[52:53], v2, s[32:35], s56 offen offset:0 sc1
    buffer_store_dwordx2 v[60:61], v2, s[32:35], s56 offen offset:2048 sc1
    s_and_b32 s14, s9, 3
    s_cbranch_scc0 L_npqQ1_2
    s_cmp_eq_u32 s14, 1
    s_cselect_b32 exec_lo, -1, 0
    s_cselect_b32 exec_hi, 0, -1
    buffer_store_dwordx2 v[38:39], v2, s[32:35], s56 offen offset:256 sc1
    buffer_store_dwordx2 v[38:39], v2, s[32:35], s56 offen offset:2304 sc1
    s_mov_b64 exec, -1
L_npqQ1_2:
    s_and_b32 s14, s11, -8
    v_mul_i32_i24 v1, s14, v29
    v_add3_u32 v2, v1, s10, v28
    buffer_store_dwordx2 v[54:55], v2, s[32:35], s56 offen offset:0 sc1
    buffer_store_dwordx2 v[62:63], v2, s[32:35], s56 offen offset:2048 sc1
    s_and_b32 s14, s11, 3
    s_cbranch_scc0 L_npqQ1_3
    s_cmp_eq_u32 s14, 1
    s_cselect_b32 exec_lo, -1, 0
    s_cselect_b32 exec_hi, 0, -1
    buffer_store_dwordx2 v[38:39], v2, s[32:35], s56 offen offset:256 sc1
    buffer_store_dwordx2 v[38:39], v2, s[32:35], s56 offen offset:2304 sc1
    s_mov_b64 exec, -1
L_npqQ1_3:
    s_barrier
    s_barrier
    s_barrier
    s_barrier
    s_add_u32 s14, s60, 0
    s_add_u32 s14, s14, s41
    s_lshl_b32 s14, s14, 4
    s_add_u32 s14, s14, s36
    s_lshl_b32 s14, s14, 2
    s_add_u32 s14, s14, s40
    s_lshl_b32 s14, s14, 2
    s_add_u32 s14, s14, 16781312
    s_waitcnt vmcnt(0)
    v_mov_b32 v1, s49
    v_mov_b32 v2, 0
    s_mov_b64 exec, 1
    buffer_store_dword v1, v2, s[32:35], s14 offen offset:0 sc1
    buffer_store_dword v1, v2, s[32:35], s14 offen offset:8 sc1
    s_mov_b64 exec, -1
    s_barrier
    s_barrier
    v_lshlrev_b32 v13, 7, v0
    s_and_b32 s14, s37, 3
    s_lshl_b32 s14, s14, 4
    s_add_u32 s14, s14, s36
    s_lshl_b32 s14, s14, 2
    s_add_u32 s14, s14, s39
    s_sub_u32 s15, s14, 196
    s_cmp_lt_u32 s14, 196
    s_cselect_b32 s14, s14, s15
    s_cselect_b32 s16, s64, s70
    s_cselect_b32 s17, s65, s71
    s_mov_b32 s15, 401408
    s_cselect_b32 s18, 1605632, s15
    s_mov_b32 s19, 0x00020000
    s_lshl_b32 s14, s14, 13
    buffer_load_dword v14, v13, s[16:19], s14 offen
    s_barrier
    s_branch L_P2poll
L_H1P:
    s_mov_b32 s60, s37
    s_lshl_b32 s101, s37, 1
    s_lshl_b32 s14, s60, 7
    s_mul_i32 s15, s39, 21504
    s_add_u32 s43, s14, s15
    s_add_u32 s44, s43, s15
    v_add_u32 v23, 20480, v22
    v_xor_b32 v7, 32, v5
    v_add3_u32 v45, v6, v7, 64
    v_add_u32 v45, 64, v45
    s_add_u32 m0, s46, 0
    s_add_u32 s52, s43, 0
    buffer_load_dwordx4 v22, s[20:23], s52 offen lds
    s_add_u32 m0, s46, 4096
    s_nop 0
    buffer_load_dwordx4 v45, s[20:23], s52 offen lds
    s_add_u32 m0, s46, 8192
    s_add_u32 s52, s43, 86016
    buffer_load_dwordx4 v22, s[20:23], s52 offen lds
    s_add_u32 m0, s46, 12288
    s_nop 0
    buffer_load_dwordx4 v45, s[20:23], s52 offen lds
    s_add_u32 m0, s48, 16384
    s_add_u32 s52, s45, 128
    buffer_load_dwordx4 v16, s[16:19], s52 offen offset:0 lds
    buffer_load_dwordx4 v17, s[16:19], s52 offen offset:1024 lds
    buffer_load_dwordx4 v18, s[16:19], s52 offen offset:2048 lds
    buffer_load_dwordx4 v19, s[16:19], s52 offen offset:3072 lds
    s_mov_b32 s24, s8
    s_mov_b32 s25, s9
    s_mov_b32 s26, 1605632
    s_mov_b32 s27, 0x00020000
    s_mov_b32 s28, s10
    s_mov_b32 s29, s11
    s_mov_b32 s30, 1605632
    s_mov_b32 s31, 0x00020000
    v_mul_u32_u24 v6, 3584, v2
    v_add_u32 v20, v6, v5
    v_add_u32 v21, v6, v7
    s_lshl_b32 s42, s101, 7
    s_mul_i32 s15, s39, 28672
    s_add_u32 s42, s42, s15
    v_add_u32 v26, 6144, v25
    v_lshlrev_b32 v24, 4, v0
    s_mov_b32 s32, s68
    s_mov_b32 s33, s69
    s_mov_b32 s34, 20971520
    s_mov_b32 s35, 0x00020000
    s_mov_b32 s3, 16777216
    s_load_dword s49, s[68:69], s3
    s_waitcnt lgkmcnt(0)
    s_add_u32 s49, s49, 0x9e3779b9
    s_and_b32 s3, s2, 7
    s_and_b32 s14, s78, 1
    s_lshl_b32 s74, s3, 1
    s_add_u32 s74, s74, s14
    s_lshr_b32 s75, s78, 1
    s_mul_i32 s14, s3, 29
    s_sub_u32 s15, s3, 4
    s_max_i32 s15, s15, 0
    s_add_u32 s14, s14, s15
    s_cmp_eq_u32 s3, 7
    s_cselect_b32 s14, 200, s14
    s_cmp_lt_u32 s3, 4
    s_cselect_b32 s15, 29, 30
    s_cmp_lt_u32 s3, 6
    s_cselect_b32 s15, s15, 24
    s_add_u32 s14, s14, s78
    s_mul_i32 s76, s14, 9363
    s_lshr_b32 s76, s76, 16
    s_mul_i32 s77, s76, 7
    s_sub_u32 s77, s14, s77
    s_cmp_ge_u32 s78, s15
    s_cselect_b32 s76, 32, s76
    s_mul_i32 s14, s74, 28
    s_lshr_b32 s15, s14, 6
    s_add_u32 s14, s14, 27
    s_lshr_b32 s14, s14, 6
    s_sub_u32 s14, s14, s15
    s_lshl_b32 s14, s14, 8
    s_lshl_b32 s15, s15, 8
    s_mov_b32 s58, 16781312
    v_bfe_u32 v1, v0, 4, 1
    v_mul_u32_u24 v1, s14, v1
    v_lshrrev_b32 v2, 5, v0
    v_mul_u32_u24 v3, 1792, v2
    v_add3_u32 v1, v1, v3, s15
    v_and_b32 v3, 15, v0
    v_lshl_add_u32 v1, v3, 4, v1
    v_add_u32 v36, 1792, v1
    v_and_b32 v1, 1, v0
    v_mul_u32_u24 v1, s14, v1
    s_lshl_b32 s13, s75, 4
    s_add_u32 s15, s15, s13
    v_add_u32 v39, s15, v1
    v_and_b32 v3, 31, v0
    v_min_u32 v3, 27, v3
    v_lshlrev_b32 v4, 2, v3
    v_lshl_add_u32 v4, v2, 12, v4
    s_lshl_b32 s13, s76, 7
    s_add_u32 s13, s13, 8192
    v_add_u32 v37, s13, v4
    v_mov_b32 v38, 158720
    v_mov_b32 v1, 0
    ds_write_b32 v38, v1
    s_mov_b32 s79, 0
    s_waitcnt lgkmcnt(0)
    s_waitcnt vmcnt(6)
    s_barrier
    s_add_u32 m0, s46, 16384
    s_add_u32 s52, s43, 172032
    buffer_load_dwordx4 v22, s[20:23], s52 offen lds
    s_add_u32 m0, s46, 20480
    s_nop 0
    buffer_load_dwordx4 v45, s[20:23], s52 offen lds
    s_add_u32 m0, s48, 32768
    s_add_u32 s52, s45, 256
    buffer_load_dwordx4 v16, s[16:19], s52 offen offset:0 lds
    buffer_load_dwordx4 v17, s[16:19], s52 offen offset:1024 lds
    buffer_load_dwordx4 v18, s[16:19], s52 offen offset:2048 lds
    buffer_load_dwordx4 v19, s[16:19], s52 offen offset:3072 lds
    s_add_u32 m0, s46, 24576
    s_add_u32 s52, s43, 258048
    buffer_load_dwordx4 v22, s[20:23], s52 offen lds
    s_add_u32 m0, s46, 28672
    s_nop 0
    buffer_load_dwordx4 v45, s[20:23], s52 offen lds
    s_add_u32 m0, s48, 49152
    s_add_u32 s52, s45, 384
    buffer_load_dwordx4 v16, s[16:19], s52 offen offset:0 lds
    buffer_load_dwordx4 v17, s[16:19], s52 offen offset:1024 lds
    buffer_load_dwordx4 v18, s[16:19], s52 offen offset:2048 lds
    buffer_load_dwordx4 v19, s[16:19], s52 offen offset:3072 lds
    s_waitcnt vmcnt(16)
    s_barrier
    s_add_u32 m0, s46, 32768
    s_add_u32 s52, s43, 344064
    buffer_load_dwordx4 v22, s[20:23], s52 offen lds
    s_add_u32 m0, s46, 36864
    s_nop 0
    buffer_load_dwordx4 v45, s[20:23], s52 offen lds
    s_add_u32 m0, s48, 65536
    s_add_u32 s52, s45, 512
    buffer_load_dwordx4 v16, s[16:19], s52 offen offset:0 lds
    buffer_load_dwordx4 v17, s[16:19], s52 offen offset:1024 lds
    buffer_load_dwordx4 v18, s[16:19], s52 offen offset:2048 lds
    buffer_load_dwordx4 v19, s[16:19], s52 offen offset:3072 lds
    s_waitcnt vmcnt(16)
    s_barrier
    s_add_u32 m0, s46, 0
    s_add_u32 s52, s43, 430080
    buffer_load_dwordx4 v22, s[20:23], s52 offen lds
    s_add_u32 m0, s46, 4096
    s_nop 0
    buffer_load_dwordx4 v45, s[20:23], s52 offen lds
    s_add_u32 m0, s48, 81920
    s_add_u32 s52, s45, 640
    buffer_load_dwordx4 v16, s[16:19], s52 offen offset:0 lds
    buffer_load_dwordx4 v17, s[16:19], s52 offen offset:1024 lds
    buffer_load_dwordx4 v18, s[16:19], s52 offen offset:2048 lds
    buffer_load_dwordx4 v19, s[16:19], s52 offen offset:3072 lds
    s_waitcnt vmcnt(16)
    s_barrier
    s_add_u32 m0, s46, 8192
    s_add_u32 s52, s43, 516096
    buffer_load_dwordx4 v22, s[20:23], s52 offen lds
    s_add_u32 m0, s46, 12288
    s_nop 0
    buffer_load_dwordx4 v45, s[20:23], s52 offen lds
    s_add_u32 m0, s48, 98304
    s_add_u32 s52, s45, 768
    buffer_load_dwordx4 v16, s[16:19], s52 offen offset:0 lds
    buffer_load_dwordx4 v17, s[16:19], s52 offen offset:1024 lds
    buffer_load_dwordx4 v18, s[16:19], s52 offen offset:2048 lds
    buffer_load_dwordx4 v19, s[16:19], s52 offen offset:3072 lds
    s_waitcnt vmcnt(16)
    s_barrier
    s_add_u32 m0, s46, 16384
    s_add_u32 s52, s43, 602112
    buffer_load_dwordx4 v22, s[20:23], s52 offen lds
    s_add_u32 m0, s46, 20480
    s_nop 0
    buffer_load_dwordx4 v45, s[20:23], s52 offen lds
    s_waitcnt vmcnt(12)
    s_barrier
    s_add_u32 m0, s46, 24576
    s_add_u32 s52, s43, 688128
    buffer_load_dwordx4 v22, s[20:23], s52 offen lds
    s_add_u32 m0, s46, 28672
    s_nop 0
    buffer_load_dwordx4 v45, s[20:23], s52 offen lds
    s_waitcnt vmcnt(8)
    s_barrier
    s_add_u32 m0, s46, 32768
    s_add_u32 s52, s43, 774144
    buffer_load_dwordx4 v22, s[20:23], s52 offen lds
    s_add_u32 m0, s46, 36864
    s_nop 0
    buffer_load_dwordx4 v45, s[20:23], s52 offen lds
    s_waitcnt vmcnt(4)
    s_barrier
    s_add_u32 m0, s46, 0
    s_add_u32 s52, s43, 860160
    buffer_load_dwordx4 v22, s[20:23], s52 offen lds
    s_add_u32 m0, s46, 4096
    s_nop 0
    buffer_load_dwordx4 v45, s[20:23], s52 offen lds
    s_waitcnt vmcnt(4)
    s_barrier
    s_add_u32 m0, s46, 8192
    s_add_u32 s52, s43, 946176
    buffer_load_dwordx4 v22, s[20:23], s52 offen lds
    s_add_u32 m0, s46, 12288
    s_nop 0
    buffer_load_dwordx4 v45, s[20:23], s52 offen lds
    s_waitcnt vmcnt(4)
    s_barrier
    s_add_u32 m0, s46, 16384
    s_add_u32 s52, s43, 1032192
    buffer_load_dwordx4 v22, s[20:23], s52 offen lds
    s_add_u32 m0, s46, 20480
    s_nop 0
    buffer_load_dwordx4 v45, s[20:23], s52 offen lds
    s_waitcnt vmcnt(4)
    s_barrier
    s_add_u32 m0, s46, 24576
    s_add_u32 s52, s43, 1118208
    buffer_load_dwordx4 v22, s[20:23], s52 offen lds
    s_add_u32 m0, s46, 28672
    s_nop 0
    buffer_load_dwordx4 v45, s[20:23], s52 offen lds
    s_waitcnt vmcnt(4)
    s_barrier
    s_add_u32 m0, s46, 32768
    s_add_u32 s52, s42, 0
    buffer_load_dwordx4 v20, s[24:27], s52 offen lds
    s_add_u32 m0, s46, 36864
    s_nop 0
    buffer_load_dwordx4 v21, s[28:31], s52 offen lds
    s_waitcnt vmcnt(4)
    s_barrier
    s_add_u32 m0, s46, 0
    s_add_u32 s52, s42, 114688
    buffer_load_dwordx4 v20, s[24:27], s52 offen lds
    s_add_u32 m0, s46, 4096
    s_nop 0
    buffer_load_dwordx4 v21, s[28:31], s52 offen lds
    s_waitcnt vmcnt(4)
    s_barrier
    s_add_u32 m0, s46, 8192
    s_add_u32 s52, s42, 229376
    buffer_load_dwordx4 v20, s[24:27], s52 offen lds
    s_add_u32 m0, s46, 12288
    s_nop 0
    buffer_load_dwordx4 v21, s[28:31], s52 offen lds
    s_waitcnt vmcnt(4)
    s_barrier
    s_add_u32 m0, s46, 16384
    s_add_u32 s52, s42, 344064
    buffer_load_dwordx4 v20, s[24:27], s52 offen lds
    s_add_u32 m0, s46, 20480
    s_nop 0
    buffer_load_dwordx4 v21, s[28:31], s52 offen lds
    s_waitcnt vmcnt(4)
    s_barrier
    s_add_u32 m0, s46, 24576
    s_add_u32 s52, s42, 458752
    buffer_load_dwordx4 v20, s[24:27], s52 offen lds
    s_add_u32 m0, s46, 28672
    s_nop 0
    buffer_load_dwordx4 v21, s[28:31], s52 offen lds
    s_waitcnt vmcnt(4)
    s_barrier
    s_add_u32 m0, s46, 32768
    s_add_u32 s52, s42, 573440
    buffer_load_dwordx4 v20, s[24:27], s52 offen lds
    s_add_u32 m0, s46, 36864
    s_nop 0
    buffer_load_dwordx4 v21, s[28:31], s52 offen lds
    s_waitcnt vmcnt(4)
    s_barrier
    s_add_u32 m0, s46, 0
    s_add_u32 s52, s42, 688128
    buffer_load_dwordx4 v20, s[24:27], s52 offen lds
    s_add_u32 m0, s46, 4096
    s_nop 0
    buffer_load_dwordx4 v21, s[28:31], s52 offen lds
    s_waitcnt vmcnt(4)
    s_barrier
    s_add_u32 m0, s46, 8192
    s_add_u32 s52, s42, 802816
    buffer_load_dwordx4 v20, s[24:27], s52 offen lds
    s_add_u32 m0, s46, 12288
    s_nop 0
    buffer_load_dwordx4 v21, s[28:31], s52 offen lds
    s_waitcnt vmcnt(4)
    s_barrier
    s_add_u32 m0, s46, 16384
    s_add_u32 s52, s42, 917504
    buffer_load_dwordx4 v20, s[24:27], s52 offen lds
    s_add_u32 m0, s46, 20480
    s_nop 0
    buffer_load_dwordx4 v21, s[28:31], s52 offen lds
    s_waitcnt vmcnt(4)
    s_barrier
    s_add_u32 m0, s46, 24576
    s_add_u32 s52, s42, 1032192
    buffer_load_dwordx4 v20, s[24:27], s52 offen lds
    s_add_u32 m0, s46, 28672
    s_nop 0
    buffer_load_dwordx4 v21, s[28:31], s52 offen lds
    s_waitcnt vmcnt(4)
    s_barrier
    s_add_u32 m0, s46, 32768
    s_add_u32 s52, s42, 1146880
    buffer_load_dwordx4 v20, s[24:27], s52 offen lds
    s_add_u32 m0, s46, 36864
    s_nop 0
    buffer_load_dwordx4 v21, s[28:31], s52 offen lds
    s_waitcnt vmcnt(4)
    s_barrier
    s_add_u32 m0, s46, 0
    s_add_u32 s52, s42, 1261568
    buffer_load_dwordx4 v20, s[24:27], s52 offen lds
    s_add_u32 m0, s46, 4096
    s_nop 0
    buffer_load_dwordx4 v21, s[28:31], s52 offen lds
    s_waitcnt vmcnt(4)
    s_barrier
    s_add_u32 m0, s46, 8192
    s_add_u32 s52, s42, 1376256
    buffer_load_dwordx4 v20, s[24:27], s52 offen lds
    s_add_u32 m0, s46, 12288
    s_nop 0
    buffer_load_dwordx4 v21, s[28:31], s52 offen lds
    s_waitcnt vmcnt(4)
    s_barrier
    s_add_u32 m0, s46, 16384
    s_add_u32 s52, s42, 1490944
    buffer_load_dwordx4 v20, s[24:27], s52 offen lds
    s_add_u32 m0, s46, 20480
    s_nop 0
    buffer_load_dwordx4 v21, s[28:31], s52 offen lds
    s_waitcnt vmcnt(4)
    s_barrier
    s_add_u32 m0, s46, 24576
    s_add_u32 s52, s42, 128
    buffer_load_dwordx4 v20, s[24:27], s52 offen lds
    s_add_u32 m0, s46, 28672
    s_nop 0
    buffer_load_dwordx4 v21, s[28:31], s52 offen lds
    s_waitcnt vmcnt(4)
    s_barrier
    s_add_u32 m0, s46, 32768
    s_add_u32 s52, s42, 114816
    buffer_load_dwordx4 v20, s[24:27], s52 offen lds
    s_add_u32 m0, s46, 36864
    s_nop 0
    buffer_load_dwordx4 v21, s[28:31], s52 offen lds
    s_waitcnt vmcnt(4)
    s_barrier
    s_add_u32 m0, s46, 0
    s_add_u32 s52, s42, 229504
    buffer_load_dwordx4 v20, s[24:27], s52 offen lds
    s_add_u32 m0, s46, 4096
    s_nop 0
    buffer_load_dwordx4 v21, s[28:31], s52 offen lds
    s_waitcnt vmcnt(4)
    s_barrier
    s_add_u32 m0, s46, 8192
    s_add_u32 s52, s42, 344192
    buffer_load_dwordx4 v20, s[24:27], s52 offen lds
    s_add_u32 m0, s46, 12288
    s_nop 0
    buffer_load_dwordx4 v21, s[28:31], s52 offen lds
    s_waitcnt vmcnt(4)
    s_barrier
    s_add_u32 m0, s46, 16384
    s_add_u32 s52, s42, 458880
    buffer_load_dwordx4 v20, s[24:27], s52 offen lds
    s_add_u32 m0, s46, 20480
    s_nop 0
    buffer_load_dwordx4 v21, s[28:31], s52 offen lds
    s_waitcnt vmcnt(4)
    s_barrier
    s_add_u32 m0, s46, 24576
    s_add_u32 s52, s42, 573568
    buffer_load_dwordx4 v20, s[24:27], s52 offen lds
    s_add_u32 m0, s46, 28672
    s_nop 0
    buffer_load_dwordx4 v21, s[28:31], s52 offen lds
    s_waitcnt vmcnt(4)
    s_barrier
    s_add_u32 m0, s46, 32768
    s_add_u32 s52, s42, 688256
    buffer_load_dwordx4 v20, s[24:27], s52 offen lds
    s_add_u32 m0, s46, 36864
    s_nop 0
    buffer_load_dwordx4 v21, s[28:31], s52 offen lds
    s_waitcnt vmcnt(4)
    s_barrier
    s_add_u32 m0, s46, 0
    s_add_u32 s52, s42, 802944
    buffer_load_dwordx4 v20, s[24:27], s52 offen lds
    s_add_u32 m0, s46, 4096
    s_nop 0
    buffer_load_dwordx4 v21, s[28:31], s52 offen lds
    s_waitcnt vmcnt(4)
    s_barrier
    s_add_u32 m0, s46, 8192
    s_add_u32 s52, s42, 917632
    buffer_load_dwordx4 v20, s[24:27], s52 offen lds
    s_add_u32 m0, s46, 12288
    s_nop 0
    buffer_load_dwordx4 v21, s[28:31], s52 offen lds
    s_waitcnt vmcnt(4)
    s_barrier
    s_add_u32 m0, s46, 16384
    s_add_u32 s52, s42, 1032320
    buffer_load_dwordx4 v20, s[24:27], s52 offen lds
    s_add_u32 m0, s46, 20480
    s_nop 0
    buffer_load_dwordx4 v21, s[28:31], s52 offen lds
    s_waitcnt vmcnt(4)
    s_barrier
    s_add_u32 m0, s46, 24576
    s_add_u32 s52, s42, 1147008
    buffer_load_dwordx4 v20, s[24:27], s52 offen lds
    s_add_u32 m0, s46, 28672
    s_nop 0
    buffer_load_dwordx4 v21, s[28:31], s52 offen lds
    s_waitcnt vmcnt(4)
    s_barrier
    s_add_u32 m0, s46, 32768
    s_add_u32 s52, s42, 1261696
    buffer_load_dwordx4 v20, s[24:27], s52 offen lds
    s_add_u32 m0, s46, 36864
    s_nop 0
    buffer_load_dwordx4 v21, s[28:31], s52 offen lds
    s_waitcnt vmcnt(4)
    s_barrier
    s_add_u32 m0, s46, 0
    s_add_u32 s52, s42, 1376384
    buffer_load_dwordx4 v20, s[24:27], s52 offen lds
    s_add_u32 m0, s46, 4096
    s_nop 0
    buffer_load_dwordx4 v21, s[28:31], s52 offen lds
    s_waitcnt vmcnt(4)
    s_barrier
    s_add_u32 m0, s46, 8192
    s_add_u32 s52, s42, 1491072
    buffer_load_dwordx4 v20, s[24:27], s52 offen lds
    s_add_u32 m0, s46, 12288
    s_nop 0
    buffer_load_dwordx4 v21, s[28:31], s52 offen lds
    s_waitcnt vmcnt(4)
    s_barrier
    s_cmp_lg_u32 s39, 0
    s_cbranch_scc1 L_HP_e1
    buffer_load_dwordx4 v[40:43], v36, s[32:35], s58 offen sc1
    buffer_load_dwordx4 v[112:115], v39, s[32:35], s58 offen sc1
L_HP_e1:
    s_waitcnt vmcnt(2)
    s_barrier
    s_waitcnt vmcnt(0)
    s_barrier
    s_cmp_lg_u32 s39, 0
    s_cbranch_scc1 L_HP_e2
    s_waitcnt vmcnt(0)
    v_cmp_ne_u32 vcc, s49, v40
    v_cmp_ne_u32 s[54:55], s49, v41
    s_or_b64 vcc, vcc, s[54:55]
    v_cmp_ne_u32 s[54:55], s49, v42
    s_or_b64 vcc, vcc, s[54:55]
    v_cmp_ne_u32 s[54:55], s49, v43
    s_or_b64 vcc, vcc, s[54:55]
    v_cmp_ne_u32 s[54:55], s49, v112
    s_or_b64 vcc, vcc, s[54:55]
    v_cmp_ne_u32 s[54:55], s49, v113
    s_or_b64 vcc, vcc, s[54:55]
    v_cmp_ne_u32 s[54:55], s49, v114
    s_or_b64 vcc, vcc, s[54:55]
    v_cmp_ne_u32 s[54:55], s49, v115
    s_or_b64 vcc, vcc, s[54:55]
    s_cbranch_vccnz L_HP_e2
    v_mov_b32 v1, s49
    ds_write_b32 v38, v1
    s_mov_b32 s79, 1
    s_waitcnt lgkmcnt(0)
L_HP_e2:
    s_barrier
    s_branch L_H2
L_BP:
    v_and_b32 v7, 31, v0
    v_lshrrev_b32 v8, 5, v0
    v_mul_u32_u24 v9, 896, v8
    v_lshl_add_u32 v9, v7, 4, v9
    s_lshl_b32 s14, s36, 4
    s_add_u32 s14, s14, s37
    s_lshl_b32 s14, s14, 2
    s_add_u32 s14, s14, s39
    s_lshl_b32 s45, s14, 1
    s_mul_i32 s14, s45, 896
    v_mov_b32 v52, 0
    v_mov_b32 v53, 0
    v_mov_b32 v54, 0
    v_mov_b32 v55, 0
    s_mov_b32 s16, s4
    s_mov_b32 s17, s5
    s_mov_b32 s18, 1835008
    s_mov_b32 s19, 0x00020000
    buffer_load_dwordx4 v[48:51], v9, s[16:19], s14 offen
    s_mov_b32 exec_lo, 0x00ffffff
    s_mov_b32 exec_hi, 0x00ffffff
    buffer_load_dwordx4 v[52:55], v9, s[16:19], s14 offen offset:512
    s_mov_b64 exec, -1
    s_getpc_b64 s[12:13]
L_pcP:
    s_sub_u32 s12, s12, L_pcP-recurrent_scan__mha_block__geglu_ffn__prompt_kernel
    s_subb_u32 s13, s13, 0
    s_lshl_b32 s14, s78, 12
    v_lshl_add_u32 v10, v7, 7, s14
    v_min_u32 v10, L_tabend-recurrent_scan__mha_block__geglu_ffn__prompt_kernel-4, v10
    global_load_dword v39, v10, s[12:13]
    s_mov_b32 s60, s37
    s_lshl_b32 s101, s37, 1
    s_and_b32 s42, s36, 7
    s_cmp_ge_u32 s42, 6
    s_cselect_b32 s46, 5, 0
    s_lshr_b32 s14, s42, 1
    s_lshl_b32 s14, s14, 7
    s_lshl_b32 s15, s101, 7
    s_add_u32 s14, s14, s15
    s_add_u32 s15, s60, s42
    s_sub_u32 s15, s15, 4
    s_lshl_b32 s15, s15, 7
    s_bitcmp1_b32 s42, 0
    s_cselect_b32 s8, s10, s8
    s_cselect_b32 s9, s11, s9
    s_cmp_ge_u32 s42, 4
    s_cselect_b32 s43, s15, s14
    s_cselect_b32 s8, s6, s8
    s_cselect_b32 s9, s7, s9
    s_mov_b32 s14, 3584
    s_cselect_b32 s44, 2688, s14
    s_mov_b32 s14, 1605632
    s_cselect_b32 s14, 1204224, s14
    s_mov_b32 s24, s8
    s_mov_b32 s25, s9
    s_mov_b32 s26, s14
    s_mov_b32 s27, 0x00020000
    v_lshrrev_b32 v12, 3, v0
    v_mul_lo_u32 v12, v12, s44
    v_and_b32 v13, 7, v0
    v_lshl_add_u32 v12, v13, 4, v12
    s_mul_i32 s14, s39, 112
    s_mul_i32 s14, s14, s44
    s_add_u32 s43, s43, s14
    s_lshl_b32 s44, s44, 3
    v_mov_b32 v38, v12
    s_and_b32 s40, s38, 1
    s_lshr_b32 s41, s39, 1
    s_mov_b32 s50, 0
    s_mov_b32 s51, -1
    v_and_b32 v7, 31, v0
    v_lshrrev_b32 v8, 5, v0
    v_bfe_u32 v9, v0, 1, 3
    v_xor_b32 v9, v9, v8
    v_lshlrev_b32 v9, 4, v9
    v_lshl_add_u32 v9, v7, 7, v9
    s_lshl_b32 s15, s40, 13
    v_add_u32 v16, s15, v9
    v_xor_b32 v17, 32, v16
    v_xor_b32 v18, 64, v16
    v_xor_b32 v19, 96, v16
    v_add_u32 v20, 0x10000, v16
    v_add_u32 v21, 0x10000, v17
    v_add_u32 v22, 0x10000, v18
    v_add_u32 v23, 0x10000, v19
    v_bfe_u32 v10, v0, 2, 2
    v_and_b32 v11, 3, v0
    v_bfe_u32 v12, v0, 4, 1
    v_bfe_u32 v13, v0, 3, 1
    v_lshlrev_b32 v13, 2, v13
    v_lshlrev_b32 v14, 10, v8
    v_lshl_add_u32 v14, v10, 7, v14
    v_add_u32 v14, 114688, v14
    v_lshl_add_u32 v2, v12, 2, v11
    s_lshl_b32 s15, s41, 3
    v_add_u32 v3, s15, v2
    v_lshrrev_b32 v1, 1, v3
    v_xor_b32 v1, v1, v13
    v_lshl_add_u32 v1, v1, 4, v14
    v_and_b32 v15, 1, v3
    v_lshl_add_u32 v26, v15, 3, v1
    v_add_u32 v4, 8, v2
    s_lshl_b32 s14, s41, 1
    s_lshl_b32 s15, s41, 12
    v_lshrrev_b32 v1, 1, v2
    v_xor_b32 v1, v1, v13
    v_xor_b32 v1, s14, v1
    v_lshl_add_u32 v1, v1, 4, v14
    v_and_b32 v15, 1, v2
    v_lshl_add_u32 v24, v15, 3, v1
    v_add_u32 v24, s15, v24
    v_lshrrev_b32 v1, 1, v4
    v_xor_b32 v1, v1, v13
    v_xor_b32 v1, s14, v1
    v_lshl_add_u32 v1, v1, 4, v14
    v_and_b32 v15, 1, v4
    v_lshl_add_u32 v25, v15, 3, v1
    v_add_u32 v25, s15, v25
    s_lshl_b32 s14, s41, 8
    s_add_u32 s14, s14, 155648
    v_lshl_add_u32 v37, v8, 4, s14
    v_lshrrev_b32 v1, 1, v11
    v_xor_b32 v1, v1, v13
    v_lshlrev_b32 v3, 1, v12
    v_xor_b32 v1, v1, v3
    s_lshl_b32 s14, s41, 2
    v_xor_b32 v1, s14, v1
    v_lshl_add_u32 v1, v1, 4, v14
    v_and_b32 v15, 1, v11
    v_lshl_add_u32 v1, v15, 3, v1
    v_lshl_add_u32 v35, v12, 12, v1
    v_xor_b32 v36, 32, v35
    s_lshl_b32 s14, s41, 7
    s_add_u32 s14, s14, 155648
    v_lshl_add_u32 v30, v8, 4, s14
    s_lshl_b32 s14, s41, 7
    s_add_u32 s14, s14, 155648
    v_lshl_add_u32 v31, v8, 4, s14
    s_lshl_b32 s14, s40, 8
    s_add_u32 s14, s14, 155648
    v_lshl_add_u32 v32, v7, 2, s14
    v_lshlrev_b32 v27, 4, v0
    v_lshlrev_b32 v28, 3, v7
    v_mov_b32 v29, v8
    s_mov_b32 s60, s37
    s_lshl_b32 s101, s37, 1
    s_and_b32 s3, s2, 7
    s_and_b32 s14, s78, 1
    s_lshl_b32 s74, s3, 1
    s_add_u32 s74, s74, s14
    s_lshr_b32 s75, s78, 1
    s_mul_i32 s14, s3, 29
    s_sub_u32 s15, s3, 4
    s_max_i32 s15, s15, 0
    s_add_u32 s14, s14, s15
    s_cmp_eq_u32 s3, 7
    s_cselect_b32 s14, 200, s14
    s_cmp_lt_u32 s3, 4
    s_cselect_b32 s15, 29, 30
    s_cmp_lt_u32 s3, 6
    s_cselect_b32 s15, s15, 24
    s_add_u32 s14, s14, s78
    s_mul_i32 s76, s14, 9363
    s_lshr_b32 s76, s76, 16
    s_mul_i32 s77, s76, 7
    s_sub_u32 s77, s14, s77
    s_cmp_ge_u32 s78, s15
    s_cselect_b32 s76, 32, s76
    s_mov_b32 s32, s68
    s_mov_b32 s33, s69
    s_mov_b32 s34, 20971520
    s_mov_b32 s35, 0x00020000
    s_mov_b32 s3, 16777216
    s_load_dword s49, s[68:69], s3
    s_waitcnt lgkmcnt(0)
    s_add_u32 s49, s49, 0x9e3779b9
    s_barrier
    s_cmp_ge_u32 s46, 5
    s_cbranch_scc1 L_BP_nd1
    buffer_load_dwordx4 v[96:99], v38, s[24:27], s43 offen
    s_add_u32 s43, s43, s44
    buffer_load_dwordx4 v[100:103], v38, s[24:27], s43 offen
    s_add_u32 s43, s43, s44
    buffer_load_dwordx4 v[104:107], v38, s[24:27], s43 offen
    s_add_u32 s43, s43, s44
    buffer_load_dwordx4 v[108:111], v38, s[24:27], s43 offen
    s_add_u32 s43, s43, s44
    buffer_load_dwordx4 v[112:115], v38, s[24:27], s43 offen
    s_add_u32 s43, s43, s44
    buffer_load_dwordx4 v[116:119], v38, s[24:27], s43 offen
    s_add_u32 s43, s43, s44
    buffer_load_dwordx4 v[120:123], v38, s[24:27], s43 offen
    s_add_u32 s43, s43, s44
    buffer_load_dwordx4 v[124:127], v38, s[24:27], s43 offen
    s_add_u32 s43, s43, s44
    buffer_load_dwordx4 v[128:131], v38, s[24:27], s43 offen
    s_add_u32 s43, s43, s44
    buffer_load_dwordx4 v[132:135], v38, s[24:27], s43 offen
    s_add_u32 s43, s43, s44
    buffer_load_dwordx4 v[136:139], v38, s[24:27], s43 offen
    s_add_u32 s43, s43, s44
    buffer_load_dwordx4 v[140:143], v38, s[24:27], s43 offen
    s_add_u32 s43, s43, s44
    buffer_load_dwordx4 v[144:147], v38, s[24:27], s43 offen
    s_add_u32 s43, s43, s44
    buffer_load_dwordx4 v[148:151], v38, s[24:27], s43 offen
L_BP_nd1:
    s_cmp_ge_u32 s46, 5
    s_cbranch_scc1 L_BP_w1
    s_waitcnt vmcnt(15)
    s_branch L_BP_w2
L_BP_w1:
    s_waitcnt vmcnt(1)
L_BP_w2:
    v_mov_b32 v1, 0
    v_mov_b32 v2, 0
    v_lshlrev_b32 v3, 16, v48
    v_and_b32 v4, 0xffff0000, v48
    v_add_f32 v1, v1, v3
    v_fmac_f32 v2, v3, v3
    v_add_f32 v1, v1, v4
    v_fmac_f32 v2, v4, v4
    v_lshlrev_b32 v3, 16, v49
    v_and_b32 v4, 0xffff0000, v49
    v_add_f32 v1, v1, v3
    v_fmac_f32 v2, v3, v3
    v_add_f32 v1, v1, v4
    v_fmac_f32 v2, v4, v4
    v_lshlrev_b32 v3, 16, v50
    v_and_b32 v4, 0xffff0000, v50
    v_add_f32 v1, v1, v3
    v_fmac_f32 v2, v3, v3
    v_add_f32 v1, v1, v4
    v_fmac_f32 v2, v4, v4
    v_lshlrev_b32 v3, 16, v51
    v_and_b32 v4, 0xffff0000, v51
    v_add_f32 v1, v1, v3
    v_fmac_f32 v2, v3, v3
    v_add_f32 v1, v1, v4
    v_fmac_f32 v2, v4, v4
    v_lshlrev_b32 v3, 16, v52
    v_and_b32 v4, 0xffff0000, v52
    v_add_f32 v1, v1, v3
    v_fmac_f32 v2, v3, v3
    v_add_f32 v1, v1, v4
    v_fmac_f32 v2, v4, v4
    v_lshlrev_b32 v3, 16, v53
    v_and_b32 v4, 0xffff0000, v53
    v_add_f32 v1, v1, v3
    v_fmac_f32 v2, v3, v3
    v_add_f32 v1, v1, v4
    v_fmac_f32 v2, v4, v4
    v_lshlrev_b32 v3, 16, v54
    v_and_b32 v4, 0xffff0000, v54
    v_add_f32 v1, v1, v3
    v_fmac_f32 v2, v3, v3
    v_add_f32 v1, v1, v4
    v_fmac_f32 v2, v4, v4
    v_lshlrev_b32 v3, 16, v55
    v_and_b32 v4, 0xffff0000, v55
    v_add_f32 v1, v1, v3
    v_fmac_f32 v2, v3, v3
    v_add_f32 v1, v1, v4
    v_fmac_f32 v2, v4, v4
    s_nop 0
    v_add_f32_dpp v1, v1, v1 quad_perm:[1,0,3,2] row_mask:0xf bank_mask:0xf
    v_add_f32_dpp v2, v2, v2 quad_perm:[1,0,3,2] row_mask:0xf bank_mask:0xf
    s_nop 0
    v_add_f32_dpp v1, v1, v1 quad_perm:[2,3,0,1] row_mask:0xf bank_mask:0xf
    v_add_f32_dpp v2, v2, v2 quad_perm:[2,3,0,1] row_mask:0xf bank_mask:0xf
    s_nop 0
    v_add_f32_dpp v1, v1, v1 row_half_mirror row_mask:0xf bank_mask:0xf
    v_add_f32_dpp v2, v2, v2 row_half_mirror row_mask:0xf bank_mask:0xf
    s_nop 0
    v_add_f32_dpp v1, v1, v1 row_mirror row_mask:0xf bank_mask:0xf
    v_add_f32_dpp v2, v2, v2 row_mirror row_mask:0xf bank_mask:0xf
    v_mov_b32 v3, v1
    v_mov_b32 v4, v2
    s_nop 0
    v_permlane16_swap_b32 v1, v3
    v_permlane16_swap_b32 v2, v4
    v_add_f32 v1, v1, v3
    v_add_f32 v2, v2, v4
    v_mul_f32 v1, 0x3b124925, v1
    v_mul_f32 v2, 0x3b124925, v2
    v_fma_f32 v2, -v1, v1, v2
    v_max_f32 v2, 0, v2
    v_cvt_pk_bf16_f32 v3, v1, v2
    v_and_b32 v5, 0xffff0000, v3
    v_add_f32 v5, 0x3727c5ac, v5
    v_cvt_pk_bf16_f32 v5, v5, v5
    v_and_b32 v5, 0xffff0000, v5
    v_sqrt_f32 v5, v5
    s_nop 0
    v_cvt_pk_bf16_f32 v4, v1, v5
    v_mov_b32 v5, s49
    v_lshrrev_b32 v6, 2, v0
    v_and_b32 v6, 8, v6
    s_lshl_b32 s14, s45, 3
    s_add_u32 s14, s14, 16809984
    s_mov_b32 exec_lo, 1
    s_mov_b32 exec_hi, 1
    buffer_store_dwordx2 v[4:5], v6, s[32:35], s14 offen sc1
    s_mov_b64 exec, -1
    s_barrier
    s_barrier
    s_barrier
    s_cmp_ge_u32 s46, 5
    s_cbranch_scc1 L_BP_c3
    s_waitcnt vmcnt(14)
    v_lshlrev_b32 v40, 16, v96
    v_and_b32 v41, 0xffff0000, v96
    v_lshlrev_b32 v42, 16, v97
    v_and_b32 v43, 0xffff0000, v97
    v_lshlrev_b32 v44, 16, v98
    v_and_b32 v45, 0xffff0000, v98
    v_lshlrev_b32 v46, 16, v99
    v_and_b32 v47, 0xffff0000, v99
    s_waitcnt vmcnt(13)
    v_lshlrev_b32 v3, 16, v100
    v_and_b32 v4, 0xffff0000, v100
    v_add_f32 v40, v40, v3
    v_add_f32 v41, v41, v4
    v_lshlrev_b32 v3, 16, v101
    v_and_b32 v4, 0xffff0000, v101
    v_add_f32 v42, v42, v3
    v_add_f32 v43, v43, v4
    v_lshlrev_b32 v3, 16, v102
    v_and_b32 v4, 0xffff0000, v102
    v_add_f32 v44, v44, v3
    v_add_f32 v45, v45, v4
    v_lshlrev_b32 v3, 16, v103
    v_and_b32 v4, 0xffff0000, v103
    v_add_f32 v46, v46, v3
    v_add_f32 v47, v47, v4
    s_waitcnt vmcnt(12)
    v_lshlrev_b32 v3, 16, v104
    v_and_b32 v4, 0xffff0000, v104
    v_add_f32 v40, v40, v3
    v_add_f32 v41, v41, v4
    v_lshlrev_b32 v3, 16, v105
    v_and_b32 v4, 0xffff0000, v105
    v_add_f32 v42, v42, v3
    v_add_f32 v43, v43, v4
    v_lshlrev_b32 v3, 16, v106
    v_and_b32 v4, 0xffff0000, v106
    v_add_f32 v44, v44, v3
    v_add_f32 v45, v45, v4
    v_lshlrev_b32 v3, 16, v107
    v_and_b32 v4, 0xffff0000, v107
    v_add_f32 v46, v46, v3
    v_add_f32 v47, v47, v4
    s_waitcnt vmcnt(11)
    v_lshlrev_b32 v3, 16, v108
    v_and_b32 v4, 0xffff0000, v108
    v_add_f32 v40, v40, v3
    v_add_f32 v41, v41, v4
    v_lshlrev_b32 v3, 16, v109
    v_and_b32 v4, 0xffff0000, v109
    v_add_f32 v42, v42, v3
    v_add_f32 v43, v43, v4
    v_lshlrev_b32 v3, 16, v110
    v_and_b32 v4, 0xffff0000, v110
    v_add_f32 v44, v44, v3
    v_add_f32 v45, v45, v4
    v_lshlrev_b32 v3, 16, v111
    v_and_b32 v4, 0xffff0000, v111
    v_add_f32 v46, v46, v3
    v_add_f32 v47, v47, v4
    s_waitcnt vmcnt(10)
    v_lshlrev_b32 v3, 16, v112
    v_and_b32 v4, 0xffff0000, v112
    v_add_f32 v40, v40, v3
    v_add_f32 v41, v41, v4
    v_lshlrev_b32 v3, 16, v113
    v_and_b32 v4, 0xffff0000, v113
    v_add_f32 v42, v42, v3
    v_add_f32 v43, v43, v4
    v_lshlrev_b32 v3, 16, v114
    v_and_b32 v4, 0xffff0000, v114
    v_add_f32 v44, v44, v3
    v_add_f32 v45, v45, v4
    v_lshlrev_b32 v3, 16, v115
    v_and_b32 v4, 0xffff0000, v115
    v_add_f32 v46, v46, v3
    v_add_f32 v47, v47, v4
L_BP_c3:
    s_barrier
    s_cmp_ge_u32 s46, 5
    s_cbranch_scc1 L_BP_c4
    s_waitcnt vmcnt(9)
    v_lshlrev_b32 v3, 16, v116
    v_and_b32 v4, 0xffff0000, v116
    v_add_f32 v40, v40, v3
    v_add_f32 v41, v41, v4
    v_lshlrev_b32 v3, 16, v117
    v_and_b32 v4, 0xffff0000, v117
    v_add_f32 v42, v42, v3
    v_add_f32 v43, v43, v4
    v_lshlrev_b32 v3, 16, v118
    v_and_b32 v4, 0xffff0000, v118
    v_add_f32 v44, v44, v3
    v_add_f32 v45, v45, v4
    v_lshlrev_b32 v3, 16, v119
    v_and_b32 v4, 0xffff0000, v119
    v_add_f32 v46, v46, v3
    v_add_f32 v47, v47, v4
    s_waitcnt vmcnt(8)
    v_lshlrev_b32 v3, 16, v120
    v_and_b32 v4, 0xffff0000, v120
    v_add_f32 v40, v40, v3
    v_add_f32 v41, v41, v4
    v_lshlrev_b32 v3, 16, v121
    v_and_b32 v4, 0xffff0000, v121
    v_add_f32 v42, v42, v3
    v_add_f32 v43, v43, v4
    v_lshlrev_b32 v3, 16, v122
    v_and_b32 v4, 0xffff0000, v122
    v_add_f32 v44, v44, v3
    v_add_f32 v45, v45, v4
    v_lshlrev_b32 v3, 16, v123
    v_and_b32 v4, 0xffff0000, v123
    v_add_f32 v46, v46, v3
    v_add_f32 v47, v47, v4
    s_waitcnt vmcnt(7)
    v_lshlrev_b32 v3, 16, v124
    v_and_b32 v4, 0xffff0000, v124
    v_add_f32 v40, v40, v3
    v_add_f32 v41, v41, v4
    v_lshlrev_b32 v3, 16, v125
    v_and_b32 v4, 0xffff0000, v125
    v_add_f32 v42, v42, v3
    v_add_f32 v43, v43, v4
    v_lshlrev_b32 v3, 16, v126
    v_and_b32 v4, 0xffff0000, v126
    v_add_f32 v44, v44, v3
    v_add_f32 v45, v45, v4
    v_lshlrev_b32 v3, 16, v127
    v_and_b32 v4, 0xffff0000, v127
    v_add_f32 v46, v46, v3
    v_add_f32 v47, v47, v4
    s_waitcnt vmcnt(6)
    v_lshlrev_b32 v3, 16, v128
    v_and_b32 v4, 0xffff0000, v128
    v_add_f32 v40, v40, v3
    v_add_f32 v41, v41, v4
    v_lshlrev_b32 v3, 16, v129
    v_and_b32 v4, 0xffff0000, v129
    v_add_f32 v42, v42, v3
    v_add_f32 v43, v43, v4
    v_lshlrev_b32 v3, 16, v130
    v_and_b32 v4, 0xffff0000, v130
    v_add_f32 v44, v44, v3
    v_add_f32 v45, v45, v4
    v_lshlrev_b32 v3, 16, v131
    v_and_b32 v4, 0xffff0000, v131
    v_add_f32 v46, v46, v3
    v_add_f32 v47, v47, v4
    s_waitcnt vmcnt(5)
    v_lshlrev_b32 v3, 16, v132
    v_and_b32 v4, 0xffff0000, v132
    v_add_f32 v40, v40, v3
    v_add_f32 v41, v41, v4
    v_lshlrev_b32 v3, 16, v133
    v_and_b32 v4, 0xffff0000, v133
    v_add_f32 v42, v42, v3
    v_add_f32 v43, v43, v4
    v_lshlrev_b32 v3, 16, v134
    v_and_b32 v4, 0xffff0000, v134
    v_add_f32 v44, v44, v3
    v_add_f32 v45, v45, v4
    v_lshlrev_b32 v3, 16, v135
    v_and_b32 v4, 0xffff0000, v135
    v_add_f32 v46, v46, v3
    v_add_f32 v47, v47, v4
L_BP_c4:
    s_barrier
    s_cmp_ge_u32 s46, 5
    s_cbranch_scc1 L_BP_c5
    s_waitcnt vmcnt(4)
    v_lshlrev_b32 v3, 16, v136
    v_and_b32 v4, 0xffff0000, v136
    v_add_f32 v40, v40, v3
    v_add_f32 v41, v41, v4
    v_lshlrev_b32 v3, 16, v137
    v_and_b32 v4, 0xffff0000, v137
    v_add_f32 v42, v42, v3
    v_add_f32 v43, v43, v4
    v_lshlrev_b32 v3, 16, v138
    v_and_b32 v4, 0xffff0000, v138
    v_add_f32 v44, v44, v3
    v_add_f32 v45, v45, v4
    v_lshlrev_b32 v3, 16, v139
    v_and_b32 v4, 0xffff0000, v139
    v_add_f32 v46, v46, v3
    v_add_f32 v47, v47, v4
    s_waitcnt vmcnt(3)
    v_lshlrev_b32 v3, 16, v140
    v_and_b32 v4, 0xffff0000, v140
    v_add_f32 v40, v40, v3
    v_add_f32 v41, v41, v4
    v_lshlrev_b32 v3, 16, v141
    v_and_b32 v4, 0xffff0000, v141
    v_add_f32 v42, v42, v3
    v_add_f32 v43, v43, v4
    v_lshlrev_b32 v3, 16, v142
    v_and_b32 v4, 0xffff0000, v142
    v_add_f32 v44, v44, v3
    v_add_f32 v45, v45, v4
    v_lshlrev_b32 v3, 16, v143
    v_and_b32 v4, 0xffff0000, v143
    v_add_f32 v46, v46, v3
    v_add_f32 v47, v47, v4
    s_waitcnt vmcnt(2)
    v_lshlrev_b32 v3, 16, v144
    v_and_b32 v4, 0xffff0000, v144
    v_add_f32 v40, v40, v3
    v_add_f32 v41, v41, v4
    v_lshlrev_b32 v3, 16, v145
    v_and_b32 v4, 0xffff0000, v145
    v_add_f32 v42, v42, v3
    v_add_f32 v43, v43, v4
    v_lshlrev_b32 v3, 16, v146
    v_and_b32 v4, 0xffff0000, v146
    v_add_f32 v44, v44, v3
    v_add_f32 v45, v45, v4
    v_lshlrev_b32 v3, 16, v147
    v_and_b32 v4, 0xffff0000, v147
    v_add_f32 v46, v46, v3
    v_add_f32 v47, v47, v4
    s_waitcnt vmcnt(1)
    v_lshlrev_b32 v3, 16, v148
    v_and_b32 v4, 0xffff0000, v148
    v_add_f32 v40, v40, v3
    v_add_f32 v41, v41, v4
    v_lshlrev_b32 v3, 16, v149
    v_and_b32 v4, 0xffff0000, v149
    v_add_f32 v42, v42, v3
    v_add_f32 v43, v43, v4
    v_lshlrev_b32 v3, 16, v150
    v_and_b32 v4, 0xffff0000, v150
    v_add_f32 v44, v44, v3
    v_add_f32 v45, v45, v4
    v_lshlrev_b32 v3, 16, v151
    v_and_b32 v4, 0xffff0000, v151
    v_add_f32 v46, v46, v3
    v_add_f32 v47, v47, v4
    v_add_f32_dpp v40, v40, v40 row_ror:8 row_mask:0xf bank_mask:0xf
    v_add_f32_dpp v41, v41, v41 row_ror:8 row_mask:0xf bank_mask:0xf
    v_add_f32_dpp v42, v42, v42 row_ror:8 row_mask:0xf bank_mask:0xf
    v_add_f32_dpp v43, v43, v43 row_ror:8 row_mask:0xf bank_mask:0xf
    v_add_f32_dpp v44, v44, v44 row_ror:8 row_mask:0xf bank_mask:0xf
    v_add_f32_dpp v45, v45, v45 row_ror:8 row_mask:0xf bank_mask:0xf
    v_add_f32_dpp v46, v46, v46 row_ror:8 row_mask:0xf bank_mask:0xf
    v_add_f32_dpp v47, v47, v47 row_ror:8 row_mask:0xf bank_mask:0xf
    v_mov_b32 v96, v40
    v_mov_b32 v97, v41
    v_mov_b32 v98, v42
    v_mov_b32 v99, v43
    v_mov_b32 v100, v44
    v_mov_b32 v101, v45
    v_mov_b32 v102, v46
    v_mov_b32 v103, v47
    v_permlane16_swap_b32 v96, v40
    v_permlane16_swap_b32 v97, v41
    v_permlane16_swap_b32 v98, v42
    v_permlane16_swap_b32 v99, v43
    v_permlane16_swap_b32 v100, v44
    v_permlane16_swap_b32 v101, v45
    v_permlane16_swap_b32 v102, v46
    v_permlane16_swap_b32 v103, v47
    v_add_f32 v40, v40, v96
    v_add_f32 v41, v41, v97
    v_add_f32 v42, v42, v98
    v_add_f32 v43, v43, v99
    v_add_f32 v44, v44, v100
    v_add_f32 v45, v45, v101
    v_add_f32 v46, v46, v102
    v_add_f32 v47, v47, v103
    v_mov_b32 v96, v40
    v_mov_b32 v97, v41
    v_mov_b32 v98, v42
    v_mov_b32 v99, v43
    v_mov_b32 v100, v44
    v_mov_b32 v101, v45
    v_mov_b32 v102, v46
    v_mov_b32 v103, v47
    v_permlane32_swap_b32 v96, v40
    v_permlane32_swap_b32 v97, v41
    v_permlane32_swap_b32 v98, v42
    v_permlane32_swap_b32 v99, v43
    v_permlane32_swap_b32 v100, v44
    v_permlane32_swap_b32 v101, v45
    v_permlane32_swap_b32 v102, v46
    v_permlane32_swap_b32 v103, v47
    v_add_f32 v40, v40, v96
    v_add_f32 v41, v41, v97
    v_add_f32 v42, v42, v98
    v_add_f32 v43, v43, v99
    v_add_f32 v44, v44, v100
    v_add_f32 v45, v45, v101
    v_add_f32 v46, v46, v102
    v_add_f32 v47, v47, v103
    s_lshl_b32 s14, s39, 8
    s_add_u32 s14, s14, 157696
    v_and_b32 v3, 7, v0
    v_lshl_add_u32 v3, v3, 5, s14
    ds_write_b128 v3, v[40:43]
    ds_write_b128 v3, v[44:47] offset:16
    s_waitcnt lgkmcnt(0)
L_BP_c5:
    s_barrier
    s_cmp_ge_u32 s46, 5
    s_cbranch_scc1 L_BP_c9
    s_cmp_lg_u32 s39, 0
    s_cbranch_scc1 L_BP_c9
    v_lshlrev_b32 v3, 2, v0
    v_add_u32 v3, 157696, v3
    ds_read_b32 v4, v3 offset:0
    ds_read_b32 v5, v3 offset:256
    ds_read_b32 v6, v3 offset:512
    ds_read_b32 v7, v3 offset:768
    s_mul_i32 s14, s37, 6
    s_add_u32 s14, s14, s42
    s_lshl_b32 s14, s14, 9
    s_add_u32 s14, s14, 16826368
    v_lshlrev_b32 v3, 3, v0
    s_waitcnt lgkmcnt(0)
    v_add_f32 v4, v4, v5
    v_add_f32 v6, v6, v7
    v_add_f32 v4, v4, v6
    v_mov_b32 v5, s49
    buffer_store_dwordx2 v[4:5], v3, s[32:35], s14 offen sc1
L_BP_c9:
    s_barrier
    s_barrier
    s_barrier
    s_barrier
    v_lshlrev_b32 v44, 3, v0
    s_mul_i32 s11, s37, 3072
    s_add_u32 s11, s11, 16826368
    s_lshl_b32 s12, s39, 1
    s_sub_u32 s12, s12, 2
    s_add_u32 s13, s12, 1
    s_lshl_b32 s14, s36, 10
    s_add_u32 s14, s14, 16809984
    s_add_u32 s15, s14, 512
    s_lshl_b32 s12, s12, 9
    s_lshl_b32 s13, s13, 9
    s_add_u32 s12, s12, s11
    s_add_u32 s13, s13, s11
    s_cmp_eq_u32 s39, 0
    s_cselect_b32 s56, s14, s12
    s_cselect_b32 s57, s15, s13
    s_lshl_b32 s14, s39, 9
    s_add_u32 s14, s14, 155648
    v_lshl_add_u32 v45, v0, 2, s14
    buffer_load_dwordx2 v[46:47], v44, s[32:35], s56 offen sc1
    buffer_load_dwordx2 v[48:49], v44, s[32:35], s57 offen sc1
    s_barrier
    s_barrier
    s_barrier
    s_waitcnt vmcnt(0)
    v_cmp_ne_u32 vcc, s49, v47
    v_cmp_ne_u32 s[54:55], s49, v49
    s_or_b64 vcc, vcc, s[54:55]
    s_cbranch_vccz L_gP_ok
    s_mov_b32 s96, 200000
L_gP:
    buffer_load_dwordx2 v[46:47], v44, s[32:35], s56 offen sc1
    buffer_load_dwordx2 v[48:49], v44, s[32:35], s57 offen sc1
    s_waitcnt vmcnt(0)
    v_cmp_ne_u32 vcc, s49, v47
    v_cmp_ne_u32 s[54:55], s49, v49
    s_or_b64 vcc, vcc, s[54:55]
    s_cbranch_vccz L_gP_ok
    s_sleep 2
    s_sub_u32 s96, s96, 1
    s_cbranch_scc0 L_gP
L_gP_ok:
    ds_write_b32 v45, v46
    ds_write_b32 v45, v48 offset:256
    s_waitcnt lgkmcnt(0)
    s_waitcnt vmcnt(1)
    s_mov_b32 s43, 0
    s_barrier
    s_setprio 2
    ds_read_b64_tr_b16 v[48:49], v35 offset:32768
    ds_read_b64_tr_b16 v[50:51], v35 offset:33280
    ds_read_b128 v[40:43], v16 offset:0
    ds_read_b128 v[44:47], v16 offset:4096
    ds_read_b64_tr_b16 v[52:53], v36 offset:32768
    ds_read_b64_tr_b16 v[54:55], v36 offset:33280
    ds_read_b64_tr_b16 v[64:65], v35 offset:34816
    ds_read_b64_tr_b16 v[66:67], v35 offset:35328
    ds_read_b128 v[56:59], v17 offset:0
    ds_read_b128 v[60:63], v17 offset:4096
    ds_read_b64_tr_b16 v[68:69], v36 offset:34816
    ds_read_b64_tr_b16 v[70:71], v36 offset:35328
    s_waitcnt lgkmcnt(8)
    v_mfma_f32_32x32x16_bf16 v[96:111], v[48:51], v[40:43], 0
    v_mfma_f32_32x32x16_bf16 v[128:143], v[48:51], v[44:47], 0
    s_barrier
    s_waitcnt lgkmcnt(6)
    v_mfma_f32_32x32x16_bf16 v[112:127], v[52:55], v[40:43], 0
    ds_read_b64_tr_b16 v[80:81], v35 offset:0
    ds_read_b64_tr_b16 v[82:83], v35 offset:512
    ds_read_b128 v[72:75], v18 offset:0
    ds_read_b128 v[76:79], v18 offset:4096
    v_mfma_f32_32x32x16_bf16 v[144:159], v[52:55], v[44:47], 0
    ds_read_b64_tr_b16 v[84:85], v36 offset:0
    ds_read_b64_tr_b16 v[86:87], v36 offset:512
    s_waitcnt lgkmcnt(8)
    v_mfma_f32_32x32x16_bf16 v[96:111], v[64:67], v[56:59], v[96:111]
    ds_read_b64_tr_b16 v[48:49], v35 offset:2048
    ds_read_b64_tr_b16 v[50:51], v35 offset:2560
    v_mfma_f32_32x32x16_bf16 v[128:143], v[64:67], v[60:63], v[128:143]
    ds_read_b128 v[40:43], v19 offset:0
    ds_read_b128 v[44:47], v19 offset:4096
    s_waitcnt lgkmcnt(10)
    v_mfma_f32_32x32x16_bf16 v[112:127], v[68:71], v[56:59], v[112:127]
    ds_read_b64_tr_b16 v[52:53], v36 offset:2048
    ds_read_b64_tr_b16 v[54:55], v36 offset:2560
    v_mfma_f32_32x32x16_bf16 v[144:159], v[68:71], v[60:63], v[144:159]
    s_waitcnt lgkmcnt(8)
    v_mfma_f32_32x32x16_bf16 v[96:111], v[80:83], v[72:75], v[96:111]
    v_mfma_f32_32x32x16_bf16 v[128:143], v[80:83], v[76:79], v[128:143]
    s_barrier
    s_waitcnt lgkmcnt(6)
    v_mfma_f32_32x32x16_bf16 v[112:127], v[84:87], v[72:75], v[112:127]
    ds_read_b64_tr_b16 v[64:65], v35 offset:8192
    ds_read_b64_tr_b16 v[66:67], v35 offset:8704
    ds_read_b128 v[56:59], v16 offset:16384
    ds_read_b128 v[60:63], v16 offset:20480
    v_mfma_f32_32x32x16_bf16 v[144:159], v[84:87], v[76:79], v[144:159]
    ds_read_b64_tr_b16 v[68:69], v36 offset:8192
    ds_read_b64_tr_b16 v[70:71], v36 offset:8704
    s_waitcnt lgkmcnt(8)
    v_mfma_f32_32x32x16_bf16 v[96:111], v[48:51], v[40:43], v[96:111]
    ds_read_b64_tr_b16 v[80:81], v35 offset:10240
    ds_read_b64_tr_b16 v[82:83], v35 offset:10752
    v_mfma_f32_32x32x16_bf16 v[128:143], v[48:51], v[44:47], v[128:143]
    ds_read_b128 v[72:75], v17 offset:16384
    ds_read_b128 v[76:79], v17 offset:20480
    s_waitcnt lgkmcnt(10)
    v_mfma_f32_32x32x16_bf16 v[112:127], v[52:55], v[40:43], v[112:127]
    ds_read_b64_tr_b16 v[84:85], v36 offset:10240
    ds_read_b64_tr_b16 v[86:87], v36 offset:10752
    v_mfma_f32_32x32x16_bf16 v[144:159], v[52:55], v[44:47], v[144:159]
    s_waitcnt lgkmcnt(8)
    v_mfma_f32_32x32x16_bf16 v[96:111], v[64:67], v[56:59], v[96:111]
    v_mfma_f32_32x32x16_bf16 v[128:143], v[64:67], v[60:63], v[128:143]
    s_barrier
    s_waitcnt lgkmcnt(6)
    v_mfma_f32_32x32x16_bf16 v[112:127], v[68:71], v[56:59], v[112:127]
    ds_read_b64_tr_b16 v[48:49], v35 offset:16384
    ds_read_b64_tr_b16 v[50:51], v35 offset:16896
    ds_read_b128 v[40:43], v18 offset:16384
    ds_read_b128 v[44:47], v18 offset:20480
    v_mfma_f32_32x32x16_bf16 v[144:159], v[68:71], v[60:63], v[144:159]
    ds_read_b64_tr_b16 v[52:53], v36 offset:16384
    ds_read_b64_tr_b16 v[54:55], v36 offset:16896
    s_waitcnt lgkmcnt(8)
    v_mfma_f32_32x32x16_bf16 v[96:111], v[80:83], v[72:75], v[96:111]
    ds_read_b64_tr_b16 v[64:65], v35 offset:18432
    ds_read_b64_tr_b16 v[66:67], v35 offset:18944
    v_mfma_f32_32x32x16_bf16 v[128:143], v[80:83], v[76:79], v[128:143]
    ds_read_b128 v[56:59], v19 offset:16384
    ds_read_b128 v[60:63], v19 offset:20480
    s_waitcnt lgkmcnt(10)
    v_mfma_f32_32x32x16_bf16 v[112:127], v[84:87], v[72:75], v[112:127]
    ds_read_b64_tr_b16 v[68:69], v36 offset:18432
    ds_read_b64_tr_b16 v[70:71], v36 offset:18944
    v_mfma_f32_32x32x16_bf16 v[144:159], v[84:87], v[76:79], v[144:159]
    s_waitcnt lgkmcnt(8)
    v_mfma_f32_32x32x16_bf16 v[96:111], v[48:51], v[40:43], v[96:111]
    v_mfma_f32_32x32x16_bf16 v[128:143], v[48:51], v[44:47], v[128:143]
    s_barrier
    s_waitcnt lgkmcnt(6)
    v_mfma_f32_32x32x16_bf16 v[112:127], v[52:55], v[40:43], v[112:127]
    ds_read_b64_tr_b16 v[80:81], v35 offset:24576
    ds_read_b64_tr_b16 v[82:83], v35 offset:25088
    ds_read_b128 v[72:75], v16 offset:32768
    ds_read_b128 v[76:79], v16 offset:36864
    v_mfma_f32_32x32x16_bf16 v[144:159], v[52:55], v[44:47], v[144:159]
    ds_read_b64_tr_b16 v[84:85], v36 offset:24576
    ds_read_b64_tr_b16 v[86:87], v36 offset:25088
    s_waitcnt lgkmcnt(8)
    v_mfma_f32_32x32x16_bf16 v[96:111], v[64:67], v[56:59], v[96:111]
    ds_read_b64_tr_b16 v[48:49], v35 offset:26624
    ds_read_b64_tr_b16 v[50:51], v35 offset:27136
    v_mfma_f32_32x32x16_bf16 v[128:143], v[64:67], v[60:63], v[128:143]
    ds_read_b128 v[40:43], v17 offset:32768
    ds_read_b128 v[44:47], v17 offset:36864
    s_waitcnt lgkmcnt(10)
    v_mfma_f32_32x32x16_bf16 v[112:127], v[68:71], v[56:59], v[112:127]
    ds_read_b64_tr_b16 v[52:53], v36 offset:26624
    ds_read_b64_tr_b16 v[54:55], v36 offset:27136
    v_mfma_f32_32x32x16_bf16 v[144:159], v[68:71], v[60:63], v[144:159]
    s_waitcnt lgkmcnt(8)
    v_mfma_f32_32x32x16_bf16 v[96:111], v[80:83], v[72:75], v[96:111]
    v_mfma_f32_32x32x16_bf16 v[128:143], v[80:83], v[76:79], v[128:143]
    s_barrier
    s_waitcnt lgkmcnt(6)
    v_mfma_f32_32x32x16_bf16 v[112:127], v[84:87], v[72:75], v[112:127]
    ds_read_b64_tr_b16 v[64:65], v35 offset:32768
    ds_read_b64_tr_b16 v[66:67], v35 offset:33280
    ds_read_b128 v[56:59], v18 offset:32768
    ds_read_b128 v[60:63], v18 offset:36864
    v_mfma_f32_32x32x16_bf16 v[144:159], v[84:87], v[76:79], v[144:159]
    ds_read_b64_tr_b16 v[68:69], v36 offset:32768
    ds_read_b64_tr_b16 v[70:71], v36 offset:33280
    s_waitcnt lgkmcnt(8)
    v_mfma_f32_32x32x16_bf16 v[96:111], v[48:51], v[40:43], v[96:111]
    ds_read_b64_tr_b16 v[80:81], v35 offset:34816
    ds_read_b64_tr_b16 v[82:83], v35 offset:35328
    v_mfma_f32_32x32x16_bf16 v[128:143], v[48:51], v[44:47], v[128:143]
    ds_read_b128 v[72:75], v19 offset:32768
    ds_read_b128 v[76:79], v19 offset:36864
    s_waitcnt lgkmcnt(10)
    v_mfma_f32_32x32x16_bf16 v[112:127], v[52:55], v[40:43], v[112:127]
    ds_read_b64_tr_b16 v[84:85], v36 offset:34816
    ds_read_b64_tr_b16 v[86:87], v36 offset:35328
    v_mfma_f32_32x32x16_bf16 v[144:159], v[52:55], v[44:47], v[144:159]
    s_waitcnt lgkmcnt(8)
    v_mfma_f32_32x32x16_bf16 v[96:111], v[64:67], v[56:59], v[96:111]
    v_mfma_f32_32x32x16_bf16 v[128:143], v[64:67], v[60:63], v[128:143]
    s_barrier
    s_waitcnt lgkmcnt(6)
    v_mfma_f32_32x32x16_bf16 v[112:127], v[68:71], v[56:59], v[112:127]
    ds_read_b64_tr_b16 v[48:49], v35 offset:0
    ds_read_b64_tr_b16 v[50:51], v35 offset:512
    ds_read_b128 v[40:43], v16 offset:49152
    ds_read_b128 v[44:47], v16 offset:53248
    v_mfma_f32_32x32x16_bf16 v[144:159], v[68:71], v[60:63], v[144:159]
    ds_read_b64_tr_b16 v[52:53], v36 offset:0
    ds_read_b64_tr_b16 v[54:55], v36 offset:512
    s_waitcnt lgkmcnt(8)
    v_mfma_f32_32x32x16_bf16 v[96:111], v[80:83], v[72:75], v[96:111]
    ds_read_b64_tr_b16 v[64:65], v35 offset:2048
    ds_read_b64_tr_b16 v[66:67], v35 offset:2560
    v_mfma_f32_32x32x16_bf16 v[128:143], v[80:83], v[76:79], v[128:143]
    ds_read_b128 v[56:59], v17 offset:49152
    ds_read_b128 v[60:63], v17 offset:53248
    s_waitcnt lgkmcnt(10)
    v_mfma_f32_32x32x16_bf16 v[112:127], v[84:87], v[72:75], v[112:127]
    ds_read_b64_tr_b16 v[68:69], v36 offset:2048
    ds_read_b64_tr_b16 v[70:71], v36 offset:2560
    v_mfma_f32_32x32x16_bf16 v[144:159], v[84:87], v[76:79], v[144:159]
    s_waitcnt lgkmcnt(8)
    v_mfma_f32_32x32x16_bf16 v[96:111], v[48:51], v[40:43], v[96:111]
    v_mfma_f32_32x32x16_bf16 v[128:143], v[48:51], v[44:47], v[128:143]
    s_barrier
    s_waitcnt lgkmcnt(6)
    v_mfma_f32_32x32x16_bf16 v[112:127], v[52:55], v[40:43], v[112:127]
    ds_read_b64_tr_b16 v[80:81], v35 offset:8192
    ds_read_b64_tr_b16 v[82:83], v35 offset:8704
    ds_read_b128 v[72:75], v18 offset:49152
    ds_read_b128 v[76:79], v18 offset:53248
    v_mfma_f32_32x32x16_bf16 v[144:159], v[52:55], v[44:47], v[144:159]
    ds_read_b64_tr_b16 v[84:85], v36 offset:8192
    ds_read_b64_tr_b16 v[86:87], v36 offset:8704
    s_waitcnt lgkmcnt(8)
    v_mfma_f32_32x32x16_bf16 v[96:111], v[64:67], v[56:59], v[96:111]
    ds_read_b64_tr_b16 v[48:49], v35 offset:10240
    ds_read_b64_tr_b16 v[50:51], v35 offset:10752
    v_mfma_f32_32x32x16_bf16 v[128:143], v[64:67], v[60:63], v[128:143]
    ds_read_b128 v[40:43], v19 offset:49152
    ds_read_b128 v[44:47], v19 offset:53248
    s_waitcnt lgkmcnt(10)
    v_mfma_f32_32x32x16_bf16 v[112:127], v[68:71], v[56:59], v[112:127]
    ds_read_b64_tr_b16 v[52:53], v36 offset:10240
    ds_read_b64_tr_b16 v[54:55], v36 offset:10752
    v_mfma_f32_32x32x16_bf16 v[144:159], v[68:71], v[60:63], v[144:159]
    s_waitcnt lgkmcnt(8)
    v_mfma_f32_32x32x16_bf16 v[96:111], v[80:83], v[72:75], v[96:111]
    v_mfma_f32_32x32x16_bf16 v[128:143], v[80:83], v[76:79], v[128:143]
    s_barrier
    s_waitcnt lgkmcnt(6)
    v_mfma_f32_32x32x16_bf16 v[112:127], v[84:87], v[72:75], v[112:127]
    ds_read_b64_tr_b16 v[64:65], v35 offset:16384
    ds_read_b64_tr_b16 v[66:67], v35 offset:16896
    ds_read_b128 v[56:59], v20 offset:0
    ds_read_b128 v[60:63], v20 offset:4096
    v_mfma_f32_32x32x16_bf16 v[144:159], v[84:87], v[76:79], v[144:159]
    ds_read_b64_tr_b16 v[68:69], v36 offset:16384
    ds_read_b64_tr_b16 v[70:71], v36 offset:16896
    s_waitcnt lgkmcnt(8)
    v_mfma_f32_32x32x16_bf16 v[96:111], v[48:51], v[40:43], v[96:111]
    ds_read_b64_tr_b16 v[80:81], v35 offset:18432
    ds_read_b64_tr_b16 v[82:83], v35 offset:18944
    v_mfma_f32_32x32x16_bf16 v[128:143], v[48:51], v[44:47], v[128:143]
    ds_read_b128 v[72:75], v21 offset:0
    ds_read_b128 v[76:79], v21 offset:4096
    s_waitcnt lgkmcnt(10)
    v_mfma_f32_32x32x16_bf16 v[112:127], v[52:55], v[40:43], v[112:127]
    ds_read_b64_tr_b16 v[84:85], v36 offset:18432
    ds_read_b64_tr_b16 v[86:87], v36 offset:18944
    v_mfma_f32_32x32x16_bf16 v[144:159], v[52:55], v[44:47], v[144:159]
    s_waitcnt lgkmcnt(8)
    v_mfma_f32_32x32x16_bf16 v[96:111], v[64:67], v[56:59], v[96:111]
    v_mfma_f32_32x32x16_bf16 v[128:143], v[64:67], v[60:63], v[128:143]
    s_barrier
    s_waitcnt lgkmcnt(6)
    v_mfma_f32_32x32x16_bf16 v[112:127], v[68:71], v[56:59], v[112:127]
    ds_read_b64_tr_b16 v[48:49], v35 offset:24576
    ds_read_b64_tr_b16 v[50:51], v35 offset:25088
    ds_read_b128 v[40:43], v22 offset:0
    ds_read_b128 v[44:47], v22 offset:4096
    v_mfma_f32_32x32x16_bf16 v[144:159], v[68:71], v[60:63], v[144:159]
    ds_read_b64_tr_b16 v[52:53], v36 offset:24576
    ds_read_b64_tr_b16 v[54:55], v36 offset:25088
    s_waitcnt lgkmcnt(8)
    v_mfma_f32_32x32x16_bf16 v[96:111], v[80:83], v[72:75], v[96:111]
    ds_read_b64_tr_b16 v[64:65], v35 offset:26624
    ds_read_b64_tr_b16 v[66:67], v35 offset:27136
    v_mfma_f32_32x32x16_bf16 v[128:143], v[80:83], v[76:79], v[128:143]
    ds_read_b128 v[56:59], v23 offset:0
    ds_read_b128 v[60:63], v23 offset:4096
    s_waitcnt lgkmcnt(10)
    v_mfma_f32_32x32x16_bf16 v[112:127], v[84:87], v[72:75], v[112:127]
    ds_read_b64_tr_b16 v[68:69], v36 offset:26624
    ds_read_b64_tr_b16 v[70:71], v36 offset:27136
    v_mfma_f32_32x32x16_bf16 v[144:159], v[84:87], v[76:79], v[144:159]
    s_waitcnt lgkmcnt(8)
    v_mfma_f32_32x32x16_bf16 v[96:111], v[48:51], v[40:43], v[96:111]
    v_mfma_f32_32x32x16_bf16 v[128:143], v[48:51], v[44:47], v[128:143]
    s_barrier
    s_waitcnt lgkmcnt(6)
    v_mfma_f32_32x32x16_bf16 v[112:127], v[52:55], v[40:43], v[112:127]
    ds_read_b64_tr_b16 v[80:81], v35 offset:32768
    ds_read_b64_tr_b16 v[82:83], v35 offset:33280
    ds_read_b128 v[72:75], v20 offset:16384
    ds_read_b128 v[76:79], v20 offset:20480
    v_mfma_f32_32x32x16_bf16 v[144:159], v[52:55], v[44:47], v[144:159]
    ds_read_b64_tr_b16 v[84:85], v36 offset:32768
    ds_read_b64_tr_b16 v[86:87], v36 offset:33280
    s_waitcnt lgkmcnt(8)
    v_mfma_f32_32x32x16_bf16 v[96:111], v[64:67], v[56:59], v[96:111]
    ds_read_b64_tr_b16 v[48:49], v35 offset:34816
    ds_read_b64_tr_b16 v[50:51], v35 offset:35328
    v_mfma_f32_32x32x16_bf16 v[128:143], v[64:67], v[60:63], v[128:143]
    ds_read_b128 v[40:43], v21 offset:16384
    ds_read_b128 v[44:47], v21 offset:20480
    s_waitcnt lgkmcnt(10)
    v_mfma_f32_32x32x16_bf16 v[112:127], v[68:71], v[56:59], v[112:127]
    ds_read_b64_tr_b16 v[52:53], v36 offset:34816
    ds_read_b64_tr_b16 v[54:55], v36 offset:35328
    v_mfma_f32_32x32x16_bf16 v[144:159], v[68:71], v[60:63], v[144:159]
    s_waitcnt lgkmcnt(8)
    v_mfma_f32_32x32x16_bf16 v[96:111], v[80:83], v[72:75], v[96:111]
    v_mfma_f32_32x32x16_bf16 v[128:143], v[80:83], v[76:79], v[128:143]
    s_barrier
    s_waitcnt lgkmcnt(6)
    v_mfma_f32_32x32x16_bf16 v[112:127], v[84:87], v[72:75], v[112:127]
    ds_read_b64_tr_b16 v[64:65], v35 offset:0
    ds_read_b64_tr_b16 v[66:67], v35 offset:512
    ds_read_b128 v[56:59], v22 offset:16384
    ds_read_b128 v[60:63], v22 offset:20480
    v_mfma_f32_32x32x16_bf16 v[144:159], v[84:87], v[76:79], v[144:159]
    ds_read_b64_tr_b16 v[68:69], v36 offset:0
    ds_read_b64_tr_b16 v[70:71], v36 offset:512
    s_waitcnt lgkmcnt(8)
    v_mfma_f32_32x32x16_bf16 v[96:111], v[48:51], v[40:43], v[96:111]
    ds_read_b64_tr_b16 v[80:81], v35 offset:2048
    ds_read_b64_tr_b16 v[82:83], v35 offset:2560
    v_mfma_f32_32x32x16_bf16 v[128:143], v[48:51], v[44:47], v[128:143]
    ds_read_b128 v[72:75], v23 offset:16384
    ds_read_b128 v[76:79], v23 offset:20480
    s_waitcnt lgkmcnt(10)
    v_mfma_f32_32x32x16_bf16 v[112:127], v[52:55], v[40:43], v[112:127]
    ds_read_b64_tr_b16 v[84:85], v36 offset:2048
    ds_read_b64_tr_b16 v[86:87], v36 offset:2560
    v_mfma_f32_32x32x16_bf16 v[144:159], v[52:55], v[44:47], v[144:159]
    s_waitcnt lgkmcnt(8)
    v_mfma_f32_32x32x16_bf16 v[96:111], v[64:67], v[56:59], v[96:111]
    v_mfma_f32_32x32x16_bf16 v[128:143], v[64:67], v[60:63], v[128:143]
    s_barrier
    s_waitcnt lgkmcnt(6)
    v_mfma_f32_32x32x16_bf16 v[112:127], v[68:71], v[56:59], v[112:127]
    ds_read_b64_tr_b16 v[48:49], v35 offset:8192
    ds_read_b64_tr_b16 v[50:51], v35 offset:8704
    ds_read_b128 v[40:43], v20 offset:32768
    ds_read_b128 v[44:47], v20 offset:36864
    v_mfma_f32_32x32x16_bf16 v[144:159], v[68:71], v[60:63], v[144:159]
    ds_read_b64_tr_b16 v[52:53], v36 offset:8192
    ds_read_b64_tr_b16 v[54:55], v36 offset:8704
    s_waitcnt lgkmcnt(8)
    v_mfma_f32_32x32x16_bf16 v[96:111], v[80:83], v[72:75], v[96:111]
    ds_read_b64_tr_b16 v[64:65], v35 offset:10240
    ds_read_b64_tr_b16 v[66:67], v35 offset:10752
    v_mfma_f32_32x32x16_bf16 v[128:143], v[80:83], v[76:79], v[128:143]
    ds_read_b128 v[56:59], v21 offset:32768
    ds_read_b128 v[60:63], v21 offset:36864
    s_waitcnt lgkmcnt(10)
    v_mfma_f32_32x32x16_bf16 v[112:127], v[84:87], v[72:75], v[112:127]
    ds_read_b64_tr_b16 v[68:69], v36 offset:10240
    ds_read_b64_tr_b16 v[70:71], v36 offset:10752
    v_mfma_f32_32x32x16_bf16 v[144:159], v[84:87], v[76:79], v[144:159]
    s_waitcnt lgkmcnt(8)
    v_mfma_f32_32x32x16_bf16 v[96:111], v[48:51], v[40:43], v[96:111]
    v_mfma_f32_32x32x16_bf16 v[128:143], v[48:51], v[44:47], v[128:143]
    s_barrier
    s_waitcnt lgkmcnt(6)
    v_mfma_f32_32x32x16_bf16 v[112:127], v[52:55], v[40:43], v[112:127]
    ds_read_b64_tr_b16 v[80:81], v35 offset:16384
    ds_read_b64_tr_b16 v[82:83], v35 offset:16896
    ds_read_b128 v[72:75], v22 offset:32768
    ds_read_b128 v[76:79], v22 offset:36864
    v_mfma_f32_32x32x16_bf16 v[144:159], v[52:55], v[44:47], v[144:159]
    ds_read_b64_tr_b16 v[84:85], v36 offset:16384
    ds_read_b64_tr_b16 v[86:87], v36 offset:16896
    s_waitcnt lgkmcnt(8)
    v_mfma_f32_32x32x16_bf16 v[96:111], v[64:67], v[56:59], v[96:111]
    ds_read_b64_tr_b16 v[48:49], v35 offset:18432
    ds_read_b64_tr_b16 v[50:51], v35 offset:18944
    v_mfma_f32_32x32x16_bf16 v[128:143], v[64:67], v[60:63], v[128:143]
    ds_read_b128 v[40:43], v23 offset:32768
    ds_read_b128 v[44:47], v23 offset:36864
    s_waitcnt lgkmcnt(10)
    v_mfma_f32_32x32x16_bf16 v[112:127], v[68:71], v[56:59], v[112:127]
    ds_read_b64_tr_b16 v[52:53], v36 offset:18432
    ds_read_b64_tr_b16 v[54:55], v36 offset:18944
    v_mfma_f32_32x32x16_bf16 v[144:159], v[68:71], v[60:63], v[144:159]
    s_waitcnt lgkmcnt(8)
    v_mfma_f32_32x32x16_bf16 v[96:111], v[80:83], v[72:75], v[96:111]
    v_mfma_f32_32x32x16_bf16 v[128:143], v[80:83], v[76:79], v[128:143]
    s_barrier
    s_waitcnt lgkmcnt(6)
    v_mfma_f32_32x32x16_bf16 v[112:127], v[84:87], v[72:75], v[112:127]
    v_mfma_f32_32x32x16_bf16 v[144:159], v[84:87], v[76:79], v[144:159]
    s_waitcnt lgkmcnt(2)
    v_mfma_f32_32x32x16_bf16 v[96:111], v[48:51], v[40:43], v[96:111]
    v_mfma_f32_32x32x16_bf16 v[128:143], v[48:51], v[44:47], v[128:143]
    s_waitcnt lgkmcnt(0)
    v_mfma_f32_32x32x16_bf16 v[112:127], v[52:55], v[40:43], v[112:127]
    v_mfma_f32_32x32x16_bf16 v[144:159], v[52:55], v[44:47], v[144:159]
    s_setprio 0
    s_lshl_b32 s54, s36, 1
    s_add_u32 s54, s54, s40
    s_mul_i32 s54, s54, 229376
    s_lshl_b32 s55, s101, 1
    s_add_u32 s55, s55, s41
    s_lshl_b32 s55, s55, 11
    s_add_u32 s55, s55, 6291456
    s_add_u32 s56, s54, s55
    s_add_u32 s57, s56, 114688
    ds_read_b32 v81, v32 offset:0
    ds_read_b32 v87, v32 offset:128
    s_waitcnt lgkmcnt(0)
    v_lshlrev_b32 v80, 16, v81
    v_and_b32 v81, 0xffff0000, v81
    v_rcp_f32 v85, v81
    v_mul_f32 v84, v81, v81
    v_mul_f32 v82, 0xc0135761, v85
    v_mul_f32 v83, v85, v85
    v_mul_f32 v83, v83, v85
    v_mul_f32 v83, 0xbdd2d3e8, v83
    v_lshlrev_b32 v86, 16, v87
    v_and_b32 v87, 0xffff0000, v87
    v_rcp_f32 v91, v87
    v_mul_f32 v90, v87, v87
    v_mul_f32 v88, 0xc0135761, v91
    v_mul_f32 v89, v91, v91
    v_mul_f32 v89, v89, v91
    v_mul_f32 v89, 0xbdd2d3e8, v89
    ds_read_b128 v[64:67], v30 offset:512
    ds_read_b128 v[68:71], v30 offset:544
    ds_read_b128 v[72:75], v30 offset:768
    ds_read_b128 v[76:79], v30 offset:800
    s_waitcnt lgkmcnt(0)
    s_barrier
    v_fma_f32 v96, -v80, v64, v96
    v_fma_f32 v104, -v80, v72, v104
    v_fma_f32 v97, -v80, v65, v97
    v_fma_f32 v105, -v80, v73, v105
    v_fma_f32 v98, -v80, v66, v98
    v_fma_f32 v106, -v80, v74, v106
    v_fma_f32 v99, -v80, v67, v99
    v_fma_f32 v107, -v80, v75, v107
    v_mul_f32 v40, v96, v96
    v_mul_f32 v41, v97, v97
    v_mul_f32 v42, v98, v98
    v_mul_f32 v43, v99, v99
    v_fma_f32 v40, v40, v83, v82
    v_fma_f32 v41, v41, v83, v82
    v_fma_f32 v42, v42, v83, v82
    v_fma_f32 v43, v43, v83, v82
    v_mul_f32 v40, v40, v96
    v_mul_f32 v41, v41, v97
    v_mul_f32 v42, v42, v98
    v_mul_f32 v43, v43, v99
    v_exp_f32 v40, v40
    v_exp_f32 v41, v41
    v_exp_f32 v42, v42
    v_exp_f32 v43, v43
    s_barrier
    v_mul_f32 v96, v96, v104
    v_mul_f32 v97, v97, v105
    v_mul_f32 v98, v98, v106
    v_mul_f32 v99, v99, v107
    v_fma_f32 v40, v40, v84, v84
    v_fma_f32 v41, v41, v84, v84
    v_fma_f32 v42, v42, v84, v84
    v_fma_f32 v43, v43, v84, v84
    v_rcp_f32 v40, v40
    v_rcp_f32 v41, v41
    v_rcp_f32 v42, v42
    v_rcp_f32 v43, v43
    v_mul_f32 v96, v96, v40
    v_mul_f32 v97, v97, v41
    v_mul_f32 v98, v98, v42
    v_mul_f32 v99, v99, v43
    v_cvt_pk_bf16_f32 v48, v96, v97
    v_cvt_pk_bf16_f32 v49, v98, v99
    v_fma_f32 v100, -v80, v68, v100
    v_fma_f32 v108, -v80, v76, v108
    v_fma_f32 v101, -v80, v69, v101
    v_fma_f32 v109, -v80, v77, v109
    v_fma_f32 v102, -v80, v70, v102
    v_fma_f32 v110, -v80, v78, v110
    v_fma_f32 v103, -v80, v71, v103
    v_fma_f32 v111, -v80, v79, v111
    v_mul_f32 v44, v100, v100
    v_mul_f32 v45, v101, v101
    v_mul_f32 v46, v102, v102
    s_barrier
    v_mul_f32 v47, v103, v103
    v_fma_f32 v44, v44, v83, v82
    v_fma_f32 v45, v45, v83, v82
    v_fma_f32 v46, v46, v83, v82
    v_fma_f32 v47, v47, v83, v82
    v_mul_f32 v44, v44, v100
    v_mul_f32 v45, v45, v101
    v_mul_f32 v46, v46, v102
    v_mul_f32 v47, v47, v103
    v_exp_f32 v44, v44
    v_exp_f32 v45, v45
    v_exp_f32 v46, v46
    v_exp_f32 v47, v47
    v_mul_f32 v100, v100, v108
    v_mul_f32 v101, v101, v109
    v_mul_f32 v102, v102, v110
    v_mul_f32 v103, v103, v111
    v_fma_f32 v44, v44, v84, v84
    v_fma_f32 v45, v45, v84, v84
    v_fma_f32 v46, v46, v84, v84
    v_fma_f32 v47, v47, v84, v84
    v_rcp_f32 v44, v44
    v_rcp_f32 v45, v45
    v_rcp_f32 v46, v46
    v_rcp_f32 v47, v47
    s_barrier
    v_mul_f32 v100, v100, v44
    v_mul_f32 v101, v101, v45
    v_mul_f32 v102, v102, v46
    v_mul_f32 v103, v103, v47
    v_cvt_pk_bf16_f32 v50, v100, v101
    v_cvt_pk_bf16_f32 v51, v102, v103
    buffer_store_dwordx4 v[48:51], v27, s[32:35], s56 offen offset:0 sc1
    v_fma_f32 v128, -v86, v64, v128
    v_fma_f32 v136, -v86, v72, v136
    v_fma_f32 v129, -v86, v65, v129
    v_fma_f32 v137, -v86, v73, v137
    v_fma_f32 v130, -v86, v66, v130
    v_fma_f32 v138, -v86, v74, v138
    v_fma_f32 v131, -v86, v67, v131
    v_fma_f32 v139, -v86, v75, v139
    v_mul_f32 v40, v128, v128
    v_mul_f32 v41, v129, v129
    v_mul_f32 v42, v130, v130
    v_mul_f32 v43, v131, v131
    v_fma_f32 v40, v40, v89, v88
    v_fma_f32 v41, v41, v89, v88
    v_fma_f32 v42, v42, v89, v88
    v_fma_f32 v43, v43, v89, v88
    v_mul_f32 v40, v40, v128
    v_mul_f32 v41, v41, v129
    v_mul_f32 v42, v42, v130
    v_mul_f32 v43, v43, v131
    v_exp_f32 v40, v40
    v_exp_f32 v41, v41
    s_barrier
    v_exp_f32 v42, v42
    v_exp_f32 v43, v43
    v_mul_f32 v128, v128, v136
    v_mul_f32 v129, v129, v137
    v_mul_f32 v130, v130, v138
    v_mul_f32 v131, v131, v139
    v_fma_f32 v40, v40, v90, v90
    v_fma_f32 v41, v41, v90, v90
    v_fma_f32 v42, v42, v90, v90
    v_fma_f32 v43, v43, v90, v90
    v_rcp_f32 v40, v40
    v_rcp_f32 v41, v41
    v_rcp_f32 v42, v42
    v_rcp_f32 v43, v43
    v_mul_f32 v128, v128, v40
    v_mul_f32 v129, v129, v41
    v_mul_f32 v130, v130, v42
    v_mul_f32 v131, v131, v43
    v_cvt_pk_bf16_f32 v52, v128, v129
    v_cvt_pk_bf16_f32 v53, v130, v131
    v_fma_f32 v132, -v86, v68, v132
    v_fma_f32 v140, -v86, v76, v140
    v_fma_f32 v133, -v86, v69, v133
    v_fma_f32 v141, -v86, v77, v141
    v_fma_f32 v134, -v86, v70, v134
    v_fma_f32 v142, -v86, v78, v142
    s_barrier
    v_fma_f32 v135, -v86, v71, v135
    v_fma_f32 v143, -v86, v79, v143
    v_mul_f32 v44, v132, v132
    v_mul_f32 v45, v133, v133
    v_mul_f32 v46, v134, v134
    v_mul_f32 v47, v135, v135
    v_fma_f32 v44, v44, v89, v88
    v_fma_f32 v45, v45, v89, v88
    v_fma_f32 v46, v46, v89, v88
    v_fma_f32 v47, v47, v89, v88
    v_mul_f32 v44, v44, v132
    v_mul_f32 v45, v45, v133
    v_mul_f32 v46, v46, v134
    v_mul_f32 v47, v47, v135
    v_exp_f32 v44, v44
    v_exp_f32 v45, v45
    v_exp_f32 v46, v46
    v_exp_f32 v47, v47
    v_mul_f32 v132, v132, v140
    v_mul_f32 v133, v133, v141
    v_mul_f32 v134, v134, v142
    v_mul_f32 v135, v135, v143
    v_fma_f32 v44, v44, v90, v90
    v_fma_f32 v45, v45, v90, v90
    v_fma_f32 v46, v46, v90, v90
    v_fma_f32 v47, v47, v90, v90
    v_rcp_f32 v44, v44
    s_barrier
    v_rcp_f32 v45, v45
    v_rcp_f32 v46, v46
    v_rcp_f32 v47, v47
    v_mul_f32 v132, v132, v44
    v_mul_f32 v133, v133, v45
    v_mul_f32 v134, v134, v46
    v_mul_f32 v135, v135, v47
    v_cvt_pk_bf16_f32 v54, v132, v133
    v_cvt_pk_bf16_f32 v55, v134, v135
    buffer_store_dwordx4 v[52:55], v27, s[32:35], s57 offen offset:0 sc1
    ds_read_b128 v[64:67], v30 offset:576
    ds_read_b128 v[68:71], v30 offset:608
    ds_read_b128 v[72:75], v30 offset:832
    ds_read_b128 v[76:79], v30 offset:864
    s_waitcnt lgkmcnt(0)
    v_fma_f32 v112, -v80, v64, v112
    v_fma_f32 v120, -v80, v72, v120
    v_fma_f32 v113, -v80, v65, v113
    v_fma_f32 v121, -v80, v73, v121
    v_fma_f32 v114, -v80, v66, v114
    v_fma_f32 v122, -v80, v74, v122
    v_fma_f32 v115, -v80, v67, v115
    v_fma_f32 v123, -v80, v75, v123
    v_mul_f32 v40, v112, v112
    v_mul_f32 v41, v113, v113
    s_barrier
    v_mul_f32 v42, v114, v114
    v_mul_f32 v43, v115, v115
    v_fma_f32 v40, v40, v83, v82
    v_fma_f32 v41, v41, v83, v82
    v_fma_f32 v42, v42, v83, v82
    v_fma_f32 v43, v43, v83, v82
    v_mul_f32 v40, v40, v112
    v_mul_f32 v41, v41, v113
    v_mul_f32 v42, v42, v114
    v_mul_f32 v43, v43, v115
    v_exp_f32 v40, v40
    v_exp_f32 v41, v41
    v_exp_f32 v42, v42
    v_exp_f32 v43, v43
    v_mul_f32 v112, v112, v120
    v_mul_f32 v113, v113, v121
    v_mul_f32 v114, v114, v122
    v_mul_f32 v115, v115, v123
    v_fma_f32 v40, v40, v84, v84
    v_fma_f32 v41, v41, v84, v84
    v_fma_f32 v42, v42, v84, v84
    v_fma_f32 v43, v43, v84, v84
    v_rcp_f32 v40, v40
    v_rcp_f32 v41, v41
    v_rcp_f32 v42, v42
    s_barrier
    v_rcp_f32 v43, v43
    v_mul_f32 v112, v112, v40
    v_mul_f32 v113, v113, v41
    v_mul_f32 v114, v114, v42
    v_mul_f32 v115, v115, v43
    v_cvt_pk_bf16_f32 v48, v112, v113
    v_cvt_pk_bf16_f32 v49, v114, v115
    v_fma_f32 v116, -v80, v68, v116
    v_fma_f32 v124, -v80, v76, v124
    v_fma_f32 v117, -v80, v69, v117
    v_fma_f32 v125, -v80, v77, v125
    v_fma_f32 v118, -v80, v70, v118
    v_fma_f32 v126, -v80, v78, v126
    v_fma_f32 v119, -v80, v71, v119
    v_fma_f32 v127, -v80, v79, v127
    v_mul_f32 v44, v116, v116
    v_mul_f32 v45, v117, v117
    v_mul_f32 v46, v118, v118
    v_mul_f32 v47, v119, v119
    v_fma_f32 v44, v44, v83, v82
    v_fma_f32 v45, v45, v83, v82
    v_fma_f32 v46, v46, v83, v82
    v_fma_f32 v47, v47, v83, v82
    v_mul_f32 v44, v44, v116
    v_mul_f32 v45, v45, v117
    v_mul_f32 v46, v46, v118
    v_mul_f32 v47, v47, v119
    v_exp_f32 v44, v44
    v_exp_f32 v45, v45
    s_barrier
    v_exp_f32 v46, v46
    v_exp_f32 v47, v47
    v_mul_f32 v116, v116, v124
    v_mul_f32 v117, v117, v125
    v_mul_f32 v118, v118, v126
    v_mul_f32 v119, v119, v127
    v_fma_f32 v44, v44, v84, v84
    v_fma_f32 v45, v45, v84, v84
    v_fma_f32 v46, v46, v84, v84
    v_fma_f32 v47, v47, v84, v84
    v_rcp_f32 v44, v44
    v_rcp_f32 v45, v45
    v_rcp_f32 v46, v46
    v_rcp_f32 v47, v47
    v_mul_f32 v116, v116, v44
    v_mul_f32 v117, v117, v45
    v_mul_f32 v118, v118, v46
    v_mul_f32 v119, v119, v47
    v_cvt_pk_bf16_f32 v50, v116, v117
    v_cvt_pk_bf16_f32 v51, v118, v119
    buffer_store_dwordx4 v[48:51], v27, s[32:35], s56 offen offset:1024 sc1
    v_fma_f32 v144, -v86, v64, v144
    v_fma_f32 v152, -v86, v72, v152
    v_fma_f32 v145, -v86, v65, v145
    v_fma_f32 v153, -v86, v73, v153
    v_fma_f32 v146, -v86, v66, v146
    s_barrier
    v_fma_f32 v154, -v86, v74, v154
    v_fma_f32 v147, -v86, v67, v147
    v_fma_f32 v155, -v86, v75, v155
    v_mul_f32 v40, v144, v144
    v_mul_f32 v41, v145, v145
    v_mul_f32 v42, v146, v146
    v_mul_f32 v43, v147, v147
    v_fma_f32 v40, v40, v89, v88
    v_fma_f32 v41, v41, v89, v88
    v_fma_f32 v42, v42, v89, v88
    v_fma_f32 v43, v43, v89, v88
    v_mul_f32 v40, v40, v144
    v_mul_f32 v41, v41, v145
    v_mul_f32 v42, v42, v146
    v_mul_f32 v43, v43, v147
    v_exp_f32 v40, v40
    v_exp_f32 v41, v41
    v_exp_f32 v42, v42
    v_exp_f32 v43, v43
    v_mul_f32 v144, v144, v152
    v_mul_f32 v145, v145, v153
    v_mul_f32 v146, v146, v154
    v_mul_f32 v147, v147, v155
    v_fma_f32 v40, v40, v90, v90
    v_fma_f32 v41, v41, v90, v90
    v_fma_f32 v42, v42, v90, v90
    v_fma_f32 v43, v43, v90, v90
    v_rcp_f32 v40, v40
    s_barrier
    v_rcp_f32 v41, v41
    v_rcp_f32 v42, v42
    v_rcp_f32 v43, v43
    v_mul_f32 v144, v144, v40
    v_mul_f32 v145, v145, v41
    v_mul_f32 v146, v146, v42
    v_mul_f32 v147, v147, v43
    v_cvt_pk_bf16_f32 v52, v144, v145
    v_cvt_pk_bf16_f32 v53, v146, v147
    v_fma_f32 v148, -v86, v68, v148
    v_fma_f32 v156, -v86, v76, v156
    v_fma_f32 v149, -v86, v69, v149
    v_fma_f32 v157, -v86, v77, v157
    v_fma_f32 v150, -v86, v70, v150
    v_fma_f32 v158, -v86, v78, v158
    v_fma_f32 v151, -v86, v71, v151
    v_fma_f32 v159, -v86, v79, v159
    v_mul_f32 v44, v148, v148
    v_mul_f32 v45, v149, v149
    v_mul_f32 v46, v150, v150
    v_mul_f32 v47, v151, v151
    v_fma_f32 v44, v44, v89, v88
    v_fma_f32 v45, v45, v89, v88
    v_fma_f32 v46, v46, v89, v88
    v_fma_f32 v47, v47, v89, v88
    v_mul_f32 v44, v44, v148
    v_mul_f32 v45, v45, v149
    v_mul_f32 v46, v46, v150
    s_barrier
    v_mul_f32 v47, v47, v151
    v_exp_f32 v44, v44
    v_exp_f32 v45, v45
    v_exp_f32 v46, v46
    v_exp_f32 v47, v47
    v_mul_f32 v148, v148, v156
    v_mul_f32 v149, v149, v157
    v_mul_f32 v150, v150, v158
    v_mul_f32 v151, v151, v159
    v_fma_f32 v44, v44, v90, v90
    v_fma_f32 v45, v45, v90, v90
    v_fma_f32 v46, v46, v90, v90
    v_fma_f32 v47, v47, v90, v90
    v_rcp_f32 v44, v44
    v_rcp_f32 v45, v45
    v_rcp_f32 v46, v46
    v_rcp_f32 v47, v47
    v_mul_f32 v148, v148, v44
    v_mul_f32 v149, v149, v45
    v_mul_f32 v150, v150, v46
    v_mul_f32 v151, v151, v47
    v_cvt_pk_bf16_f32 v54, v148, v149
    v_cvt_pk_bf16_f32 v55, v150, v151
    buffer_store_dwordx4 v[52:55], v27, s[32:35], s57 offen offset:1024 sc1
    s_barrier
    s_lshl_b32 s14, s36, 1
    s_add_u32 s14, s14, s40
    s_lshl_b32 s14, s14, 5
    s_and_b32 s15, s101, -2
    s_add_u32 s14, s14, s15
    s_add_u32 s14, s14, s41
    s_lshl_b32 s14, s14, 2
    s_and_b32 s15, s101, 1
    s_lshl_b32 s15, s15, 12
    s_add_u32 s14, s14, s15
    s_add_u32 s14, s14, 16789504
    s_waitcnt vmcnt(0)
    v_mov_b32 v1, s49
    v_mov_b32 v2, 0
    s_mov_b64 exec, 1
    buffer_store_dword v1, v2, s[32:35], s14 offen offset:0 sc1
    s_mov_b64 exec, -1
    s_branch L_P2poll
L_AP:
    s_mov_b32 s60, s37
    s_lshl_b32 s101, s37, 1
    s_mov_b32 s20, s6
    s_mov_b32 s21, s7
    s_mov_b32 s22, 1204224
    s_mov_b32 s23, 0x00020000
    s_and_b32 s14, s36, 7
    s_mul_i32 s14, s14, 150528
    s_and_b32 s15, s39, 1
    s_add_u32 s15, s15, s60
    s_lshl_b32 s15, s15, 7
    s_add_u32 s14, s14, s15
    v_min_u32 v1, 55, v0
    v_mul_u32_u24 v1, 2688, v1
    buffer_load_dword v39, v1, s[20:23], s14 offen
    s_and_b32 s40, s38, 1
    s_lshr_b32 s41, s39, 1
    s_mov_b32 s50, 0
    s_mov_b32 s51, -1
    v_and_b32 v7, 31, v0
    v_lshrrev_b32 v8, 5, v0
    v_bfe_u32 v9, v0, 1, 3
    v_xor_b32 v9, v9, v8
    v_lshlrev_b32 v9, 4, v9
    v_lshl_add_u32 v9, v7, 7, v9
    s_lshl_b32 s15, s40, 13
    v_add_u32 v16, s15, v9
    v_xor_b32 v17, 32, v16
    v_xor_b32 v18, 64, v16
    v_xor_b32 v19, 96, v16
    v_add_u32 v20, 0x10000, v16
    v_add_u32 v21, 0x10000, v17
    v_add_u32 v22, 0x10000, v18
    v_add_u32 v23, 0x10000, v19
    v_bfe_u32 v10, v0, 2, 2
    v_and_b32 v11, 3, v0
    v_bfe_u32 v12, v0, 4, 1
    v_bfe_u32 v13, v0, 3, 1
    v_lshlrev_b32 v13, 2, v13
    v_lshlrev_b32 v14, 10, v8
    v_lshl_add_u32 v14, v10, 7, v14
    v_add_u32 v14, 114688, v14
    v_lshl_add_u32 v2, v12, 2, v11
    s_lshl_b32 s15, s41, 3
    v_add_u32 v3, s15, v2
    v_lshrrev_b32 v1, 1, v3
    v_xor_b32 v1, v1, v13
    v_lshl_add_u32 v1, v1, 4, v14
    v_and_b32 v15, 1, v3
    v_lshl_add_u32 v26, v15, 3, v1
    v_add_u32 v4, 8, v2
    s_lshl_b32 s14, s41, 1
    s_lshl_b32 s15, s41, 12
    v_lshrrev_b32 v1, 1, v2
    v_xor_b32 v1, v1, v13
    v_xor_b32 v1, s14, v1
    v_lshl_add_u32 v1, v1, 4, v14
    v_and_b32 v15, 1, v2
    v_lshl_add_u32 v24, v15, 3, v1
    v_add_u32 v24, s15, v24
    v_lshrrev_b32 v1, 1, v4
    v_xor_b32 v1, v1, v13
    v_xor_b32 v1, s14, v1
    v_lshl_add_u32 v1, v1, 4, v14
    v_and_b32 v15, 1, v4
    v_lshl_add_u32 v25, v15, 3, v1
    v_add_u32 v25, s15, v25
    s_lshl_b32 s14, s41, 8
    s_add_u32 s14, s14, 155648
    v_lshl_add_u32 v37, v8, 4, s14
    v_lshrrev_b32 v1, 1, v11
    v_xor_b32 v1, v1, v13
    v_lshlrev_b32 v3, 1, v12
    v_xor_b32 v1, v1, v3
    s_lshl_b32 s14, s41, 2
    v_xor_b32 v1, s14, v1
    v_lshl_add_u32 v1, v1, 4, v14
    v_and_b32 v15, 1, v11
    v_lshl_add_u32 v1, v15, 3, v1
    v_lshl_add_u32 v35, v12, 12, v1
    v_xor_b32 v36, 32, v35
    s_lshl_b32 s14, s41, 7
    s_add_u32 s14, s14, 155648
    v_lshl_add_u32 v30, v8, 4, s14
    s_lshl_b32 s14, s41, 7
    s_add_u32 s14, s14, 155648
    v_lshl_add_u32 v31, v8, 4, s14
    s_lshl_b32 s14, s40, 8
    s_add_u32 s14, s14, 155648
    v_lshl_add_u32 v32, v7, 2, s14
    v_lshlrev_b32 v27, 4, v0
    v_lshlrev_b32 v28, 3, v7
    v_mov_b32 v29, v8
    s_mov_b32 s60, s37
    s_lshl_b32 s101, s37, 1
    s_and_b32 s3, s2, 7
    s_and_b32 s14, s78, 1
    s_lshl_b32 s74, s3, 1
    s_add_u32 s74, s74, s14
    s_lshr_b32 s75, s78, 1
    s_mul_i32 s14, s3, 29
    s_sub_u32 s15, s3, 4
    s_max_i32 s15, s15, 0
    s_add_u32 s14, s14, s15
    s_cmp_eq_u32 s3, 7
    s_cselect_b32 s14, 200, s14
    s_cmp_lt_u32 s3, 4
    s_cselect_b32 s15, 29, 30
    s_cmp_lt_u32 s3, 6
    s_cselect_b32 s15, s15, 24
    s_add_u32 s14, s14, s78
    s_mul_i32 s76, s14, 9363
    s_lshr_b32 s76, s76, 16
    s_mul_i32 s77, s76, 7
    s_sub_u32 s77, s14, s77
    s_cmp_ge_u32 s78, s15
    s_cselect_b32 s76, 32, s76
    s_mov_b32 s43, 0
    s_barrier
    s_setprio 2
    ds_read_b64_tr_b16 v[48:49], v24 offset:0
    ds_read_b64_tr_b16 v[50:51], v24 offset:512
    ds_read_b128 v[40:43], v16 offset:0
    ds_read_b128 v[44:47], v16 offset:4096
    ds_read_b64_tr_b16 v[52:53], v25 offset:0
    ds_read_b64_tr_b16 v[54:55], v25 offset:512
    ds_read_b64_tr_b16 v[64:65], v24 offset:2048
    ds_read_b64_tr_b16 v[66:67], v24 offset:2560
    ds_read_b128 v[56:59], v17 offset:0
    ds_read_b128 v[60:63], v17 offset:4096
    ds_read_b64_tr_b16 v[68:69], v25 offset:2048
    ds_read_b64_tr_b16 v[70:71], v25 offset:2560
    s_waitcnt lgkmcnt(8)
    v_mfma_f32_32x32x16_bf16 v[96:111], v[48:51], v[40:43], 0
    v_mfma_f32_32x32x16_bf16 v[128:143], v[48:51], v[44:47], 0
    s_barrier
    s_waitcnt lgkmcnt(6)
    v_mfma_f32_32x32x16_bf16 v[112:127], v[52:55], v[40:43], 0
    ds_read_b64_tr_b16 v[80:81], v24 offset:8192
    ds_read_b64_tr_b16 v[82:83], v24 offset:8704
    ds_read_b128 v[72:75], v18 offset:0
    ds_read_b128 v[76:79], v18 offset:4096
    v_mfma_f32_32x32x16_bf16 v[144:159], v[52:55], v[44:47], 0
    ds_read_b64_tr_b16 v[84:85], v25 offset:8192
    ds_read_b64_tr_b16 v[86:87], v25 offset:8704
    s_waitcnt lgkmcnt(8)
    v_mfma_f32_32x32x16_bf16 v[96:111], v[64:67], v[56:59], v[96:111]
    ds_read_b64_tr_b16 v[48:49], v24 offset:10240
    ds_read_b64_tr_b16 v[50:51], v24 offset:10752
    v_mfma_f32_32x32x16_bf16 v[128:143], v[64:67], v[60:63], v[128:143]
    ds_read_b128 v[40:43], v19 offset:0
    ds_read_b128 v[44:47], v19 offset:4096
    s_waitcnt lgkmcnt(10)
    v_mfma_f32_32x32x16_bf16 v[112:127], v[68:71], v[56:59], v[112:127]
    ds_read_b64_tr_b16 v[52:53], v25 offset:10240
    ds_read_b64_tr_b16 v[54:55], v25 offset:10752
    v_mfma_f32_32x32x16_bf16 v[144:159], v[68:71], v[60:63], v[144:159]
    s_waitcnt lgkmcnt(8)
    v_mfma_f32_32x32x16_bf16 v[96:111], v[80:83], v[72:75], v[96:111]
    v_mfma_f32_32x32x16_bf16 v[128:143], v[80:83], v[76:79], v[128:143]
    s_barrier
    s_waitcnt lgkmcnt(6)
    v_mfma_f32_32x32x16_bf16 v[112:127], v[84:87], v[72:75], v[112:127]
    ds_read_b64_tr_b16 v[64:65], v24 offset:16384
    ds_read_b64_tr_b16 v[66:67], v24 offset:16896
    ds_read_b128 v[56:59], v16 offset:16384
    ds_read_b128 v[60:63], v16 offset:20480
    v_mfma_f32_32x32x16_bf16 v[144:159], v[84:87], v[76:79], v[144:159]
    ds_read_b64_tr_b16 v[68:69], v25 offset:16384
    ds_read_b64_tr_b16 v[70:71], v25 offset:16896
    s_waitcnt lgkmcnt(8)
    v_mfma_f32_32x32x16_bf16 v[96:111], v[48:51], v[40:43], v[96:111]
    ds_read_b64_tr_b16 v[80:81], v24 offset:18432
    ds_read_b64_tr_b16 v[82:83], v24 offset:18944
    v_mfma_f32_32x32x16_bf16 v[128:143], v[48:51], v[44:47], v[128:143]
    ds_read_b128 v[72:75], v17 offset:16384
    ds_read_b128 v[76:79], v17 offset:20480
    s_waitcnt lgkmcnt(10)
    v_mfma_f32_32x32x16_bf16 v[112:127], v[52:55], v[40:43], v[112:127]
    ds_read_b64_tr_b16 v[84:85], v25 offset:18432
    ds_read_b64_tr_b16 v[86:87], v25 offset:18944
    v_mfma_f32_32x32x16_bf16 v[144:159], v[52:55], v[44:47], v[144:159]
    s_waitcnt lgkmcnt(8)
    v_mfma_f32_32x32x16_bf16 v[96:111], v[64:67], v[56:59], v[96:111]
    v_mfma_f32_32x32x16_bf16 v[128:143], v[64:67], v[60:63], v[128:143]
    s_barrier
    s_waitcnt lgkmcnt(6)
    v_mfma_f32_32x32x16_bf16 v[112:127], v[68:71], v[56:59], v[112:127]
    ds_read_b64_tr_b16 v[48:49], v24 offset:24576
    ds_read_b64_tr_b16 v[50:51], v24 offset:25088
    ds_read_b128 v[40:43], v18 offset:16384
    ds_read_b128 v[44:47], v18 offset:20480
    v_mfma_f32_32x32x16_bf16 v[144:159], v[68:71], v[60:63], v[144:159]
    ds_read_b64_tr_b16 v[52:53], v25 offset:24576
    ds_read_b64_tr_b16 v[54:55], v25 offset:25088
    s_waitcnt lgkmcnt(8)
    v_mfma_f32_32x32x16_bf16 v[96:111], v[80:83], v[72:75], v[96:111]
    ds_read_b64_tr_b16 v[64:65], v24 offset:26624
    ds_read_b64_tr_b16 v[66:67], v24 offset:27136
    v_mfma_f32_32x32x16_bf16 v[128:143], v[80:83], v[76:79], v[128:143]
    ds_read_b128 v[56:59], v19 offset:16384
    ds_read_b128 v[60:63], v19 offset:20480
    s_waitcnt lgkmcnt(10)
    v_mfma_f32_32x32x16_bf16 v[112:127], v[84:87], v[72:75], v[112:127]
    ds_read_b64_tr_b16 v[68:69], v25 offset:26624
    ds_read_b64_tr_b16 v[70:71], v25 offset:27136
    v_mfma_f32_32x32x16_bf16 v[144:159], v[84:87], v[76:79], v[144:159]
    s_waitcnt lgkmcnt(8)
    v_mfma_f32_32x32x16_bf16 v[96:111], v[48:51], v[40:43], v[96:111]
    v_mfma_f32_32x32x16_bf16 v[128:143], v[48:51], v[44:47], v[128:143]
    s_barrier
    s_waitcnt lgkmcnt(6)
    v_mfma_f32_32x32x16_bf16 v[112:127], v[52:55], v[40:43], v[112:127]
    ds_read_b64_tr_b16 v[80:81], v24 offset:32768
    ds_read_b64_tr_b16 v[82:83], v24 offset:33280
    ds_read_b128 v[72:75], v16 offset:32768
    ds_read_b128 v[76:79], v16 offset:36864
    v_mfma_f32_32x32x16_bf16 v[144:159], v[52:55], v[44:47], v[144:159]
    ds_read_b64_tr_b16 v[84:85], v25 offset:32768
    ds_read_b64_tr_b16 v[86:87], v25 offset:33280
    s_waitcnt lgkmcnt(8)
    v_mfma_f32_32x32x16_bf16 v[96:111], v[64:67], v[56:59], v[96:111]
    ds_read_b64_tr_b16 v[48:49], v24 offset:34816
    ds_read_b64_tr_b16 v[50:51], v24 offset:35328
    v_mfma_f32_32x32x16_bf16 v[128:143], v[64:67], v[60:63], v[128:143]
    ds_read_b128 v[40:43], v17 offset:32768
    ds_read_b128 v[44:47], v17 offset:36864
    s_waitcnt lgkmcnt(10)
    v_mfma_f32_32x32x16_bf16 v[112:127], v[68:71], v[56:59], v[112:127]
    ds_read_b64_tr_b16 v[52:53], v25 offset:34816
    ds_read_b64_tr_b16 v[54:55], v25 offset:35328
    v_mfma_f32_32x32x16_bf16 v[144:159], v[68:71], v[60:63], v[144:159]
    s_waitcnt lgkmcnt(8)
    v_mfma_f32_32x32x16_bf16 v[96:111], v[80:83], v[72:75], v[96:111]
    v_mfma_f32_32x32x16_bf16 v[128:143], v[80:83], v[76:79], v[128:143]
    s_barrier
    s_waitcnt lgkmcnt(6)
    v_mfma_f32_32x32x16_bf16 v[112:127], v[84:87], v[72:75], v[112:127]
    ds_read_b64_tr_b16 v[64:65], v24 offset:0
    ds_read_b64_tr_b16 v[66:67], v24 offset:512
    ds_read_b128 v[56:59], v18 offset:32768
    ds_read_b128 v[60:63], v18 offset:36864
    v_mfma_f32_32x32x16_bf16 v[144:159], v[84:87], v[76:79], v[144:159]
    ds_read_b64_tr_b16 v[68:69], v25 offset:0
    ds_read_b64_tr_b16 v[70:71], v25 offset:512
    s_waitcnt lgkmcnt(8)
    v_mfma_f32_32x32x16_bf16 v[96:111], v[48:51], v[40:43], v[96:111]
    ds_read_b64_tr_b16 v[80:81], v24 offset:2048
    ds_read_b64_tr_b16 v[82:83], v24 offset:2560
    v_mfma_f32_32x32x16_bf16 v[128:143], v[48:51], v[44:47], v[128:143]
    ds_read_b128 v[72:75], v19 offset:32768
    ds_read_b128 v[76:79], v19 offset:36864
    s_waitcnt lgkmcnt(10)
    v_mfma_f32_32x32x16_bf16 v[112:127], v[52:55], v[40:43], v[112:127]
    ds_read_b64_tr_b16 v[84:85], v25 offset:2048
    ds_read_b64_tr_b16 v[86:87], v25 offset:2560
    v_mfma_f32_32x32x16_bf16 v[144:159], v[52:55], v[44:47], v[144:159]
    s_waitcnt lgkmcnt(8)
    v_mfma_f32_32x32x16_bf16 v[96:111], v[64:67], v[56:59], v[96:111]
    v_mfma_f32_32x32x16_bf16 v[128:143], v[64:67], v[60:63], v[128:143]
    s_barrier
    s_waitcnt lgkmcnt(6)
    v_mfma_f32_32x32x16_bf16 v[112:127], v[68:71], v[56:59], v[112:127]
    ds_read_b64_tr_b16 v[48:49], v24 offset:8192
    ds_read_b64_tr_b16 v[50:51], v24 offset:8704
    ds_read_b128 v[40:43], v16 offset:49152
    ds_read_b128 v[44:47], v16 offset:53248
    v_mfma_f32_32x32x16_bf16 v[144:159], v[68:71], v[60:63], v[144:159]
    ds_read_b64_tr_b16 v[52:53], v25 offset:8192
    ds_read_b64_tr_b16 v[54:55], v25 offset:8704
    s_waitcnt lgkmcnt(8)
    v_mfma_f32_32x32x16_bf16 v[96:111], v[80:83], v[72:75], v[96:111]
    ds_read_b64_tr_b16 v[64:65], v24 offset:10240
    ds_read_b64_tr_b16 v[66:67], v24 offset:10752
    v_mfma_f32_32x32x16_bf16 v[128:143], v[80:83], v[76:79], v[128:143]
    ds_read_b128 v[56:59], v17 offset:49152
    ds_read_b128 v[60:63], v17 offset:53248
    s_waitcnt lgkmcnt(10)
    v_mfma_f32_32x32x16_bf16 v[112:127], v[84:87], v[72:75], v[112:127]
    ds_read_b64_tr_b16 v[68:69], v25 offset:10240
    ds_read_b64_tr_b16 v[70:71], v25 offset:10752
    v_mfma_f32_32x32x16_bf16 v[144:159], v[84:87], v[76:79], v[144:159]
    s_waitcnt lgkmcnt(8)
    v_mfma_f32_32x32x16_bf16 v[96:111], v[48:51], v[40:43], v[96:111]
    v_mfma_f32_32x32x16_bf16 v[128:143], v[48:51], v[44:47], v[128:143]
    s_barrier
    s_waitcnt lgkmcnt(6)
    v_mfma_f32_32x32x16_bf16 v[112:127], v[52:55], v[40:43], v[112:127]
    ds_read_b64_tr_b16 v[80:81], v24 offset:16384
    ds_read_b64_tr_b16 v[82:83], v24 offset:16896
    ds_read_b128 v[72:75], v18 offset:49152
    ds_read_b128 v[76:79], v18 offset:53248
    v_mfma_f32_32x32x16_bf16 v[144:159], v[52:55], v[44:47], v[144:159]
    ds_read_b64_tr_b16 v[84:85], v25 offset:16384
    ds_read_b64_tr_b16 v[86:87], v25 offset:16896
    s_waitcnt lgkmcnt(8)
    v_mfma_f32_32x32x16_bf16 v[96:111], v[64:67], v[56:59], v[96:111]
    ds_read_b64_tr_b16 v[48:49], v24 offset:18432
    ds_read_b64_tr_b16 v[50:51], v24 offset:18944
    v_mfma_f32_32x32x16_bf16 v[128:143], v[64:67], v[60:63], v[128:143]
    ds_read_b128 v[40:43], v19 offset:49152
    ds_read_b128 v[44:47], v19 offset:53248
    s_waitcnt lgkmcnt(10)
    v_mfma_f32_32x32x16_bf16 v[112:127], v[68:71], v[56:59], v[112:127]
    ds_read_b64_tr_b16 v[52:53], v25 offset:18432
    ds_read_b64_tr_b16 v[54:55], v25 offset:18944
    v_mfma_f32_32x32x16_bf16 v[144:159], v[68:71], v[60:63], v[144:159]
    s_waitcnt lgkmcnt(8)
    v_mfma_f32_32x32x16_bf16 v[96:111], v[80:83], v[72:75], v[96:111]
    v_mfma_f32_32x32x16_bf16 v[128:143], v[80:83], v[76:79], v[128:143]
    s_barrier
    s_waitcnt lgkmcnt(6)
    v_mfma_f32_32x32x16_bf16 v[112:127], v[84:87], v[72:75], v[112:127]
    ds_read_b64_tr_b16 v[64:65], v24 offset:24576
    ds_read_b64_tr_b16 v[66:67], v24 offset:25088
    ds_read_b128 v[56:59], v20 offset:0
    ds_read_b128 v[60:63], v20 offset:4096
    v_mfma_f32_32x32x16_bf16 v[144:159], v[84:87], v[76:79], v[144:159]
    ds_read_b64_tr_b16 v[68:69], v25 offset:24576
    ds_read_b64_tr_b16 v[70:71], v25 offset:25088
    s_waitcnt lgkmcnt(8)
    v_mfma_f32_32x32x16_bf16 v[96:111], v[48:51], v[40:43], v[96:111]
    ds_read_b64_tr_b16 v[80:81], v24 offset:26624
    ds_read_b64_tr_b16 v[82:83], v24 offset:27136
    v_mfma_f32_32x32x16_bf16 v[128:143], v[48:51], v[44:47], v[128:143]
    ds_read_b128 v[72:75], v21 offset:0
    ds_read_b128 v[76:79], v21 offset:4096
    s_waitcnt lgkmcnt(10)
    v_mfma_f32_32x32x16_bf16 v[112:127], v[52:55], v[40:43], v[112:127]
    ds_read_b64_tr_b16 v[84:85], v25 offset:26624
    ds_read_b64_tr_b16 v[86:87], v25 offset:27136
    v_mfma_f32_32x32x16_bf16 v[144:159], v[52:55], v[44:47], v[144:159]
    s_waitcnt lgkmcnt(8)
    v_mfma_f32_32x32x16_bf16 v[96:111], v[64:67], v[56:59], v[96:111]
    v_mfma_f32_32x32x16_bf16 v[128:143], v[64:67], v[60:63], v[128:143]
    s_barrier
    s_waitcnt lgkmcnt(6)
    v_mfma_f32_32x32x16_bf16 v[112:127], v[68:71], v[56:59], v[112:127]
    ds_read_b64_tr_b16 v[48:49], v24 offset:32768
    ds_read_b64_tr_b16 v[50:51], v24 offset:33280
    ds_read_b128 v[40:43], v22 offset:0
    ds_read_b128 v[44:47], v22 offset:4096
    v_mfma_f32_32x32x16_bf16 v[144:159], v[68:71], v[60:63], v[144:159]
    ds_read_b64_tr_b16 v[52:53], v25 offset:32768
    ds_read_b64_tr_b16 v[54:55], v25 offset:33280
    s_waitcnt lgkmcnt(8)
    v_mfma_f32_32x32x16_bf16 v[96:111], v[80:83], v[72:75], v[96:111]
    ds_read_b64_tr_b16 v[64:65], v24 offset:34816
    ds_read_b64_tr_b16 v[66:67], v24 offset:35328
    v_mfma_f32_32x32x16_bf16 v[128:143], v[80:83], v[76:79], v[128:143]
    ds_read_b128 v[56:59], v23 offset:0
    ds_read_b128 v[60:63], v23 offset:4096
    s_waitcnt lgkmcnt(10)
    v_mfma_f32_32x32x16_bf16 v[112:127], v[84:87], v[72:75], v[112:127]
    ds_read_b64_tr_b16 v[68:69], v25 offset:34816
    ds_read_b64_tr_b16 v[70:71], v25 offset:35328
    v_mfma_f32_32x32x16_bf16 v[144:159], v[84:87], v[76:79], v[144:159]
    s_waitcnt lgkmcnt(8)
    v_mfma_f32_32x32x16_bf16 v[96:111], v[48:51], v[40:43], v[96:111]
    v_mfma_f32_32x32x16_bf16 v[128:143], v[48:51], v[44:47], v[128:143]
    s_barrier
    s_waitcnt lgkmcnt(6)
    v_mfma_f32_32x32x16_bf16 v[112:127], v[52:55], v[40:43], v[112:127]
    ds_read_b64_tr_b16 v[80:81], v24 offset:0
    ds_read_b64_tr_b16 v[82:83], v24 offset:512
    ds_read_b128 v[72:75], v20 offset:16384
    ds_read_b128 v[76:79], v20 offset:20480
    v_mfma_f32_32x32x16_bf16 v[144:159], v[52:55], v[44:47], v[144:159]
    ds_read_b64_tr_b16 v[84:85], v25 offset:0
    ds_read_b64_tr_b16 v[86:87], v25 offset:512
    s_waitcnt lgkmcnt(8)
    v_mfma_f32_32x32x16_bf16 v[96:111], v[64:67], v[56:59], v[96:111]
    ds_read_b64_tr_b16 v[48:49], v24 offset:2048
    ds_read_b64_tr_b16 v[50:51], v24 offset:2560
    v_mfma_f32_32x32x16_bf16 v[128:143], v[64:67], v[60:63], v[128:143]
    ds_read_b128 v[40:43], v21 offset:16384
    ds_read_b128 v[44:47], v21 offset:20480
    s_waitcnt lgkmcnt(10)
    v_mfma_f32_32x32x16_bf16 v[112:127], v[68:71], v[56:59], v[112:127]
    ds_read_b64_tr_b16 v[52:53], v25 offset:2048
    ds_read_b64_tr_b16 v[54:55], v25 offset:2560
    v_mfma_f32_32x32x16_bf16 v[144:159], v[68:71], v[60:63], v[144:159]
    s_waitcnt lgkmcnt(8)
    v_mfma_f32_32x32x16_bf16 v[96:111], v[80:83], v[72:75], v[96:111]
    v_mfma_f32_32x32x16_bf16 v[128:143], v[80:83], v[76:79], v[128:143]
    s_barrier
    s_waitcnt lgkmcnt(6)
    v_mfma_f32_32x32x16_bf16 v[112:127], v[84:87], v[72:75], v[112:127]
    ds_read_b64_tr_b16 v[64:65], v24 offset:8192
    ds_read_b64_tr_b16 v[66:67], v24 offset:8704
    ds_read_b128 v[56:59], v22 offset:16384
    ds_read_b128 v[60:63], v22 offset:20480
    v_mfma_f32_32x32x16_bf16 v[144:159], v[84:87], v[76:79], v[144:159]
    ds_read_b64_tr_b16 v[68:69], v25 offset:8192
    ds_read_b64_tr_b16 v[70:71], v25 offset:8704
    s_waitcnt lgkmcnt(8)
    v_mfma_f32_32x32x16_bf16 v[96:111], v[48:51], v[40:43], v[96:111]
    ds_read_b64_tr_b16 v[80:81], v24 offset:10240
    ds_read_b64_tr_b16 v[82:83], v24 offset:10752
    v_mfma_f32_32x32x16_bf16 v[128:143], v[48:51], v[44:47], v[128:143]
    ds_read_b128 v[72:75], v23 offset:16384
    ds_read_b128 v[76:79], v23 offset:20480
    s_waitcnt lgkmcnt(10)
    v_mfma_f32_32x32x16_bf16 v[112:127], v[52:55], v[40:43], v[112:127]
    ds_read_b64_tr_b16 v[84:85], v25 offset:10240
    ds_read_b64_tr_b16 v[86:87], v25 offset:10752
    v_mfma_f32_32x32x16_bf16 v[144:159], v[52:55], v[44:47], v[144:159]
    s_waitcnt lgkmcnt(8)
    v_mfma_f32_32x32x16_bf16 v[96:111], v[64:67], v[56:59], v[96:111]
    v_mfma_f32_32x32x16_bf16 v[128:143], v[64:67], v[60:63], v[128:143]
    s_barrier
    s_waitcnt lgkmcnt(6)
    v_mfma_f32_32x32x16_bf16 v[112:127], v[68:71], v[56:59], v[112:127]
    ds_read_b64_tr_b16 v[48:49], v24 offset:16384
    ds_read_b64_tr_b16 v[50:51], v24 offset:16896
    ds_read_b128 v[40:43], v20 offset:32768
    ds_read_b128 v[44:47], v20 offset:36864
    v_mfma_f32_32x32x16_bf16 v[144:159], v[68:71], v[60:63], v[144:159]
    ds_read_b64_tr_b16 v[52:53], v25 offset:16384
    ds_read_b64_tr_b16 v[54:55], v25 offset:16896
    s_waitcnt lgkmcnt(8)
    v_mfma_f32_32x32x16_bf16 v[96:111], v[80:83], v[72:75], v[96:111]
    ds_read_b64_tr_b16 v[64:65], v24 offset:18432
    ds_read_b64_tr_b16 v[66:67], v24 offset:18944
    v_mfma_f32_32x32x16_bf16 v[128:143], v[80:83], v[76:79], v[128:143]
    ds_read_b128 v[56:59], v21 offset:32768
    ds_read_b128 v[60:63], v21 offset:36864
    s_waitcnt lgkmcnt(10)
    v_mfma_f32_32x32x16_bf16 v[112:127], v[84:87], v[72:75], v[112:127]
    ds_read_b64_tr_b16 v[68:69], v25 offset:18432
    ds_read_b64_tr_b16 v[70:71], v25 offset:18944
    v_mfma_f32_32x32x16_bf16 v[144:159], v[84:87], v[76:79], v[144:159]
    s_waitcnt lgkmcnt(8)
    v_mfma_f32_32x32x16_bf16 v[96:111], v[48:51], v[40:43], v[96:111]
    v_mfma_f32_32x32x16_bf16 v[128:143], v[48:51], v[44:47], v[128:143]
    s_barrier
    s_waitcnt lgkmcnt(6)
    v_mfma_f32_32x32x16_bf16 v[112:127], v[52:55], v[40:43], v[112:127]
    ds_read_b64_tr_b16 v[80:81], v24 offset:24576
    ds_read_b64_tr_b16 v[82:83], v24 offset:25088
    ds_read_b128 v[72:75], v22 offset:32768
    ds_read_b128 v[76:79], v22 offset:36864
    v_mfma_f32_32x32x16_bf16 v[144:159], v[52:55], v[44:47], v[144:159]
    ds_read_b64_tr_b16 v[84:85], v25 offset:24576
    ds_read_b64_tr_b16 v[86:87], v25 offset:25088
    s_waitcnt lgkmcnt(8)
    v_mfma_f32_32x32x16_bf16 v[96:111], v[64:67], v[56:59], v[96:111]
    ds_read_b64_tr_b16 v[48:49], v24 offset:26624
    ds_read_b64_tr_b16 v[50:51], v24 offset:27136
    v_mfma_f32_32x32x16_bf16 v[128:143], v[64:67], v[60:63], v[128:143]
    ds_read_b128 v[40:43], v23 offset:32768
    ds_read_b128 v[44:47], v23 offset:36864
    s_waitcnt lgkmcnt(10)
    v_mfma_f32_32x32x16_bf16 v[112:127], v[68:71], v[56:59], v[112:127]
    ds_read_b64_tr_b16 v[52:53], v25 offset:26624
    ds_read_b64_tr_b16 v[54:55], v25 offset:27136
    v_mfma_f32_32x32x16_bf16 v[144:159], v[68:71], v[60:63], v[144:159]
    s_waitcnt lgkmcnt(8)
    v_mfma_f32_32x32x16_bf16 v[96:111], v[80:83], v[72:75], v[96:111]
    v_mfma_f32_32x32x16_bf16 v[128:143], v[80:83], v[76:79], v[128:143]
    s_barrier
    s_waitcnt lgkmcnt(6)
    v_mfma_f32_32x32x16_bf16 v[112:127], v[84:87], v[72:75], v[112:127]
    v_mfma_f32_32x32x16_bf16 v[144:159], v[84:87], v[76:79], v[144:159]
    s_waitcnt lgkmcnt(2)
    v_mfma_f32_32x32x16_bf16 v[96:111], v[48:51], v[40:43], v[96:111]
    v_mfma_f32_32x32x16_bf16 v[128:143], v[48:51], v[44:47], v[128:143]
    s_waitcnt lgkmcnt(0)
    v_mfma_f32_32x32x16_bf16 v[112:127], v[52:55], v[40:43], v[112:127]
    v_mfma_f32_32x32x16_bf16 v[144:159], v[52:55], v[44:47], v[144:159]
    s_setprio 0
    s_waitcnt vmcnt(0)
    ds_read_b32 v81, v32 offset:0
    ds_read_b32 v87, v32 offset:128
    s_waitcnt lgkmcnt(0)
    v_lshlrev_b32 v80, 16, v81
    v_and_b32 v81, 0xffff0000, v81
    v_rcp_f32 v85, v81
    v_lshlrev_b32 v86, 16, v87
    v_and_b32 v87, 0xffff0000, v87
    v_rcp_f32 v91, v87
    ds_read_b128 v[64:67], v37 offset:1536
    ds_read_b128 v[68:71], v37 offset:1568
    ds_read_b128 v[72:75], v37 offset:1600
    ds_read_b128 v[76:79], v37 offset:1632
    s_waitcnt lgkmcnt(0)
    s_add_u32 s54, s60, s41
    s_mov_b32 s55, 0
    s_mul_i32 s57, s54, 37
    s_lshr_b32 s57, s57, 8
    s_mul_i32 s14, s57, 7
    s_sub_u32 s14, s54, s14
    s_lshl_b32 s14, s14, 1
    s_add_u32 s14, s14, s55
    s_lshl_b32 s14, s14, 5
    s_getpc_b64 s[12:13]
L_tpqP0:
    s_add_u32 s14, s14, L_tab-L_tpqP0
    s_load_dwordx8 s[4:11], s[12:13], s14
    s_lshl_b32 s56, s57, 21
    s_lshl_b32 s54, s36, 1
    s_add_u32 s54, s54, s40
    s_lshl_b32 s54, s54, 12
    s_add_u32 s56, s56, s54
    s_cmp_eq_u32 s57, 0
    s_cselect_b32 s61, 0x3e8b97f6, 1.0
    s_cselect_b32 s14, 0, 0x3f80
    s_cmp_eq_u32 s57, 1
    s_cselect_b32 s14, 0x3f803f80, s14
    s_cselect_b32 s15, 0x3f80, 0
    v_mov_b32 v38, s14
    v_mov_b32 v39, s15
    v_mul_f32 v82, s61, v85
    v_fma_f32 v96, -v80, v64, v96
    v_fma_f32 v97, -v80, v65, v97
    v_fma_f32 v98, -v80, v66, v98
    s_barrier
    v_fma_f32 v99, -v80, v67, v99
    v_fma_f32 v100, -v80, v68, v100
    v_fma_f32 v101, -v80, v69, v101
    v_fma_f32 v102, -v80, v70, v102
    v_fma_f32 v103, -v80, v71, v103
    v_fma_f32 v104, -v80, v72, v104
    v_fma_f32 v105, -v80, v73, v105
    v_fma_f32 v106, -v80, v74, v106
    v_fma_f32 v107, -v80, v75, v107
    v_fma_f32 v108, -v80, v76, v108
    v_fma_f32 v109, -v80, v77, v109
    v_fma_f32 v110, -v80, v78, v110
    v_fma_f32 v111, -v80, v79, v111
    v_mul_f32 v96, v96, v82
    v_mul_f32 v97, v97, v82
    v_mul_f32 v98, v98, v82
    v_mul_f32 v99, v99, v82
    v_mul_f32 v100, v100, v82
    v_mul_f32 v101, v101, v82
    v_mul_f32 v102, v102, v82
    v_mul_f32 v103, v103, v82
    v_mul_f32 v104, v104, v82
    v_mul_f32 v105, v105, v82
    v_mul_f32 v106, v106, v82
    v_mul_f32 v107, v107, v82
    v_mul_f32 v108, v108, v82
    v_mul_f32 v109, v109, v82
    v_mul_f32 v110, v110, v82
    v_mul_f32 v111, v111, v82
    v_cvt_pk_bf16_f32 v48, v96, v97
    v_cvt_pk_bf16_f32 v49, v98, v99
    v_cvt_pk_bf16_f32 v50, v100, v101
    v_cvt_pk_bf16_f32 v51, v102, v103
    v_cvt_pk_bf16_f32 v52, v104, v105
    v_cvt_pk_bf16_f32 v53, v106, v107
    v_cvt_pk_bf16_f32 v54, v108, v109
    s_barrier
    v_cvt_pk_bf16_f32 v55, v110, v111
    v_mul_f32 v88, s61, v91
    v_fma_f32 v128, -v86, v64, v128
    v_fma_f32 v129, -v86, v65, v129
    v_fma_f32 v130, -v86, v66, v130
    v_fma_f32 v131, -v86, v67, v131
    v_fma_f32 v132, -v86, v68, v132
    v_fma_f32 v133, -v86, v69, v133
    v_fma_f32 v134, -v86, v70, v134
    v_fma_f32 v135, -v86, v71, v135
    v_fma_f32 v136, -v86, v72, v136
    v_fma_f32 v137, -v86, v73, v137
    v_fma_f32 v138, -v86, v74, v138
    v_fma_f32 v139, -v86, v75, v139
    v_fma_f32 v140, -v86, v76, v140
    v_fma_f32 v141, -v86, v77, v141
    v_fma_f32 v142, -v86, v78, v142
    v_fma_f32 v143, -v86, v79, v143
    v_mul_f32 v128, v128, v88
    v_mul_f32 v129, v129, v88
    v_mul_f32 v130, v130, v88
    v_mul_f32 v131, v131, v88
    v_mul_f32 v132, v132, v88
    v_mul_f32 v133, v133, v88
    v_mul_f32 v134, v134, v88
    v_mul_f32 v135, v135, v88
    v_mul_f32 v136, v136, v88
    v_mul_f32 v137, v137, v88
    v_mul_f32 v138, v138, v88
    v_mul_f32 v139, v139, v88
    v_mul_f32 v140, v140, v88
    v_mul_f32 v141, v141, v88
    v_mul_f32 v142, v142, v88
    v_mul_f32 v143, v143, v88
    v_cvt_pk_bf16_f32 v56, v128, v129
    v_cvt_pk_bf16_f32 v57, v130, v131
    s_barrier
    v_cvt_pk_bf16_f32 v58, v132, v133
    v_cvt_pk_bf16_f32 v59, v134, v135
    v_cvt_pk_bf16_f32 v60, v136, v137
    v_cvt_pk_bf16_f32 v61, v138, v139
    v_cvt_pk_bf16_f32 v62, v140, v141
    v_cvt_pk_bf16_f32 v63, v142, v143
    s_waitcnt lgkmcnt(0)
    s_and_b32 s14, s5, -8
    v_mul_i32_i24 v1, s14, v29
    v_add3_u32 v2, v1, s4, v28
    buffer_store_dwordx2 v[48:49], v2, s[32:35], s56 offen offset:0 sc1
    buffer_store_dwordx2 v[56:57], v2, s[32:35], s56 offen offset:2048 sc1
    s_and_b32 s14, s5, 3
    s_cbranch_scc0 L_npqP0_0
    s_cmp_eq_u32 s14, 1
    s_cselect_b32 exec_lo, -1, 0
    s_cselect_b32 exec_hi, 0, -1
    buffer_store_dwordx2 v[38:39], v2, s[32:35], s56 offen offset:256 sc1
    buffer_store_dwordx2 v[38:39], v2, s[32:35], s56 offen offset:2304 sc1
    s_mov_b64 exec, -1
L_npqP0_0:
    s_and_b32 s14, s7, -8
    v_mul_i32_i24 v1, s14, v29
    v_add3_u32 v2, v1, s6, v28
    buffer_store_dwordx2 v[50:51], v2, s[32:35], s56 offen offset:0 sc1
    buffer_store_dwordx2 v[58:59], v2, s[32:35], s56 offen offset:2048 sc1
    s_and_b32 s14, s7, 3
    s_cbranch_scc0 L_npqP0_1
    s_cmp_eq_u32 s14, 1
    s_cselect_b32 exec_lo, -1, 0
    s_cselect_b32 exec_hi, 0, -1
    buffer_store_dwordx2 v[38:39], v2, s[32:35], s56 offen offset:256 sc1
    buffer_store_dwordx2 v[38:39], v2, s[32:35], s56 offen offset:2304 sc1
    s_mov_b64 exec, -1
L_npqP0_1:
    s_and_b32 s14, s9, -8
    v_mul_i32_i24 v1, s14, v29
    v_add3_u32 v2, v1, s8, v28
    buffer_store_dwordx2 v[52:53], v2, s[32:35], s56 offen offset:0 sc1
    buffer_store_dwordx2 v[60:61], v2, s[32:35], s56 offen offset:2048 sc1
    s_and_b32 s14, s9, 3
    s_cbranch_scc0 L_npqP0_2
    s_cmp_eq_u32 s14, 1
    s_cselect_b32 exec_lo, -1, 0
    s_cselect_b32 exec_hi, 0, -1
    buffer_store_dwordx2 v[38:39], v2, s[32:35], s56 offen offset:256 sc1
    buffer_store_dwordx2 v[38:39], v2, s[32:35], s56 offen offset:2304 sc1
    s_mov_b64 exec, -1
L_npqP0_2:
    s_and_b32 s14, s11, -8
    v_mul_i32_i24 v1, s14, v29
    s_barrier
    v_add3_u32 v2, v1, s10, v28
    buffer_store_dwordx2 v[54:55], v2, s[32:35], s56 offen offset:0 sc1
    buffer_store_dwordx2 v[62:63], v2, s[32:35], s56 offen offset:2048 sc1
    s_and_b32 s14, s11, 3
    s_cbranch_scc0 L_npqP0_3
    s_cmp_eq_u32 s14, 1
    s_cselect_b32 exec_lo, -1, 0
    s_cselect_b32 exec_hi, 0, -1
    buffer_store_dwordx2 v[38:39], v2, s[32:35], s56 offen offset:256 sc1
    buffer_store_dwordx2 v[38:39], v2, s[32:35], s56 offen offset:2304 sc1
    s_mov_b64 exec, -1
L_npqP0_3:
    ds_read_b128 v[64:67], v37 offset:1664
    ds_read_b128 v[68:71], v37 offset:1696
    ds_read_b128 v[72:75], v37 offset:1728
    ds_read_b128 v[76:79], v37 offset:1760
    s_waitcnt lgkmcnt(0)
    s_add_u32 s54, s60, s41
    s_mov_b32 s55, 1
    s_mul_i32 s57, s54, 37
    s_lshr_b32 s57, s57, 8
    s_mul_i32 s14, s57, 7
    s_sub_u32 s14, s54, s14
    s_lshl_b32 s14, s14, 1
    s_add_u32 s14, s14, s55
    s_lshl_b32 s14, s14, 5
    s_getpc_b64 s[12:13]
L_tpqP1:
    s_add_u32 s14, s14, L_tab-L_tpqP1
    s_load_dwordx8 s[4:11], s[12:13], s14
    s_lshl_b32 s56, s57, 21
    s_lshl_b32 s54, s36, 1
    s_add_u32 s54, s54, s40
    s_lshl_b32 s54, s54, 12
    s_add_u32 s56, s56, s54
    s_cmp_eq_u32 s57, 0
    s_cselect_b32 s61, 0x3e8b97f6, 1.0
    s_cselect_b32 s14, 0, 0x3f80
    s_cmp_eq_u32 s57, 1
    s_cselect_b32 s14, 0x3f803f80, s14
    s_cselect_b32 s15, 0x3f80, 0
    v_mov_b32 v38, s14
    v_mov_b32 v39, s15
    v_mul_f32 v82, s61, v85
    v_fma_f32 v112, -v80, v64, v112
    v_fma_f32 v113, -v80, v65, v113
    v_fma_f32 v114, -v80, v66, v114
    v_fma_f32 v115, -v80, v67, v115
    v_fma_f32 v116, -v80, v68, v116
    v_fma_f32 v117, -v80, v69, v117
    v_fma_f32 v118, -v80, v70, v118
    v_fma_f32 v119, -v80, v71, v119
    v_fma_f32 v120, -v80, v72, v120
    v_fma_f32 v121, -v80, v73, v121
    v_fma_f32 v122, -v80, v74, v122
    s_barrier
    v_fma_f32 v123, -v80, v75, v123
    v_fma_f32 v124, -v80, v76, v124
    v_fma_f32 v125, -v80, v77, v125
    v_fma_f32 v126, -v80, v78, v126
    v_fma_f32 v127, -v80, v79, v127
    v_mul_f32 v112, v112, v82
    v_mul_f32 v113, v113, v82
    v_mul_f32 v114, v114, v82
    v_mul_f32 v115, v115, v82
    v_mul_f32 v116, v116, v82
    v_mul_f32 v117, v117, v82
    v_mul_f32 v118, v118, v82
    v_mul_f32 v119, v119, v82
    v_mul_f32 v120, v120, v82
    v_mul_f32 v121, v121, v82
    v_mul_f32 v122, v122, v82
    v_mul_f32 v123, v123, v82
    v_mul_f32 v124, v124, v82
    v_mul_f32 v125, v125, v82
    v_mul_f32 v126, v126, v82
    v_mul_f32 v127, v127, v82
    v_cvt_pk_bf16_f32 v48, v112, v113
    v_cvt_pk_bf16_f32 v49, v114, v115
    v_cvt_pk_bf16_f32 v50, v116, v117
    v_cvt_pk_bf16_f32 v51, v118, v119
    v_cvt_pk_bf16_f32 v52, v120, v121
    v_cvt_pk_bf16_f32 v53, v122, v123
    v_cvt_pk_bf16_f32 v54, v124, v125
    v_cvt_pk_bf16_f32 v55, v126, v127
    v_mul_f32 v88, s61, v91
    v_fma_f32 v144, -v86, v64, v144
    v_fma_f32 v145, -v86, v65, v145
    v_fma_f32 v146, -v86, v66, v146
    v_fma_f32 v147, -v86, v67, v147
    v_fma_f32 v148, -v86, v68, v148
    v_fma_f32 v149, -v86, v69, v149
    s_barrier
    v_fma_f32 v150, -v86, v70, v150
    v_fma_f32 v151, -v86, v71, v151
    v_fma_f32 v152, -v86, v72, v152
    v_fma_f32 v153, -v86, v73, v153
    v_fma_f32 v154, -v86, v74, v154
    v_fma_f32 v155, -v86, v75, v155
    v_fma_f32 v156, -v86, v76, v156
    v_fma_f32 v157, -v86, v77, v157
    v_fma_f32 v158, -v86, v78, v158
    v_fma_f32 v159, -v86, v79, v159
    v_mul_f32 v144, v144, v88
    v_mul_f32 v145, v145, v88
    v_mul_f32 v146, v146, v88
    v_mul_f32 v147, v147, v88
    v_mul_f32 v148, v148, v88
    v_mul_f32 v149, v149, v88
    v_mul_f32 v150, v150, v88
    v_mul_f32 v151, v151, v88
    v_mul_f32 v152, v152, v88
    v_mul_f32 v153, v153, v88
    v_mul_f32 v154, v154, v88
    v_mul_f32 v155, v155, v88
    v_mul_f32 v156, v156, v88
    v_mul_f32 v157, v157, v88
    v_mul_f32 v158, v158, v88
    v_mul_f32 v159, v159, v88
    v_cvt_pk_bf16_f32 v56, v144, v145
    v_cvt_pk_bf16_f32 v57, v146, v147
    v_cvt_pk_bf16_f32 v58, v148, v149
    v_cvt_pk_bf16_f32 v59, v150, v151
    v_cvt_pk_bf16_f32 v60, v152, v153
    v_cvt_pk_bf16_f32 v61, v154, v155
    v_cvt_pk_bf16_f32 v62, v156, v157
    v_cvt_pk_bf16_f32 v63, v158, v159
    s_waitcnt lgkmcnt(0)
    s_barrier
    s_and_b32 s14, s5, -8
    v_mul_i32_i24 v1, s14, v29
    v_add3_u32 v2, v1, s4, v28
    buffer_store_dwordx2 v[48:49], v2, s[32:35], s56 offen offset:0 sc1
    buffer_store_dwordx2 v[56:57], v2, s[32:35], s56 offen offset:2048 sc1
    s_and_b32 s14, s5, 3
    s_cbranch_scc0 L_npqP1_0
    s_cmp_eq_u32 s14, 1
    s_cselect_b32 exec_lo, -1, 0
    s_cselect_b32 exec_hi, 0, -1
    buffer_store_dwordx2 v[38:39], v2, s[32:35], s56 offen offset:256 sc1
    buffer_store_dwordx2 v[38:39], v2, s[32:35], s56 offen offset:2304 sc1
    s_mov_b64 exec, -1
L_npqP1_0:
    s_and_b32 s14, s7, -8
    v_mul_i32_i24 v1, s14, v29
    v_add3_u32 v2, v1, s6, v28
    buffer_store_dwordx2 v[50:51], v2, s[32:35], s56 offen offset:0 sc1
    buffer_store_dwordx2 v[58:59], v2, s[32:35], s56 offen offset:2048 sc1
    s_and_b32 s14, s7, 3
    s_cbranch_scc0 L_npqP1_1
    s_cmp_eq_u32 s14, 1
    s_cselect_b32 exec_lo, -1, 0
    s_cselect_b32 exec_hi, 0, -1
    buffer_store_dwordx2 v[38:39], v2, s[32:35], s56 offen offset:256 sc1
    buffer_store_dwordx2 v[38:39], v2, s[32:35], s56 offen offset:2304 sc1
    s_mov_b64 exec, -1
L_npqP1_1:
    s_and_b32 s14, s9, -8
    v_mul_i32_i24 v1, s14, v29
    v_add3_u32 v2, v1, s8, v28
    buffer_store_dwordx2 v[52:53], v2, s[32:35], s56 offen offset:0 sc1
    buffer_store_dwordx2 v[60:61], v2, s[32:35], s56 offen offset:2048 sc1
    s_and_b32 s14, s9, 3
    s_cbranch_scc0 L_npqP1_2
    s_cmp_eq_u32 s14, 1
    s_cselect_b32 exec_lo, -1, 0
    s_cselect_b32 exec_hi, 0, -1
    buffer_store_dwordx2 v[38:39], v2, s[32:35], s56 offen offset:256 sc1
    buffer_store_dwordx2 v[38:39], v2, s[32:35], s56 offen offset:2304 sc1
    s_mov_b64 exec, -1
L_npqP1_2:
    s_and_b32 s14, s11, -8
    v_mul_i32_i24 v1, s14, v29
    v_add3_u32 v2, v1, s10, v28
    buffer_store_dwordx2 v[54:55], v2, s[32:35], s56 offen offset:0 sc1
    buffer_store_dwordx2 v[62:63], v2, s[32:35], s56 offen offset:2048 sc1
    s_and_b32 s14, s11, 3
    s_cbranch_scc0 L_npqP1_3
    s_cmp_eq_u32 s14, 1
    s_cselect_b32 exec_lo, -1, 0
    s_cselect_b32 exec_hi, 0, -1
    buffer_store_dwordx2 v[38:39], v2, s[32:35], s56 offen offset:256 sc1
    buffer_store_dwordx2 v[38:39], v2, s[32:35], s56 offen offset:2304 sc1
    s_mov_b64 exec, -1
L_npqP1_3:
    s_barrier
    s_barrier
    s_barrier
    s_barrier
    s_add_u32 s14, s60, 0
    s_add_u32 s14, s14, s41
    s_lshl_b32 s14, s14, 4
    s_add_u32 s14, s14, s36
    s_lshl_b32 s14, s14, 2
    s_add_u32 s14, s14, s40
    s_lshl_b32 s14, s14, 2
    s_add_u32 s14, s14, 16781312
    s_waitcnt vmcnt(0)
    v_mov_b32 v1, s49
    v_mov_b32 v2, 0
    s_mov_b64 exec, 1
    buffer_store_dword v1, v2, s[32:35], s14 offen offset:0 sc1
    buffer_store_dword v1, v2, s[32:35], s14 offen offset:8 sc1
    s_mov_b64 exec, -1
    s_barrier
    s_barrier
    s_barrier
    s_setprio 2
    ds_read_b64_tr_b16 v[48:49], v35 offset:24576
    ds_read_b64_tr_b16 v[50:51], v35 offset:25088
    ds_read_b128 v[40:43], v16 offset:0
    ds_read_b128 v[44:47], v16 offset:4096
    ds_read_b64_tr_b16 v[52:53], v36 offset:24576
    ds_read_b64_tr_b16 v[54:55], v36 offset:25088
    ds_read_b64_tr_b16 v[64:65], v35 offset:26624
    ds_read_b64_tr_b16 v[66:67], v35 offset:27136
    ds_read_b128 v[56:59], v17 offset:0
    ds_read_b128 v[60:63], v17 offset:4096
    ds_read_b64_tr_b16 v[68:69], v36 offset:26624
    ds_read_b64_tr_b16 v[70:71], v36 offset:27136
    s_waitcnt lgkmcnt(8)
    v_mfma_f32_32x32x16_bf16 v[96:111], v[48:51], v[40:43], 0
    v_mfma_f32_32x32x16_bf16 v[128:143], v[48:51], v[44:47], 0
    s_barrier
    s_waitcnt lgkmcnt(6)
    v_mfma_f32_32x32x16_bf16 v[112:127], v[52:55], v[40:43], 0
    ds_read_b64_tr_b16 v[80:81], v35 offset:32768
    ds_read_b64_tr_b16 v[82:83], v35 offset:33280
    ds_read_b128 v[72:75], v18 offset:0
    ds_read_b128 v[76:79], v18 offset:4096
    v_mfma_f32_32x32x16_bf16 v[144:159], v[52:55], v[44:47], 0
    ds_read_b64_tr_b16 v[84:85], v36 offset:32768
    ds_read_b64_tr_b16 v[86:87], v36 offset:33280
    s_waitcnt lgkmcnt(8)
    v_mfma_f32_32x32x16_bf16 v[96:111], v[64:67], v[56:59], v[96:111]
    ds_read_b64_tr_b16 v[48:49], v35 offset:34816
    ds_read_b64_tr_b16 v[50:51], v35 offset:35328
    v_mfma_f32_32x32x16_bf16 v[128:143], v[64:67], v[60:63], v[128:143]
    ds_read_b128 v[40:43], v19 offset:0
    ds_read_b128 v[44:47], v19 offset:4096
    s_waitcnt lgkmcnt(10)
    v_mfma_f32_32x32x16_bf16 v[112:127], v[68:71], v[56:59], v[112:127]
    ds_read_b64_tr_b16 v[52:53], v36 offset:34816
    ds_read_b64_tr_b16 v[54:55], v36 offset:35328
    v_mfma_f32_32x32x16_bf16 v[144:159], v[68:71], v[60:63], v[144:159]
    s_waitcnt lgkmcnt(8)
    v_mfma_f32_32x32x16_bf16 v[96:111], v[80:83], v[72:75], v[96:111]
    v_mfma_f32_32x32x16_bf16 v[128:143], v[80:83], v[76:79], v[128:143]
    s_barrier
    s_waitcnt lgkmcnt(6)
    v_mfma_f32_32x32x16_bf16 v[112:127], v[84:87], v[72:75], v[112:127]
    ds_read_b64_tr_b16 v[64:65], v35 offset:0
    ds_read_b64_tr_b16 v[66:67], v35 offset:512
    ds_read_b128 v[56:59], v16 offset:16384
    ds_read_b128 v[60:63], v16 offset:20480
    v_mfma_f32_32x32x16_bf16 v[144:159], v[84:87], v[76:79], v[144:159]
    ds_read_b64_tr_b16 v[68:69], v36 offset:0
    ds_read_b64_tr_b16 v[70:71], v36 offset:512
    s_waitcnt lgkmcnt(8)
    v_mfma_f32_32x32x16_bf16 v[96:111], v[48:51], v[40:43], v[96:111]
    ds_read_b64_tr_b16 v[80:81], v35 offset:2048
    ds_read_b64_tr_b16 v[82:83], v35 offset:2560
    v_mfma_f32_32x32x16_bf16 v[128:143], v[48:51], v[44:47], v[128:143]
    ds_read_b128 v[72:75], v17 offset:16384
    ds_read_b128 v[76:79], v17 offset:20480
    s_waitcnt lgkmcnt(10)
    v_mfma_f32_32x32x16_bf16 v[112:127], v[52:55], v[40:43], v[112:127]
    ds_read_b64_tr_b16 v[84:85], v36 offset:2048
    ds_read_b64_tr_b16 v[86:87], v36 offset:2560
    v_mfma_f32_32x32x16_bf16 v[144:159], v[52:55], v[44:47], v[144:159]
    s_waitcnt lgkmcnt(8)
    v_mfma_f32_32x32x16_bf16 v[96:111], v[64:67], v[56:59], v[96:111]
    v_mfma_f32_32x32x16_bf16 v[128:143], v[64:67], v[60:63], v[128:143]
    s_barrier
    s_waitcnt lgkmcnt(6)
    v_mfma_f32_32x32x16_bf16 v[112:127], v[68:71], v[56:59], v[112:127]
    ds_read_b64_tr_b16 v[48:49], v35 offset:8192
    ds_read_b64_tr_b16 v[50:51], v35 offset:8704
    ds_read_b128 v[40:43], v18 offset:16384
    ds_read_b128 v[44:47], v18 offset:20480
    v_mfma_f32_32x32x16_bf16 v[144:159], v[68:71], v[60:63], v[144:159]
    ds_read_b64_tr_b16 v[52:53], v36 offset:8192
    ds_read_b64_tr_b16 v[54:55], v36 offset:8704
    s_waitcnt lgkmcnt(8)
    v_mfma_f32_32x32x16_bf16 v[96:111], v[80:83], v[72:75], v[96:111]
    ds_read_b64_tr_b16 v[64:65], v35 offset:10240
    ds_read_b64_tr_b16 v[66:67], v35 offset:10752
    v_mfma_f32_32x32x16_bf16 v[128:143], v[80:83], v[76:79], v[128:143]
    ds_read_b128 v[56:59], v19 offset:16384
    ds_read_b128 v[60:63], v19 offset:20480
    s_waitcnt lgkmcnt(10)
    v_mfma_f32_32x32x16_bf16 v[112:127], v[84:87], v[72:75], v[112:127]
    ds_read_b64_tr_b16 v[68:69], v36 offset:10240
    ds_read_b64_tr_b16 v[70:71], v36 offset:10752
    v_mfma_f32_32x32x16_bf16 v[144:159], v[84:87], v[76:79], v[144:159]
    s_waitcnt lgkmcnt(8)
    v_mfma_f32_32x32x16_bf16 v[96:111], v[48:51], v[40:43], v[96:111]
    v_mfma_f32_32x32x16_bf16 v[128:143], v[48:51], v[44:47], v[128:143]
    s_barrier
    s_waitcnt lgkmcnt(6)
    v_mfma_f32_32x32x16_bf16 v[112:127], v[52:55], v[40:43], v[112:127]
    ds_read_b64_tr_b16 v[80:81], v35 offset:16384
    ds_read_b64_tr_b16 v[82:83], v35 offset:16896
    ds_read_b128 v[72:75], v16 offset:32768
    ds_read_b128 v[76:79], v16 offset:36864
    v_mfma_f32_32x32x16_bf16 v[144:159], v[52:55], v[44:47], v[144:159]
    ds_read_b64_tr_b16 v[84:85], v36 offset:16384
    ds_read_b64_tr_b16 v[86:87], v36 offset:16896
    s_waitcnt lgkmcnt(8)
    v_mfma_f32_32x32x16_bf16 v[96:111], v[64:67], v[56:59], v[96:111]
    ds_read_b64_tr_b16 v[48:49], v35 offset:18432
    ds_read_b64_tr_b16 v[50:51], v35 offset:18944
    v_mfma_f32_32x32x16_bf16 v[128:143], v[64:67], v[60:63], v[128:143]
    ds_read_b128 v[40:43], v17 offset:32768
    ds_read_b128 v[44:47], v17 offset:36864
    s_waitcnt lgkmcnt(10)
    v_mfma_f32_32x32x16_bf16 v[112:127], v[68:71], v[56:59], v[112:127]
    ds_read_b64_tr_b16 v[52:53], v36 offset:18432
    ds_read_b64_tr_b16 v[54:55], v36 offset:18944
    v_mfma_f32_32x32x16_bf16 v[144:159], v[68:71], v[60:63], v[144:159]
    s_waitcnt lgkmcnt(8)
    v_mfma_f32_32x32x16_bf16 v[96:111], v[80:83], v[72:75], v[96:111]
    v_mfma_f32_32x32x16_bf16 v[128:143], v[80:83], v[76:79], v[128:143]
    s_barrier
    s_waitcnt lgkmcnt(6)
    v_mfma_f32_32x32x16_bf16 v[112:127], v[84:87], v[72:75], v[112:127]
    ds_read_b64_tr_b16 v[64:65], v35 offset:24576
    ds_read_b64_tr_b16 v[66:67], v35 offset:25088
    ds_read_b128 v[56:59], v18 offset:32768
    ds_read_b128 v[60:63], v18 offset:36864
    v_mfma_f32_32x32x16_bf16 v[144:159], v[84:87], v[76:79], v[144:159]
    ds_read_b64_tr_b16 v[68:69], v36 offset:24576
    ds_read_b64_tr_b16 v[70:71], v36 offset:25088
    s_waitcnt lgkmcnt(8)
    v_mfma_f32_32x32x16_bf16 v[96:111], v[48:51], v[40:43], v[96:111]
    ds_read_b64_tr_b16 v[80:81], v35 offset:26624
    ds_read_b64_tr_b16 v[82:83], v35 offset:27136
    v_mfma_f32_32x32x16_bf16 v[128:143], v[48:51], v[44:47], v[128:143]
    ds_read_b128 v[72:75], v19 offset:32768
    ds_read_b128 v[76:79], v19 offset:36864
    s_waitcnt lgkmcnt(10)
    v_mfma_f32_32x32x16_bf16 v[112:127], v[52:55], v[40:43], v[112:127]
    ds_read_b64_tr_b16 v[84:85], v36 offset:26624
    ds_read_b64_tr_b16 v[86:87], v36 offset:27136
    v_mfma_f32_32x32x16_bf16 v[144:159], v[52:55], v[44:47], v[144:159]
    s_waitcnt lgkmcnt(8)
    v_mfma_f32_32x32x16_bf16 v[96:111], v[64:67], v[56:59], v[96:111]
    v_mfma_f32_32x32x16_bf16 v[128:143], v[64:67], v[60:63], v[128:143]
    s_barrier
    s_waitcnt lgkmcnt(6)
    v_mfma_f32_32x32x16_bf16 v[112:127], v[68:71], v[56:59], v[112:127]
    ds_read_b64_tr_b16 v[48:49], v35 offset:32768
    ds_read_b64_tr_b16 v[50:51], v35 offset:33280
    ds_read_b128 v[40:43], v16 offset:49152
    ds_read_b128 v[44:47], v16 offset:53248
    v_mfma_f32_32x32x16_bf16 v[144:159], v[68:71], v[60:63], v[144:159]
    ds_read_b64_tr_b16 v[52:53], v36 offset:32768
    ds_read_b64_tr_b16 v[54:55], v36 offset:33280
    s_waitcnt lgkmcnt(8)
    v_mfma_f32_32x32x16_bf16 v[96:111], v[80:83], v[72:75], v[96:111]
    ds_read_b64_tr_b16 v[64:65], v35 offset:34816
    ds_read_b64_tr_b16 v[66:67], v35 offset:35328
    v_mfma_f32_32x32x16_bf16 v[128:143], v[80:83], v[76:79], v[128:143]
    ds_read_b128 v[56:59], v17 offset:49152
    ds_read_b128 v[60:63], v17 offset:53248
    s_waitcnt lgkmcnt(10)
    v_mfma_f32_32x32x16_bf16 v[112:127], v[84:87], v[72:75], v[112:127]
    ds_read_b64_tr_b16 v[68:69], v36 offset:34816
    ds_read_b64_tr_b16 v[70:71], v36 offset:35328
    v_mfma_f32_32x32x16_bf16 v[144:159], v[84:87], v[76:79], v[144:159]
    s_waitcnt lgkmcnt(8)
    v_mfma_f32_32x32x16_bf16 v[96:111], v[48:51], v[40:43], v[96:111]
    v_mfma_f32_32x32x16_bf16 v[128:143], v[48:51], v[44:47], v[128:143]
    s_barrier
    s_waitcnt lgkmcnt(6)
    v_mfma_f32_32x32x16_bf16 v[112:127], v[52:55], v[40:43], v[112:127]
    ds_read_b64_tr_b16 v[80:81], v35 offset:0
    ds_read_b64_tr_b16 v[82:83], v35 offset:512
    ds_read_b128 v[72:75], v18 offset:49152
    ds_read_b128 v[76:79], v18 offset:53248
    v_mfma_f32_32x32x16_bf16 v[144:159], v[52:55], v[44:47], v[144:159]
    ds_read_b64_tr_b16 v[84:85], v36 offset:0
    ds_read_b64_tr_b16 v[86:87], v36 offset:512
    s_waitcnt lgkmcnt(8)
    v_mfma_f32_32x32x16_bf16 v[96:111], v[64:67], v[56:59], v[96:111]
    ds_read_b64_tr_b16 v[48:49], v35 offset:2048
    ds_read_b64_tr_b16 v[50:51], v35 offset:2560
    v_mfma_f32_32x32x16_bf16 v[128:143], v[64:67], v[60:63], v[128:143]
    ds_read_b128 v[40:43], v19 offset:49152
    ds_read_b128 v[44:47], v19 offset:53248
    s_waitcnt lgkmcnt(10)
    v_mfma_f32_32x32x16_bf16 v[112:127], v[68:71], v[56:59], v[112:127]
    ds_read_b64_tr_b16 v[52:53], v36 offset:2048
    ds_read_b64_tr_b16 v[54:55], v36 offset:2560
    v_mfma_f32_32x32x16_bf16 v[144:159], v[68:71], v[60:63], v[144:159]
    s_waitcnt lgkmcnt(8)
    v_mfma_f32_32x32x16_bf16 v[96:111], v[80:83], v[72:75], v[96:111]
    v_mfma_f32_32x32x16_bf16 v[128:143], v[80:83], v[76:79], v[128:143]
    s_barrier
    s_waitcnt lgkmcnt(6)
    v_mfma_f32_32x32x16_bf16 v[112:127], v[84:87], v[72:75], v[112:127]
    ds_read_b64_tr_b16 v[64:65], v35 offset:8192
    ds_read_b64_tr_b16 v[66:67], v35 offset:8704
    ds_read_b128 v[56:59], v20 offset:0
    ds_read_b128 v[60:63], v20 offset:4096
    v_mfma_f32_32x32x16_bf16 v[144:159], v[84:87], v[76:79], v[144:159]
    ds_read_b64_tr_b16 v[68:69], v36 offset:8192
    ds_read_b64_tr_b16 v[70:71], v36 offset:8704
    s_waitcnt lgkmcnt(8)
    v_mfma_f32_32x32x16_bf16 v[96:111], v[48:51], v[40:43], v[96:111]
    ds_read_b64_tr_b16 v[80:81], v35 offset:10240
    ds_read_b64_tr_b16 v[82:83], v35 offset:10752
    v_mfma_f32_32x32x16_bf16 v[128:143], v[48:51], v[44:47], v[128:143]
    ds_read_b128 v[72:75], v21 offset:0
    ds_read_b128 v[76:79], v21 offset:4096
    s_waitcnt lgkmcnt(10)
    v_mfma_f32_32x32x16_bf16 v[112:127], v[52:55], v[40:43], v[112:127]
    ds_read_b64_tr_b16 v[84:85], v36 offset:10240
    ds_read_b64_tr_b16 v[86:87], v36 offset:10752
    v_mfma_f32_32x32x16_bf16 v[144:159], v[52:55], v[44:47], v[144:159]
    s_waitcnt lgkmcnt(8)
    v_mfma_f32_32x32x16_bf16 v[96:111], v[64:67], v[56:59], v[96:111]
    v_mfma_f32_32x32x16_bf16 v[128:143], v[64:67], v[60:63], v[128:143]
    s_barrier
    s_waitcnt lgkmcnt(6)
    v_mfma_f32_32x32x16_bf16 v[112:127], v[68:71], v[56:59], v[112:127]
    ds_read_b64_tr_b16 v[48:49], v35 offset:16384
    ds_read_b64_tr_b16 v[50:51], v35 offset:16896
    ds_read_b128 v[40:43], v22 offset:0
    ds_read_b128 v[44:47], v22 offset:4096
    v_mfma_f32_32x32x16_bf16 v[144:159], v[68:71], v[60:63], v[144:159]
    ds_read_b64_tr_b16 v[52:53], v36 offset:16384
    ds_read_b64_tr_b16 v[54:55], v36 offset:16896
    s_waitcnt lgkmcnt(8)
    v_mfma_f32_32x32x16_bf16 v[96:111], v[80:83], v[72:75], v[96:111]
    ds_read_b64_tr_b16 v[64:65], v35 offset:18432
    ds_read_b64_tr_b16 v[66:67], v35 offset:18944
    v_mfma_f32_32x32x16_bf16 v[128:143], v[80:83], v[76:79], v[128:143]
    ds_read_b128 v[56:59], v23 offset:0
    ds_read_b128 v[60:63], v23 offset:4096
    s_waitcnt lgkmcnt(10)
    v_mfma_f32_32x32x16_bf16 v[112:127], v[84:87], v[72:75], v[112:127]
    ds_read_b64_tr_b16 v[68:69], v36 offset:18432
    ds_read_b64_tr_b16 v[70:71], v36 offset:18944
    v_mfma_f32_32x32x16_bf16 v[144:159], v[84:87], v[76:79], v[144:159]
    s_waitcnt lgkmcnt(8)
    v_mfma_f32_32x32x16_bf16 v[96:111], v[48:51], v[40:43], v[96:111]
    v_mfma_f32_32x32x16_bf16 v[128:143], v[48:51], v[44:47], v[128:143]
    s_barrier
    s_waitcnt lgkmcnt(6)
    v_mfma_f32_32x32x16_bf16 v[112:127], v[52:55], v[40:43], v[112:127]
    ds_read_b64_tr_b16 v[80:81], v35 offset:24576
    ds_read_b64_tr_b16 v[82:83], v35 offset:25088
    ds_read_b128 v[72:75], v20 offset:16384
    ds_read_b128 v[76:79], v20 offset:20480
    v_mfma_f32_32x32x16_bf16 v[144:159], v[52:55], v[44:47], v[144:159]
    ds_read_b64_tr_b16 v[84:85], v36 offset:24576
    ds_read_b64_tr_b16 v[86:87], v36 offset:25088
    s_waitcnt lgkmcnt(8)
    v_mfma_f32_32x32x16_bf16 v[96:111], v[64:67], v[56:59], v[96:111]
    ds_read_b64_tr_b16 v[48:49], v35 offset:26624
    ds_read_b64_tr_b16 v[50:51], v35 offset:27136
    v_mfma_f32_32x32x16_bf16 v[128:143], v[64:67], v[60:63], v[128:143]
    ds_read_b128 v[40:43], v21 offset:16384
    ds_read_b128 v[44:47], v21 offset:20480
    s_waitcnt lgkmcnt(10)
    v_mfma_f32_32x32x16_bf16 v[112:127], v[68:71], v[56:59], v[112:127]
    ds_read_b64_tr_b16 v[52:53], v36 offset:26624
    ds_read_b64_tr_b16 v[54:55], v36 offset:27136
    v_mfma_f32_32x32x16_bf16 v[144:159], v[68:71], v[60:63], v[144:159]
    s_waitcnt lgkmcnt(8)
    v_mfma_f32_32x32x16_bf16 v[96:111], v[80:83], v[72:75], v[96:111]
    v_mfma_f32_32x32x16_bf16 v[128:143], v[80:83], v[76:79], v[128:143]
    s_barrier
    s_waitcnt lgkmcnt(6)
    v_mfma_f32_32x32x16_bf16 v[112:127], v[84:87], v[72:75], v[112:127]
    ds_read_b64_tr_b16 v[64:65], v35 offset:32768
    ds_read_b64_tr_b16 v[66:67], v35 offset:33280
    ds_read_b128 v[56:59], v22 offset:16384
    ds_read_b128 v[60:63], v22 offset:20480
    v_mfma_f32_32x32x16_bf16 v[144:159], v[84:87], v[76:79], v[144:159]
    ds_read_b64_tr_b16 v[68:69], v36 offset:32768
    ds_read_b64_tr_b16 v[70:71], v36 offset:33280
    s_waitcnt lgkmcnt(8)
    v_mfma_f32_32x32x16_bf16 v[96:111], v[48:51], v[40:43], v[96:111]
    ds_read_b64_tr_b16 v[80:81], v35 offset:34816
    ds_read_b64_tr_b16 v[82:83], v35 offset:35328
    v_mfma_f32_32x32x16_bf16 v[128:143], v[48:51], v[44:47], v[128:143]
    ds_read_b128 v[72:75], v23 offset:16384
    ds_read_b128 v[76:79], v23 offset:20480
    s_waitcnt lgkmcnt(10)
    v_mfma_f32_32x32x16_bf16 v[112:127], v[52:55], v[40:43], v[112:127]
    ds_read_b64_tr_b16 v[84:85], v36 offset:34816
    ds_read_b64_tr_b16 v[86:87], v36 offset:35328
    v_mfma_f32_32x32x16_bf16 v[144:159], v[52:55], v[44:47], v[144:159]
    s_waitcnt lgkmcnt(8)
    v_mfma_f32_32x32x16_bf16 v[96:111], v[64:67], v[56:59], v[96:111]
    v_mfma_f32_32x32x16_bf16 v[128:143], v[64:67], v[60:63], v[128:143]
    s_barrier
    s_waitcnt lgkmcnt(6)
    v_mfma_f32_32x32x16_bf16 v[112:127], v[68:71], v[56:59], v[112:127]
    ds_read_b64_tr_b16 v[48:49], v35 offset:0
    ds_read_b64_tr_b16 v[50:51], v35 offset:512
    ds_read_b128 v[40:43], v20 offset:32768
    ds_read_b128 v[44:47], v20 offset:36864
    v_mfma_f32_32x32x16_bf16 v[144:159], v[68:71], v[60:63], v[144:159]
    ds_read_b64_tr_b16 v[52:53], v36 offset:0
    ds_read_b64_tr_b16 v[54:55], v36 offset:512
    s_waitcnt lgkmcnt(8)
    v_mfma_f32_32x32x16_bf16 v[96:111], v[80:83], v[72:75], v[96:111]
    ds_read_b64_tr_b16 v[64:65], v35 offset:2048
    ds_read_b64_tr_b16 v[66:67], v35 offset:2560
    v_mfma_f32_32x32x16_bf16 v[128:143], v[80:83], v[76:79], v[128:143]
    ds_read_b128 v[56:59], v21 offset:32768
    ds_read_b128 v[60:63], v21 offset:36864
    s_waitcnt lgkmcnt(10)
    v_mfma_f32_32x32x16_bf16 v[112:127], v[84:87], v[72:75], v[112:127]
    ds_read_b64_tr_b16 v[68:69], v36 offset:2048
    ds_read_b64_tr_b16 v[70:71], v36 offset:2560
    v_mfma_f32_32x32x16_bf16 v[144:159], v[84:87], v[76:79], v[144:159]
    s_waitcnt lgkmcnt(8)
    v_mfma_f32_32x32x16_bf16 v[96:111], v[48:51], v[40:43], v[96:111]
    v_mfma_f32_32x32x16_bf16 v[128:143], v[48:51], v[44:47], v[128:143]
    s_barrier
    s_waitcnt lgkmcnt(6)
    v_mfma_f32_32x32x16_bf16 v[112:127], v[52:55], v[40:43], v[112:127]
    ds_read_b64_tr_b16 v[80:81], v35 offset:8192
    ds_read_b64_tr_b16 v[82:83], v35 offset:8704
    ds_read_b128 v[72:75], v22 offset:32768
    ds_read_b128 v[76:79], v22 offset:36864
    v_mfma_f32_32x32x16_bf16 v[144:159], v[52:55], v[44:47], v[144:159]
    ds_read_b64_tr_b16 v[84:85], v36 offset:8192
    ds_read_b64_tr_b16 v[86:87], v36 offset:8704
    s_waitcnt lgkmcnt(8)
    v_mfma_f32_32x32x16_bf16 v[96:111], v[64:67], v[56:59], v[96:111]
    ds_read_b64_tr_b16 v[48:49], v35 offset:10240
    ds_read_b64_tr_b16 v[50:51], v35 offset:10752
    v_mfma_f32_32x32x16_bf16 v[128:143], v[64:67], v[60:63], v[128:143]
    ds_read_b128 v[40:43], v23 offset:32768
    ds_read_b128 v[44:47], v23 offset:36864
    s_waitcnt lgkmcnt(10)
    v_mfma_f32_32x32x16_bf16 v[112:127], v[68:71], v[56:59], v[112:127]
    ds_read_b64_tr_b16 v[52:53], v36 offset:10240
    ds_read_b64_tr_b16 v[54:55], v36 offset:10752
    v_mfma_f32_32x32x16_bf16 v[144:159], v[68:71], v[60:63], v[144:159]
    s_waitcnt lgkmcnt(8)
    v_mfma_f32_32x32x16_bf16 v[96:111], v[80:83], v[72:75], v[96:111]
    v_mfma_f32_32x32x16_bf16 v[128:143], v[80:83], v[76:79], v[128:143]
    s_waitcnt lgkmcnt(0)
    s_barrier
    v_mfma_f32_32x32x16_bf16 v[112:127], v[84:87], v[72:75], v[112:127]
    v_mfma_f32_32x32x16_bf16 v[144:159], v[84:87], v[76:79], v[144:159]
    v_mfma_f32_32x32x16_bf16 v[96:111], v[48:51], v[40:43], v[96:111]
    v_mfma_f32_32x32x16_bf16 v[128:143], v[48:51], v[44:47], v[128:143]
    v_mfma_f32_32x32x16_bf16 v[112:127], v[52:55], v[40:43], v[112:127]
    v_mfma_f32_32x32x16_bf16 v[144:159], v[52:55], v[44:47], v[144:159]
    s_setprio 0
    s_mov_b32 s79, 0
    s_lshl_b32 s54, s36, 1
    s_add_u32 s54, s54, s40
    s_mul_i32 s54, s54, 229376
    s_lshl_b32 s55, s101, 1
    s_add_u32 s55, s55, s41
    s_lshl_b32 s55, s55, 11
    s_add_u32 s55, s55, 6295552
    s_add_u32 s56, s54, s55
    s_add_u32 s57, s56, 114688
    ds_read_b32 v81, v32 offset:0
    ds_read_b32 v87, v32 offset:128
    s_waitcnt lgkmcnt(0)
    v_lshlrev_b32 v80, 16, v81
    v_and_b32 v81, 0xffff0000, v81
    v_rcp_f32 v85, v81
    v_mul_f32 v84, v81, v81
    v_mul_f32 v82, 0xc0135761, v85
    v_mul_f32 v83, v85, v85
    v_mul_f32 v83, v83, v85
    v_mul_f32 v83, 0xbdd2d3e8, v83
    v_lshlrev_b32 v86, 16, v87
    v_and_b32 v87, 0xffff0000, v87
    v_rcp_f32 v91, v87
    v_mul_f32 v90, v87, v87
    v_mul_f32 v88, 0xc0135761, v91
    v_mul_f32 v89, v91, v91
    v_mul_f32 v89, v89, v91
    v_mul_f32 v89, 0xbdd2d3e8, v89
    ds_read_b128 v[64:67], v30 offset:1024
    ds_read_b128 v[68:71], v30 offset:1056
    ds_read_b128 v[72:75], v30 offset:1280
    ds_read_b128 v[76:79], v30 offset:1312
    s_waitcnt lgkmcnt(0)
    v_fma_f32 v96, -v80, v64, v96
    v_fma_f32 v104, -v80, v72, v104
    v_fma_f32 v97, -v80, v65, v97
    v_fma_f32 v105, -v80, v73, v105
    v_fma_f32 v98, -v80, v66, v98
    v_fma_f32 v106, -v80, v74, v106
    v_fma_f32 v99, -v80, v67, v99
    v_fma_f32 v107, -v80, v75, v107
    v_mul_f32 v40, v96, v96
    v_mul_f32 v41, v97, v97
    v_mul_f32 v42, v98, v98
    v_mul_f32 v43, v99, v99
    v_fma_f32 v40, v40, v83, v82
    v_fma_f32 v41, v41, v83, v82
    v_fma_f32 v42, v42, v83, v82
    v_fma_f32 v43, v43, v83, v82
    v_mul_f32 v40, v40, v96
    v_mul_f32 v41, v41, v97
    v_mul_f32 v42, v42, v98
    v_mul_f32 v43, v43, v99
    v_exp_f32 v40, v40
    v_exp_f32 v41, v41
    v_exp_f32 v42, v42
    v_exp_f32 v43, v43
    v_mul_f32 v96, v96, v104
    v_mul_f32 v97, v97, v105
    v_mul_f32 v98, v98, v106
    v_mul_f32 v99, v99, v107
    v_fma_f32 v40, v40, v84, v84
    v_fma_f32 v41, v41, v84, v84
    v_fma_f32 v42, v42, v84, v84
    v_fma_f32 v43, v43, v84, v84
    v_rcp_f32 v40, v40
    v_rcp_f32 v41, v41
    v_rcp_f32 v42, v42
    v_rcp_f32 v43, v43
    v_mul_f32 v96, v96, v40
    v_mul_f32 v97, v97, v41
    v_mul_f32 v98, v98, v42
    v_mul_f32 v99, v99, v43
    v_cvt_pk_bf16_f32 v48, v96, v97
    v_cvt_pk_bf16_f32 v49, v98, v99
    v_fma_f32 v100, -v80, v68, v100
    v_fma_f32 v108, -v80, v76, v108
    v_fma_f32 v101, -v80, v69, v101
    v_fma_f32 v109, -v80, v77, v109
    v_fma_f32 v102, -v80, v70, v102
    v_fma_f32 v110, -v80, v78, v110
    v_fma_f32 v103, -v80, v71, v103
    v_fma_f32 v111, -v80, v79, v111
    v_mul_f32 v44, v100, v100
    v_mul_f32 v45, v101, v101
    v_mul_f32 v46, v102, v102
    v_mul_f32 v47, v103, v103
    v_fma_f32 v44, v44, v83, v82
    v_fma_f32 v45, v45, v83, v82
    v_fma_f32 v46, v46, v83, v82
    v_fma_f32 v47, v47, v83, v82
    v_mul_f32 v44, v44, v100
    v_mul_f32 v45, v45, v101
    v_mul_f32 v46, v46, v102
    v_mul_f32 v47, v47, v103
    v_exp_f32 v44, v44
    v_exp_f32 v45, v45
    v_exp_f32 v46, v46
    v_exp_f32 v47, v47
    v_mul_f32 v100, v100, v108
    v_mul_f32 v101, v101, v109
    v_mul_f32 v102, v102, v110
    v_mul_f32 v103, v103, v111
    v_fma_f32 v44, v44, v84, v84
    v_fma_f32 v45, v45, v84, v84
    v_fma_f32 v46, v46, v84, v84
    v_fma_f32 v47, v47, v84, v84
    v_rcp_f32 v44, v44
    v_rcp_f32 v45, v45
    v_rcp_f32 v46, v46
    v_rcp_f32 v47, v47
    v_mul_f32 v100, v100, v44
    v_mul_f32 v101, v101, v45
    v_mul_f32 v102, v102, v46
    v_mul_f32 v103, v103, v47
    v_cvt_pk_bf16_f32 v50, v100, v101
    v_cvt_pk_bf16_f32 v51, v102, v103
    buffer_store_dwordx4 v[48:51], v27, s[32:35], s56 offen offset:0 sc1
    s_cmp_lg_u32 s79, 0
    s_cbranch_scc1 L_AP_nr0
    v_mov_b32 v1, 158720
    ds_read_b32 v1, v1
    s_waitcnt lgkmcnt(0)
    v_cmp_ne_u32 vcc, s49, v1
    s_cbranch_vccnz L_AP_nr0
    s_mov_b32 s79, 1
    s_lshl_b32 s11, s74, 17
    s_lshl_b32 s12, s75, 2
    s_add_u32 s12, s12, s39
    s_lshl_b32 s13, s12, 11
    s_add_u32 s13, s13, s11
    s_lshr_b32 s14, s38, 2
    s_lshl_b32 s14, s14, 16
    s_add_u32 s14, s14, s11
    s_add_u32 s14, s14, 2097152
    v_lshl_add_u32 v34, v29, 9, v28
    buffer_load_dwordx2 v[160:161], v34, s[32:35], s13 offen offset:0 sc1
    buffer_load_dwordx2 v[162:163], v34, s[32:35], s13 offen offset:256 sc1
    buffer_load_dwordx2 v[164:165], v34, s[32:35], s13 offen offset:1024 sc1
    buffer_load_dwordx2 v[166:167], v34, s[32:35], s13 offen offset:1280 sc1
    buffer_load_dwordx2 v[96:97], v34, s[32:35], s14 offen offset:0 sc1
    buffer_load_dwordx2 v[98:99], v34, s[32:35], s14 offen offset:256 sc1
    buffer_load_dwordx2 v[100:101], v34, s[32:35], s14 offen offset:1024 sc1
    buffer_load_dwordx2 v[102:103], v34, s[32:35], s14 offen offset:1280 sc1
L_AP_nr0:
    v_fma_f32 v128, -v86, v64, v128
    v_fma_f32 v136, -v86, v72, v136
    v_fma_f32 v129, -v86, v65, v129
    v_fma_f32 v137, -v86, v73, v137
    v_fma_f32 v130, -v86, v66, v130
    v_fma_f32 v138, -v86, v74, v138
    v_fma_f32 v131, -v86, v67, v131
    v_fma_f32 v139, -v86, v75, v139
    v_mul_f32 v40, v128, v128
    v_mul_f32 v41, v129, v129
    v_mul_f32 v42, v130, v130
    v_mul_f32 v43, v131, v131
    v_fma_f32 v40, v40, v89, v88
    v_fma_f32 v41, v41, v89, v88
    v_fma_f32 v42, v42, v89, v88
    v_fma_f32 v43, v43, v89, v88
    v_mul_f32 v40, v40, v128
    v_mul_f32 v41, v41, v129
    v_mul_f32 v42, v42, v130
    v_mul_f32 v43, v43, v131
    v_exp_f32 v40, v40
    v_exp_f32 v41, v41
    v_exp_f32 v42, v42
    v_exp_f32 v43, v43
    v_mul_f32 v128, v128, v136
    v_mul_f32 v129, v129, v137
    v_mul_f32 v130, v130, v138
    v_mul_f32 v131, v131, v139
    v_fma_f32 v40, v40, v90, v90
    v_fma_f32 v41, v41, v90, v90
    v_fma_f32 v42, v42, v90, v90
    v_fma_f32 v43, v43, v90, v90
    v_rcp_f32 v40, v40
    v_rcp_f32 v41, v41
    v_rcp_f32 v42, v42
    v_rcp_f32 v43, v43
    v_mul_f32 v128, v128, v40
    v_mul_f32 v129, v129, v41
    v_mul_f32 v130, v130, v42
    v_mul_f32 v131, v131, v43
    v_cvt_pk_bf16_f32 v52, v128, v129
    v_cvt_pk_bf16_f32 v53, v130, v131
    v_fma_f32 v132, -v86, v68, v132
    v_fma_f32 v140, -v86, v76, v140
    v_fma_f32 v133, -v86, v69, v133
    v_fma_f32 v141, -v86, v77, v141
    v_fma_f32 v134, -v86, v70, v134
    v_fma_f32 v142, -v86, v78, v142
    v_fma_f32 v135, -v86, v71, v135
    v_fma_f32 v143, -v86, v79, v143
    v_mul_f32 v44, v132, v132
    v_mul_f32 v45, v133, v133
    v_mul_f32 v46, v134, v134
    v_mul_f32 v47, v135, v135
    v_fma_f32 v44, v44, v89, v88
    v_fma_f32 v45, v45, v89, v88
    v_fma_f32 v46, v46, v89, v88
    v_fma_f32 v47, v47, v89, v88
    v_mul_f32 v44, v44, v132
    v_mul_f32 v45, v45, v133
    v_mul_f32 v46, v46, v134
    v_mul_f32 v47, v47, v135
    v_exp_f32 v44, v44
    v_exp_f32 v45, v45
    v_exp_f32 v46, v46
    v_exp_f32 v47, v47
    v_mul_f32 v132, v132, v140
    v_mul_f32 v133, v133, v141
    v_mul_f32 v134, v134, v142
    v_mul_f32 v135, v135, v143
    v_fma_f32 v44, v44, v90, v90
    v_fma_f32 v45, v45, v90, v90
    v_fma_f32 v46, v46, v90, v90
    v_fma_f32 v47, v47, v90, v90
    v_rcp_f32 v44, v44
    v_rcp_f32 v45, v45
    v_rcp_f32 v46, v46
    v_rcp_f32 v47, v47
    v_mul_f32 v132, v132, v44
    v_mul_f32 v133, v133, v45
    v_mul_f32 v134, v134, v46
    v_mul_f32 v135, v135, v47
    v_cvt_pk_bf16_f32 v54, v132, v133
    v_cvt_pk_bf16_f32 v55, v134, v135
    buffer_store_dwordx4 v[52:55], v27, s[32:35], s57 offen offset:0 sc1
    ds_read_b128 v[64:67], v30 offset:1088
    ds_read_b128 v[68:71], v30 offset:1120
    ds_read_b128 v[72:75], v30 offset:1344
    ds_read_b128 v[76:79], v30 offset:1376
    s_waitcnt lgkmcnt(0)
    v_fma_f32 v112, -v80, v64, v112
    v_fma_f32 v120, -v80, v72, v120
    v_fma_f32 v113, -v80, v65, v113
    v_fma_f32 v121, -v80, v73, v121
    v_fma_f32 v114, -v80, v66, v114
    v_fma_f32 v122, -v80, v74, v122
    v_fma_f32 v115, -v80, v67, v115
    v_fma_f32 v123, -v80, v75, v123
    v_mul_f32 v40, v112, v112
    v_mul_f32 v41, v113, v113
    v_mul_f32 v42, v114, v114
    v_mul_f32 v43, v115, v115
    v_fma_f32 v40, v40, v83, v82
    v_fma_f32 v41, v41, v83, v82
    v_fma_f32 v42, v42, v83, v82
    v_fma_f32 v43, v43, v83, v82
    v_mul_f32 v40, v40, v112
    v_mul_f32 v41, v41, v113
    v_mul_f32 v42, v42, v114
    v_mul_f32 v43, v43, v115
    v_exp_f32 v40, v40
    v_exp_f32 v41, v41
    v_exp_f32 v42, v42
    v_exp_f32 v43, v43
    v_mul_f32 v112, v112, v120
    v_mul_f32 v113, v113, v121
    v_mul_f32 v114, v114, v122
    v_mul_f32 v115, v115, v123
    v_fma_f32 v40, v40, v84, v84
    v_fma_f32 v41, v41, v84, v84
    v_fma_f32 v42, v42, v84, v84
    v_fma_f32 v43, v43, v84, v84
    v_rcp_f32 v40, v40
    v_rcp_f32 v41, v41
    v_rcp_f32 v42, v42
    v_rcp_f32 v43, v43
    v_mul_f32 v112, v112, v40
    v_mul_f32 v113, v113, v41
    v_mul_f32 v114, v114, v42
    v_mul_f32 v115, v115, v43
    v_cvt_pk_bf16_f32 v48, v112, v113
    v_cvt_pk_bf16_f32 v49, v114, v115
    v_fma_f32 v116, -v80, v68, v116
    v_fma_f32 v124, -v80, v76, v124
    v_fma_f32 v117, -v80, v69, v117
    v_fma_f32 v125, -v80, v77, v125
    v_fma_f32 v118, -v80, v70, v118
    v_fma_f32 v126, -v80, v78, v126
    v_fma_f32 v119, -v80, v71, v119
    v_fma_f32 v127, -v80, v79, v127
    v_mul_f32 v44, v116, v116
    v_mul_f32 v45, v117, v117
    v_mul_f32 v46, v118, v118
    v_mul_f32 v47, v119, v119
    v_fma_f32 v44, v44, v83, v82
    v_fma_f32 v45, v45, v83, v82
    v_fma_f32 v46, v46, v83, v82
    v_fma_f32 v47, v47, v83, v82
    v_mul_f32 v44, v44, v116
    v_mul_f32 v45, v45, v117
    v_mul_f32 v46, v46, v118
    v_mul_f32 v47, v47, v119
    v_exp_f32 v44, v44
    v_exp_f32 v45, v45
    v_exp_f32 v46, v46
    v_exp_f32 v47, v47
    v_mul_f32 v116, v116, v124
    v_mul_f32 v117, v117, v125
    v_mul_f32 v118, v118, v126
    v_mul_f32 v119, v119, v127
    v_fma_f32 v44, v44, v84, v84
    v_fma_f32 v45, v45, v84, v84
    v_fma_f32 v46, v46, v84, v84
    v_fma_f32 v47, v47, v84, v84
    v_rcp_f32 v44, v44
    v_rcp_f32 v45, v45
    v_rcp_f32 v46, v46
    v_rcp_f32 v47, v47
    v_mul_f32 v116, v116, v44
    v_mul_f32 v117, v117, v45
    v_mul_f32 v118, v118, v46
    v_mul_f32 v119, v119, v47
    v_cvt_pk_bf16_f32 v50, v116, v117
    v_cvt_pk_bf16_f32 v51, v118, v119
    buffer_store_dwordx4 v[48:51], v27, s[32:35], s56 offen offset:1024 sc1
    s_cmp_lg_u32 s79, 0
    s_cbranch_scc1 L_AP_nr1
    v_mov_b32 v1, 158720
    ds_read_b32 v1, v1
    s_waitcnt lgkmcnt(0)
    v_cmp_ne_u32 vcc, s49, v1
    s_cbranch_vccnz L_AP_nr1
    s_mov_b32 s79, 2
    s_lshl_b32 s11, s74, 17
    s_lshl_b32 s12, s75, 2
    s_add_u32 s12, s12, s39
    s_lshl_b32 s13, s12, 11
    s_add_u32 s13, s13, s11
    s_lshr_b32 s14, s38, 2
    s_lshl_b32 s14, s14, 16
    s_add_u32 s14, s14, s11
    s_add_u32 s14, s14, 2097152
    v_lshl_add_u32 v34, v29, 9, v28
    buffer_load_dwordx2 v[160:161], v34, s[32:35], s13 offen offset:0 sc1
    buffer_load_dwordx2 v[162:163], v34, s[32:35], s13 offen offset:256 sc1
    buffer_load_dwordx2 v[164:165], v34, s[32:35], s13 offen offset:1024 sc1
    buffer_load_dwordx2 v[166:167], v34, s[32:35], s13 offen offset:1280 sc1
    buffer_load_dwordx2 v[96:97], v34, s[32:35], s14 offen offset:0 sc1
    buffer_load_dwordx2 v[98:99], v34, s[32:35], s14 offen offset:256 sc1
    buffer_load_dwordx2 v[100:101], v34, s[32:35], s14 offen offset:1024 sc1
    buffer_load_dwordx2 v[102:103], v34, s[32:35], s14 offen offset:1280 sc1
L_AP_nr1:
    v_fma_f32 v144, -v86, v64, v144
    v_fma_f32 v152, -v86, v72, v152
    v_fma_f32 v145, -v86, v65, v145
    v_fma_f32 v153, -v86, v73, v153
    v_fma_f32 v146, -v86, v66, v146
    v_fma_f32 v154, -v86, v74, v154
    v_fma_f32 v147, -v86, v67, v147
    v_fma_f32 v155, -v86, v75, v155
    v_mul_f32 v40, v144, v144
    v_mul_f32 v41, v145, v145
    v_mul_f32 v42, v146, v146
    v_mul_f32 v43, v147, v147
    v_fma_f32 v40, v40, v89, v88
    v_fma_f32 v41, v41, v89, v88
    v_fma_f32 v42, v42, v89, v88
    v_fma_f32 v43, v43, v89, v88
    v_mul_f32 v40, v40, v144
    v_mul_f32 v41, v41, v145
    v_mul_f32 v42, v42, v146
    v_mul_f32 v43, v43, v147
    v_exp_f32 v40, v40
    v_exp_f32 v41, v41
    v_exp_f32 v42, v42
    v_exp_f32 v43, v43
    v_mul_f32 v144, v144, v152
    v_mul_f32 v145, v145, v153
    v_mul_f32 v146, v146, v154
    v_mul_f32 v147, v147, v155
    v_fma_f32 v40, v40, v90, v90
    v_fma_f32 v41, v41, v90, v90
    v_fma_f32 v42, v42, v90, v90
    v_fma_f32 v43, v43, v90, v90
    v_rcp_f32 v40, v40
    v_rcp_f32 v41, v41
    v_rcp_f32 v42, v42
    v_rcp_f32 v43, v43
    v_mul_f32 v144, v144, v40
    v_mul_f32 v145, v145, v41
    v_mul_f32 v146, v146, v42
    v_mul_f32 v147, v147, v43
    v_cvt_pk_bf16_f32 v52, v144, v145
    v_cvt_pk_bf16_f32 v53, v146, v147
    v_fma_f32 v148, -v86, v68, v148
    v_fma_f32 v156, -v86, v76, v156
    v_fma_f32 v149, -v86, v69, v149
    v_fma_f32 v157, -v86, v77, v157
    v_fma_f32 v150, -v86, v70, v150
    v_fma_f32 v158, -v86, v78, v158
    v_fma_f32 v151, -v86, v71, v151
    v_fma_f32 v159, -v86, v79, v159
    v_mul_f32 v44, v148, v148
    v_mul_f32 v45, v149, v149
    v_mul_f32 v46, v150, v150
    v_mul_f32 v47, v151, v151
    v_fma_f32 v44, v44, v89, v88
    v_fma_f32 v45, v45, v89, v88
    v_fma_f32 v46, v46, v89, v88
    v_fma_f32 v47, v47, v89, v88
    v_mul_f32 v44, v44, v148
    v_mul_f32 v45, v45, v149
    v_mul_f32 v46, v46, v150
    v_mul_f32 v47, v47, v151
    v_exp_f32 v44, v44
    v_exp_f32 v45, v45
    v_exp_f32 v46, v46
    v_exp_f32 v47, v47
    v_mul_f32 v148, v148, v156
    v_mul_f32 v149, v149, v157
    v_mul_f32 v150, v150, v158
    v_mul_f32 v151, v151, v159
    v_fma_f32 v44, v44, v90, v90
    v_fma_f32 v45, v45, v90, v90
    v_fma_f32 v46, v46, v90, v90
    v_fma_f32 v47, v47, v90, v90
    v_rcp_f32 v44, v44
    v_rcp_f32 v45, v45
    v_rcp_f32 v46, v46
    v_rcp_f32 v47, v47
    v_mul_f32 v148, v148, v44
    v_mul_f32 v149, v149, v45
    v_mul_f32 v150, v150, v46
    v_mul_f32 v151, v151, v47
    v_cvt_pk_bf16_f32 v54, v148, v149
    v_cvt_pk_bf16_f32 v55, v150, v151
    buffer_store_dwordx4 v[52:55], v27, s[32:35], s57 offen offset:1024 sc1
    s_lshl_b32 s14, s36, 1
    s_add_u32 s14, s14, s40
    s_lshl_b32 s14, s14, 5
    s_and_b32 s15, s101, -2
    s_add_u32 s14, s14, s15
    s_add_u32 s14, s14, s41
    s_lshl_b32 s14, s14, 2
    s_and_b32 s15, s101, 1
    s_lshl_b32 s15, s15, 12
    s_add_u32 s14, s14, s15
    s_add_u32 s14, s14, 16793600
    s_mov_b32 s43, s14
    s_waitcnt vmcnt(3)
    s_cmp_eq_u32 s79, 1
    s_cbranch_scc1 L_P2
    s_cmp_eq_u32 s79, 0
    s_cbranch_scc1 L_AP_late
    s_waitcnt vmcnt(1)
    s_branch L_P2
L_AP_late:
    s_waitcnt vmcnt(0)
    v_mov_b32 v1, s49
    v_mov_b32 v2, 0
    s_mov_b64 exec, 1
    buffer_store_dword v1, v2, s[32:35], s43 offen offset:0 sc1
    s_mov_b64 exec, -1
    s_mov_b32 s43, 0
    s_branch L_P2poll
L_end:
    s_endpgm
    .p2align 6
L_tab:
    .long 0x0, 0x100, 0x200, 0x100, 0x400, 0x100, 0x600, 0x1fa01
    .long 0x20100, 0x100, 0x20300, 0x100, 0x20500, 0x102, 0x40000, 0x100
    .long 0x40200, 0x100, 0x40400, 0x100, 0x40600, 0x1fa01, 0x60100, 0x100
    .long 0x60300, 0x100, 0x60500, 0x102, 0x80000, 0x100, 0x80200, 0x100
    .long 0x80400, 0x100, 0x80600, 0x1fa01, 0xa0100, 0x100, 0xa0300, 0x100
    .long 0xa0500, 0x102, 0xc0000, 0x100, 0xc0200, 0x100, 0xc0400, 0x100
    .long 0xc0600, 0x1fa01, 0xe0100, 0x100, 0xe0300, 0x100, 0xe0500, 0x102
    .long 0x100000, 0x100, 0x100200, 0x100, 0x100400, 0x100, 0x100600, 0x1fa01
    .long 0x120100, 0x100, 0x120300, 0x100, 0x120500, 0x102, 0x140000, 0x100
    .long 0x140200, 0x100, 0x140400, 0x100, 0x140600, 0x1fa01, 0x160100, 0x100
    .long 0x160300, 0x100, 0x160500, 0x102, 0x180000, 0x100, 0x180200, 0x100
    .long 0x180400, 0x100, 0x180600, 0x1fa01, 0x1a0100, 0x100, 0x1a0300, 0x100
    .long 0x1a0500, 0x102, 0x1c0000, 0x100, 0x1c0200, 0x100, 0x1c0400, 0x100
    .long 0x1c0600, 0x1fa01, 0x1e0100, 0x100, 0x1e0300, 0x100, 0x1e0500, 0x102
L_tabend:
.section .rodata,"a"
.p2align 6
.amdhsa_kernel recurrent_scan__mha_block__geglu_ffn__prompt_kernel
  .amdhsa_next_free_vgpr 168
  .amdhsa_next_free_sgpr 102
  .amdhsa_accum_offset 168
  .amdhsa_group_segment_fixed_size 0
  .amdhsa_kernarg_size 80
  .amdhsa_user_sgpr_count 2
  .amdhsa_user_sgpr_kernarg_segment_ptr 1
  .amdhsa_system_sgpr_workgroup_id_x 1
.end_amdhsa_kernel
.text
```
